```python
import torch

def _softmax(x, axis=-1):
    return torch.softmax(x, dim=axis)
def _gelu(x):
    return torch.nn.functional.gelu(x, approximate="tanh")
def _silu(x):
    return torch.nn.functional.silu(x)
def _sigmoid(x):
    return torch.sigmoid(x)
def _layernorm(x, axis=-1, eps=1e-5):
    m = x.mean(dim=axis, keepdim=True)
    v = x.var(dim=axis, keepdim=True, unbiased=False)
    return (x - m) / torch.sqrt(v + eps)
def _scatter_add(tgt, idx, src, axis=0):
    return tgt.clone().index_add_(axis, idx, src)
def _segment_sum(src, seg, n):
    out = torch.zeros((n,) + src.shape[1:], dtype=src.dtype)
    return out.index_add_(0, seg, src)
def _pad(x, pw):
    flat = tuple(v for pair in reversed(pw) for v in pair)
    return torch.nn.functional.pad(x, flat)

kernel_name = 'concat_heads__mha_block_cached__mha_block_cached__near_ridge'

def setup_inputs():

    _w = (lambda a: (lambda t: t.to(torch.bfloat16) if t.is_floating_point() else t)(torch.as_tensor(a)))
    def _A_setup():
        B, Sq, D = 16, 128, 640
        H, Sk, Dh = 32, 512, 128
        return {
            "x": _w((lambda *s: torch.randn(*s, dtype=torch.bfloat16) * 0.8)(B, Sq, D)),
            "k_cache": _w((lambda *s: torch.randn(*s, dtype=torch.bfloat16) * 0.8)(B, H, Sk, Dh)),
            "v_cache": _w((lambda *s: torch.randn(*s, dtype=torch.bfloat16) * 0.05)(B, H, Sk, Dh)),
            "wq": _w((lambda *s: torch.randn(*s, dtype=torch.bfloat16) * 0.8)(D, H * Dh) * (D ** -0.5)),
            "wo": _w((lambda *s: torch.randn(*s, dtype=torch.bfloat16) * 0.05)(H * Dh, D) * ((H * Dh) ** -0.5)),
        }
    _A_in = _A_setup()

    def _B_setup():
        B, Sq, D = 16, 128, 640
        H, Sk, Dh = 32, 512, 128
        return {
            "x": _w((lambda *s: torch.randn(*s, dtype=torch.bfloat16) * 0.8)(B, Sq, D)),
            "k_cache": _w((lambda *s: torch.randn(*s, dtype=torch.bfloat16) * 0.8)(B, H, Sk, Dh)),
            "v_cache": _w((lambda *s: torch.randn(*s, dtype=torch.bfloat16) * 0.05)(B, H, Sk, Dh)),
            "wq": _w((lambda *s: torch.randn(*s, dtype=torch.bfloat16) * 0.8)(D, H * Dh) * (D ** -0.5)),
            "wo": _w((lambda *s: torch.randn(*s, dtype=torch.bfloat16) * 0.05)(H * Dh, D) * ((H * Dh) ** -0.5)),
        }
    _B_in = _B_setup()

    return {
        "A_x": _A_in["x"],
        "A_k_cache": _A_in["k_cache"],
        "A_v_cache": _A_in["v_cache"],
        "A_wq": _A_in["wq"],
        "A_wo": _A_in["wo"],
        "B_x": _B_in["x"],
        "B_k_cache": _B_in["k_cache"],
        "B_v_cache": _B_in["v_cache"],
        "B_wq": _B_in["wq"],
        "B_wo": _B_in["wo"],
    }

def reference(A_x, A_k_cache, A_v_cache, A_wq, A_wo, B_x, B_k_cache, B_v_cache, B_wq, B_wo):
    def _A_ref(x, k_cache, v_cache, wq, wo):
        B, Sq, D = x.shape
        H, Dh = 32, 128
        q = (lambda x, *d: x.permute(*d))((x @ wq).reshape(B, Sq, H, Dh), 0, 2, 1, 3)
        scores = torch.einsum("bhqd,bhkd->bhqk", q, k_cache) * (Dh ** -0.5)
        p = _softmax(scores, axis=-1)
        o = torch.einsum("bhqk,bhkd->bhqd", p, v_cache)
        return (lambda x, *d: x.permute(*d))(o, 0, 2, 1, 3).reshape(B, Sq, H * Dh) @ wo

    def _B_ref(x, k_cache, v_cache, wq, wo):
        B, Sq, D = x.shape
        H, Dh = 32, 128
        q = (lambda x, *d: x.permute(*d))((x @ wq).reshape(B, Sq, H, Dh), 0, 2, 1, 3)
        scores = torch.einsum("bhqd,bhkd->bhqk", q, k_cache) * (Dh ** -0.5)
        p = _softmax(scores, axis=-1)
        o = torch.einsum("bhqk,bhkd->bhqd", p, v_cache)
        return (lambda x, *d: x.permute(*d))(o, 0, 2, 1, 3).reshape(B, Sq, H * Dh) @ wo

    a = _A_ref(A_x, A_k_cache, A_v_cache, A_wq, A_wo)
    b = _B_ref(B_x, B_k_cache, B_v_cache, B_wq, B_wo)
    return torch.concatenate([a, b], axis=-1)
```

```asm
; @launch grid=(256,1,1) block=(256,1,1) lds=160320
.amdgcn_target "amdgcn-amd-amdhsa--gfx950"
.text
.globl concat_heads__mha_block_cached__mha_block_cached__near_ridge_kernel
.p2align 8
.type concat_heads__mha_block_cached__mha_block_cached__near_ridge_kernel,@function
concat_heads__mha_block_cached__mha_block_cached__near_ridge_kernel:
    s_cmp_ge_u32 s2, 256
    s_cbranch_scc1 L_end
    s_load_dwordx16 s[36:51], s[0:1], 0
    s_load_dwordx4 s[52:55], s[0:1], 64
    s_load_dwordx2 s[56:57], s[0:1], 96
    s_load_dwordx2 s[80:81], s[0:1], 80
    s_load_dwordx2 s[96:97], s[0:1], 88
    s_load_dwordx2 s[84:85], s[0:1], 96
    s_memrealtime s[100:101]
    v_lshrrev_b32 v32, 6, v0
    v_and_b32 v0, 63, v0
    v_readfirstlane_b32 s35, v32
    v_bfe_u32 v33, v0, 2, 2
    v_and_b32 v34, 3, v0
    v_lshrrev_b32 v35, 5, v0
    v_bfe_u32 v36, v0, 4, 1
    v_lshrrev_b32 v37, 4, v0
    v_and_b32 v38, 15, v0
    v_and_b32 v39, 1, v34
    v_lshlrev_b32 v39, 1, v39
    v_lshrrev_b32 v40, 1, v34
    v_or_b32 v41, v39, v40
    v_and_b32 v39, 1, v37
    v_lshlrev_b32 v39, 1, v39
    v_lshrrev_b32 v40, 1, v37
    v_or_b32 v42, v39, v40
    v_mul_u32_u24 v39, 2112, v33
    v_lshl_add_u32 v39, v35, 8, v39
    v_lshl_add_u32 v39, v36, 5, v39
    v_lshl_add_u32 v4, v34, 3, v39
    v_lshl_add_u32 v1, v41, 3, v39
    v_and_b32 v39, 7, v0
    v_mul_u32_u24 v39, 2112, v39
    v_bfe_u32 v40, v0, 3, 2
    v_lshl_add_u32 v39, v40, 8, v39
    v_xor_b32 v40, v40, v35
    v_lshl_add_u32 v7, v40, 4, v39
    v_xor_b32 v40, 2, v40
    v_lshl_add_u32 v10, v40, 4, v39
    v_add_u32 v2, 50688, v1
    v_add_u32 v3, 101376, v1
    v_add_u32 v5, 50688, v4
    v_add_u32 v6, 101376, v4
    v_add_u32 v8, 50688, v7
    v_add_u32 v9, 101376, v7
    v_add_u32 v11, 50688, v10
    v_add_u32 v12, 101376, v10
    s_lshr_b32 s58, s35, 1
    s_lshl_b32 s58, s58, 4
    s_and_b32 s59, s35, 1
    s_lshl_b32 s59, s59, 1
    s_add_u32 s58, s58, s59
    v_lshlrev_b32 v38, 4, v38
    v_add_u32 v40, 4096, v38
    v_lshl_add_u32 v39, v37, 2, s58
    v_lshl_add_u32 v15, v39, 8, v40
    v_add_u32 v16, 4294965440, v15
    v_mul_u32_u24 v19, 1280, v39
    v_add_u32 v19, v19, v40
    v_add_u32 v20, 4294966464, v19
    v_lshl_add_u32 v39, v42, 2, s58
    v_lshl_add_u32 v13, v39, 13, v40
    v_add_u32 v14, 6080, v13
    s_lshl_b32 s59, s35, 1
    v_lshl_add_u32 v39, v37, 3, s59
    v_lshlrev_b32 v40, 4, v37
    v_xor_b32 v40, v40, v38
    v_add_u32 v40, 4096, v40
    v_lshl_add_u32 v17, v39, 8, v40
    v_add_u32 v18, 4294965440, v17
    s_mul_i32 s59, s35, 40960
    s_lshl_b32 s58, s35, 10
    v_lshl_add_u32 v21, v0, 4, s58
    v_lshrrev_b32 v39, 3, v0
    v_mul_u32_u24 v39, 1280, v39
    v_and_b32 v40, 7, v0
    v_xor_b32 v40, v40, v37
    v_lshl_add_u32 v39, v40, 4, v39
    v_add_u32 v44, s59, v39
    v_add_u32 v46, 9216, v44
    v_add_u32 v45, 18368, v44
    v_add_u32 v47, 27584, v44
    s_mul_i32 s24, s35, 4224
    s_and_b32 s58, s2, 3
    s_lshl_b32 s58, s58, 1
    s_bfe_u32 s59, s2, 0x10003
    s_add_u32 s58, s58, s59
    s_lshr_b32 s59, s2, 4
    s_bfe_u32 s3, s2, 0x10002
    s_waitcnt lgkmcnt(0)
    s_cmp_eq_u32 s3, 0
    s_cselect_b64 s[20:21], s[36:37], s[46:47]
    s_cselect_b64 s[4:5], s[38:39], s[48:49]
    s_cselect_b64 s[8:9], s[40:41], s[50:51]
    s_cselect_b64 s[12:13], s[42:43], s[52:53]
    s_cselect_b64 s[16:17], s[44:45], s[54:55]
    s_mul_i32 s34, s59, 163840
    s_add_u32 s20, s20, s34
    s_addc_u32 s21, s21, 0
    s_mov_b32 s22, 163840
    s_mov_b32 s23, 0x00020000
    s_lshl_b32 s34, s58, 10
    s_add_u32 s12, s12, s34
    s_addc_u32 s13, s13, 0
    s_sub_u32 s12, s12, 4096
    s_subb_u32 s13, s13, 0
    s_mov_b32 s14, 5246976
    s_mov_b32 s15, 0x00020000
    s_add_u32 m0, s24, 33792
    s_mov_b32 s29, 0
    buffer_load_dwordx4 v44, s[20:23], s29 offen nt lds
    buffer_load_dwordx4 v46, s[20:23], s29 offen offset:1024 nt lds
    buffer_load_dwordx4 v45, s[20:23], s29 offen offset:2112 nt lds
    buffer_load_dwordx4 v47, s[20:23], s29 offen offset:3136 nt lds
    s_add_u32 m0, s24, 135168
    s_mov_b32 s29, 0
    s_mov_b32 s30, 261120
    buffer_load_dwordx4 v13, s[12:15], s29 offen nt lds
    buffer_load_dwordx4 v13, s[12:15], s30 offen offset:1024 nt lds
    buffer_load_dwordx4 v14, s[12:15], s29 offen offset:2112 nt lds
    buffer_load_dwordx4 v14, s[12:15], s30 offen offset:3136 nt lds
    s_add_u32 m0, s24, 101376
    s_mov_b32 s29, 128
    buffer_load_dwordx4 v44, s[20:23], s29 offen nt lds
    buffer_load_dwordx4 v46, s[20:23], s29 offen offset:1024 nt lds
    buffer_load_dwordx4 v45, s[20:23], s29 offen offset:2112 nt lds
    buffer_load_dwordx4 v47, s[20:23], s29 offen offset:3136 nt lds
    s_add_u32 m0, s24, 50688
    s_mov_b32 s29, 256
    buffer_load_dwordx4 v44, s[20:23], s29 offen nt lds
    buffer_load_dwordx4 v46, s[20:23], s29 offen offset:1024 nt lds
    buffer_load_dwordx4 v45, s[20:23], s29 offen offset:2112 nt lds
    buffer_load_dwordx4 v47, s[20:23], s29 offen offset:3136 nt lds
    s_add_u32 m0, s24, 0
    s_mov_b32 s29, 524288
    s_mov_b32 s30, 785408
    buffer_load_dwordx4 v13, s[12:15], s29 offen nt lds
    buffer_load_dwordx4 v13, s[12:15], s30 offen offset:1024 nt lds
    buffer_load_dwordx4 v14, s[12:15], s29 offen offset:2112 nt lds
    buffer_load_dwordx4 v14, s[12:15], s30 offen offset:3136 nt lds
    s_add_u32 m0, s24, 118272
    s_mov_b32 s29, 384
    buffer_load_dwordx4 v44, s[20:23], s29 offen nt lds
    buffer_load_dwordx4 v46, s[20:23], s29 offen offset:1024 nt lds
    buffer_load_dwordx4 v45, s[20:23], s29 offen offset:2112 nt lds
    buffer_load_dwordx4 v47, s[20:23], s29 offen offset:3136 nt lds
    s_add_u32 m0, s24, 67584
    s_mov_b32 s29, 512
    buffer_load_dwordx4 v44, s[20:23], s29 offen nt lds
    buffer_load_dwordx4 v46, s[20:23], s29 offen offset:1024 nt lds
    buffer_load_dwordx4 v45, s[20:23], s29 offen offset:2112 nt lds
    buffer_load_dwordx4 v47, s[20:23], s29 offen offset:3136 nt lds
    s_add_u32 m0, s24, 84480
    s_mov_b32 s29, 640
    buffer_load_dwordx4 v44, s[20:23], s29 offen nt lds
    buffer_load_dwordx4 v46, s[20:23], s29 offen offset:1024 nt lds
    buffer_load_dwordx4 v45, s[20:23], s29 offen offset:2112 nt lds
    buffer_load_dwordx4 v47, s[20:23], s29 offen offset:3136 nt lds
    s_add_u32 m0, s24, 16896
    s_mov_b32 s29, 1048576
    s_mov_b32 s30, 1309696
    buffer_load_dwordx4 v13, s[12:15], s29 offen nt lds
    buffer_load_dwordx4 v13, s[12:15], s30 offen offset:1024 nt lds
    buffer_load_dwordx4 v14, s[12:15], s29 offen offset:2112 nt lds
    buffer_load_dwordx4 v14, s[12:15], s30 offen offset:3136 nt lds
    v_mul_u32_u24 v39, 2112, v36
    v_bfe_u32 v40, v0, 3, 1
    v_lshl_add_u32 v39, v40, 10, v39
    v_and_b32 v40, 7, v0
    v_lshl_add_u32 v39, v40, 7, v39
    v_add_u32 v39, s24, v39
    v_bfe_u32 v40, v0, 1, 2
    v_xor_b32 v40, v40, v35
    v_lshl_add_u32 v48, v40, 4, v39
    v_xor_b32 v40, 2, v40
    v_lshl_add_u32 v49, v40, 4, v39
    v_add_u32 v50, 50688, v48
    v_add_u32 v51, 50688, v49
    v_add_u32 v52, 101376, v48
    v_add_u32 v53, 101376, v49
    s_lshl_b32 s34, s59, 22
    s_lshl_b32 s35, s58, 19
    s_add_u32 s34, s34, s35
    s_add_u32 s4, s4, s34
    s_addc_u32 s5, s5, 0
    s_sub_u32 s4, s4, 4096
    s_subb_u32 s5, s5, 0
    s_mov_b32 s6, 528384
    s_mov_b32 s7, 0x00020000
    s_add_u32 s8, s8, s34
    s_addc_u32 s9, s9, 0
    s_sub_u32 s8, s8, 4096
    s_subb_u32 s9, s9, 0
    s_mov_b32 s10, 528384
    s_mov_b32 s11, 0x00020000
    s_mul_i32 s34, s58, 655360
    s_add_u32 s16, s16, s34
    s_addc_u32 s17, s17, 0
    s_sub_u32 s16, s16, 4096
    s_subb_u32 s17, s17, 0
    s_mov_b32 s18, 659456
    s_mov_b32 s19, 0x00020000
    s_and_b32 s92, s59, 3
    s_mul_i32 s92, s92, 163840
    s_lshr_b32 s93, s59, 2
    s_mul_i32 s93, s93, 10240
    s_add_u32 s92, s92, s93
    s_add_u32 s92, s92, 4096
    s_mov_b32 s32, 0x47800000
    s_mov_b32 s33, 0x3e0293ee
    s_lshl_b32 s34, s3, 4
    s_add_u32 s34, s34, s59
    s_mov_b32 s82, 5242880
    s_mov_b32 s83, 0x00020000
    s_mov_b32 s86, 67108864
    s_mov_b32 s87, 0x00020000
    s_lshl_b32 s35, s34, 3
    s_add_u32 s96, s96, s35
    s_addc_u32 s97, s97, 0
    s_mov_b32 s98, 8
    s_mov_b32 s99, 0x00020000
    s_cmp_eq_u32 s24, 0
    s_cselect_b32 s98, 8, 0
    s_lshl_b32 s90, s34, 9
    s_add_u32 s90, s90, 50331648
    s_lshl_b32 s94, s58, 3
    s_add_u32 s94, s94, s90
    s_mov_b32 s91, s58
    s_or_b32 s100, s100, 1
    s_lshr_b32 s35, s24, 12
    s_lshr_b32 s79, s2, 4
    s_lshl_b32 s78, s3, 4
    s_add_u32 s78, s78, s79
    s_mul_i32 s78, s78, 32768
    s_mul_i32 s79, s79, 327680
    s_mul_i32 s93, s3, 1280
    s_add_u32 s79, s79, s93
    s_lshr_b32 s93, s58, 1
    s_mul_i32 s93, s93, 1024
    s_add_u32 s78, s78, s93
    s_mul_i32 s93, s93, 80
    s_add_u32 s79, s79, s93
    s_and_b32 s93, s58, 1
    s_lshl_b32 s93, s93, 7
    s_add_u32 s79, s79, s93
    s_mul_i32 s93, s93, 32768
    s_add_u32 s78, s78, s93
    s_lshl_b32 s93, s35, 7
    s_add_u32 s78, s78, s93
    s_mul_i32 s93, s35, 20480
    s_add_u32 s79, s79, s93
    s_lshl_b32 s34, s34, 3
    s_add_u32 s34, s34, s58
    s_mov_b32 s95, s59
    s_mul_i32 s34, s34, 4096
    s_add_u32 s56, s56, s34
    s_addc_u32 s57, s57, 0
    s_mov_b32 s58, 40898560
    s_mov_b32 s59, 0x00020000
    s_waitcnt vmcnt(32)
    ds_read_b128 a[0:3], v48 offset:33792
    ds_read_b128 a[4:7], v49 offset:33792
    ds_read_b128 a[8:11], v48 offset:33856
    ds_read_b128 a[12:15], v49 offset:33856
    s_waitcnt vmcnt(28)
    s_barrier
    ds_read_b64_tr_b16 a[224:225], v3 offset:33792
    ds_read_b64_tr_b16 a[226:227], v3 offset:34304
    ds_read_b64_tr_b16 a[228:229], v3 offset:33856
    ds_read_b64_tr_b16 a[230:231], v3 offset:34368
    ds_read_b64_tr_b16 a[232:233], v3 offset:33920
    ds_read_b64_tr_b16 a[234:235], v3 offset:34432
    ds_read_b64_tr_b16 a[236:237], v3 offset:33984
    ds_read_b64_tr_b16 a[238:239], v3 offset:34496
    ds_read_b64_tr_b16 a[240:241], v3 offset:42240
    ds_read_b64_tr_b16 a[242:243], v3 offset:42752
    ds_read_b64_tr_b16 a[244:245], v3 offset:42304
    s_waitcnt lgkmcnt(11)
    ds_read_b64_tr_b16 a[246:247], v3 offset:42816
    s_add_u32 m0, s24, 33792
    s_mov_b32 s29, 1572864
    s_mov_b32 s30, 1833984
    buffer_load_dwordx4 v13, s[12:15], s29 offen nt lds
    buffer_load_dwordx4 v13, s[12:15], s30 offen offset:1024 nt lds
    buffer_load_dwordx4 v14, s[12:15], s29 offen offset:2112 nt lds
    buffer_load_dwordx4 v14, s[12:15], s30 offen offset:3136 nt lds
    s_waitcnt lgkmcnt(8)
    v_mfma_f32_32x32x16_bf16 v[192:207], a[224:227], a[0:3], 0
    ds_read_b64_tr_b16 a[248:249], v3 offset:42368
    ds_read_b64_tr_b16 a[250:251], v3 offset:42880
    s_waitcnt vmcnt(28)
    ds_read_b128 a[16:19], v52 offset:0
    ds_read_b128 a[20:23], v53 offset:0
    ds_read_b128 a[24:27], v52 offset:64
    ds_read_b128 a[28:31], v53 offset:64
    v_mfma_f32_32x32x16_bf16 v[208:223], a[228:231], a[0:3], 0
    ds_read_b64_tr_b16 a[252:253], v3 offset:42432
    s_waitcnt lgkmcnt(11)
    ds_read_b64_tr_b16 a[254:255], v3 offset:42944
    v_mfma_f32_32x32x16_bf16 v[224:239], a[232:235], a[0:3], 0
    ds_read_b64_tr_b16 a[224:225], v3 offset:34816
    ds_read_b64_tr_b16 a[226:227], v3 offset:35328
    s_waitcnt vmcnt(24)
    ds_read_b128 a[32:35], v50 offset:0
    s_waitcnt lgkmcnt(11)
    ds_read_b128 a[36:39], v51 offset:0
    ds_read_b128 a[40:43], v50 offset:64
    ds_read_b128 a[44:47], v51 offset:64
    v_mfma_f32_32x32x16_bf16 v[240:255], a[236:239], a[0:3], 0
    ds_read_b64_tr_b16 a[228:229], v3 offset:34880
    s_waitcnt lgkmcnt(11)
    ds_read_b64_tr_b16 a[230:231], v3 offset:35392
    s_waitcnt lgkmcnt(10)
    s_add_u32 m0, s24, 101376
    s_mov_b32 s29, 768
    buffer_load_dwordx4 v44, s[20:23], s29 offen nt lds
    v_mfma_f32_32x32x16_bf16 v[192:207], a[240:243], a[4:7], v[192:207]
    ds_read_b64_tr_b16 a[232:233], v3 offset:34944
    ds_read_b64_tr_b16 a[234:235], v3 offset:35456
    buffer_load_dwordx4 v46, s[20:23], s29 offen offset:1024 nt lds
    v_mfma_f32_32x32x16_bf16 v[208:223], a[244:247], a[4:7], v[208:223]
    ds_read_b64_tr_b16 a[236:237], v3 offset:35008
    ds_read_b64_tr_b16 a[238:239], v3 offset:35520
    buffer_load_dwordx4 v45, s[20:23], s29 offen offset:2112 nt lds
    s_waitcnt lgkmcnt(12)
    v_mfma_f32_32x32x16_bf16 v[224:239], a[248:251], a[4:7], v[224:239]
    ds_read_b64_tr_b16 a[240:241], v3 offset:43264
    ds_read_b64_tr_b16 a[242:243], v3 offset:43776
    buffer_load_dwordx4 v47, s[20:23], s29 offen offset:3136 nt lds
    v_mfma_f32_32x32x16_bf16 v[240:255], a[252:255], a[4:7], v[240:255]
    ds_read_b64_tr_b16 a[244:245], v3 offset:43328
    s_waitcnt lgkmcnt(11)
    ds_read_b64_tr_b16 a[246:247], v3 offset:43840
    s_waitcnt lgkmcnt(10)
    s_add_u32 m0, s24, 50688
    s_mov_b32 s29, 2097152
    s_mov_b32 s30, 2358272
    buffer_load_dwordx4 v13, s[12:15], s29 offen nt lds
    s_waitcnt lgkmcnt(8)
    v_mfma_f32_32x32x16_bf16 v[192:207], a[224:227], a[8:11], v[192:207]
    ds_read_b64_tr_b16 a[248:249], v3 offset:43392
    ds_read_b64_tr_b16 a[250:251], v3 offset:43904
    s_waitcnt vmcnt(25)
    s_barrier
    buffer_load_dwordx4 v13, s[12:15], s30 offen offset:1024 nt lds
    v_mfma_f32_32x32x16_bf16 v[208:223], a[228:231], a[8:11], v[208:223]
    ds_read_b64_tr_b16 a[252:253], v3 offset:43456
    ds_read_b64_tr_b16 a[254:255], v3 offset:43968
    buffer_load_dwordx4 v14, s[12:15], s29 offen offset:2112 nt lds
    s_waitcnt vmcnt(23)
    ds_read_b128 a[48:51], v52 offset:16896
    ds_read_b128 a[52:55], v53 offset:16896
    ds_read_b128 a[56:59], v52 offset:16960
    s_waitcnt lgkmcnt(11)
    ds_read_b128 a[60:63], v53 offset:16960
    v_mfma_f32_32x32x16_bf16 v[224:239], a[232:235], a[8:11], v[224:239]
    ds_read_b64_tr_b16 a[224:225], v1 offset:0
    ds_read_b64_tr_b16 a[226:227], v1 offset:512
    buffer_load_dwordx4 v14, s[12:15], s30 offen offset:3136 nt lds
    v_mfma_f32_32x32x16_bf16 v[240:255], a[236:239], a[8:11], v[240:255]
    ds_read_b64_tr_b16 a[228:229], v1 offset:64
    s_waitcnt lgkmcnt(11)
    ds_read_b64_tr_b16 a[230:231], v1 offset:576
    s_waitcnt vmcnt(20)
    ds_read_b128 a[64:67], v50 offset:16896
    ds_read_b128 a[68:71], v51 offset:16896
    ds_read_b128 a[72:75], v50 offset:16960
    s_waitcnt lgkmcnt(11)
    ds_read_b128 a[76:79], v51 offset:16960
    v_mfma_f32_32x32x16_bf16 v[192:207], a[240:243], a[12:15], v[192:207]
    ds_read_b64_tr_b16 a[232:233], v1 offset:128
    ds_read_b64_tr_b16 a[234:235], v1 offset:640
    s_waitcnt lgkmcnt(10)
    s_add_u32 m0, s24, 118272
    s_mov_b32 s29, 896
    buffer_load_dwordx4 v44, s[20:23], s29 offen nt lds
    v_mfma_f32_32x32x16_bf16 v[208:223], a[244:247], a[12:15], v[208:223]
    ds_read_b64_tr_b16 a[236:237], v1 offset:192
    ds_read_b64_tr_b16 a[238:239], v1 offset:704
    buffer_load_dwordx4 v46, s[20:23], s29 offen offset:1024 nt lds
    v_mfma_f32_32x32x16_bf16 v[224:239], a[248:251], a[12:15], v[224:239]
    ds_read_b64_tr_b16 a[240:241], v1 offset:8448
    ds_read_b64_tr_b16 a[242:243], v1 offset:8960
    buffer_load_dwordx4 v45, s[20:23], s29 offen offset:2112 nt lds
    v_mfma_f32_32x32x16_bf16 v[240:255], a[252:255], a[12:15], v[240:255]
    ds_read_b64_tr_b16 a[244:245], v1 offset:8512
    s_waitcnt lgkmcnt(11)
    ds_read_b64_tr_b16 a[246:247], v1 offset:9024
    buffer_load_dwordx4 v47, s[20:23], s29 offen offset:3136 nt lds
    v_mfma_f32_32x32x16_bf16 v[192:207], a[224:227], a[16:19], v[192:207]
    ds_read_b64_tr_b16 a[248:249], v1 offset:8576
    ds_read_b64_tr_b16 a[250:251], v1 offset:9088
    s_waitcnt lgkmcnt(10)
    s_add_u32 m0, s24, 67584
    s_mov_b32 s29, 2621440
    s_mov_b32 s30, 2882560
    buffer_load_dwordx4 v13, s[12:15], s29 offen nt lds
    v_mfma_f32_32x32x16_bf16 v[208:223], a[228:231], a[16:19], v[208:223]
    ds_read_b64_tr_b16 a[252:253], v1 offset:8640
    ds_read_b64_tr_b16 a[254:255], v1 offset:9152
    buffer_load_dwordx4 v13, s[12:15], s30 offen offset:1024 nt lds
    s_waitcnt vmcnt(22)
    ds_read_b128 a[80:83], v50 offset:33792
    ds_read_b128 a[84:87], v51 offset:33792
    ds_read_b128 a[88:91], v50 offset:33856
    s_waitcnt lgkmcnt(11)
    ds_read_b128 a[92:95], v51 offset:33856
    v_mfma_f32_32x32x16_bf16 v[224:239], a[232:235], a[16:19], v[224:239]
    ds_read_b64_tr_b16 a[224:225], v1 offset:1024
    ds_read_b64_tr_b16 a[226:227], v1 offset:1536
    buffer_load_dwordx4 v14, s[12:15], s29 offen offset:2112 nt lds
    v_mfma_f32_32x32x16_bf16 v[240:255], a[236:239], a[16:19], v[240:255]
    ds_read_b64_tr_b16 a[228:229], v1 offset:1088
    s_waitcnt lgkmcnt(11)
    ds_read_b64_tr_b16 a[230:231], v1 offset:1600
    buffer_load_dwordx4 v14, s[12:15], s30 offen offset:3136 nt lds
    v_mfma_f32_32x32x16_bf16 v[192:207], a[240:243], a[20:23], v[192:207]
    ds_read_b64_tr_b16 a[232:233], v1 offset:1152
    ds_read_b64_tr_b16 a[234:235], v1 offset:1664
    s_waitcnt lgkmcnt(6)
    s_add_u32 m0, s24, 84480
    s_mov_b32 s29, 3145728
    s_mov_b32 s30, 3406848
    buffer_load_dwordx4 v13, s[12:15], s29 offen nt lds
    v_mfma_f32_32x32x16_bf16 v[208:223], a[244:247], a[20:23], v[208:223]
    ds_read_b64_tr_b16 a[236:237], v1 offset:1216
    ds_read_b64_tr_b16 a[238:239], v1 offset:1728
    buffer_load_dwordx4 v13, s[12:15], s30 offen offset:1024 nt lds
    v_mfma_f32_32x32x16_bf16 v[224:239], a[248:251], a[20:23], v[224:239]
    ds_read_b64_tr_b16 a[240:241], v1 offset:9472
    ds_read_b64_tr_b16 a[242:243], v1 offset:9984
    buffer_load_dwordx4 v14, s[12:15], s29 offen offset:2112 nt lds
    v_mfma_f32_32x32x16_bf16 v[240:255], a[252:255], a[20:23], v[240:255]
    ds_read_b64_tr_b16 a[244:245], v1 offset:9536
    ds_read_b64_tr_b16 a[246:247], v1 offset:10048
    buffer_load_dwordx4 v14, s[12:15], s30 offen offset:3136 nt lds
    s_waitcnt lgkmcnt(8)
    v_mfma_f32_32x32x16_bf16 v[192:207], a[224:227], a[24:27], v[192:207]
    ds_read_b64_tr_b16 a[248:249], v1 offset:9600
    ds_read_b64_tr_b16 a[250:251], v1 offset:10112
    s_waitcnt vmcnt(24)
    s_barrier
    v_mfma_f32_32x32x16_bf16 v[208:223], a[228:231], a[24:27], v[208:223]
    ds_read_b64_tr_b16 a[252:253], v1 offset:9664
    ds_read_b64_tr_b16 a[254:255], v1 offset:10176
    s_add_u32 m0, s24, 135168
    s_mov_b32 s29, 1024
    buffer_load_dwordx4 v44, s[20:23], s29 offen nt lds
    s_waitcnt lgkmcnt(8)
    v_mfma_f32_32x32x16_bf16 v[224:239], a[232:235], a[24:27], v[224:239]
    ds_read_b64_tr_b16 a[224:225], v1 offset:16896
    ds_read_b64_tr_b16 a[226:227], v1 offset:17408
    buffer_load_dwordx4 v46, s[20:23], s29 offen offset:1024 nt lds
    v_mfma_f32_32x32x16_bf16 v[240:255], a[236:239], a[24:27], v[240:255]
    ds_read_b64_tr_b16 a[228:229], v1 offset:16960
    ds_read_b64_tr_b16 a[230:231], v1 offset:17472
    buffer_load_dwordx4 v45, s[20:23], s29 offen offset:2112 nt lds
    s_waitcnt lgkmcnt(8)
    v_mfma_f32_32x32x16_bf16 v[192:207], a[240:243], a[28:31], v[192:207]
    ds_read_b64_tr_b16 a[232:233], v1 offset:17024
    ds_read_b64_tr_b16 a[234:235], v1 offset:17536
    buffer_load_dwordx4 v47, s[20:23], s29 offen offset:3136 nt lds
    v_mfma_f32_32x32x16_bf16 v[208:223], a[244:247], a[28:31], v[208:223]
    ds_read_b64_tr_b16 a[236:237], v1 offset:17088
    ds_read_b64_tr_b16 a[238:239], v1 offset:17600
    s_waitcnt lgkmcnt(8)
    v_mfma_f32_32x32x16_bf16 v[224:239], a[248:251], a[28:31], v[224:239]
    ds_read_b64_tr_b16 a[240:241], v1 offset:25344
    ds_read_b64_tr_b16 a[242:243], v1 offset:25856
    v_mfma_f32_32x32x16_bf16 v[240:255], a[252:255], a[28:31], v[240:255]
    ds_read_b64_tr_b16 a[244:245], v1 offset:25408
    ds_read_b64_tr_b16 a[246:247], v1 offset:25920
    s_waitcnt lgkmcnt(8)
    v_mfma_f32_32x32x16_bf16 v[192:207], a[224:227], a[32:35], v[192:207]
    ds_read_b64_tr_b16 a[248:249], v1 offset:25472
    ds_read_b64_tr_b16 a[250:251], v1 offset:25984
    v_mfma_f32_32x32x16_bf16 v[208:223], a[228:231], a[32:35], v[208:223]
    ds_read_b64_tr_b16 a[252:253], v1 offset:25536
    ds_read_b64_tr_b16 a[254:255], v1 offset:26048
    s_waitcnt lgkmcnt(8)
    v_mfma_f32_32x32x16_bf16 v[224:239], a[232:235], a[32:35], v[224:239]
    ds_read_b64_tr_b16 a[224:225], v1 offset:17920
    ds_read_b64_tr_b16 a[226:227], v1 offset:18432
    v_mfma_f32_32x32x16_bf16 v[240:255], a[236:239], a[32:35], v[240:255]
    ds_read_b64_tr_b16 a[228:229], v1 offset:17984
    ds_read_b64_tr_b16 a[230:231], v1 offset:18496
    s_waitcnt lgkmcnt(8)
    v_mfma_f32_32x32x16_bf16 v[192:207], a[240:243], a[36:39], v[192:207]
    ds_read_b64_tr_b16 a[232:233], v1 offset:18048
    ds_read_b64_tr_b16 a[234:235], v1 offset:18560
    v_mfma_f32_32x32x16_bf16 v[208:223], a[244:247], a[36:39], v[208:223]
    ds_read_b64_tr_b16 a[236:237], v1 offset:18112
    ds_read_b64_tr_b16 a[238:239], v1 offset:18624
    s_waitcnt lgkmcnt(8)
    v_mfma_f32_32x32x16_bf16 v[224:239], a[248:251], a[36:39], v[224:239]
    ds_read_b64_tr_b16 a[240:241], v1 offset:26368
    ds_read_b64_tr_b16 a[242:243], v1 offset:26880
    v_mfma_f32_32x32x16_bf16 v[240:255], a[252:255], a[36:39], v[240:255]
    ds_read_b64_tr_b16 a[244:245], v1 offset:26432
    ds_read_b64_tr_b16 a[246:247], v1 offset:26944
    s_waitcnt lgkmcnt(8)
    v_mfma_f32_32x32x16_bf16 v[192:207], a[224:227], a[40:43], v[192:207]
    ds_read_b64_tr_b16 a[248:249], v1 offset:26496
    ds_read_b64_tr_b16 a[250:251], v1 offset:27008
    s_waitcnt vmcnt(24)
    s_barrier
    v_mfma_f32_32x32x16_bf16 v[208:223], a[228:231], a[40:43], v[208:223]
    ds_read_b64_tr_b16 a[252:253], v1 offset:26560
    ds_read_b64_tr_b16 a[254:255], v1 offset:27072
    s_add_u32 m0, s24, 0
    s_mov_b32 s29, 1152
    buffer_load_dwordx4 v44, s[20:23], s29 offen nt lds
    s_waitcnt lgkmcnt(8)
    v_mfma_f32_32x32x16_bf16 v[224:239], a[232:235], a[40:43], v[224:239]
    ds_read_b64_tr_b16 a[224:225], v1 offset:33792
    ds_read_b64_tr_b16 a[226:227], v1 offset:34304
    buffer_load_dwordx4 v46, s[20:23], s29 offen offset:1024 nt lds
    v_mfma_f32_32x32x16_bf16 v[240:255], a[236:239], a[40:43], v[240:255]
    ds_read_b64_tr_b16 a[228:229], v1 offset:33856
    ds_read_b64_tr_b16 a[230:231], v1 offset:34368
    buffer_load_dwordx4 v45, s[20:23], s29 offen offset:2112 nt lds
    s_waitcnt lgkmcnt(8)
    v_mfma_f32_32x32x16_bf16 v[192:207], a[240:243], a[44:47], v[192:207]
    ds_read_b64_tr_b16 a[232:233], v1 offset:33920
    ds_read_b64_tr_b16 a[234:235], v1 offset:34432
    buffer_load_dwordx4 v47, s[20:23], s29 offen offset:3136 nt lds
    v_mfma_f32_32x32x16_bf16 v[208:223], a[244:247], a[44:47], v[208:223]
    ds_read_b64_tr_b16 a[236:237], v1 offset:33984
    ds_read_b64_tr_b16 a[238:239], v1 offset:34496
    s_waitcnt vmcnt(24)
    ds_read_b128 a[96:99], v52 offset:0
    ds_read_b128 a[100:103], v53 offset:0
    ds_read_b128 a[104:107], v52 offset:64
    s_waitcnt lgkmcnt(11)
    ds_read_b128 a[108:111], v53 offset:64
    v_mfma_f32_32x32x16_bf16 v[224:239], a[248:251], a[44:47], v[224:239]
    ds_read_b64_tr_b16 a[240:241], v1 offset:42240
    ds_read_b64_tr_b16 a[242:243], v1 offset:42752
    v_mfma_f32_32x32x16_bf16 v[240:255], a[252:255], a[44:47], v[240:255]
    ds_read_b64_tr_b16 a[244:245], v1 offset:42304
    s_waitcnt lgkmcnt(11)
    ds_read_b64_tr_b16 a[246:247], v1 offset:42816
    v_mfma_f32_32x32x16_bf16 v[192:207], a[224:227], a[48:51], v[192:207]
    ds_read_b64_tr_b16 a[248:249], v1 offset:42368
    ds_read_b64_tr_b16 a[250:251], v1 offset:42880
    v_mfma_f32_32x32x16_bf16 v[208:223], a[228:231], a[48:51], v[208:223]
    ds_read_b64_tr_b16 a[252:253], v1 offset:42432
    s_waitcnt lgkmcnt(11)
    ds_read_b64_tr_b16 a[254:255], v1 offset:42944
    s_waitcnt lgkmcnt(8)
    s_add_u32 m0, s24, 101376
    s_mov_b32 s29, 3670016
    s_mov_b32 s30, 3931136
    buffer_load_dwordx4 v13, s[12:15], s29 offen nt lds
    v_mfma_f32_32x32x16_bf16 v[224:239], a[232:235], a[48:51], v[224:239]
    ds_read_b64_tr_b16 a[224:225], v1 offset:34816
    ds_read_b64_tr_b16 a[226:227], v1 offset:35328
    buffer_load_dwordx4 v13, s[12:15], s30 offen offset:1024 nt lds
    v_mfma_f32_32x32x16_bf16 v[240:255], a[236:239], a[48:51], v[240:255]
    ds_read_b64_tr_b16 a[228:229], v1 offset:34880
    ds_read_b64_tr_b16 a[230:231], v1 offset:35392
    buffer_load_dwordx4 v14, s[12:15], s29 offen offset:2112 nt lds
    s_waitcnt lgkmcnt(8)
    v_mfma_f32_32x32x16_bf16 v[192:207], a[240:243], a[52:55], v[192:207]
    ds_read_b64_tr_b16 a[232:233], v1 offset:34944
    ds_read_b64_tr_b16 a[234:235], v1 offset:35456
    buffer_load_dwordx4 v14, s[12:15], s30 offen offset:3136 nt lds
    v_mfma_f32_32x32x16_bf16 v[208:223], a[244:247], a[52:55], v[208:223]
    ds_read_b64_tr_b16 a[236:237], v1 offset:35008
    ds_read_b64_tr_b16 a[238:239], v1 offset:35520
    s_waitcnt lgkmcnt(8)
    v_mfma_f32_32x32x16_bf16 v[224:239], a[248:251], a[52:55], v[224:239]
    ds_read_b64_tr_b16 a[240:241], v1 offset:43264
    ds_read_b64_tr_b16 a[242:243], v1 offset:43776
    v_mfma_f32_32x32x16_bf16 v[240:255], a[252:255], a[52:55], v[240:255]
    ds_read_b64_tr_b16 a[244:245], v1 offset:43328
    ds_read_b64_tr_b16 a[246:247], v1 offset:43840
    s_waitcnt lgkmcnt(8)
    v_mfma_f32_32x32x16_bf16 v[192:207], a[224:227], a[56:59], v[192:207]
    ds_read_b64_tr_b16 a[248:249], v1 offset:43392
    ds_read_b64_tr_b16 a[250:251], v1 offset:43904
    s_waitcnt vmcnt(24)
    s_barrier
    v_mfma_f32_32x32x16_bf16 v[208:223], a[228:231], a[56:59], v[208:223]
    ds_read_b64_tr_b16 a[252:253], v1 offset:43456
    ds_read_b64_tr_b16 a[254:255], v1 offset:43968
    s_add_u32 m0, s24, 16896
    s_mov_b32 s93, 0
    s_mov_b32 s95, 7168
    buffer_load_dwordx4 v17, s[4:7], s93 offen nt lds
    s_waitcnt lgkmcnt(8)
    v_mfma_f32_32x32x16_bf16 v[224:239], a[232:235], a[56:59], v[224:239]
    ds_read_b64_tr_b16 a[224:225], v2 offset:0
    ds_read_b64_tr_b16 a[226:227], v2 offset:512
    buffer_load_dwordx4 v17, s[4:7], s95 offen offset:1024 nt lds
    v_mfma_f32_32x32x16_bf16 v[240:255], a[236:239], a[56:59], v[240:255]
    ds_read_b64_tr_b16 a[228:229], v2 offset:64
    ds_read_b64_tr_b16 a[230:231], v2 offset:576
    buffer_load_dwordx4 v18, s[4:7], s93 offen offset:2112 nt lds
    s_waitcnt lgkmcnt(8)
    v_mfma_f32_32x32x16_bf16 v[192:207], a[240:243], a[60:63], v[192:207]
    ds_read_b64_tr_b16 a[232:233], v2 offset:128
    ds_read_b64_tr_b16 a[234:235], v2 offset:640
    buffer_load_dwordx4 v18, s[4:7], s95 offen offset:3136 nt lds
    v_mfma_f32_32x32x16_bf16 v[208:223], a[244:247], a[60:63], v[208:223]
    ds_read_b64_tr_b16 a[236:237], v2 offset:192
    ds_read_b64_tr_b16 a[238:239], v2 offset:704
    s_waitcnt vmcnt(24)
    ds_read_b128 a[112:115], v52 offset:16896
    ds_read_b128 a[116:119], v53 offset:16896
    ds_read_b128 a[120:123], v52 offset:16960
    s_waitcnt lgkmcnt(11)
    ds_read_b128 a[124:127], v53 offset:16960
    v_mfma_f32_32x32x16_bf16 v[224:239], a[248:251], a[60:63], v[224:239]
    ds_read_b64_tr_b16 a[240:241], v2 offset:8448
    ds_read_b64_tr_b16 a[242:243], v2 offset:8960
    v_mfma_f32_32x32x16_bf16 v[240:255], a[252:255], a[60:63], v[240:255]
    ds_read_b64_tr_b16 a[244:245], v2 offset:8512
    s_waitcnt lgkmcnt(11)
    ds_read_b64_tr_b16 a[246:247], v2 offset:9024
    v_mfma_f32_32x32x16_bf16 v[192:207], a[224:227], a[64:67], v[192:207]
    ds_read_b64_tr_b16 a[248:249], v2 offset:8576
    ds_read_b64_tr_b16 a[250:251], v2 offset:9088
    v_mfma_f32_32x32x16_bf16 v[208:223], a[228:231], a[64:67], v[208:223]
    ds_read_b64_tr_b16 a[252:253], v2 offset:8640
    s_waitcnt lgkmcnt(11)
    ds_read_b64_tr_b16 a[254:255], v2 offset:9152
    s_waitcnt lgkmcnt(8)
    s_add_u32 m0, s24, 118272
    s_mov_b32 s29, 4194304
    s_mov_b32 s30, 4455424
    buffer_load_dwordx4 v13, s[12:15], s29 offen nt lds
    v_mfma_f32_32x32x16_bf16 v[224:239], a[232:235], a[64:67], v[224:239]
    ds_read_b64_tr_b16 a[224:225], v2 offset:1024
    ds_read_b64_tr_b16 a[226:227], v2 offset:1536
    buffer_load_dwordx4 v13, s[12:15], s30 offen offset:1024 nt lds
    v_mfma_f32_32x32x16_bf16 v[240:255], a[236:239], a[64:67], v[240:255]
    ds_read_b64_tr_b16 a[228:229], v2 offset:1088
    ds_read_b64_tr_b16 a[230:231], v2 offset:1600
    buffer_load_dwordx4 v14, s[12:15], s29 offen offset:2112 nt lds
    s_waitcnt lgkmcnt(8)
    v_mfma_f32_32x32x16_bf16 v[192:207], a[240:243], a[68:71], v[192:207]
    ds_read_b64_tr_b16 a[232:233], v2 offset:1152
    ds_read_b64_tr_b16 a[234:235], v2 offset:1664
    buffer_load_dwordx4 v14, s[12:15], s30 offen offset:3136 nt lds
    v_mfma_f32_32x32x16_bf16 v[208:223], a[244:247], a[68:71], v[208:223]
    ds_read_b64_tr_b16 a[236:237], v2 offset:1216
    ds_read_b64_tr_b16 a[238:239], v2 offset:1728
    s_waitcnt lgkmcnt(8)
    v_mfma_f32_32x32x16_bf16 v[224:239], a[248:251], a[68:71], v[224:239]
    ds_read_b64_tr_b16 a[240:241], v2 offset:9472
    ds_read_b64_tr_b16 a[242:243], v2 offset:9984
    v_mfma_f32_32x32x16_bf16 v[240:255], a[252:255], a[68:71], v[240:255]
    ds_read_b64_tr_b16 a[244:245], v2 offset:9536
    ds_read_b64_tr_b16 a[246:247], v2 offset:10048
    s_waitcnt lgkmcnt(8)
    v_mfma_f32_32x32x16_bf16 v[192:207], a[224:227], a[72:75], v[192:207]
    ds_read_b64_tr_b16 a[248:249], v2 offset:9600
    ds_read_b64_tr_b16 a[250:251], v2 offset:10112
    s_waitcnt vmcnt(24)
    s_barrier
    v_mfma_f32_32x32x16_bf16 v[208:223], a[228:231], a[72:75], v[208:223]
    ds_read_b64_tr_b16 a[252:253], v2 offset:9664
    ds_read_b64_tr_b16 a[254:255], v2 offset:10176
    s_waitcnt vmcnt(16)
    ds_read_b128 a[128:131], v52 offset:33792
    ds_read_b128 a[132:135], v53 offset:33792
    ds_read_b128 a[136:139], v52 offset:33856
    s_waitcnt lgkmcnt(11)
    ds_read_b128 a[140:143], v53 offset:33856
    v_mfma_f32_32x32x16_bf16 v[224:239], a[232:235], a[72:75], v[224:239]
    ds_read_b64_tr_b16 a[224:225], v2 offset:16896
    ds_read_b64_tr_b16 a[226:227], v2 offset:17408
    v_mfma_f32_32x32x16_bf16 v[240:255], a[236:239], a[72:75], v[240:255]
    ds_read_b64_tr_b16 a[228:229], v2 offset:16960
    s_waitcnt lgkmcnt(11)
    ds_read_b64_tr_b16 a[230:231], v2 offset:17472
    v_mfma_f32_32x32x16_bf16 v[192:207], a[240:243], a[76:79], v[192:207]
    ds_read_b64_tr_b16 a[232:233], v2 offset:17024
    ds_read_b64_tr_b16 a[234:235], v2 offset:17536
    s_waitcnt lgkmcnt(6)
    s_add_u32 m0, s24, 135168
    s_mov_b32 s29, 4718592
    s_mov_b32 s30, 4979712
    buffer_load_dwordx4 v13, s[12:15], s29 offen nt lds
    v_mfma_f32_32x32x16_bf16 v[208:223], a[244:247], a[76:79], v[208:223]
    ds_read_b64_tr_b16 a[236:237], v2 offset:17088
    ds_read_b64_tr_b16 a[238:239], v2 offset:17600
    buffer_load_dwordx4 v13, s[12:15], s30 offen offset:1024 nt lds
    v_mfma_f32_32x32x16_bf16 v[224:239], a[248:251], a[76:79], v[224:239]
    ds_read_b64_tr_b16 a[240:241], v2 offset:25344
    ds_read_b64_tr_b16 a[242:243], v2 offset:25856
    buffer_load_dwordx4 v14, s[12:15], s29 offen offset:2112 nt lds
    v_mfma_f32_32x32x16_bf16 v[240:255], a[252:255], a[76:79], v[240:255]
    ds_read_b64_tr_b16 a[244:245], v2 offset:25408
    ds_read_b64_tr_b16 a[246:247], v2 offset:25920
    buffer_load_dwordx4 v14, s[12:15], s30 offen offset:3136 nt lds
    s_waitcnt lgkmcnt(8)
    v_mfma_f32_32x32x16_bf16 v[192:207], a[224:227], a[80:83], v[192:207]
    ds_read_b64_tr_b16 a[248:249], v2 offset:25472
    ds_read_b64_tr_b16 a[250:251], v2 offset:25984
    v_mfma_f32_32x32x16_bf16 v[208:223], a[228:231], a[80:83], v[208:223]
    ds_read_b64_tr_b16 a[252:253], v2 offset:25536
    ds_read_b64_tr_b16 a[254:255], v2 offset:26048
    s_waitcnt vmcnt(16)
    ds_read_b128 a[144:147], v48 offset:0
    ds_read_b128 a[148:151], v49 offset:0
    ds_read_b128 a[152:155], v48 offset:64
    s_waitcnt lgkmcnt(11)
    ds_read_b128 a[156:159], v49 offset:64
    v_mfma_f32_32x32x16_bf16 v[224:239], a[232:235], a[80:83], v[224:239]
    ds_read_b64_tr_b16 a[224:225], v2 offset:17920
    ds_read_b64_tr_b16 a[226:227], v2 offset:18432
    v_mfma_f32_32x32x16_bf16 v[240:255], a[236:239], a[80:83], v[240:255]
    ds_read_b64_tr_b16 a[228:229], v2 offset:17984
    s_waitcnt lgkmcnt(11)
    ds_read_b64_tr_b16 a[230:231], v2 offset:18496
    v_mfma_f32_32x32x16_bf16 v[192:207], a[240:243], a[84:87], v[192:207]
    ds_read_b64_tr_b16 a[232:233], v2 offset:18048
    ds_read_b64_tr_b16 a[234:235], v2 offset:18560
    s_waitcnt lgkmcnt(6)
    s_add_u32 m0, s24, 0
    s_mov_b32 s29, 256
    s_mov_b32 s30, 261376
    buffer_load_dwordx4 v13, s[12:15], s29 offen nt lds
    v_mfma_f32_32x32x16_bf16 v[208:223], a[244:247], a[84:87], v[208:223]
    ds_read_b64_tr_b16 a[236:237], v2 offset:18112
    ds_read_b64_tr_b16 a[238:239], v2 offset:18624
    buffer_load_dwordx4 v13, s[12:15], s30 offen offset:1024 nt lds
    v_mfma_f32_32x32x16_bf16 v[224:239], a[248:251], a[84:87], v[224:239]
    ds_read_b64_tr_b16 a[240:241], v2 offset:26368
    ds_read_b64_tr_b16 a[242:243], v2 offset:26880
    buffer_load_dwordx4 v14, s[12:15], s29 offen offset:2112 nt lds
    v_mfma_f32_32x32x16_bf16 v[240:255], a[252:255], a[84:87], v[240:255]
    ds_read_b64_tr_b16 a[244:245], v2 offset:26432
    ds_read_b64_tr_b16 a[246:247], v2 offset:26944
    buffer_load_dwordx4 v14, s[12:15], s30 offen offset:3136 nt lds
    s_waitcnt lgkmcnt(8)
    v_mfma_f32_32x32x16_bf16 v[192:207], a[224:227], a[88:91], v[192:207]
    ds_read_b64_tr_b16 a[248:249], v2 offset:26496
    ds_read_b64_tr_b16 a[250:251], v2 offset:27008
    s_barrier
    v_mfma_f32_32x32x16_bf16 v[208:223], a[228:231], a[88:91], v[208:223]
    ds_read_b64_tr_b16 a[252:253], v2 offset:26560
    ds_read_b64_tr_b16 a[254:255], v2 offset:27072
    s_add_u32 m0, s24, 33792
    s_mov_b32 s29, 524544
    s_mov_b32 s30, 785664
    buffer_load_dwordx4 v13, s[12:15], s29 offen nt lds
    s_waitcnt lgkmcnt(8)
    v_mfma_f32_32x32x16_bf16 v[224:239], a[232:235], a[88:91], v[224:239]
    ds_read_b64_tr_b16 a[224:225], v2 offset:33792
    ds_read_b64_tr_b16 a[226:227], v2 offset:34304
    buffer_load_dwordx4 v13, s[12:15], s30 offen offset:1024 nt lds
    v_mov_b32 v64, s100
    v_accvgpr_write_b32 a192, v64
    v_accvgpr_write_b32 a193, 0
    v_mfma_f32_32x32x16_bf16 v[240:255], a[236:239], a[88:91], v[240:255]
    ds_read_b64_tr_b16 a[228:229], v2 offset:33856
    ds_read_b64_tr_b16 a[230:231], v2 offset:34368
    buffer_load_dwordx4 v14, s[12:15], s29 offen offset:2112 nt lds
    s_waitcnt lgkmcnt(8)
    v_mfma_f32_32x32x16_bf16 v[192:207], a[240:243], a[92:95], v[192:207]
    ds_read_b64_tr_b16 a[232:233], v2 offset:33920
    ds_read_b64_tr_b16 a[234:235], v2 offset:34432
    buffer_load_dwordx4 v14, s[12:15], s30 offen offset:3136 nt lds
    v_mfma_f32_32x32x16_bf16 v[208:223], a[244:247], a[92:95], v[208:223]
    ds_read_b64_tr_b16 a[236:237], v2 offset:33984
    ds_read_b64_tr_b16 a[238:239], v2 offset:34496
    s_mov_b64 exec, 1
    buffer_atomic_cmpswap a[192:193], off, s[96:99], 0 sc0
    s_mov_b64 exec, -1
    s_add_u32 m0, s24, 50688
    s_mov_b32 s93, 0
    s_mov_b32 s95, 15360
    buffer_load_dwordx4 v15, s[8:11], s93 offen nt lds
    s_waitcnt lgkmcnt(8)
    v_mfma_f32_32x32x16_bf16 v[224:239], a[248:251], a[92:95], v[224:239]
    ds_read_b64_tr_b16 a[240:241], v2 offset:42240
    ds_read_b64_tr_b16 a[242:243], v2 offset:42752
    buffer_load_dwordx4 v17, s[4:7], s95 offen offset:1024 nt lds
    v_mfma_f32_32x32x16_bf16 v[240:255], a[252:255], a[92:95], v[240:255]
    ds_read_b64_tr_b16 a[244:245], v2 offset:42304
    ds_read_b64_tr_b16 a[246:247], v2 offset:42816
    buffer_load_dwordx4 v16, s[8:11], s93 offen offset:2112 nt lds
    s_waitcnt lgkmcnt(8)
    v_mfma_f32_32x32x16_bf16 v[192:207], a[224:227], a[96:99], v[192:207]
    ds_read_b64_tr_b16 a[248:249], v2 offset:42368
    ds_read_b64_tr_b16 a[250:251], v2 offset:42880
    buffer_load_dwordx4 v18, s[4:7], s95 offen offset:3136 nt lds
    v_mfma_f32_32x32x16_bf16 v[208:223], a[228:231], a[96:99], v[208:223]
    ds_read_b64_tr_b16 a[252:253], v2 offset:42432
    ds_read_b64_tr_b16 a[254:255], v2 offset:42944
    s_waitcnt lgkmcnt(8)
    v_mfma_f32_32x32x16_bf16 v[224:239], a[232:235], a[96:99], v[224:239]
    ds_read_b64_tr_b16 a[224:225], v2 offset:34816
    ds_read_b64_tr_b16 a[226:227], v2 offset:35328
    v_mfma_f32_32x32x16_bf16 v[240:255], a[236:239], a[96:99], v[240:255]
    ds_read_b64_tr_b16 a[228:229], v2 offset:34880
    ds_read_b64_tr_b16 a[230:231], v2 offset:35392
    s_waitcnt lgkmcnt(8)
    v_mfma_f32_32x32x16_bf16 v[192:207], a[240:243], a[100:103], v[192:207]
    ds_read_b64_tr_b16 a[232:233], v2 offset:34944
    ds_read_b64_tr_b16 a[234:235], v2 offset:35456
    v_mfma_f32_32x32x16_bf16 v[208:223], a[244:247], a[100:103], v[208:223]
    ds_read_b64_tr_b16 a[236:237], v2 offset:35008
    ds_read_b64_tr_b16 a[238:239], v2 offset:35520
    s_waitcnt lgkmcnt(8)
    v_mfma_f32_32x32x16_bf16 v[224:239], a[248:251], a[100:103], v[224:239]
    ds_read_b64_tr_b16 a[240:241], v2 offset:43264
    ds_read_b64_tr_b16 a[242:243], v2 offset:43776
    v_mfma_f32_32x32x16_bf16 v[240:255], a[252:255], a[100:103], v[240:255]
    ds_read_b64_tr_b16 a[244:245], v2 offset:43328
    ds_read_b64_tr_b16 a[246:247], v2 offset:43840
    s_waitcnt lgkmcnt(8)
    v_mfma_f32_32x32x16_bf16 v[192:207], a[224:227], a[104:107], v[192:207]
    ds_read_b64_tr_b16 a[248:249], v2 offset:43392
    ds_read_b64_tr_b16 a[250:251], v2 offset:43904
    s_waitcnt vmcnt(25)
    s_barrier
    v_mfma_f32_32x32x16_bf16 v[208:223], a[228:231], a[104:107], v[208:223]
    ds_read_b64_tr_b16 a[252:253], v2 offset:43456
    ds_read_b64_tr_b16 a[254:255], v2 offset:43968
    s_add_u32 m0, s24, 67584
    s_mov_b32 s29, 1048832
    s_mov_b32 s30, 1309952
    buffer_load_dwordx4 v13, s[12:15], s29 offen nt lds
    s_waitcnt lgkmcnt(8)
    v_mfma_f32_32x32x16_bf16 v[224:239], a[232:235], a[104:107], v[224:239]
    ds_read_b64_tr_b16 a[224:225], v3 offset:0
    ds_read_b64_tr_b16 a[226:227], v3 offset:512
    buffer_load_dwordx4 v13, s[12:15], s30 offen offset:1024 nt lds
    v_mfma_f32_32x32x16_bf16 v[240:255], a[236:239], a[104:107], v[240:255]
    ds_read_b64_tr_b16 a[228:229], v3 offset:64
    ds_read_b64_tr_b16 a[230:231], v3 offset:576
    s_waitcnt lgkmcnt(8)
    v_mfma_f32_32x32x16_bf16 v[192:207], a[240:243], a[108:111], v[192:207]
    ds_read_b64_tr_b16 a[232:233], v3 offset:128
    ds_read_b64_tr_b16 a[234:235], v3 offset:640
    buffer_load_dwordx4 v14, s[12:15], s29 offen offset:2112 nt lds
    v_mfma_f32_32x32x16_bf16 v[208:223], a[244:247], a[108:111], v[208:223]
    ds_read_b64_tr_b16 a[236:237], v3 offset:192
    ds_read_b64_tr_b16 a[238:239], v3 offset:704
    s_waitcnt lgkmcnt(8)
    v_mfma_f32_32x32x16_bf16 v[224:239], a[248:251], a[108:111], v[224:239]
    ds_read_b64_tr_b16 a[240:241], v3 offset:8448
    ds_read_b64_tr_b16 a[242:243], v3 offset:8960
    buffer_load_dwordx4 v14, s[12:15], s30 offen offset:3136 nt lds
    v_mfma_f32_32x32x16_bf16 v[240:255], a[252:255], a[108:111], v[240:255]
    ds_read_b64_tr_b16 a[244:245], v3 offset:8512
    ds_read_b64_tr_b16 a[246:247], v3 offset:9024
    s_waitcnt lgkmcnt(8)
    v_mfma_f32_32x32x16_bf16 v[192:207], a[224:227], a[112:115], v[192:207]
    ds_read_b64_tr_b16 a[248:249], v3 offset:8576
    ds_read_b64_tr_b16 a[250:251], v3 offset:9088
    v_mfma_f32_32x32x16_bf16 v[208:223], a[228:231], a[112:115], v[208:223]
    ds_read_b64_tr_b16 a[252:253], v3 offset:8640
    ds_read_b64_tr_b16 a[254:255], v3 offset:9152
    s_waitcnt lgkmcnt(8)
    v_mfma_f32_32x32x16_bf16 v[224:239], a[232:235], a[112:115], v[224:239]
    ds_read_b64_tr_b16 a[224:225], v3 offset:1024
    ds_read_b64_tr_b16 a[226:227], v3 offset:1536
    v_mfma_f32_32x32x16_bf16 v[240:255], a[236:239], a[112:115], v[240:255]
    ds_read_b64_tr_b16 a[228:229], v3 offset:1088
    ds_read_b64_tr_b16 a[230:231], v3 offset:1600
    s_waitcnt lgkmcnt(8)
    v_mfma_f32_32x32x16_bf16 v[192:207], a[240:243], a[116:119], v[192:207]
    ds_read_b64_tr_b16 a[232:233], v3 offset:1152
    ds_read_b64_tr_b16 a[234:235], v3 offset:1664
    v_mfma_f32_32x32x16_bf16 v[208:223], a[244:247], a[116:119], v[208:223]
    ds_read_b64_tr_b16 a[236:237], v3 offset:1216
    ds_read_b64_tr_b16 a[238:239], v3 offset:1728
    s_waitcnt lgkmcnt(8)
    v_mfma_f32_32x32x16_bf16 v[224:239], a[248:251], a[116:119], v[224:239]
    ds_read_b64_tr_b16 a[240:241], v3 offset:9472
    ds_read_b64_tr_b16 a[242:243], v3 offset:9984
    v_mfma_f32_32x32x16_bf16 v[240:255], a[252:255], a[116:119], v[240:255]
    ds_read_b64_tr_b16 a[244:245], v3 offset:9536
    ds_read_b64_tr_b16 a[246:247], v3 offset:10048
    s_waitcnt lgkmcnt(8)
    v_mfma_f32_32x32x16_bf16 v[192:207], a[224:227], a[120:123], v[192:207]
    ds_read_b64_tr_b16 a[248:249], v3 offset:9600
    ds_read_b64_tr_b16 a[250:251], v3 offset:10112
    s_waitcnt vmcnt(21)
    s_barrier
    v_mfma_f32_32x32x16_bf16 v[208:223], a[228:231], a[120:123], v[208:223]
    ds_read_b64_tr_b16 a[252:253], v3 offset:9664
    ds_read_b64_tr_b16 a[254:255], v3 offset:10176
    s_add_u32 m0, s24, 84480
    s_mov_b32 s93, 8192
    s_mov_b32 s95, 23552
    buffer_load_dwordx4 v15, s[8:11], s93 offen nt lds
    s_waitcnt lgkmcnt(8)
    v_mfma_f32_32x32x16_bf16 v[224:239], a[232:235], a[120:123], v[224:239]
    ds_read_b64_tr_b16 a[224:225], v3 offset:16896
    ds_read_b64_tr_b16 a[226:227], v3 offset:17408
    buffer_load_dwordx4 v17, s[4:7], s95 offen offset:1024 nt lds
    v_mfma_f32_32x32x16_bf16 v[240:255], a[236:239], a[120:123], v[240:255]
    ds_read_b64_tr_b16 a[228:229], v3 offset:16960
    ds_read_b64_tr_b16 a[230:231], v3 offset:17472
    s_waitcnt lgkmcnt(8)
    v_mfma_f32_32x32x16_bf16 v[192:207], a[240:243], a[124:127], v[192:207]
    ds_read_b64_tr_b16 a[232:233], v3 offset:17024
    ds_read_b64_tr_b16 a[234:235], v3 offset:17536
    buffer_load_dwordx4 v16, s[8:11], s93 offen offset:2112 nt lds
    v_mfma_f32_32x32x16_bf16 v[208:223], a[244:247], a[124:127], v[208:223]
    ds_read_b64_tr_b16 a[236:237], v3 offset:17088
    ds_read_b64_tr_b16 a[238:239], v3 offset:17600
    s_waitcnt lgkmcnt(8)
    v_mfma_f32_32x32x16_bf16 v[224:239], a[248:251], a[124:127], v[224:239]
    ds_read_b64_tr_b16 a[240:241], v3 offset:25344
    ds_read_b64_tr_b16 a[242:243], v3 offset:25856
    buffer_load_dwordx4 v18, s[4:7], s95 offen offset:3136 nt lds
    v_mfma_f32_32x32x16_bf16 v[240:255], a[252:255], a[124:127], v[240:255]
    ds_read_b64_tr_b16 a[244:245], v3 offset:25408
    ds_read_b64_tr_b16 a[246:247], v3 offset:25920
    s_waitcnt lgkmcnt(8)
    v_mfma_f32_32x32x16_bf16 v[192:207], a[224:227], a[128:131], v[192:207]
    ds_read_b64_tr_b16 a[248:249], v3 offset:25472
    ds_read_b64_tr_b16 a[250:251], v3 offset:25984
    v_mfma_f32_32x32x16_bf16 v[208:223], a[228:231], a[128:131], v[208:223]
    ds_read_b64_tr_b16 a[252:253], v3 offset:25536
    ds_read_b64_tr_b16 a[254:255], v3 offset:26048
    s_waitcnt lgkmcnt(8)
    v_mfma_f32_32x32x16_bf16 v[224:239], a[232:235], a[128:131], v[224:239]
    ds_read_b64_tr_b16 a[224:225], v3 offset:17920
    ds_read_b64_tr_b16 a[226:227], v3 offset:18432
    v_mfma_f32_32x32x16_bf16 v[240:255], a[236:239], a[128:131], v[240:255]
    ds_read_b64_tr_b16 a[228:229], v3 offset:17984
    ds_read_b64_tr_b16 a[230:231], v3 offset:18496
    s_waitcnt lgkmcnt(8)
    v_mfma_f32_32x32x16_bf16 v[192:207], a[240:243], a[132:135], v[192:207]
    ds_read_b64_tr_b16 a[232:233], v3 offset:18048
    ds_read_b64_tr_b16 a[234:235], v3 offset:18560
    v_mfma_f32_32x32x16_bf16 v[208:223], a[244:247], a[132:135], v[208:223]
    ds_read_b64_tr_b16 a[236:237], v3 offset:18112
    ds_read_b64_tr_b16 a[238:239], v3 offset:18624
    s_waitcnt lgkmcnt(8)
    v_mfma_f32_32x32x16_bf16 v[224:239], a[248:251], a[132:135], v[224:239]
    ds_read_b64_tr_b16 a[240:241], v3 offset:26368
    ds_read_b64_tr_b16 a[242:243], v3 offset:26880
    v_mfma_f32_32x32x16_bf16 v[240:255], a[252:255], a[132:135], v[240:255]
    ds_read_b64_tr_b16 a[244:245], v3 offset:26432
    ds_read_b64_tr_b16 a[246:247], v3 offset:26944
    s_waitcnt lgkmcnt(8)
    v_mfma_f32_32x32x16_bf16 v[192:207], a[224:227], a[136:139], v[192:207]
    ds_read_b64_tr_b16 a[248:249], v3 offset:26496
    ds_read_b64_tr_b16 a[250:251], v3 offset:27008
    s_waitcnt vmcnt(21)
    s_barrier
    v_mfma_f32_32x32x16_bf16 v[208:223], a[228:231], a[136:139], v[208:223]
    ds_read_b64_tr_b16 a[252:253], v3 offset:26560
    ds_read_b64_tr_b16 a[254:255], v3 offset:27072
    s_add_u32 m0, s24, 101376
    s_mov_b32 s93, 16384
    s_mov_b32 s95, 31744
    buffer_load_dwordx4 v15, s[8:11], s93 offen nt lds
    s_waitcnt lgkmcnt(8)
    v_mfma_f32_32x32x16_bf16 v[224:239], a[232:235], a[136:139], v[224:239]
    ds_read_b64_tr_b16 a[224:225], v3 offset:33792
    ds_read_b64_tr_b16 a[226:227], v3 offset:34304
    buffer_load_dwordx4 v17, s[4:7], s95 offen offset:1024 nt lds
    v_mfma_f32_32x32x16_bf16 v[240:255], a[236:239], a[136:139], v[240:255]
    ds_read_b64_tr_b16 a[228:229], v3 offset:42240
    ds_read_b64_tr_b16 a[230:231], v3 offset:42752
    s_waitcnt lgkmcnt(8)
    v_mfma_f32_32x32x16_bf16 v[192:207], a[240:243], a[140:143], v[192:207]
    ds_read_b64_tr_b16 a[232:233], v3 offset:34816
    ds_read_b64_tr_b16 a[234:235], v3 offset:35328
    buffer_load_dwordx4 v16, s[8:11], s93 offen offset:2112 nt lds
    v_mfma_f32_32x32x16_bf16 v[208:223], a[244:247], a[140:143], v[208:223]
    ds_read_b64_tr_b16 a[236:237], v3 offset:43264
    ds_read_b64_tr_b16 a[238:239], v3 offset:43776
    s_waitcnt lgkmcnt(8)
    v_mfma_f32_32x32x16_bf16 v[224:239], a[248:251], a[140:143], v[224:239]
    ds_read_b64_tr_b16 a[240:241], v3 offset:33856
    ds_read_b64_tr_b16 a[242:243], v3 offset:34368
    buffer_load_dwordx4 v18, s[4:7], s95 offen offset:3136 nt lds
    v_mfma_f32_32x32x16_bf16 v[240:255], a[252:255], a[140:143], v[240:255]
    ds_read_b64_tr_b16 a[244:245], v3 offset:42304
    ds_read_b64_tr_b16 a[246:247], v3 offset:42816
    s_waitcnt lgkmcnt(8)
    v_mfma_f32_32x32x16_bf16 v[192:207], a[224:227], a[144:147], v[192:207]
    ds_read_b64_tr_b16 a[248:249], v3 offset:34880
    ds_read_b64_tr_b16 a[250:251], v3 offset:35392
    v_mfma_f32_32x32x16_bf16 v[192:207], a[228:231], a[148:151], v[192:207]
    ds_read_b64_tr_b16 a[252:253], v3 offset:43328
    ds_read_b64_tr_b16 a[254:255], v3 offset:43840
    s_waitcnt lgkmcnt(8)
    v_mfma_f32_32x32x16_bf16 v[192:207], a[232:235], a[152:155], v[192:207]
    ds_read_b64_tr_b16 a[224:225], v3 offset:33920
    ds_read_b64_tr_b16 a[226:227], v3 offset:34432
    v_mfma_f32_32x32x16_bf16 v[192:207], a[236:239], a[156:159], v[192:207]
    ds_read_b64_tr_b16 a[228:229], v3 offset:42368
    ds_read_b64_tr_b16 a[230:231], v3 offset:42880
    s_waitcnt lgkmcnt(8)
    v_mfma_f32_32x32x16_bf16 v[208:223], a[240:243], a[144:147], v[208:223]
    ds_read_b64_tr_b16 a[232:233], v3 offset:34944
    ds_read_b64_tr_b16 a[234:235], v3 offset:35456
    v_mfma_f32_32x32x16_bf16 v[208:223], a[244:247], a[148:151], v[208:223]
    ds_read_b64_tr_b16 a[236:237], v3 offset:43392
    ds_read_b64_tr_b16 a[238:239], v3 offset:43904
    s_waitcnt lgkmcnt(8)
    v_mfma_f32_32x32x16_bf16 v[208:223], a[248:251], a[152:155], v[208:223]
    ds_read_b64_tr_b16 a[240:241], v3 offset:33984
    ds_read_b64_tr_b16 a[242:243], v3 offset:34496
    v_mul_f32 v192, s33, v192
    v_mul_f32 v193, s33, v193
    v_cvt_pk_bf16_f32 v32, v192, v193
    v_mul_f32 v194, s33, v194
    v_mul_f32 v195, s33, v195
    v_cvt_pk_bf16_f32 v33, v194, v195
    v_mfma_f32_32x32x16_bf16 v[208:223], a[252:255], a[156:159], v[208:223]
    ds_read_b64_tr_b16 a[244:245], v3 offset:42432
    ds_read_b64_tr_b16 a[246:247], v3 offset:42944
    v_mul_f32 v196, s33, v196
    v_mul_f32 v197, s33, v197
    v_cvt_pk_bf16_f32 v34, v196, v197
    v_mul_f32 v198, s33, v198
    v_mul_f32 v199, s33, v199
    v_cvt_pk_bf16_f32 v35, v198, v199
    s_waitcnt lgkmcnt(8)
    v_mfma_f32_32x32x16_bf16 v[224:239], a[224:227], a[144:147], v[224:239]
    ds_read_b64_tr_b16 a[248:249], v3 offset:35008
    ds_read_b64_tr_b16 a[250:251], v3 offset:35520
    s_waitcnt vmcnt(21)
    s_barrier
    v_mul_f32 v200, s33, v200
    v_mul_f32 v201, s33, v201
    v_cvt_pk_bf16_f32 v36, v200, v201
    v_mul_f32 v202, s33, v202
    v_mul_f32 v203, s33, v203
    v_cvt_pk_bf16_f32 v37, v202, v203
    v_mfma_f32_32x32x16_bf16 v[224:239], a[228:231], a[148:151], v[224:239]
    ds_read_b64_tr_b16 a[252:253], v3 offset:43456
    ds_read_b64_tr_b16 a[254:255], v3 offset:43968
    s_add_u32 m0, s24, 118272
    s_mov_b32 s29, 1573120
    s_mov_b32 s30, 1834240
    buffer_load_dwordx4 v13, s[12:15], s29 offen nt lds
    v_mul_f32 v204, s33, v204
    v_mul_f32 v205, s33, v205
    v_cvt_pk_bf16_f32 v38, v204, v205
    v_mul_f32 v206, s33, v206
    v_mul_f32 v207, s33, v207
    v_cvt_pk_bf16_f32 v39, v206, v207
    s_waitcnt lgkmcnt(8)
    v_mfma_f32_32x32x16_bf16 v[224:239], a[232:235], a[152:155], v[224:239]
    ds_read_b64_tr_b16 a[224:225], v1 offset:0
    ds_read_b64_tr_b16 a[226:227], v1 offset:512
    buffer_load_dwordx4 v13, s[12:15], s30 offen offset:1024 nt lds
    v_mul_f32 v208, s33, v208
    v_mul_f32 v209, s33, v209
    v_cvt_pk_bf16_f32 v40, v208, v209
    v_mul_f32 v210, s33, v210
    v_mul_f32 v211, s33, v211
    v_cvt_pk_bf16_f32 v41, v210, v211
    v_mfma_f32_32x32x16_bf16 v[224:239], a[236:239], a[156:159], v[224:239]
    ds_read_b64_tr_b16 a[228:229], v1 offset:64
    ds_read_b64_tr_b16 a[230:231], v1 offset:576
    v_mul_f32 v212, s33, v212
    v_mul_f32 v213, s33, v213
    v_cvt_pk_bf16_f32 v42, v212, v213
    v_mul_f32 v214, s33, v214
    v_mul_f32 v215, s33, v215
    v_cvt_pk_bf16_f32 v43, v214, v215
    s_waitcnt lgkmcnt(8)
    v_mfma_f32_32x32x16_bf16 v[240:255], a[240:243], a[144:147], v[240:255]
    ds_read_b64_tr_b16 a[232:233], v1 offset:128
    ds_read_b64_tr_b16 a[234:235], v1 offset:640
    buffer_load_dwordx4 v14, s[12:15], s29 offen offset:2112 nt lds
    v_mul_f32 v216, s33, v216
    v_mul_f32 v217, s33, v217
    v_cvt_pk_bf16_f32 v44, v216, v217
    v_mul_f32 v218, s33, v218
    v_mul_f32 v219, s33, v219
    v_cvt_pk_bf16_f32 v45, v218, v219
    v_mfma_f32_32x32x16_bf16 v[240:255], a[244:247], a[148:151], v[240:255]
    ds_read_b64_tr_b16 a[236:237], v1 offset:192
    ds_read_b64_tr_b16 a[238:239], v1 offset:704
    v_mul_f32 v220, s33, v220
    v_mul_f32 v221, s33, v221
    v_cvt_pk_bf16_f32 v46, v220, v221
    v_mul_f32 v222, s33, v222
    v_mul_f32 v223, s33, v223
    v_cvt_pk_bf16_f32 v47, v222, v223
    s_waitcnt lgkmcnt(8)
    v_mfma_f32_32x32x16_bf16 v[240:255], a[248:251], a[152:155], v[240:255]
    ds_read_b64_tr_b16 a[240:241], v1 offset:8448
    ds_read_b64_tr_b16 a[242:243], v1 offset:8960
    buffer_load_dwordx4 v14, s[12:15], s30 offen offset:3136 nt lds
    v_mul_f32 v224, s33, v224
    v_mul_f32 v225, s33, v225
    v_cvt_pk_bf16_f32 v48, v224, v225
    v_mul_f32 v226, s33, v226
    v_mul_f32 v227, s33, v227
    v_cvt_pk_bf16_f32 v49, v226, v227
    v_mul_f32 v228, s33, v228
    v_mul_f32 v229, s33, v229
    v_cvt_pk_bf16_f32 v50, v228, v229
    v_mul_f32 v230, s33, v230
    v_mul_f32 v231, s33, v231
    v_cvt_pk_bf16_f32 v51, v230, v231
    v_mfma_f32_32x32x16_bf16 v[240:255], a[252:255], a[156:159], v[240:255]
    ds_read_b64_tr_b16 a[244:245], v1 offset:8512
    ds_read_b64_tr_b16 a[246:247], v1 offset:9024
    v_mul_f32 v232, s33, v232
    v_mul_f32 v233, s33, v233
    v_cvt_pk_bf16_f32 v52, v232, v233
    v_mul_f32 v234, s33, v234
    v_mul_f32 v235, s33, v235
    v_cvt_pk_bf16_f32 v53, v234, v235
    v_mul_f32 v236, s33, v236
    v_mul_f32 v237, s33, v237
    v_cvt_pk_bf16_f32 v54, v236, v237
    v_mul_f32 v238, s33, v238
    v_mul_f32 v239, s33, v239
    v_cvt_pk_bf16_f32 v55, v238, v239
    v_mul_f32 v240, s33, v240
    v_mul_f32 v241, s33, v241
    v_cvt_pk_bf16_f32 v56, v240, v241
    v_mul_f32 v242, s33, v242
    v_mul_f32 v243, s33, v243
    v_cvt_pk_bf16_f32 v57, v242, v243
    v_mul_f32 v244, s33, v244
    v_mul_f32 v245, s33, v245
    v_cvt_pk_bf16_f32 v58, v244, v245
    v_mul_f32 v246, s33, v246
    v_mul_f32 v247, s33, v247
    v_cvt_pk_bf16_f32 v59, v246, v247
    v_mul_f32 v248, s33, v248
    v_mul_f32 v249, s33, v249
    v_cvt_pk_bf16_f32 v60, v248, v249
    v_mul_f32 v250, s33, v250
    v_mul_f32 v251, s33, v251
    v_cvt_pk_bf16_f32 v61, v250, v251
    v_mul_f32 v252, s33, v252
    v_mul_f32 v253, s33, v253
    v_cvt_pk_bf16_f32 v62, v252, v253
    v_mul_f32 v254, s33, v254
    v_mul_f32 v255, s33, v255
    v_cvt_pk_bf16_f32 v63, v254, v255
    s_waitcnt lgkmcnt(8)
    v_mfma_f32_32x32x16_bf16 v[192:207], a[224:227], a[0:3], 0
    ds_read_b64_tr_b16 a[248:249], v1 offset:8576
    ds_read_b64_tr_b16 a[250:251], v1 offset:9088
    v_mfma_f32_32x32x16_bf16 v[208:223], a[228:231], a[0:3], 0
    ds_read_b64_tr_b16 a[252:253], v1 offset:8640
    ds_read_b64_tr_b16 a[254:255], v1 offset:9152
    s_waitcnt lgkmcnt(8)
    v_mfma_f32_32x32x16_bf16 v[224:239], a[232:235], a[0:3], 0
    ds_read_b64_tr_b16 a[224:225], v1 offset:1024
    ds_read_b64_tr_b16 a[226:227], v1 offset:1536
    v_mfma_f32_32x32x16_bf16 v[240:255], a[236:239], a[0:3], 0
    ds_read_b64_tr_b16 a[228:229], v1 offset:1088
    ds_read_b64_tr_b16 a[230:231], v1 offset:1600
    s_waitcnt lgkmcnt(8)
    v_mfma_f32_32x32x16_bf16 v[192:207], a[240:243], a[4:7], v[192:207]
    ds_read_b64_tr_b16 a[232:233], v1 offset:1152
    ds_read_b64_tr_b16 a[234:235], v1 offset:1664
    v_mfma_f32_32x32x16_bf16 v[208:223], a[244:247], a[4:7], v[208:223]
    ds_read_b64_tr_b16 a[236:237], v1 offset:1216
    ds_read_b64_tr_b16 a[238:239], v1 offset:1728
    s_waitcnt lgkmcnt(8)
    v_mfma_f32_32x32x16_bf16 v[224:239], a[248:251], a[4:7], v[224:239]
    ds_read_b64_tr_b16 a[240:241], v1 offset:9472
    ds_read_b64_tr_b16 a[242:243], v1 offset:9984
    v_mfma_f32_32x32x16_bf16 v[240:255], a[252:255], a[4:7], v[240:255]
    ds_read_b64_tr_b16 a[244:245], v1 offset:9536
    ds_read_b64_tr_b16 a[246:247], v1 offset:10048
    s_waitcnt lgkmcnt(8)
    v_mfma_f32_32x32x16_bf16 v[192:207], a[224:227], a[8:11], v[192:207]
    ds_read_b64_tr_b16 a[248:249], v1 offset:9600
    ds_read_b64_tr_b16 a[250:251], v1 offset:10112
    s_barrier
    s_add_u32 m0, s24, 135168
    s_mov_b32 s93, 24576
    s_mov_b32 s95, 39936
    v_mfma_f32_32x32x16_bf16 v[208:223], a[228:231], a[8:11], v[208:223]
    ds_read_b64_tr_b16 a[252:253], v1 offset:9664
    ds_read_b64_tr_b16 a[254:255], v1 offset:10176
    buffer_load_dwordx4 v15, s[8:11], s93 offen nt lds
    s_waitcnt lgkmcnt(8)
    v_mfma_f32_32x32x16_bf16 v[224:239], a[232:235], a[8:11], v[224:239]
    ds_read_b128 a[224:227], v7 offset:16896
    v_mfma_f32_32x32x16_bf16 v[240:255], a[236:239], a[8:11], v[240:255]
    ds_read_b128 a[228:231], v10 offset:16896
    buffer_load_dwordx4 v17, s[4:7], s95 offen offset:1024 nt lds
    s_waitcnt lgkmcnt(6)
    v_mfma_f32_32x32x16_bf16 v[192:207], a[240:243], a[12:15], v[192:207]
    ds_read_b128 a[232:235], v7 offset:16960
    v_mfma_f32_32x32x16_bf16 v[208:223], a[244:247], a[12:15], v[208:223]
    ds_read_b128 a[236:239], v10 offset:16960
    buffer_load_dwordx4 v16, s[8:11], s93 offen offset:2112 nt lds
    s_waitcnt lgkmcnt(4)
    v_mfma_f32_32x32x16_bf16 v[224:239], a[248:251], a[12:15], v[224:239]
    ds_read_b128 a[240:243], v7 offset:17024
    v_mfma_f32_32x32x16_bf16 v[240:255], a[252:255], a[12:15], v[240:255]
    ds_read_b128 a[244:247], v10 offset:17024
    buffer_load_dwordx4 v18, s[4:7], s95 offen offset:3136 nt lds
    s_waitcnt lgkmcnt(4)
    v_mfma_f32_32x32x16_bf16 v[128:143], a[224:227], v[32:35], 0
    ds_read_b128 a[248:251], v7 offset:17088
    v_mfma_f32_32x32x16_bf16 v[128:143], a[228:231], v[36:39], v[128:143]
    ds_read_b128 a[252:255], v10 offset:17088
    s_waitcnt lgkmcnt(4)
    v_mfma_f32_32x32x16_bf16 v[128:143], a[232:235], v[40:43], v[128:143]
    ds_read_b128 a[224:227], v7 offset:17920
    v_mfma_f32_32x32x16_bf16 v[128:143], a[236:239], v[44:47], v[128:143]
    ds_read_b128 a[228:231], v10 offset:17920
    s_waitcnt lgkmcnt(4)
    v_mfma_f32_32x32x16_bf16 v[128:143], a[240:243], v[48:51], v[128:143]
    ds_read_b128 a[232:235], v7 offset:17984
    v_mfma_f32_32x32x16_bf16 v[128:143], a[244:247], v[52:55], v[128:143]
    ds_read_b128 a[236:239], v10 offset:17984
    s_waitcnt lgkmcnt(4)
    v_mfma_f32_32x32x16_bf16 v[128:143], a[248:251], v[56:59], v[128:143]
    ds_read_b128 a[240:243], v7 offset:18048
    v_mfma_f32_32x32x16_bf16 v[128:143], a[252:255], v[60:63], v[128:143]
    ds_read_b128 a[244:247], v10 offset:18048
    s_waitcnt lgkmcnt(4)
    v_mfma_f32_32x32x16_bf16 v[144:159], a[224:227], v[32:35], 0
    ds_read_b128 a[248:251], v7 offset:18112
    s_waitcnt vmcnt(25)
    s_barrier
    s_add_u32 m0, s24, 0
    s_mov_b32 s29, 2097408
    s_mov_b32 s30, 2358528
    v_mfma_f32_32x32x16_bf16 v[144:159], a[228:231], v[36:39], v[144:159]
    ds_read_b128 a[252:255], v10 offset:18112
    buffer_load_dwordx4 v13, s[12:15], s29 offen nt lds
    s_waitcnt lgkmcnt(4)
    v_mfma_f32_32x32x16_bf16 v[144:159], a[232:235], v[40:43], v[144:159]
    ds_read_b64_tr_b16 a[224:225], v1 offset:33792
    ds_read_b64_tr_b16 a[226:227], v1 offset:34304
    v_max3_f32 v30, v128, v129, v130
    v_max3_f32 v31, v131, v132, v133
    v_max3_f32 v30, v30, v134, v135
    v_max3_f32 v31, v31, v136, v137
    v_max3_f32 v30, v30, v138, v139
    v_max3_f32 v31, v31, v140, v141
    v_max3_f32 v30, v30, v142, v143
    v_mfma_f32_32x32x16_bf16 v[144:159], a[236:239], v[44:47], v[144:159]
    ds_read_b64_tr_b16 a[228:229], v1 offset:33856
    ds_read_b64_tr_b16 a[230:231], v1 offset:34368
    buffer_load_dwordx4 v13, s[12:15], s30 offen offset:1024 nt lds
    v_max_f32 v30, v30, v31
    v_mov_b32 v31, v30
    s_nop 1
    v_permlane32_swap_b32 v30, v31
    v_max_f32 v30, v30, v31
    v_sub_f32 v30, 0, v30
    v_add_f32 v128, v128, v30
    s_waitcnt lgkmcnt(6)
    v_mfma_f32_32x32x16_bf16 v[144:159], a[240:243], v[48:51], v[144:159]
    ds_read_b64_tr_b16 a[232:233], v1 offset:33920
    ds_read_b64_tr_b16 a[234:235], v1 offset:34432
    v_add_f32 v129, v129, v30
    v_add_f32 v130, v130, v30
    v_add_f32 v131, v131, v30
    v_add_f32 v132, v132, v30
    v_add_f32 v133, v133, v30
    v_add_f32 v134, v134, v30
    v_mfma_f32_32x32x16_bf16 v[144:159], a[244:247], v[52:55], v[144:159]
    ds_read_b64_tr_b16 a[236:237], v1 offset:33984
    ds_read_b64_tr_b16 a[238:239], v1 offset:34496
    buffer_load_dwordx4 v14, s[12:15], s29 offen offset:2112 nt lds
    v_add_f32 v135, v135, v30
    v_add_f32 v136, v136, v30
    v_add_f32 v137, v137, v30
    v_add_f32 v138, v138, v30
    v_add_f32 v139, v139, v30
    v_add_f32 v140, v140, v30
    s_waitcnt lgkmcnt(8)
    v_mfma_f32_32x32x16_bf16 v[144:159], a[248:251], v[56:59], v[144:159]
    ds_read_b64_tr_b16 a[240:241], v1 offset:42240
    ds_read_b64_tr_b16 a[242:243], v1 offset:42752
    v_add_f32 v141, v141, v30
    v_add_f32 v142, v142, v30
    v_add_f32 v143, v143, v30
    v_exp_f32 v24, v128
    v_exp_f32 v25, v129
    s_nop 0
    v_cvt_pk_bf16_f32 v176, v24, v25
    v_mfma_f32_32x32x16_bf16 v[144:159], a[252:255], v[60:63], v[144:159]
    ds_read_b64_tr_b16 a[244:245], v1 offset:42304
    ds_read_b64_tr_b16 a[246:247], v1 offset:42816
    buffer_load_dwordx4 v14, s[12:15], s30 offen offset:3136 nt lds
    v_add_f32 v28, v24, v25
    v_exp_f32 v26, v130
    v_exp_f32 v27, v131
    s_nop 0
    v_cvt_pk_bf16_f32 v177, v26, v27
    v_add_f32 v29, v26, v27
    v_exp_f32 v24, v132
    v_exp_f32 v25, v133
    s_waitcnt lgkmcnt(8)
    v_mfma_f32_32x32x16_bf16 v[192:207], a[224:227], a[16:19], v[192:207]
    ds_read_b64_tr_b16 a[248:249], v1 offset:42368
    ds_read_b64_tr_b16 a[250:251], v1 offset:42880
    v_add_f32 v28, v28, v24
    v_cvt_pk_bf16_f32 v178, v24, v25
    v_add_f32 v29, v29, v25
    v_exp_f32 v26, v134
    v_exp_f32 v27, v135
    v_add_f32 v28, v28, v26
    v_mfma_f32_32x32x16_bf16 v[208:223], a[228:231], a[16:19], v[208:223]
    ds_read_b64_tr_b16 a[252:253], v1 offset:42432
    ds_read_b64_tr_b16 a[254:255], v1 offset:42944
    v_cvt_pk_bf16_f32 v179, v26, v27
    v_add_f32 v29, v29, v27
    v_exp_f32 v24, v136
    v_exp_f32 v25, v137
    v_add_f32 v28, v28, v24
    v_cvt_pk_bf16_f32 v180, v24, v25
    s_waitcnt lgkmcnt(8)
    v_mfma_f32_32x32x16_bf16 v[224:239], a[232:235], a[16:19], v[224:239]
    ds_read_b64_tr_b16 a[224:225], v1 offset:34816
    ds_read_b64_tr_b16 a[226:227], v1 offset:35328
    v_add_f32 v29, v29, v25
    v_exp_f32 v26, v138
    v_exp_f32 v27, v139
    v_add_f32 v28, v28, v26
    v_cvt_pk_bf16_f32 v181, v26, v27
    v_add_f32 v29, v29, v27
    v_mfma_f32_32x32x16_bf16 v[240:255], a[236:239], a[16:19], v[240:255]
    ds_read_b64_tr_b16 a[228:229], v1 offset:34880
    ds_read_b64_tr_b16 a[230:231], v1 offset:35392
    v_exp_f32 v24, v140
    v_exp_f32 v25, v141
    v_add_f32 v28, v28, v24
    v_cvt_pk_bf16_f32 v182, v24, v25
    v_add_f32 v29, v29, v25
    v_exp_f32 v26, v142
    s_waitcnt lgkmcnt(8)
    v_mfma_f32_32x32x16_bf16 v[192:207], a[240:243], a[20:23], v[192:207]
    ds_read_b64_tr_b16 a[232:233], v1 offset:34944
    ds_read_b64_tr_b16 a[234:235], v1 offset:35456
    v_exp_f32 v27, v143
    v_add_f32 v28, v28, v26
    v_cvt_pk_bf16_f32 v183, v26, v27
    v_add_f32 v29, v29, v27
    v_add_f32 v22, v28, v29
    v_mov_b32 v160, v30
    v_mov_b32 v161, v30
    v_mfma_f32_32x32x16_bf16 v[208:223], a[244:247], a[20:23], v[208:223]
    ds_read_b64_tr_b16 a[236:237], v1 offset:35008
    ds_read_b64_tr_b16 a[238:239], v1 offset:35520
    v_mov_b32 v162, v30
    v_mov_b32 v163, v30
    v_mov_b32 v164, v30
    v_mov_b32 v165, v30
    v_mov_b32 v166, v30
    v_mov_b32 v167, v30
    s_waitcnt lgkmcnt(8)
    v_mfma_f32_32x32x16_bf16 v[224:239], a[248:251], a[20:23], v[224:239]
    ds_read_b64_tr_b16 a[240:241], v1 offset:43264
    ds_read_b64_tr_b16 a[242:243], v1 offset:43776
    v_mov_b32 v168, v30
    v_mov_b32 v169, v30
    v_mov_b32 v170, v30
    v_mov_b32 v171, v30
    v_mov_b32 v172, v30
    v_mov_b32 v173, v30
    v_mfma_f32_32x32x16_bf16 v[240:255], a[252:255], a[20:23], v[240:255]
    ds_read_b64_tr_b16 a[244:245], v1 offset:43328
    ds_read_b64_tr_b16 a[246:247], v1 offset:43840
    v_mov_b32 v174, v30
    v_mov_b32 v175, v30
    v_add_f32 v144, v144, v30
    v_add_f32 v145, v145, v30
    v_add_f32 v146, v146, v30
    v_add_f32 v147, v147, v30
    s_waitcnt lgkmcnt(8)
    v_mfma_f32_32x32x16_bf16 v[192:207], a[224:227], a[24:27], v[192:207]
    ds_read_b64_tr_b16 a[248:249], v1 offset:43392
    ds_read_b64_tr_b16 a[250:251], v1 offset:43904
    s_waitcnt vmcnt(24)
    s_barrier
    s_add_u32 m0, s24, 16896
    s_mov_b32 s93, 32768
    s_mov_b32 s95, 48128
    v_add_f32 v148, v148, v30
    v_add_f32 v149, v149, v30
    v_add_f32 v150, v150, v30
    v_add_f32 v151, v151, v30
    v_add_f32 v152, v152, v30
    v_add_f32 v153, v153, v30
    v_mfma_f32_32x32x16_bf16 v[208:223], a[228:231], a[24:27], v[208:223]
    ds_read_b64_tr_b16 a[252:253], v1 offset:43456
    ds_read_b64_tr_b16 a[254:255], v1 offset:43968
    buffer_load_dwordx4 v15, s[8:11], s93 offen nt lds
    v_add_f32 v154, v154, v30
    v_add_f32 v155, v155, v30
    v_add_f32 v156, v156, v30
    v_add_f32 v157, v157, v30
    v_add_f32 v158, v158, v30
    v_add_f32 v159, v159, v30
    s_waitcnt lgkmcnt(8)
    v_mfma_f32_32x32x16_bf16 v[224:239], a[232:235], a[24:27], v[224:239]
    ds_read_b128 a[224:227], v8 offset:1024
    v_mfma_f32_32x32x16_bf16 v[240:255], a[236:239], a[24:27], v[240:255]
    ds_read_b128 a[228:231], v11 offset:1024
    buffer_load_dwordx4 v17, s[4:7], s95 offen offset:1024 nt lds
    s_waitcnt lgkmcnt(6)
    v_mfma_f32_32x32x16_bf16 v[192:207], a[240:243], a[28:31], v[192:207]
    ds_read_b128 a[232:235], v8 offset:1088
    v_mfma_f32_32x32x16_bf16 v[208:223], a[244:247], a[28:31], v[208:223]
    ds_read_b128 a[236:239], v11 offset:1088
    buffer_load_dwordx4 v16, s[8:11], s93 offen offset:2112 nt lds
    s_waitcnt lgkmcnt(4)
    v_mfma_f32_32x32x16_bf16 v[224:239], a[248:251], a[28:31], v[224:239]
    ds_read_b128 a[240:243], v8 offset:1152
    v_mfma_f32_32x32x16_bf16 v[240:255], a[252:255], a[28:31], v[240:255]
    ds_read_b128 a[244:247], v11 offset:1152
    buffer_load_dwordx4 v18, s[4:7], s95 offen offset:3136 nt lds
    s_waitcnt lgkmcnt(4)
    v_mfma_f32_32x32x16_bf16 v[128:143], a[224:227], v[32:35], v[160:175]
    ds_read_b128 a[248:251], v8 offset:1216
    v_exp_f32 v24, v144
    v_exp_f32 v25, v145
    v_mfma_f32_32x32x16_bf16 v[128:143], a[228:231], v[36:39], v[128:143]
    ds_read_b128 a[252:255], v11 offset:1216
    v_cvt_pk_bf16_f32 v184, v24, v25
    v_add_f32 v28, v24, v25
    s_waitcnt lgkmcnt(4)
    v_mfma_f32_32x32x16_bf16 v[128:143], a[232:235], v[40:43], v[128:143]
    ds_read_b64_tr_b16 a[224:225], v5 offset:0
    ds_read_b64_tr_b16 a[226:227], v5 offset:512
    v_mfma_f32_32x32x16_bf16 v[128:143], a[236:239], v[44:47], v[128:143]
    ds_read_b64_tr_b16 a[228:229], v5 offset:64
    ds_read_b64_tr_b16 a[230:231], v5 offset:576
    v_exp_f32 v26, v146
    v_exp_f32 v27, v147
    s_waitcnt lgkmcnt(6)
    v_mfma_f32_32x32x16_bf16 v[128:143], a[240:243], v[48:51], v[128:143]
    ds_read_b64_tr_b16 a[232:233], v5 offset:128
    ds_read_b64_tr_b16 a[234:235], v5 offset:640
    v_cvt_pk_bf16_f32 v185, v26, v27
    v_add_f32 v29, v26, v27
    v_mfma_f32_32x32x16_bf16 v[128:143], a[244:247], v[52:55], v[128:143]
    ds_read_b64_tr_b16 a[236:237], v5 offset:192
    ds_read_b64_tr_b16 a[238:239], v5 offset:704
    s_waitcnt lgkmcnt(8)
    v_mfma_f32_32x32x16_bf16 v[128:143], a[248:251], v[56:59], v[128:143]
    ds_read_b64_tr_b16 a[240:241], v5 offset:8448
    ds_read_b64_tr_b16 a[242:243], v5 offset:8960
    v_exp_f32 v24, v148
    v_exp_f32 v25, v149
    v_mfma_f32_32x32x16_bf16 v[128:143], a[252:255], v[60:63], v[128:143]
    ds_read_b64_tr_b16 a[244:245], v5 offset:8512
    ds_read_b64_tr_b16 a[246:247], v5 offset:9024
    v_add_f32 v28, v28, v24
    v_cvt_pk_bf16_f32 v186, v24, v25
    v_add_f32 v29, v29, v25
    s_waitcnt lgkmcnt(8)
    v_mfma_f32_32x32x16_bf16 v[64:79], a[224:227], v[176:179], 0
    ds_read_b64_tr_b16 a[248:249], v5 offset:8576
    ds_read_b64_tr_b16 a[250:251], v5 offset:9088
    s_waitcnt vmcnt(24)
    s_barrier
    s_add_u32 m0, s24, 33792
    s_mov_b32 s93, 40960
    s_mov_b32 s95, 56320
    v_mfma_f32_32x32x16_bf16 v[80:95], a[228:231], v[176:179], 0
    ds_read_b64_tr_b16 a[252:253], v5 offset:8640
    ds_read_b64_tr_b16 a[254:255], v5 offset:9152
    buffer_load_dwordx4 v15, s[8:11], s93 offen nt lds
    v_exp_f32 v26, v150
    v_exp_f32 v27, v151
    s_waitcnt lgkmcnt(8)
    v_mfma_f32_32x32x16_bf16 v[96:111], a[232:235], v[176:179], 0
    ds_read_b64_tr_b16 a[224:225], v2 offset:16896
    ds_read_b64_tr_b16 a[226:227], v2 offset:17408
    v_add_f32 v28, v28, v26
    v_cvt_pk_bf16_f32 v187, v26, v27
    v_add_f32 v29, v29, v27
    v_mfma_f32_32x32x16_bf16 v[112:127], a[236:239], v[176:179], 0
    ds_read_b64_tr_b16 a[228:229], v2 offset:16960
    ds_read_b64_tr_b16 a[230:231], v2 offset:17472
    buffer_load_dwordx4 v17, s[4:7], s95 offen offset:1024 nt lds
    s_waitcnt lgkmcnt(8)
    v_mfma_f32_32x32x16_bf16 v[64:79], a[240:243], v[180:183], v[64:79]
    ds_read_b64_tr_b16 a[232:233], v2 offset:17024
    ds_read_b64_tr_b16 a[234:235], v2 offset:17536
    v_exp_f32 v24, v152
    v_exp_f32 v25, v153
    v_mfma_f32_32x32x16_bf16 v[80:95], a[244:247], v[180:183], v[80:95]
    ds_read_b64_tr_b16 a[236:237], v2 offset:17088
    ds_read_b64_tr_b16 a[238:239], v2 offset:17600
    buffer_load_dwordx4 v16, s[8:11], s93 offen offset:2112 nt lds
    v_add_f32 v28, v28, v24
    v_cvt_pk_bf16_f32 v188, v24, v25
    v_add_f32 v29, v29, v25
    s_waitcnt lgkmcnt(8)
    v_mfma_f32_32x32x16_bf16 v[96:111], a[248:251], v[180:183], v[96:111]
    ds_read_b64_tr_b16 a[240:241], v2 offset:25344
    ds_read_b64_tr_b16 a[242:243], v2 offset:25856
    v_mfma_f32_32x32x16_bf16 v[112:127], a[252:255], v[180:183], v[112:127]
    ds_read_b64_tr_b16 a[244:245], v2 offset:25408
    ds_read_b64_tr_b16 a[246:247], v2 offset:25920
    buffer_load_dwordx4 v18, s[4:7], s95 offen offset:3136 nt lds
    v_exp_f32 v26, v154
    v_exp_f32 v27, v155
    s_waitcnt lgkmcnt(8)
    v_mfma_f32_32x32x16_bf16 v[192:207], a[224:227], a[32:35], v[192:207]
    ds_read_b64_tr_b16 a[248:249], v2 offset:25472
    ds_read_b64_tr_b16 a[250:251], v2 offset:25984
    v_add_f32 v28, v28, v26
    v_cvt_pk_bf16_f32 v189, v26, v27
    v_add_f32 v29, v29, v27
    v_mfma_f32_32x32x16_bf16 v[208:223], a[228:231], a[32:35], v[208:223]
    ds_read_b64_tr_b16 a[252:253], v2 offset:25536
    ds_read_b64_tr_b16 a[254:255], v2 offset:26048
    s_waitcnt lgkmcnt(8)
    v_mfma_f32_32x32x16_bf16 v[224:239], a[232:235], a[32:35], v[224:239]
    ds_read_b64_tr_b16 a[224:225], v2 offset:17920
    ds_read_b64_tr_b16 a[226:227], v2 offset:18432
    v_exp_f32 v24, v156
    v_exp_f32 v25, v157
    v_mfma_f32_32x32x16_bf16 v[240:255], a[236:239], a[32:35], v[240:255]
    ds_read_b64_tr_b16 a[228:229], v2 offset:17984
    ds_read_b64_tr_b16 a[230:231], v2 offset:18496
    v_add_f32 v28, v28, v24
    v_cvt_pk_bf16_f32 v190, v24, v25
    v_add_f32 v29, v29, v25
    s_waitcnt lgkmcnt(8)
    v_mfma_f32_32x32x16_bf16 v[192:207], a[240:243], a[36:39], v[192:207]
    ds_read_b64_tr_b16 a[232:233], v2 offset:18048
    ds_read_b64_tr_b16 a[234:235], v2 offset:18560
    v_mfma_f32_32x32x16_bf16 v[208:223], a[244:247], a[36:39], v[208:223]
    ds_read_b64_tr_b16 a[236:237], v2 offset:18112
    ds_read_b64_tr_b16 a[238:239], v2 offset:18624
    v_exp_f32 v26, v158
    v_exp_f32 v27, v159
    s_waitcnt lgkmcnt(8)
    v_mfma_f32_32x32x16_bf16 v[224:239], a[248:251], a[36:39], v[224:239]
    ds_read_b64_tr_b16 a[240:241], v2 offset:26368
    ds_read_b64_tr_b16 a[242:243], v2 offset:26880
    v_add_f32 v28, v28, v26
    v_cvt_pk_bf16_f32 v191, v26, v27
    v_add_f32 v29, v29, v27
    v_mfma_f32_32x32x16_bf16 v[240:255], a[252:255], a[36:39], v[240:255]
    ds_read_b64_tr_b16 a[244:245], v2 offset:26432
    ds_read_b64_tr_b16 a[246:247], v2 offset:26944
    v_add_f32 v28, v28, v29
    v_cmp_nge_f32 vcc, s32, v28
    s_cbranch_vccnz L_rs1
L_back1:
    v_add_f32 v22, v22, v28
    s_waitcnt lgkmcnt(8)
    v_mfma_f32_32x32x16_bf16 v[192:207], a[224:227], a[40:43], v[192:207]
    ds_read_b64_tr_b16 a[248:249], v2 offset:26496
    ds_read_b64_tr_b16 a[250:251], v2 offset:27008
    s_waitcnt vmcnt(24)
    s_barrier
    s_add_u32 m0, s24, 50688
    s_mov_b32 s29, 2621696
    s_mov_b32 s30, 2882816
    v_exp_f32 v24, v128
    v_exp_f32 v25, v129
    v_mfma_f32_32x32x16_bf16 v[208:223], a[228:231], a[40:43], v[208:223]
    ds_read_b64_tr_b16 a[252:253], v2 offset:26560
    ds_read_b64_tr_b16 a[254:255], v2 offset:27072
    buffer_load_dwordx4 v13, s[12:15], s29 offen nt lds
    v_cvt_pk_bf16_f32 v176, v24, v25
    v_add_f32 v28, v24, v25
    s_waitcnt lgkmcnt(8)
    v_mfma_f32_32x32x16_bf16 v[224:239], a[232:235], a[40:43], v[224:239]
    ds_read_b128 a[224:227], v8 offset:34816
    v_mfma_f32_32x32x16_bf16 v[240:255], a[236:239], a[40:43], v[240:255]
    ds_read_b128 a[228:231], v11 offset:34816
    buffer_load_dwordx4 v13, s[12:15], s30 offen offset:1024 nt lds
    v_exp_f32 v26, v130
    v_exp_f32 v27, v131
    s_waitcnt lgkmcnt(6)
    v_mfma_f32_32x32x16_bf16 v[192:207], a[240:243], a[44:47], v[192:207]
    ds_read_b128 a[232:235], v8 offset:34880
    v_cvt_pk_bf16_f32 v177, v26, v27
    v_add_f32 v29, v26, v27
    v_mfma_f32_32x32x16_bf16 v[208:223], a[244:247], a[44:47], v[208:223]
    ds_read_b128 a[236:239], v11 offset:34880
    buffer_load_dwordx4 v14, s[12:15], s29 offen offset:2112 nt lds
    s_waitcnt lgkmcnt(4)
    v_mfma_f32_32x32x16_bf16 v[224:239], a[248:251], a[44:47], v[224:239]
    ds_read_b128 a[240:243], v8 offset:34944
    v_exp_f32 v24, v132
    v_exp_f32 v25, v133
    v_mfma_f32_32x32x16_bf16 v[240:255], a[252:255], a[44:47], v[240:255]
    ds_read_b128 a[244:247], v11 offset:34944
    buffer_load_dwordx4 v14, s[12:15], s30 offen offset:3136 nt lds
    v_add_f32 v28, v28, v24
    v_cvt_pk_bf16_f32 v178, v24, v25
    v_add_f32 v29, v29, v25
    s_waitcnt lgkmcnt(4)
    v_mfma_f32_32x32x16_bf16 v[144:159], a[224:227], v[32:35], v[160:175]
    ds_read_b128 a[248:251], v8 offset:35008
    v_mfma_f32_32x32x16_bf16 v[144:159], a[228:231], v[36:39], v[144:159]
    ds_read_b128 a[252:255], v11 offset:35008
    v_exp_f32 v26, v134
    v_exp_f32 v27, v135
    s_waitcnt lgkmcnt(4)
    v_mfma_f32_32x32x16_bf16 v[144:159], a[232:235], v[40:43], v[144:159]
    ds_read_b64_tr_b16 a[224:225], v5 offset:33792
    ds_read_b64_tr_b16 a[226:227], v5 offset:34304
    v_add_f32 v28, v28, v26
    v_cvt_pk_bf16_f32 v179, v26, v27
    v_add_f32 v29, v29, v27
    v_mfma_f32_32x32x16_bf16 v[144:159], a[236:239], v[44:47], v[144:159]
    ds_read_b64_tr_b16 a[228:229], v5 offset:33856
    ds_read_b64_tr_b16 a[230:231], v5 offset:34368
    s_waitcnt lgkmcnt(6)
    v_mfma_f32_32x32x16_bf16 v[144:159], a[240:243], v[48:51], v[144:159]
    ds_read_b64_tr_b16 a[232:233], v5 offset:33920
    ds_read_b64_tr_b16 a[234:235], v5 offset:34432
    v_exp_f32 v24, v136
    v_exp_f32 v25, v137
    v_mfma_f32_32x32x16_bf16 v[144:159], a[244:247], v[52:55], v[144:159]
    ds_read_b64_tr_b16 a[236:237], v5 offset:33984
    ds_read_b64_tr_b16 a[238:239], v5 offset:34496
    v_add_f32 v28, v28, v24
    v_cvt_pk_bf16_f32 v180, v24, v25
    v_add_f32 v29, v29, v25
    s_waitcnt lgkmcnt(8)
    v_mfma_f32_32x32x16_bf16 v[144:159], a[248:251], v[56:59], v[144:159]
    ds_read_b64_tr_b16 a[240:241], v5 offset:42240
    ds_read_b64_tr_b16 a[242:243], v5 offset:42752
    v_mfma_f32_32x32x16_bf16 v[144:159], a[252:255], v[60:63], v[144:159]
    ds_read_b64_tr_b16 a[244:245], v5 offset:42304
    ds_read_b64_tr_b16 a[246:247], v5 offset:42816
    v_exp_f32 v26, v138
    v_exp_f32 v27, v139
    s_waitcnt lgkmcnt(8)
    v_mfma_f32_32x32x16_bf16 v[64:79], a[224:227], v[184:187], v[64:79]
    ds_read_b64_tr_b16 a[248:249], v5 offset:42368
    ds_read_b64_tr_b16 a[250:251], v5 offset:42880
    s_waitcnt vmcnt(24)
    s_barrier
    s_add_u32 m0, s24, 67584
    s_mov_b32 s93, 49152
    s_mov_b32 s95, 64512
    v_add_f32 v28, v28, v26
    v_cvt_pk_bf16_f32 v181, v26, v27
    v_add_f32 v29, v29, v27
    v_mfma_f32_32x32x16_bf16 v[80:95], a[228:231], v[184:187], v[80:95]
    ds_read_b64_tr_b16 a[252:253], v5 offset:42432
    ds_read_b64_tr_b16 a[254:255], v5 offset:42944
    buffer_load_dwordx4 v15, s[8:11], s93 offen nt lds
    s_waitcnt lgkmcnt(8)
    v_mfma_f32_32x32x16_bf16 v[96:111], a[232:235], v[184:187], v[96:111]
    ds_read_b128 a[224:227], v9 offset:1024
    v_exp_f32 v24, v140
    v_exp_f32 v25, v141
    v_mfma_f32_32x32x16_bf16 v[112:127], a[236:239], v[184:187], v[112:127]
    ds_read_b128 a[228:231], v12 offset:1024
    buffer_load_dwordx4 v17, s[4:7], s95 offen offset:1024 nt lds
    v_add_f32 v28, v28, v24
    v_cvt_pk_bf16_f32 v182, v24, v25
    v_add_f32 v29, v29, v25
    s_waitcnt lgkmcnt(6)
    v_mfma_f32_32x32x16_bf16 v[64:79], a[240:243], v[188:191], v[64:79]
    ds_read_b128 a[232:235], v9 offset:1088
    v_mfma_f32_32x32x16_bf16 v[80:95], a[244:247], v[188:191], v[80:95]
    ds_read_b128 a[236:239], v12 offset:1088
    buffer_load_dwordx4 v16, s[8:11], s93 offen offset:2112 nt lds
    v_exp_f32 v26, v142
    v_exp_f32 v27, v143
    s_waitcnt lgkmcnt(4)
    v_mfma_f32_32x32x16_bf16 v[96:111], a[248:251], v[188:191], v[96:111]
    ds_read_b128 a[240:243], v9 offset:1152
    v_add_f32 v28, v28, v26
    v_cvt_pk_bf16_f32 v183, v26, v27
    v_add_f32 v29, v29, v27
    v_mfma_f32_32x32x16_bf16 v[112:127], a[252:255], v[188:191], v[112:127]
    ds_read_b128 a[244:247], v12 offset:1152
    buffer_load_dwordx4 v18, s[4:7], s95 offen offset:3136 nt lds
    v_add_f32 v28, v28, v29
    v_cmp_nge_f32 vcc, s32, v28
    s_cbranch_vccnz L_rs2
L_back2:
    v_add_f32 v22, v22, v28
    s_waitcnt lgkmcnt(4)
    v_mfma_f32_32x32x16_bf16 v[128:143], a[224:227], v[32:35], v[160:175]
    ds_read_b128 a[248:251], v9 offset:1216
    v_exp_f32 v24, v144
    v_exp_f32 v25, v145
    v_mfma_f32_32x32x16_bf16 v[128:143], a[228:231], v[36:39], v[128:143]
    ds_read_b128 a[252:255], v12 offset:1216
    v_cvt_pk_bf16_f32 v184, v24, v25
    v_add_f32 v28, v24, v25
    s_waitcnt lgkmcnt(4)
    v_mfma_f32_32x32x16_bf16 v[128:143], a[232:235], v[40:43], v[128:143]
    ds_read_b64_tr_b16 a[224:225], v6 offset:0
    ds_read_b64_tr_b16 a[226:227], v6 offset:512
    v_mfma_f32_32x32x16_bf16 v[128:143], a[236:239], v[44:47], v[128:143]
    ds_read_b64_tr_b16 a[228:229], v6 offset:64
    ds_read_b64_tr_b16 a[230:231], v6 offset:576
    v_exp_f32 v26, v146
    v_exp_f32 v27, v147
    s_waitcnt lgkmcnt(6)
    v_mfma_f32_32x32x16_bf16 v[128:143], a[240:243], v[48:51], v[128:143]
    ds_read_b64_tr_b16 a[232:233], v6 offset:128
    ds_read_b64_tr_b16 a[234:235], v6 offset:640
    v_cvt_pk_bf16_f32 v185, v26, v27
    v_add_f32 v29, v26, v27
    v_mfma_f32_32x32x16_bf16 v[128:143], a[244:247], v[52:55], v[128:143]
    ds_read_b64_tr_b16 a[236:237], v6 offset:192
    ds_read_b64_tr_b16 a[238:239], v6 offset:704
    s_waitcnt lgkmcnt(8)
    v_mfma_f32_32x32x16_bf16 v[128:143], a[248:251], v[56:59], v[128:143]
    ds_read_b64_tr_b16 a[240:241], v6 offset:8448
    ds_read_b64_tr_b16 a[242:243], v6 offset:8960
    v_exp_f32 v24, v148
    v_exp_f32 v25, v149
    v_mfma_f32_32x32x16_bf16 v[128:143], a[252:255], v[60:63], v[128:143]
    ds_read_b64_tr_b16 a[244:245], v6 offset:8512
    ds_read_b64_tr_b16 a[246:247], v6 offset:9024
    v_add_f32 v28, v28, v24
    v_cvt_pk_bf16_f32 v186, v24, v25
    v_add_f32 v29, v29, v25
    s_waitcnt lgkmcnt(8)
    v_mfma_f32_32x32x16_bf16 v[64:79], a[224:227], v[176:179], v[64:79]
    ds_read_b64_tr_b16 a[248:249], v6 offset:8576
    ds_read_b64_tr_b16 a[250:251], v6 offset:9088
    s_waitcnt vmcnt(24)
    s_barrier
    s_add_u32 m0, s24, 84480
    s_mov_b32 s29, 3145984
    s_mov_b32 s30, 3407104
    v_mfma_f32_32x32x16_bf16 v[80:95], a[228:231], v[176:179], v[80:95]
    ds_read_b64_tr_b16 a[252:253], v6 offset:8640
    ds_read_b64_tr_b16 a[254:255], v6 offset:9152
    buffer_load_dwordx4 v13, s[12:15], s29 offen nt lds
    v_exp_f32 v26, v150
    v_exp_f32 v27, v151
    s_waitcnt lgkmcnt(8)
    v_mfma_f32_32x32x16_bf16 v[96:111], a[232:235], v[176:179], v[96:111]
    ds_read_b64_tr_b16 a[224:225], v3 offset:16896
    ds_read_b64_tr_b16 a[226:227], v3 offset:17408
    v_add_f32 v28, v28, v26
    v_cvt_pk_bf16_f32 v187, v26, v27
    v_add_f32 v29, v29, v27
    v_mfma_f32_32x32x16_bf16 v[112:127], a[236:239], v[176:179], v[112:127]
    ds_read_b64_tr_b16 a[228:229], v3 offset:16960
    ds_read_b64_tr_b16 a[230:231], v3 offset:17472
    buffer_load_dwordx4 v13, s[12:15], s30 offen offset:1024 nt lds
    s_waitcnt lgkmcnt(8)
    v_mfma_f32_32x32x16_bf16 v[64:79], a[240:243], v[180:183], v[64:79]
    ds_read_b64_tr_b16 a[232:233], v3 offset:17024
    ds_read_b64_tr_b16 a[234:235], v3 offset:17536
    v_exp_f32 v24, v152
    v_exp_f32 v25, v153
    v_mfma_f32_32x32x16_bf16 v[80:95], a[244:247], v[180:183], v[80:95]
    ds_read_b64_tr_b16 a[236:237], v3 offset:17088
    ds_read_b64_tr_b16 a[238:239], v3 offset:17600
    buffer_load_dwordx4 v14, s[12:15], s29 offen offset:2112 nt lds
    v_add_f32 v28, v28, v24
    v_cvt_pk_bf16_f32 v188, v24, v25
    v_add_f32 v29, v29, v25
    s_waitcnt lgkmcnt(8)
    v_mfma_f32_32x32x16_bf16 v[96:111], a[248:251], v[180:183], v[96:111]
    ds_read_b64_tr_b16 a[240:241], v3 offset:25344
    ds_read_b64_tr_b16 a[242:243], v3 offset:25856
    v_mfma_f32_32x32x16_bf16 v[112:127], a[252:255], v[180:183], v[112:127]
    ds_read_b64_tr_b16 a[244:245], v3 offset:25408
    ds_read_b64_tr_b16 a[246:247], v3 offset:25920
    buffer_load_dwordx4 v14, s[12:15], s30 offen offset:3136 nt lds
    v_exp_f32 v26, v154
    v_exp_f32 v27, v155
    s_waitcnt lgkmcnt(8)
    v_mfma_f32_32x32x16_bf16 v[192:207], a[224:227], a[48:51], v[192:207]
    ds_read_b64_tr_b16 a[248:249], v3 offset:25472
    ds_read_b64_tr_b16 a[250:251], v3 offset:25984
    v_add_f32 v28, v28, v26
    v_cvt_pk_bf16_f32 v189, v26, v27
    v_add_f32 v29, v29, v27
    v_mfma_f32_32x32x16_bf16 v[208:223], a[228:231], a[48:51], v[208:223]
    ds_read_b64_tr_b16 a[252:253], v3 offset:25536
    ds_read_b64_tr_b16 a[254:255], v3 offset:26048
    s_waitcnt lgkmcnt(8)
    v_mfma_f32_32x32x16_bf16 v[224:239], a[232:235], a[48:51], v[224:239]
    ds_read_b64_tr_b16 a[224:225], v3 offset:17920
    ds_read_b64_tr_b16 a[226:227], v3 offset:18432
    v_exp_f32 v24, v156
    v_exp_f32 v25, v157
    v_mfma_f32_32x32x16_bf16 v[240:255], a[236:239], a[48:51], v[240:255]
    ds_read_b64_tr_b16 a[228:229], v3 offset:17984
    ds_read_b64_tr_b16 a[230:231], v3 offset:18496
    v_add_f32 v28, v28, v24
    v_cvt_pk_bf16_f32 v190, v24, v25
    v_add_f32 v29, v29, v25
    s_waitcnt lgkmcnt(8)
    v_mfma_f32_32x32x16_bf16 v[192:207], a[240:243], a[52:55], v[192:207]
    ds_read_b64_tr_b16 a[232:233], v3 offset:18048
    ds_read_b64_tr_b16 a[234:235], v3 offset:18560
    v_mfma_f32_32x32x16_bf16 v[208:223], a[244:247], a[52:55], v[208:223]
    ds_read_b64_tr_b16 a[236:237], v3 offset:18112
    ds_read_b64_tr_b16 a[238:239], v3 offset:18624
    v_exp_f32 v26, v158
    v_exp_f32 v27, v159
    s_waitcnt lgkmcnt(8)
    v_mfma_f32_32x32x16_bf16 v[224:239], a[248:251], a[52:55], v[224:239]
    ds_read_b64_tr_b16 a[240:241], v3 offset:26368
    ds_read_b64_tr_b16 a[242:243], v3 offset:26880
    v_add_f32 v28, v28, v26
    v_cvt_pk_bf16_f32 v191, v26, v27
    v_add_f32 v29, v29, v27
    v_mfma_f32_32x32x16_bf16 v[240:255], a[252:255], a[52:55], v[240:255]
    ds_read_b64_tr_b16 a[244:245], v3 offset:26432
    ds_read_b64_tr_b16 a[246:247], v3 offset:26944
    v_add_f32 v28, v28, v29
    v_cmp_nge_f32 vcc, s32, v28
    s_cbranch_vccnz L_rs3
L_back3:
    v_add_f32 v22, v22, v28
    s_waitcnt lgkmcnt(8)
    v_mfma_f32_32x32x16_bf16 v[192:207], a[224:227], a[56:59], v[192:207]
    ds_read_b64_tr_b16 a[248:249], v3 offset:26496
    ds_read_b64_tr_b16 a[250:251], v3 offset:27008
    s_waitcnt vmcnt(24)
    s_barrier
    s_add_u32 m0, s24, 101376
    s_mov_b32 s93, 57344
    s_mov_b32 s95, 72704
    v_exp_f32 v24, v128
    v_exp_f32 v25, v129
    v_mfma_f32_32x32x16_bf16 v[208:223], a[228:231], a[56:59], v[208:223]
    ds_read_b64_tr_b16 a[252:253], v3 offset:26560
    ds_read_b64_tr_b16 a[254:255], v3 offset:27072
    buffer_load_dwordx4 v15, s[8:11], s93 offen nt lds
    s_waitcnt lgkmcnt(8)
    v_mfma_f32_32x32x16_bf16 v[224:239], a[232:235], a[56:59], v[224:239]
    ds_read_b128 a[224:227], v9 offset:34816
    v_cvt_pk_bf16_f32 v176, v24, v25
    v_add_f32 v28, v24, v25
    v_mfma_f32_32x32x16_bf16 v[240:255], a[236:239], a[56:59], v[240:255]
    ds_read_b128 a[228:231], v12 offset:34816
    buffer_load_dwordx4 v17, s[4:7], s95 offen offset:1024 nt lds
    s_waitcnt lgkmcnt(6)
    v_mfma_f32_32x32x16_bf16 v[192:207], a[240:243], a[60:63], v[192:207]
    ds_read_b128 a[232:235], v9 offset:34880
    v_exp_f32 v26, v130
    v_exp_f32 v27, v131
    v_mfma_f32_32x32x16_bf16 v[208:223], a[244:247], a[60:63], v[208:223]
    ds_read_b128 a[236:239], v12 offset:34880
    buffer_load_dwordx4 v16, s[8:11], s93 offen offset:2112 nt lds
    s_waitcnt lgkmcnt(4)
    v_mfma_f32_32x32x16_bf16 v[224:239], a[248:251], a[60:63], v[224:239]
    ds_read_b128 a[240:243], v9 offset:34944
    v_cvt_pk_bf16_f32 v177, v26, v27
    v_add_f32 v29, v26, v27
    v_mfma_f32_32x32x16_bf16 v[240:255], a[252:255], a[60:63], v[240:255]
    ds_read_b128 a[244:247], v12 offset:34944
    buffer_load_dwordx4 v18, s[4:7], s95 offen offset:3136 nt lds
    s_waitcnt lgkmcnt(4)
    v_mfma_f32_32x32x16_bf16 v[144:159], a[224:227], v[32:35], v[160:175]
    ds_read_b128 a[248:251], v9 offset:35008
    v_exp_f32 v24, v132
    v_exp_f32 v25, v133
    v_mfma_f32_32x32x16_bf16 v[144:159], a[228:231], v[36:39], v[144:159]
    ds_read_b128 a[252:255], v12 offset:35008
    s_waitcnt lgkmcnt(4)
    v_mfma_f32_32x32x16_bf16 v[144:159], a[232:235], v[40:43], v[144:159]
    ds_read_b64_tr_b16 a[224:225], v6 offset:33792
    ds_read_b64_tr_b16 a[226:227], v6 offset:34304
    v_add_f32 v28, v28, v24
    v_cvt_pk_bf16_f32 v178, v24, v25
    v_add_f32 v29, v29, v25
    v_mfma_f32_32x32x16_bf16 v[144:159], a[236:239], v[44:47], v[144:159]
    ds_read_b64_tr_b16 a[228:229], v6 offset:33856
    ds_read_b64_tr_b16 a[230:231], v6 offset:34368
    s_waitcnt lgkmcnt(6)
    v_mfma_f32_32x32x16_bf16 v[144:159], a[240:243], v[48:51], v[144:159]
    ds_read_b64_tr_b16 a[232:233], v6 offset:33920
    ds_read_b64_tr_b16 a[234:235], v6 offset:34432
    v_exp_f32 v26, v134
    v_exp_f32 v27, v135
    v_mfma_f32_32x32x16_bf16 v[144:159], a[244:247], v[52:55], v[144:159]
    ds_read_b64_tr_b16 a[236:237], v6 offset:33984
    ds_read_b64_tr_b16 a[238:239], v6 offset:34496
    s_waitcnt lgkmcnt(8)
    v_mfma_f32_32x32x16_bf16 v[144:159], a[248:251], v[56:59], v[144:159]
    ds_read_b64_tr_b16 a[240:241], v6 offset:42240
    ds_read_b64_tr_b16 a[242:243], v6 offset:42752
    v_add_f32 v28, v28, v26
    v_cvt_pk_bf16_f32 v179, v26, v27
    v_add_f32 v29, v29, v27
    v_mfma_f32_32x32x16_bf16 v[144:159], a[252:255], v[60:63], v[144:159]
    ds_read_b64_tr_b16 a[244:245], v6 offset:42304
    ds_read_b64_tr_b16 a[246:247], v6 offset:42816
    s_waitcnt lgkmcnt(8)
    v_mfma_f32_32x32x16_bf16 v[64:79], a[224:227], v[184:187], v[64:79]
    ds_read_b64_tr_b16 a[248:249], v6 offset:42368
    ds_read_b64_tr_b16 a[250:251], v6 offset:42880
    s_waitcnt vmcnt(24)
    s_barrier
    s_add_u32 m0, s24, 118272
    s_mov_b32 s29, 3670272
    s_mov_b32 s30, 3931392
    v_exp_f32 v24, v136
    v_exp_f32 v25, v137
    v_mfma_f32_32x32x16_bf16 v[80:95], a[228:231], v[184:187], v[80:95]
    ds_read_b64_tr_b16 a[252:253], v6 offset:42432
    ds_read_b64_tr_b16 a[254:255], v6 offset:42944
    buffer_load_dwordx4 v13, s[12:15], s29 offen nt lds
    s_waitcnt lgkmcnt(8)
    v_mfma_f32_32x32x16_bf16 v[96:111], a[232:235], v[184:187], v[96:111]
    ds_read_b64_tr_b16 a[224:225], v1 offset:0
    ds_read_b64_tr_b16 a[226:227], v1 offset:512
    v_add_f32 v28, v28, v24
    v_cvt_pk_bf16_f32 v180, v24, v25
    v_add_f32 v29, v29, v25
    v_mfma_f32_32x32x16_bf16 v[112:127], a[236:239], v[184:187], v[112:127]
    ds_read_b64_tr_b16 a[228:229], v1 offset:64
    ds_read_b64_tr_b16 a[230:231], v1 offset:576
    buffer_load_dwordx4 v13, s[12:15], s30 offen offset:1024 nt lds
    s_waitcnt lgkmcnt(8)
    v_mfma_f32_32x32x16_bf16 v[64:79], a[240:243], v[188:191], v[64:79]
    ds_read_b64_tr_b16 a[232:233], v1 offset:128
    ds_read_b64_tr_b16 a[234:235], v1 offset:640
    v_exp_f32 v26, v138
    v_exp_f32 v27, v139
    v_mfma_f32_32x32x16_bf16 v[80:95], a[244:247], v[188:191], v[80:95]
    ds_read_b64_tr_b16 a[236:237], v1 offset:192
    ds_read_b64_tr_b16 a[238:239], v1 offset:704
    buffer_load_dwordx4 v14, s[12:15], s29 offen offset:2112 nt lds
    s_waitcnt lgkmcnt(8)
    v_mfma_f32_32x32x16_bf16 v[96:111], a[248:251], v[188:191], v[96:111]
    ds_read_b64_tr_b16 a[240:241], v1 offset:8448
    ds_read_b64_tr_b16 a[242:243], v1 offset:8960
    v_add_f32 v28, v28, v26
    v_cvt_pk_bf16_f32 v181, v26, v27
    v_add_f32 v29, v29, v27
    v_mfma_f32_32x32x16_bf16 v[112:127], a[252:255], v[188:191], v[112:127]
    ds_read_b64_tr_b16 a[244:245], v1 offset:8512
    ds_read_b64_tr_b16 a[246:247], v1 offset:9024
    buffer_load_dwordx4 v14, s[12:15], s30 offen offset:3136 nt lds
    s_waitcnt lgkmcnt(8)
    v_mfma_f32_32x32x16_bf16 v[192:207], a[224:227], a[64:67], v[192:207]
    ds_read_b64_tr_b16 a[248:249], v1 offset:8576
    ds_read_b64_tr_b16 a[250:251], v1 offset:9088
    v_exp_f32 v24, v140
    v_exp_f32 v25, v141
    v_mfma_f32_32x32x16_bf16 v[208:223], a[228:231], a[64:67], v[208:223]
    ds_read_b64_tr_b16 a[252:253], v1 offset:8640
    ds_read_b64_tr_b16 a[254:255], v1 offset:9152
    s_waitcnt lgkmcnt(8)
    v_mfma_f32_32x32x16_bf16 v[224:239], a[232:235], a[64:67], v[224:239]
    ds_read_b64_tr_b16 a[224:225], v1 offset:1024
    ds_read_b64_tr_b16 a[226:227], v1 offset:1536
    v_add_f32 v28, v28, v24
    v_cvt_pk_bf16_f32 v182, v24, v25
    v_add_f32 v29, v29, v25
    v_mfma_f32_32x32x16_bf16 v[240:255], a[236:239], a[64:67], v[240:255]
    ds_read_b64_tr_b16 a[228:229], v1 offset:1088
    ds_read_b64_tr_b16 a[230:231], v1 offset:1600
    s_waitcnt lgkmcnt(8)
    v_mfma_f32_32x32x16_bf16 v[192:207], a[240:243], a[68:71], v[192:207]
    ds_read_b64_tr_b16 a[232:233], v1 offset:1152
    ds_read_b64_tr_b16 a[234:235], v1 offset:1664
    v_exp_f32 v26, v142
    v_exp_f32 v27, v143
    v_mfma_f32_32x32x16_bf16 v[208:223], a[244:247], a[68:71], v[208:223]
    ds_read_b64_tr_b16 a[236:237], v1 offset:1216
    ds_read_b64_tr_b16 a[238:239], v1 offset:1728
    s_waitcnt lgkmcnt(8)
    v_mfma_f32_32x32x16_bf16 v[224:239], a[248:251], a[68:71], v[224:239]
    ds_read_b64_tr_b16 a[240:241], v1 offset:9472
    ds_read_b64_tr_b16 a[242:243], v1 offset:9984
    v_add_f32 v28, v28, v26
    v_cvt_pk_bf16_f32 v183, v26, v27
    v_add_f32 v29, v29, v27
    v_mfma_f32_32x32x16_bf16 v[240:255], a[252:255], a[68:71], v[240:255]
    ds_read_b64_tr_b16 a[244:245], v1 offset:9536
    ds_read_b64_tr_b16 a[246:247], v1 offset:10048
    v_add_f32 v28, v28, v29
    v_cmp_nge_f32 vcc, s32, v28
    s_cbranch_vccnz L_rs4
L_back4:
    v_add_f32 v22, v22, v28
    s_waitcnt lgkmcnt(8)
    v_mfma_f32_32x32x16_bf16 v[192:207], a[224:227], a[72:75], v[192:207]
    ds_read_b64_tr_b16 a[248:249], v1 offset:9600
    ds_read_b64_tr_b16 a[250:251], v1 offset:10112
    s_waitcnt vmcnt(24)
    s_barrier
    s_add_u32 m0, s24, 135168
    s_mov_b32 s93, 65536
    s_mov_b32 s95, 80896
    v_exp_f32 v24, v144
    v_exp_f32 v25, v145
    v_mfma_f32_32x32x16_bf16 v[208:223], a[228:231], a[72:75], v[208:223]
    ds_read_b64_tr_b16 a[252:253], v1 offset:9664
    ds_read_b64_tr_b16 a[254:255], v1 offset:10176
    buffer_load_dwordx4 v15, s[8:11], s93 offen nt lds
    v_cvt_pk_bf16_f32 v184, v24, v25
    v_add_f32 v28, v24, v25
    s_waitcnt lgkmcnt(8)
    v_mfma_f32_32x32x16_bf16 v[224:239], a[232:235], a[72:75], v[224:239]
    ds_read_b128 a[224:227], v7 offset:17920
    v_mfma_f32_32x32x16_bf16 v[240:255], a[236:239], a[72:75], v[240:255]
    ds_read_b128 a[228:231], v10 offset:17920
    buffer_load_dwordx4 v17, s[4:7], s95 offen offset:1024 nt lds
    v_exp_f32 v26, v146
    v_exp_f32 v27, v147
    s_waitcnt lgkmcnt(6)
    v_mfma_f32_32x32x16_bf16 v[192:207], a[240:243], a[76:79], v[192:207]
    ds_read_b128 a[232:235], v7 offset:17984
    v_cvt_pk_bf16_f32 v185, v26, v27
    v_add_f32 v29, v26, v27
    v_mfma_f32_32x32x16_bf16 v[208:223], a[244:247], a[76:79], v[208:223]
    ds_read_b128 a[236:239], v10 offset:17984
    buffer_load_dwordx4 v16, s[8:11], s93 offen offset:2112 nt lds
    s_waitcnt lgkmcnt(4)
    v_mfma_f32_32x32x16_bf16 v[224:239], a[248:251], a[76:79], v[224:239]
    ds_read_b128 a[240:243], v7 offset:18048
    v_exp_f32 v24, v148
    v_exp_f32 v25, v149
    v_mfma_f32_32x32x16_bf16 v[240:255], a[252:255], a[76:79], v[240:255]
    ds_read_b128 a[244:247], v10 offset:18048
    buffer_load_dwordx4 v18, s[4:7], s95 offen offset:3136 nt lds
    v_add_f32 v28, v28, v24
    v_cvt_pk_bf16_f32 v186, v24, v25
    v_add_f32 v29, v29, v25
    s_waitcnt lgkmcnt(4)
    v_mfma_f32_32x32x16_bf16 v[128:143], a[224:227], v[32:35], v[160:175]
    ds_read_b128 a[248:251], v7 offset:18112
    v_mfma_f32_32x32x16_bf16 v[128:143], a[228:231], v[36:39], v[128:143]
    ds_read_b128 a[252:255], v10 offset:18112
    v_exp_f32 v26, v150
    v_exp_f32 v27, v151
    s_waitcnt lgkmcnt(4)
    v_mfma_f32_32x32x16_bf16 v[128:143], a[232:235], v[40:43], v[128:143]
    ds_read_b64_tr_b16 a[224:225], v4 offset:16896
    ds_read_b64_tr_b16 a[226:227], v4 offset:17408
    v_add_f32 v28, v28, v26
    v_cvt_pk_bf16_f32 v187, v26, v27
    v_add_f32 v29, v29, v27
    v_mfma_f32_32x32x16_bf16 v[128:143], a[236:239], v[44:47], v[128:143]
    ds_read_b64_tr_b16 a[228:229], v4 offset:16960
    ds_read_b64_tr_b16 a[230:231], v4 offset:17472
    s_waitcnt lgkmcnt(6)
    v_mfma_f32_32x32x16_bf16 v[128:143], a[240:243], v[48:51], v[128:143]
    ds_read_b64_tr_b16 a[232:233], v4 offset:17024
    ds_read_b64_tr_b16 a[234:235], v4 offset:17536
    v_exp_f32 v24, v152
    v_exp_f32 v25, v153
    v_mfma_f32_32x32x16_bf16 v[128:143], a[244:247], v[52:55], v[128:143]
    ds_read_b64_tr_b16 a[236:237], v4 offset:17088
    ds_read_b64_tr_b16 a[238:239], v4 offset:17600
    v_add_f32 v28, v28, v24
    v_cvt_pk_bf16_f32 v188, v24, v25
    v_add_f32 v29, v29, v25
    s_waitcnt lgkmcnt(8)
    v_mfma_f32_32x32x16_bf16 v[128:143], a[248:251], v[56:59], v[128:143]
    ds_read_b64_tr_b16 a[240:241], v4 offset:25344
    ds_read_b64_tr_b16 a[242:243], v4 offset:25856
    v_mfma_f32_32x32x16_bf16 v[128:143], a[252:255], v[60:63], v[128:143]
    ds_read_b64_tr_b16 a[244:245], v4 offset:25408
    ds_read_b64_tr_b16 a[246:247], v4 offset:25920
    v_exp_f32 v26, v154
    v_exp_f32 v27, v155
    s_waitcnt lgkmcnt(8)
    v_mfma_f32_32x32x16_bf16 v[64:79], a[224:227], v[176:179], v[64:79]
    ds_read_b64_tr_b16 a[248:249], v4 offset:25472
    ds_read_b64_tr_b16 a[250:251], v4 offset:25984
    s_waitcnt vmcnt(24)
    s_barrier
    s_add_u32 m0, s24, 0
    s_mov_b32 s93, 73728
    s_mov_b32 s95, 89088
    v_add_f32 v28, v28, v26
    v_cvt_pk_bf16_f32 v189, v26, v27
    v_add_f32 v29, v29, v27
    v_mfma_f32_32x32x16_bf16 v[80:95], a[228:231], v[176:179], v[80:95]
    ds_read_b64_tr_b16 a[252:253], v4 offset:25536
    ds_read_b64_tr_b16 a[254:255], v4 offset:26048
    buffer_load_dwordx4 v15, s[8:11], s93 offen nt lds
    s_waitcnt lgkmcnt(8)
    v_mfma_f32_32x32x16_bf16 v[96:111], a[232:235], v[176:179], v[96:111]
    ds_read_b128 a[224:227], v7 offset:34816
    v_exp_f32 v24, v156
    v_exp_f32 v25, v157
    v_mfma_f32_32x32x16_bf16 v[112:127], a[236:239], v[176:179], v[112:127]
    ds_read_b128 a[228:231], v10 offset:34816
    buffer_load_dwordx4 v17, s[4:7], s95 offen offset:1024 nt lds
    v_add_f32 v28, v28, v24
    v_cvt_pk_bf16_f32 v190, v24, v25
    v_add_f32 v29, v29, v25
    s_waitcnt lgkmcnt(6)
    v_mfma_f32_32x32x16_bf16 v[64:79], a[240:243], v[180:183], v[64:79]
    ds_read_b128 a[232:235], v7 offset:34880
    v_mfma_f32_32x32x16_bf16 v[80:95], a[244:247], v[180:183], v[80:95]
    ds_read_b128 a[236:239], v10 offset:34880
    buffer_load_dwordx4 v16, s[8:11], s93 offen offset:2112 nt lds
    v_exp_f32 v26, v158
    v_exp_f32 v27, v159
    s_waitcnt lgkmcnt(4)
    v_mfma_f32_32x32x16_bf16 v[96:111], a[248:251], v[180:183], v[96:111]
    ds_read_b128 a[240:243], v7 offset:34944
    v_add_f32 v28, v28, v26
    v_cvt_pk_bf16_f32 v191, v26, v27
    v_add_f32 v29, v29, v27
    v_mfma_f32_32x32x16_bf16 v[112:127], a[252:255], v[180:183], v[112:127]
    ds_read_b128 a[244:247], v10 offset:34944
    buffer_load_dwordx4 v18, s[4:7], s95 offen offset:3136 nt lds
    v_add_f32 v28, v28, v29
    v_cmp_nge_f32 vcc, s32, v28
    s_cbranch_vccnz L_rs5
L_back5:
    v_add_f32 v22, v22, v28
    s_waitcnt lgkmcnt(4)
    v_mfma_f32_32x32x16_bf16 v[144:159], a[224:227], v[32:35], v[160:175]
    ds_read_b128 a[248:251], v7 offset:35008
    v_exp_f32 v24, v128
    v_exp_f32 v25, v129
    v_mfma_f32_32x32x16_bf16 v[144:159], a[228:231], v[36:39], v[144:159]
    ds_read_b128 a[252:255], v10 offset:35008
    v_cvt_pk_bf16_f32 v176, v24, v25
    v_add_f32 v28, v24, v25
    s_waitcnt lgkmcnt(4)
    v_mfma_f32_32x32x16_bf16 v[144:159], a[232:235], v[40:43], v[144:159]
    ds_read_b64_tr_b16 a[224:225], v4 offset:33792
    ds_read_b64_tr_b16 a[226:227], v4 offset:34304
    v_mfma_f32_32x32x16_bf16 v[144:159], a[236:239], v[44:47], v[144:159]
    ds_read_b64_tr_b16 a[228:229], v4 offset:33856
    ds_read_b64_tr_b16 a[230:231], v4 offset:34368
    v_exp_f32 v26, v130
    v_exp_f32 v27, v131
    s_waitcnt lgkmcnt(6)
    v_mfma_f32_32x32x16_bf16 v[144:159], a[240:243], v[48:51], v[144:159]
    ds_read_b64_tr_b16 a[232:233], v4 offset:33920
    ds_read_b64_tr_b16 a[234:235], v4 offset:34432
    v_cvt_pk_bf16_f32 v177, v26, v27
    v_add_f32 v29, v26, v27
    v_mfma_f32_32x32x16_bf16 v[144:159], a[244:247], v[52:55], v[144:159]
    ds_read_b64_tr_b16 a[236:237], v4 offset:33984
    ds_read_b64_tr_b16 a[238:239], v4 offset:34496
    s_waitcnt lgkmcnt(8)
    v_mfma_f32_32x32x16_bf16 v[144:159], a[248:251], v[56:59], v[144:159]
    ds_read_b64_tr_b16 a[240:241], v4 offset:42240
    ds_read_b64_tr_b16 a[242:243], v4 offset:42752
    v_exp_f32 v24, v132
    v_exp_f32 v25, v133
    v_mfma_f32_32x32x16_bf16 v[144:159], a[252:255], v[60:63], v[144:159]
    ds_read_b64_tr_b16 a[244:245], v4 offset:42304
    ds_read_b64_tr_b16 a[246:247], v4 offset:42816
    v_add_f32 v28, v28, v24
    v_cvt_pk_bf16_f32 v178, v24, v25
    v_add_f32 v29, v29, v25
    s_waitcnt lgkmcnt(8)
    v_mfma_f32_32x32x16_bf16 v[64:79], a[224:227], v[184:187], v[64:79]
    ds_read_b64_tr_b16 a[248:249], v4 offset:42368
    ds_read_b64_tr_b16 a[250:251], v4 offset:42880
    s_waitcnt vmcnt(24)
    s_barrier
    s_add_u32 m0, s24, 16896
    s_mov_b32 s29, 4194560
    s_mov_b32 s30, 4455680
    v_mfma_f32_32x32x16_bf16 v[80:95], a[228:231], v[184:187], v[80:95]
    ds_read_b64_tr_b16 a[252:253], v4 offset:42432
    ds_read_b64_tr_b16 a[254:255], v4 offset:42944
    buffer_load_dwordx4 v13, s[12:15], s29 offen nt lds
    v_exp_f32 v26, v134
    v_exp_f32 v27, v135
    s_waitcnt lgkmcnt(8)
    v_mfma_f32_32x32x16_bf16 v[96:111], a[232:235], v[184:187], v[96:111]
    ds_read_b64_tr_b16 a[224:225], v2 offset:0
    ds_read_b64_tr_b16 a[226:227], v2 offset:512
    v_add_f32 v28, v28, v26
    v_cvt_pk_bf16_f32 v179, v26, v27
    v_add_f32 v29, v29, v27
    v_mfma_f32_32x32x16_bf16 v[112:127], a[236:239], v[184:187], v[112:127]
    ds_read_b64_tr_b16 a[228:229], v2 offset:64
    ds_read_b64_tr_b16 a[230:231], v2 offset:576
    buffer_load_dwordx4 v13, s[12:15], s30 offen offset:1024 nt lds
    s_waitcnt lgkmcnt(8)
    v_mfma_f32_32x32x16_bf16 v[64:79], a[240:243], v[188:191], v[64:79]
    ds_read_b64_tr_b16 a[232:233], v2 offset:128
    ds_read_b64_tr_b16 a[234:235], v2 offset:640
    v_exp_f32 v24, v136
    v_exp_f32 v25, v137
    v_mfma_f32_32x32x16_bf16 v[80:95], a[244:247], v[188:191], v[80:95]
    ds_read_b64_tr_b16 a[236:237], v2 offset:192
    ds_read_b64_tr_b16 a[238:239], v2 offset:704
    buffer_load_dwordx4 v14, s[12:15], s29 offen offset:2112 nt lds
    v_add_f32 v28, v28, v24
    v_cvt_pk_bf16_f32 v180, v24, v25
    v_add_f32 v29, v29, v25
    s_waitcnt lgkmcnt(8)
    v_mfma_f32_32x32x16_bf16 v[96:111], a[248:251], v[188:191], v[96:111]
    ds_read_b64_tr_b16 a[240:241], v2 offset:8448
    ds_read_b64_tr_b16 a[242:243], v2 offset:8960
    v_mfma_f32_32x32x16_bf16 v[112:127], a[252:255], v[188:191], v[112:127]
    ds_read_b64_tr_b16 a[244:245], v2 offset:8512
    ds_read_b64_tr_b16 a[246:247], v2 offset:9024
    buffer_load_dwordx4 v14, s[12:15], s30 offen offset:3136 nt lds
    v_exp_f32 v26, v138
    v_exp_f32 v27, v139
    s_waitcnt lgkmcnt(8)
    v_mfma_f32_32x32x16_bf16 v[192:207], a[224:227], a[80:83], v[192:207]
    ds_read_b64_tr_b16 a[248:249], v2 offset:8576
    ds_read_b64_tr_b16 a[250:251], v2 offset:9088
    v_add_f32 v28, v28, v26
    v_cvt_pk_bf16_f32 v181, v26, v27
    v_add_f32 v29, v29, v27
    v_mfma_f32_32x32x16_bf16 v[208:223], a[228:231], a[80:83], v[208:223]
    ds_read_b64_tr_b16 a[252:253], v2 offset:8640
    ds_read_b64_tr_b16 a[254:255], v2 offset:9152
    s_waitcnt lgkmcnt(8)
    v_mfma_f32_32x32x16_bf16 v[224:239], a[232:235], a[80:83], v[224:239]
    ds_read_b64_tr_b16 a[224:225], v2 offset:1024
    ds_read_b64_tr_b16 a[226:227], v2 offset:1536
    v_exp_f32 v24, v140
    v_exp_f32 v25, v141
    v_mfma_f32_32x32x16_bf16 v[240:255], a[236:239], a[80:83], v[240:255]
    ds_read_b64_tr_b16 a[228:229], v2 offset:1088
    ds_read_b64_tr_b16 a[230:231], v2 offset:1600
    v_add_f32 v28, v28, v24
    v_cvt_pk_bf16_f32 v182, v24, v25
    v_add_f32 v29, v29, v25
    s_waitcnt lgkmcnt(8)
    v_mfma_f32_32x32x16_bf16 v[192:207], a[240:243], a[84:87], v[192:207]
    ds_read_b64_tr_b16 a[232:233], v2 offset:1152
    ds_read_b64_tr_b16 a[234:235], v2 offset:1664
    v_mfma_f32_32x32x16_bf16 v[208:223], a[244:247], a[84:87], v[208:223]
    ds_read_b64_tr_b16 a[236:237], v2 offset:1216
    ds_read_b64_tr_b16 a[238:239], v2 offset:1728
    v_exp_f32 v26, v142
    v_exp_f32 v27, v143
    s_waitcnt lgkmcnt(8)
    v_mfma_f32_32x32x16_bf16 v[224:239], a[248:251], a[84:87], v[224:239]
    ds_read_b64_tr_b16 a[240:241], v2 offset:9472
    ds_read_b64_tr_b16 a[242:243], v2 offset:9984
    v_add_f32 v28, v28, v26
    v_cvt_pk_bf16_f32 v183, v26, v27
    v_add_f32 v29, v29, v27
    v_mfma_f32_32x32x16_bf16 v[240:255], a[252:255], a[84:87], v[240:255]
    ds_read_b64_tr_b16 a[244:245], v2 offset:9536
    ds_read_b64_tr_b16 a[246:247], v2 offset:10048
    v_add_f32 v28, v28, v29
    v_cmp_nge_f32 vcc, s32, v28
    s_cbranch_vccnz L_rs6
L_back6:
    v_add_f32 v22, v22, v28
    s_waitcnt lgkmcnt(8)
    v_mfma_f32_32x32x16_bf16 v[192:207], a[224:227], a[88:91], v[192:207]
    ds_read_b64_tr_b16 a[248:249], v2 offset:9600
    ds_read_b64_tr_b16 a[250:251], v2 offset:10112
    s_waitcnt vmcnt(24)
    s_barrier
    s_add_u32 m0, s24, 33792
    s_mov_b32 s93, 81920
    s_mov_b32 s95, 97280
    v_exp_f32 v24, v144
    v_exp_f32 v25, v145
    v_mfma_f32_32x32x16_bf16 v[208:223], a[228:231], a[88:91], v[208:223]
    ds_read_b64_tr_b16 a[252:253], v2 offset:9664
    ds_read_b64_tr_b16 a[254:255], v2 offset:10176
    buffer_load_dwordx4 v15, s[8:11], s93 offen nt lds
    s_waitcnt lgkmcnt(8)
    v_mfma_f32_32x32x16_bf16 v[224:239], a[232:235], a[88:91], v[224:239]
    ds_read_b128 a[224:227], v8 offset:17920
    v_cvt_pk_bf16_f32 v184, v24, v25
    v_add_f32 v28, v24, v25
    v_mfma_f32_32x32x16_bf16 v[240:255], a[236:239], a[88:91], v[240:255]
    ds_read_b128 a[228:231], v11 offset:17920
    buffer_load_dwordx4 v17, s[4:7], s95 offen offset:1024 nt lds
    s_waitcnt lgkmcnt(6)
    v_mfma_f32_32x32x16_bf16 v[192:207], a[240:243], a[92:95], v[192:207]
    ds_read_b128 a[232:235], v8 offset:17984
    v_exp_f32 v26, v146
    v_exp_f32 v27, v147
    v_mfma_f32_32x32x16_bf16 v[208:223], a[244:247], a[92:95], v[208:223]
    ds_read_b128 a[236:239], v11 offset:17984
    buffer_load_dwordx4 v16, s[8:11], s93 offen offset:2112 nt lds
    s_waitcnt lgkmcnt(4)
    v_mfma_f32_32x32x16_bf16 v[224:239], a[248:251], a[92:95], v[224:239]
    ds_read_b128 a[240:243], v8 offset:18048
    v_cvt_pk_bf16_f32 v185, v26, v27
    v_add_f32 v29, v26, v27
    v_mfma_f32_32x32x16_bf16 v[240:255], a[252:255], a[92:95], v[240:255]
    ds_read_b128 a[244:247], v11 offset:18048
    buffer_load_dwordx4 v18, s[4:7], s95 offen offset:3136 nt lds
    s_waitcnt lgkmcnt(4)
    v_mfma_f32_32x32x16_bf16 v[128:143], a[224:227], v[32:35], v[160:175]
    ds_read_b128 a[248:251], v8 offset:18112
    v_exp_f32 v24, v148
    v_exp_f32 v25, v149
    v_mfma_f32_32x32x16_bf16 v[128:143], a[228:231], v[36:39], v[128:143]
    ds_read_b128 a[252:255], v11 offset:18112
    s_waitcnt lgkmcnt(4)
    v_mfma_f32_32x32x16_bf16 v[128:143], a[232:235], v[40:43], v[128:143]
    ds_read_b64_tr_b16 a[224:225], v5 offset:16896
    ds_read_b64_tr_b16 a[226:227], v5 offset:17408
    v_add_f32 v28, v28, v24
    v_cvt_pk_bf16_f32 v186, v24, v25
    v_add_f32 v29, v29, v25
    v_mfma_f32_32x32x16_bf16 v[128:143], a[236:239], v[44:47], v[128:143]
    ds_read_b64_tr_b16 a[228:229], v5 offset:16960
    ds_read_b64_tr_b16 a[230:231], v5 offset:17472
    s_waitcnt lgkmcnt(6)
    v_mfma_f32_32x32x16_bf16 v[128:143], a[240:243], v[48:51], v[128:143]
    ds_read_b64_tr_b16 a[232:233], v5 offset:17024
    ds_read_b64_tr_b16 a[234:235], v5 offset:17536
    v_exp_f32 v26, v150
    v_exp_f32 v27, v151
    v_mfma_f32_32x32x16_bf16 v[128:143], a[244:247], v[52:55], v[128:143]
    ds_read_b64_tr_b16 a[236:237], v5 offset:17088
    ds_read_b64_tr_b16 a[238:239], v5 offset:17600
    s_waitcnt lgkmcnt(8)
    v_mfma_f32_32x32x16_bf16 v[128:143], a[248:251], v[56:59], v[128:143]
    ds_read_b64_tr_b16 a[240:241], v5 offset:25344
    ds_read_b64_tr_b16 a[242:243], v5 offset:25856
    v_add_f32 v28, v28, v26
    v_cvt_pk_bf16_f32 v187, v26, v27
    v_add_f32 v29, v29, v27
    v_mfma_f32_32x32x16_bf16 v[128:143], a[252:255], v[60:63], v[128:143]
    ds_read_b64_tr_b16 a[244:245], v5 offset:25408
    ds_read_b64_tr_b16 a[246:247], v5 offset:25920
    s_waitcnt lgkmcnt(8)
    v_mfma_f32_32x32x16_bf16 v[64:79], a[224:227], v[176:179], v[64:79]
    ds_read_b64_tr_b16 a[248:249], v5 offset:25472
    ds_read_b64_tr_b16 a[250:251], v5 offset:25984
    s_waitcnt vmcnt(24)
    s_barrier
    s_add_u32 m0, s24, 50688
    s_mov_b32 s29, 4718848
    s_mov_b32 s30, 4979968
    v_exp_f32 v24, v152
    v_exp_f32 v25, v153
    v_mfma_f32_32x32x16_bf16 v[80:95], a[228:231], v[176:179], v[80:95]
    ds_read_b64_tr_b16 a[252:253], v5 offset:25536
    ds_read_b64_tr_b16 a[254:255], v5 offset:26048
    buffer_load_dwordx4 v13, s[12:15], s29 offen nt lds
    s_waitcnt lgkmcnt(8)
    v_mfma_f32_32x32x16_bf16 v[96:111], a[232:235], v[176:179], v[96:111]
    ds_read_b64_tr_b16 a[224:225], v2 offset:33792
    ds_read_b64_tr_b16 a[226:227], v2 offset:34304
    v_add_f32 v28, v28, v24
    v_cvt_pk_bf16_f32 v188, v24, v25
    v_add_f32 v29, v29, v25
    v_mfma_f32_32x32x16_bf16 v[112:127], a[236:239], v[176:179], v[112:127]
    ds_read_b64_tr_b16 a[228:229], v2 offset:33856
    ds_read_b64_tr_b16 a[230:231], v2 offset:34368
    buffer_load_dwordx4 v13, s[12:15], s30 offen offset:1024 nt lds
    s_waitcnt lgkmcnt(8)
    v_mfma_f32_32x32x16_bf16 v[64:79], a[240:243], v[180:183], v[64:79]
    ds_read_b64_tr_b16 a[232:233], v2 offset:33920
    ds_read_b64_tr_b16 a[234:235], v2 offset:34432
    v_exp_f32 v26, v154
    v_exp_f32 v27, v155
    v_mfma_f32_32x32x16_bf16 v[80:95], a[244:247], v[180:183], v[80:95]
    ds_read_b64_tr_b16 a[236:237], v2 offset:33984
    ds_read_b64_tr_b16 a[238:239], v2 offset:34496
    buffer_load_dwordx4 v14, s[12:15], s29 offen offset:2112 nt lds
    s_waitcnt lgkmcnt(8)
    v_mfma_f32_32x32x16_bf16 v[96:111], a[248:251], v[180:183], v[96:111]
    ds_read_b64_tr_b16 a[240:241], v2 offset:42240
    ds_read_b64_tr_b16 a[242:243], v2 offset:42752
    v_add_f32 v28, v28, v26
    v_cvt_pk_bf16_f32 v189, v26, v27
    v_add_f32 v29, v29, v27
    v_mfma_f32_32x32x16_bf16 v[112:127], a[252:255], v[180:183], v[112:127]
    ds_read_b64_tr_b16 a[244:245], v2 offset:42304
    ds_read_b64_tr_b16 a[246:247], v2 offset:42816
    buffer_load_dwordx4 v14, s[12:15], s30 offen offset:3136 nt lds
    s_waitcnt lgkmcnt(8)
    v_mfma_f32_32x32x16_bf16 v[192:207], a[224:227], a[96:99], v[192:207]
    ds_read_b64_tr_b16 a[248:249], v2 offset:42368
    ds_read_b64_tr_b16 a[250:251], v2 offset:42880
    v_exp_f32 v24, v156
    v_exp_f32 v25, v157
    v_mfma_f32_32x32x16_bf16 v[208:223], a[228:231], a[96:99], v[208:223]
    ds_read_b64_tr_b16 a[252:253], v2 offset:42432
    ds_read_b64_tr_b16 a[254:255], v2 offset:42944
    s_waitcnt lgkmcnt(8)
    v_mfma_f32_32x32x16_bf16 v[224:239], a[232:235], a[96:99], v[224:239]
    ds_read_b64_tr_b16 a[224:225], v2 offset:34816
    ds_read_b64_tr_b16 a[226:227], v2 offset:35328
    v_add_f32 v28, v28, v24
    v_cvt_pk_bf16_f32 v190, v24, v25
    v_add_f32 v29, v29, v25
    v_mfma_f32_32x32x16_bf16 v[240:255], a[236:239], a[96:99], v[240:255]
    ds_read_b64_tr_b16 a[228:229], v2 offset:34880
    ds_read_b64_tr_b16 a[230:231], v2 offset:35392
    s_waitcnt lgkmcnt(8)
    v_mfma_f32_32x32x16_bf16 v[192:207], a[240:243], a[100:103], v[192:207]
    ds_read_b64_tr_b16 a[232:233], v2 offset:34944
    ds_read_b64_tr_b16 a[234:235], v2 offset:35456
    v_exp_f32 v26, v158
    v_exp_f32 v27, v159
    v_mfma_f32_32x32x16_bf16 v[208:223], a[244:247], a[100:103], v[208:223]
    ds_read_b64_tr_b16 a[236:237], v2 offset:35008
    ds_read_b64_tr_b16 a[238:239], v2 offset:35520
    s_waitcnt lgkmcnt(8)
    v_mfma_f32_32x32x16_bf16 v[224:239], a[248:251], a[100:103], v[224:239]
    ds_read_b64_tr_b16 a[240:241], v2 offset:43264
    ds_read_b64_tr_b16 a[242:243], v2 offset:43776
    v_add_f32 v28, v28, v26
    v_cvt_pk_bf16_f32 v191, v26, v27
    v_add_f32 v29, v29, v27
    v_mfma_f32_32x32x16_bf16 v[240:255], a[252:255], a[100:103], v[240:255]
    ds_read_b64_tr_b16 a[244:245], v2 offset:43328
    ds_read_b64_tr_b16 a[246:247], v2 offset:43840
    v_add_f32 v28, v28, v29
    v_cmp_nge_f32 vcc, s32, v28
    s_cbranch_vccnz L_rs7
L_back7:
    v_add_f32 v22, v22, v28
    s_waitcnt lgkmcnt(8)
    v_mfma_f32_32x32x16_bf16 v[192:207], a[224:227], a[104:107], v[192:207]
    ds_read_b64_tr_b16 a[248:249], v2 offset:43392
    ds_read_b64_tr_b16 a[250:251], v2 offset:43904
    s_waitcnt vmcnt(24)
    s_barrier
    s_add_u32 m0, s24, 67584
    s_mov_b32 s93, 90112
    s_mov_b32 s95, 105472
    v_exp_f32 v24, v128
    v_exp_f32 v25, v129
    v_mfma_f32_32x32x16_bf16 v[208:223], a[228:231], a[104:107], v[208:223]
    ds_read_b64_tr_b16 a[252:253], v2 offset:43456
    ds_read_b64_tr_b16 a[254:255], v2 offset:43968
    buffer_load_dwordx4 v15, s[8:11], s93 offen nt lds
    s_waitcnt lgkmcnt(8)
    v_mfma_f32_32x32x16_bf16 v[224:239], a[232:235], a[104:107], v[224:239]
    ds_read_b128 a[224:227], v9 offset:1024
    v_cvt_pk_bf16_f32 v176, v24, v25
    v_add_f32 v28, v24, v25
    v_mfma_f32_32x32x16_bf16 v[240:255], a[236:239], a[104:107], v[240:255]
    ds_read_b128 a[228:231], v12 offset:1024
    buffer_load_dwordx4 v17, s[4:7], s95 offen offset:1024 nt lds
    s_waitcnt lgkmcnt(6)
    v_mfma_f32_32x32x16_bf16 v[192:207], a[240:243], a[108:111], v[192:207]
    ds_read_b128 a[232:235], v9 offset:1088
    v_exp_f32 v26, v130
    v_exp_f32 v27, v131
    v_mfma_f32_32x32x16_bf16 v[208:223], a[244:247], a[108:111], v[208:223]
    ds_read_b128 a[236:239], v12 offset:1088
    buffer_load_dwordx4 v16, s[8:11], s93 offen offset:2112 nt lds
    s_waitcnt lgkmcnt(4)
    v_mfma_f32_32x32x16_bf16 v[224:239], a[248:251], a[108:111], v[224:239]
    ds_read_b128 a[240:243], v9 offset:1152
    v_cvt_pk_bf16_f32 v177, v26, v27
    v_add_f32 v29, v26, v27
    v_mfma_f32_32x32x16_bf16 v[240:255], a[252:255], a[108:111], v[240:255]
    ds_read_b128 a[244:247], v12 offset:1152
    buffer_load_dwordx4 v18, s[4:7], s95 offen offset:3136 nt lds
    s_waitcnt lgkmcnt(4)
    v_mfma_f32_32x32x16_bf16 v[144:159], a[224:227], v[32:35], v[160:175]
    ds_read_b128 a[248:251], v9 offset:1216
    v_exp_f32 v24, v132
    v_exp_f32 v25, v133
    v_mfma_f32_32x32x16_bf16 v[144:159], a[228:231], v[36:39], v[144:159]
    ds_read_b128 a[252:255], v12 offset:1216
    s_waitcnt lgkmcnt(4)
    v_mfma_f32_32x32x16_bf16 v[144:159], a[232:235], v[40:43], v[144:159]
    ds_read_b64_tr_b16 a[224:225], v6 offset:0
    ds_read_b64_tr_b16 a[226:227], v6 offset:512
    v_add_f32 v28, v28, v24
    v_cvt_pk_bf16_f32 v178, v24, v25
    v_add_f32 v29, v29, v25
    v_mfma_f32_32x32x16_bf16 v[144:159], a[236:239], v[44:47], v[144:159]
    ds_read_b64_tr_b16 a[228:229], v6 offset:64
    ds_read_b64_tr_b16 a[230:231], v6 offset:576
    s_waitcnt lgkmcnt(6)
    v_mfma_f32_32x32x16_bf16 v[144:159], a[240:243], v[48:51], v[144:159]
    ds_read_b64_tr_b16 a[232:233], v6 offset:128
    ds_read_b64_tr_b16 a[234:235], v6 offset:640
    v_exp_f32 v26, v134
    v_exp_f32 v27, v135
    v_mfma_f32_32x32x16_bf16 v[144:159], a[244:247], v[52:55], v[144:159]
    ds_read_b64_tr_b16 a[236:237], v6 offset:192
    ds_read_b64_tr_b16 a[238:239], v6 offset:704
    s_waitcnt lgkmcnt(8)
    v_mfma_f32_32x32x16_bf16 v[144:159], a[248:251], v[56:59], v[144:159]
    ds_read_b64_tr_b16 a[240:241], v6 offset:8448
    ds_read_b64_tr_b16 a[242:243], v6 offset:8960
    v_add_f32 v28, v28, v26
    v_cvt_pk_bf16_f32 v179, v26, v27
    v_add_f32 v29, v29, v27
    v_mfma_f32_32x32x16_bf16 v[144:159], a[252:255], v[60:63], v[144:159]
    ds_read_b64_tr_b16 a[244:245], v6 offset:8512
    ds_read_b64_tr_b16 a[246:247], v6 offset:9024
    s_waitcnt lgkmcnt(8)
    v_mfma_f32_32x32x16_bf16 v[64:79], a[224:227], v[184:187], v[64:79]
    ds_read_b64_tr_b16 a[248:249], v6 offset:8576
    ds_read_b64_tr_b16 a[250:251], v6 offset:9088
    s_waitcnt vmcnt(24)
    s_barrier
    s_add_u32 m0, s24, 84480
    s_mov_b32 s93, 98304
    s_mov_b32 s95, 113664
    v_exp_f32 v24, v136
    v_exp_f32 v25, v137
    v_mfma_f32_32x32x16_bf16 v[80:95], a[228:231], v[184:187], v[80:95]
    ds_read_b64_tr_b16 a[252:253], v6 offset:8640
    ds_read_b64_tr_b16 a[254:255], v6 offset:9152
    buffer_load_dwordx4 v15, s[8:11], s93 offen nt lds
    s_waitcnt lgkmcnt(8)
    v_mfma_f32_32x32x16_bf16 v[96:111], a[232:235], v[184:187], v[96:111]
    ds_read_b64_tr_b16 a[224:225], v3 offset:16896
    ds_read_b64_tr_b16 a[226:227], v3 offset:17408
    v_add_f32 v28, v28, v24
    v_cvt_pk_bf16_f32 v180, v24, v25
    v_add_f32 v29, v29, v25
    v_mfma_f32_32x32x16_bf16 v[112:127], a[236:239], v[184:187], v[112:127]
    ds_read_b64_tr_b16 a[228:229], v3 offset:16960
    ds_read_b64_tr_b16 a[230:231], v3 offset:17472
    buffer_load_dwordx4 v17, s[4:7], s95 offen offset:1024 nt lds
    s_waitcnt lgkmcnt(8)
    v_mfma_f32_32x32x16_bf16 v[64:79], a[240:243], v[188:191], v[64:79]
    ds_read_b64_tr_b16 a[232:233], v3 offset:17024
    ds_read_b64_tr_b16 a[234:235], v3 offset:17536
    v_exp_f32 v26, v138
    v_exp_f32 v27, v139
    v_mfma_f32_32x32x16_bf16 v[80:95], a[244:247], v[188:191], v[80:95]
    ds_read_b64_tr_b16 a[236:237], v3 offset:17088
    ds_read_b64_tr_b16 a[238:239], v3 offset:17600
    buffer_load_dwordx4 v16, s[8:11], s93 offen offset:2112 nt lds
    s_waitcnt lgkmcnt(8)
    v_mfma_f32_32x32x16_bf16 v[96:111], a[248:251], v[188:191], v[96:111]
    ds_read_b64_tr_b16 a[240:241], v3 offset:25344
    ds_read_b64_tr_b16 a[242:243], v3 offset:25856
    v_add_f32 v28, v28, v26
    v_cvt_pk_bf16_f32 v181, v26, v27
    v_add_f32 v29, v29, v27
    v_mfma_f32_32x32x16_bf16 v[112:127], a[252:255], v[188:191], v[112:127]
    ds_read_b64_tr_b16 a[244:245], v3 offset:25408
    ds_read_b64_tr_b16 a[246:247], v3 offset:25920
    buffer_load_dwordx4 v18, s[4:7], s95 offen offset:3136 nt lds
    s_waitcnt lgkmcnt(8)
    v_mfma_f32_32x32x16_bf16 v[192:207], a[224:227], a[112:115], v[192:207]
    ds_read_b64_tr_b16 a[248:249], v3 offset:25472
    ds_read_b64_tr_b16 a[250:251], v3 offset:25984
    v_exp_f32 v24, v140
    v_exp_f32 v25, v141
    v_mfma_f32_32x32x16_bf16 v[208:223], a[228:231], a[112:115], v[208:223]
    ds_read_b64_tr_b16 a[252:253], v3 offset:25536
    ds_read_b64_tr_b16 a[254:255], v3 offset:26048
    s_waitcnt lgkmcnt(8)
    v_mfma_f32_32x32x16_bf16 v[224:239], a[232:235], a[112:115], v[224:239]
    ds_read_b64_tr_b16 a[224:225], v3 offset:17920
    ds_read_b64_tr_b16 a[226:227], v3 offset:18432
    v_add_f32 v28, v28, v24
    v_cvt_pk_bf16_f32 v182, v24, v25
    v_add_f32 v29, v29, v25
    v_mfma_f32_32x32x16_bf16 v[240:255], a[236:239], a[112:115], v[240:255]
    ds_read_b64_tr_b16 a[228:229], v3 offset:17984
    ds_read_b64_tr_b16 a[230:231], v3 offset:18496
    s_waitcnt lgkmcnt(8)
    v_mfma_f32_32x32x16_bf16 v[192:207], a[240:243], a[116:119], v[192:207]
    ds_read_b64_tr_b16 a[232:233], v3 offset:18048
    ds_read_b64_tr_b16 a[234:235], v3 offset:18560
    v_exp_f32 v26, v142
    v_exp_f32 v27, v143
    v_mfma_f32_32x32x16_bf16 v[208:223], a[244:247], a[116:119], v[208:223]
    ds_read_b64_tr_b16 a[236:237], v3 offset:18112
    ds_read_b64_tr_b16 a[238:239], v3 offset:18624
    s_waitcnt lgkmcnt(8)
    v_mfma_f32_32x32x16_bf16 v[224:239], a[248:251], a[116:119], v[224:239]
    ds_read_b64_tr_b16 a[240:241], v3 offset:26368
    ds_read_b64_tr_b16 a[242:243], v3 offset:26880
    v_add_f32 v28, v28, v26
    v_cvt_pk_bf16_f32 v183, v26, v27
    v_add_f32 v29, v29, v27
    v_mfma_f32_32x32x16_bf16 v[240:255], a[252:255], a[116:119], v[240:255]
    ds_read_b64_tr_b16 a[244:245], v3 offset:26432
    ds_read_b64_tr_b16 a[246:247], v3 offset:26944
    v_add_f32 v28, v28, v29
    v_cmp_nge_f32 vcc, s32, v28
    s_cbranch_vccnz L_rs8
L_back8:
    v_add_f32 v22, v22, v28
    s_waitcnt lgkmcnt(8)
    v_mfma_f32_32x32x16_bf16 v[192:207], a[224:227], a[120:123], v[192:207]
    ds_read_b64_tr_b16 a[248:249], v3 offset:26496
    ds_read_b64_tr_b16 a[250:251], v3 offset:27008
    s_waitcnt vmcnt(24)
    s_barrier
    s_add_u32 m0, s24, 101376
    s_mov_b32 s29, 512
    s_mov_b32 s30, 261632
    v_exp_f32 v24, v144
    v_exp_f32 v25, v145
    v_mfma_f32_32x32x16_bf16 v[208:223], a[228:231], a[120:123], v[208:223]
    ds_read_b64_tr_b16 a[252:253], v3 offset:26560
    ds_read_b64_tr_b16 a[254:255], v3 offset:27072
    buffer_load_dwordx4 v13, s[12:15], s29 offen nt lds
    v_cvt_pk_bf16_f32 v184, v24, v25
    v_add_f32 v28, v24, v25
    s_waitcnt lgkmcnt(8)
    v_mfma_f32_32x32x16_bf16 v[224:239], a[232:235], a[120:123], v[224:239]
    ds_read_b128 a[224:227], v9 offset:34816
    v_mfma_f32_32x32x16_bf16 v[240:255], a[236:239], a[120:123], v[240:255]
    ds_read_b128 a[228:231], v12 offset:34816
    buffer_load_dwordx4 v13, s[12:15], s30 offen offset:1024 nt lds
    v_exp_f32 v26, v146
    v_exp_f32 v27, v147
    s_waitcnt lgkmcnt(6)
    v_mfma_f32_32x32x16_bf16 v[192:207], a[240:243], a[124:127], v[192:207]
    ds_read_b128 a[232:235], v9 offset:34880
    v_cvt_pk_bf16_f32 v185, v26, v27
    v_add_f32 v29, v26, v27
    v_mfma_f32_32x32x16_bf16 v[208:223], a[244:247], a[124:127], v[208:223]
    ds_read_b128 a[236:239], v12 offset:34880
    buffer_load_dwordx4 v14, s[12:15], s29 offen offset:2112 nt lds
    s_waitcnt lgkmcnt(4)
    v_mfma_f32_32x32x16_bf16 v[224:239], a[248:251], a[124:127], v[224:239]
    ds_read_b128 a[240:243], v9 offset:34944
    v_exp_f32 v24, v148
    v_exp_f32 v25, v149
    v_mfma_f32_32x32x16_bf16 v[240:255], a[252:255], a[124:127], v[240:255]
    ds_read_b128 a[244:247], v12 offset:34944
    buffer_load_dwordx4 v14, s[12:15], s30 offen offset:3136 nt lds
    v_add_f32 v28, v28, v24
    v_cvt_pk_bf16_f32 v186, v24, v25
    v_add_f32 v29, v29, v25
    s_waitcnt lgkmcnt(4)
    v_mfma_f32_32x32x16_bf16 v[128:143], a[224:227], v[32:35], v[160:175]
    ds_read_b128 a[248:251], v9 offset:35008
    v_mfma_f32_32x32x16_bf16 v[128:143], a[228:231], v[36:39], v[128:143]
    ds_read_b128 a[252:255], v12 offset:35008
    v_exp_f32 v26, v150
    v_exp_f32 v27, v151
    s_waitcnt lgkmcnt(4)
    v_mfma_f32_32x32x16_bf16 v[128:143], a[232:235], v[40:43], v[128:143]
    ds_read_b64_tr_b16 a[224:225], v6 offset:33792
    ds_read_b64_tr_b16 a[226:227], v6 offset:34304
    v_add_f32 v28, v28, v26
    v_cvt_pk_bf16_f32 v187, v26, v27
    v_add_f32 v29, v29, v27
    v_mfma_f32_32x32x16_bf16 v[128:143], a[236:239], v[44:47], v[128:143]
    ds_read_b64_tr_b16 a[228:229], v6 offset:33856
    ds_read_b64_tr_b16 a[230:231], v6 offset:34368
    s_waitcnt lgkmcnt(6)
    v_mfma_f32_32x32x16_bf16 v[128:143], a[240:243], v[48:51], v[128:143]
    ds_read_b64_tr_b16 a[232:233], v6 offset:33920
    ds_read_b64_tr_b16 a[234:235], v6 offset:34432
    v_exp_f32 v24, v152
    v_exp_f32 v25, v153
    v_mfma_f32_32x32x16_bf16 v[128:143], a[244:247], v[52:55], v[128:143]
    ds_read_b64_tr_b16 a[236:237], v6 offset:33984
    ds_read_b64_tr_b16 a[238:239], v6 offset:34496
    v_add_f32 v28, v28, v24
    v_cvt_pk_bf16_f32 v188, v24, v25
    v_add_f32 v29, v29, v25
    s_waitcnt lgkmcnt(8)
    v_mfma_f32_32x32x16_bf16 v[128:143], a[248:251], v[56:59], v[128:143]
    ds_read_b64_tr_b16 a[240:241], v6 offset:42240
    ds_read_b64_tr_b16 a[242:243], v6 offset:42752
    v_mfma_f32_32x32x16_bf16 v[128:143], a[252:255], v[60:63], v[128:143]
    ds_read_b64_tr_b16 a[244:245], v6 offset:42304
    ds_read_b64_tr_b16 a[246:247], v6 offset:42816
    v_exp_f32 v26, v154
    v_exp_f32 v27, v155
    s_waitcnt lgkmcnt(8)
    v_mfma_f32_32x32x16_bf16 v[64:79], a[224:227], v[176:179], v[64:79]
    ds_read_b64_tr_b16 a[248:249], v6 offset:42368
    ds_read_b64_tr_b16 a[250:251], v6 offset:42880
    s_waitcnt vmcnt(24)
    s_barrier
    s_add_u32 m0, s24, 118272
    s_mov_b32 s93, 106496
    s_mov_b32 s95, 121856
    v_add_f32 v28, v28, v26
    v_cvt_pk_bf16_f32 v189, v26, v27
    v_add_f32 v29, v29, v27
    v_mfma_f32_32x32x16_bf16 v[80:95], a[228:231], v[176:179], v[80:95]
    ds_read_b64_tr_b16 a[252:253], v6 offset:42432
    ds_read_b64_tr_b16 a[254:255], v6 offset:42944
    buffer_load_dwordx4 v15, s[8:11], s93 offen nt lds
    s_waitcnt lgkmcnt(8)
    v_mfma_f32_32x32x16_bf16 v[96:111], a[232:235], v[176:179], v[96:111]
    ds_read_b128 a[224:227], v7 offset:1024
    v_exp_f32 v24, v156
    v_exp_f32 v25, v157
    v_mfma_f32_32x32x16_bf16 v[112:127], a[236:239], v[176:179], v[112:127]
    ds_read_b128 a[228:231], v10 offset:1024
    buffer_load_dwordx4 v17, s[4:7], s95 offen offset:1024 nt lds
    v_add_f32 v28, v28, v24
    v_cvt_pk_bf16_f32 v190, v24, v25
    v_add_f32 v29, v29, v25
    s_waitcnt lgkmcnt(6)
    v_mfma_f32_32x32x16_bf16 v[64:79], a[240:243], v[180:183], v[64:79]
    ds_read_b128 a[232:235], v7 offset:1088
    v_mfma_f32_32x32x16_bf16 v[80:95], a[244:247], v[180:183], v[80:95]
    ds_read_b128 a[236:239], v10 offset:1088
    buffer_load_dwordx4 v16, s[8:11], s93 offen offset:2112 nt lds
    v_exp_f32 v26, v158
    v_exp_f32 v27, v159
    s_waitcnt lgkmcnt(4)
    v_mfma_f32_32x32x16_bf16 v[96:111], a[248:251], v[180:183], v[96:111]
    ds_read_b128 a[240:243], v7 offset:1152
    v_add_f32 v28, v28, v26
    v_cvt_pk_bf16_f32 v191, v26, v27
    v_add_f32 v29, v29, v27
    v_mfma_f32_32x32x16_bf16 v[112:127], a[252:255], v[180:183], v[112:127]
    ds_read_b128 a[244:247], v10 offset:1152
    buffer_load_dwordx4 v18, s[4:7], s95 offen offset:3136 nt lds
    v_add_f32 v28, v28, v29
    v_cmp_nge_f32 vcc, s32, v28
    s_cbranch_vccnz L_rs9
L_back9:
    v_add_f32 v22, v22, v28
    s_waitcnt lgkmcnt(4)
    v_mfma_f32_32x32x16_bf16 v[144:159], a[224:227], v[32:35], v[160:175]
    ds_read_b128 a[248:251], v7 offset:1216
    v_exp_f32 v24, v128
    v_exp_f32 v25, v129
    v_mfma_f32_32x32x16_bf16 v[144:159], a[228:231], v[36:39], v[144:159]
    ds_read_b128 a[252:255], v10 offset:1216
    v_cvt_pk_bf16_f32 v176, v24, v25
    v_add_f32 v28, v24, v25
    s_waitcnt lgkmcnt(4)
    v_mfma_f32_32x32x16_bf16 v[144:159], a[232:235], v[40:43], v[144:159]
    ds_read_b64_tr_b16 a[224:225], v4 offset:0
    ds_read_b64_tr_b16 a[226:227], v4 offset:512
    v_mfma_f32_32x32x16_bf16 v[144:159], a[236:239], v[44:47], v[144:159]
    ds_read_b64_tr_b16 a[228:229], v4 offset:64
    ds_read_b64_tr_b16 a[230:231], v4 offset:576
    v_exp_f32 v26, v130
    v_exp_f32 v27, v131
    s_waitcnt lgkmcnt(6)
    v_mfma_f32_32x32x16_bf16 v[144:159], a[240:243], v[48:51], v[144:159]
    ds_read_b64_tr_b16 a[232:233], v4 offset:128
    ds_read_b64_tr_b16 a[234:235], v4 offset:640
    v_cvt_pk_bf16_f32 v177, v26, v27
    v_add_f32 v29, v26, v27
    v_mfma_f32_32x32x16_bf16 v[144:159], a[244:247], v[52:55], v[144:159]
    ds_read_b64_tr_b16 a[236:237], v4 offset:192
    ds_read_b64_tr_b16 a[238:239], v4 offset:704
    s_waitcnt lgkmcnt(8)
    v_mfma_f32_32x32x16_bf16 v[144:159], a[248:251], v[56:59], v[144:159]
    ds_read_b64_tr_b16 a[240:241], v4 offset:8448
    ds_read_b64_tr_b16 a[242:243], v4 offset:8960
    v_exp_f32 v24, v132
    v_exp_f32 v25, v133
    v_mfma_f32_32x32x16_bf16 v[144:159], a[252:255], v[60:63], v[144:159]
    ds_read_b64_tr_b16 a[244:245], v4 offset:8512
    ds_read_b64_tr_b16 a[246:247], v4 offset:9024
    v_add_f32 v28, v28, v24
    v_cvt_pk_bf16_f32 v178, v24, v25
    v_add_f32 v29, v29, v25
    s_waitcnt lgkmcnt(8)
    v_mfma_f32_32x32x16_bf16 v[64:79], a[224:227], v[184:187], v[64:79]
    ds_read_b64_tr_b16 a[248:249], v4 offset:8576
    ds_read_b64_tr_b16 a[250:251], v4 offset:9088
    s_waitcnt vmcnt(24)
    s_barrier
    s_add_u32 m0, s24, 135168
    s_mov_b32 s29, 524800
    s_mov_b32 s30, 785920
    v_mfma_f32_32x32x16_bf16 v[80:95], a[228:231], v[184:187], v[80:95]
    ds_read_b64_tr_b16 a[252:253], v4 offset:8640
    ds_read_b64_tr_b16 a[254:255], v4 offset:9152
    buffer_load_dwordx4 v13, s[12:15], s29 offen nt lds
    v_exp_f32 v26, v134
    v_exp_f32 v27, v135
    s_waitcnt lgkmcnt(8)
    v_mfma_f32_32x32x16_bf16 v[96:111], a[232:235], v[184:187], v[96:111]
    ds_read_b64_tr_b16 a[224:225], v1 offset:16896
    ds_read_b64_tr_b16 a[226:227], v1 offset:17408
    v_add_f32 v28, v28, v26
    v_cvt_pk_bf16_f32 v179, v26, v27
    v_add_f32 v29, v29, v27
    v_mfma_f32_32x32x16_bf16 v[112:127], a[236:239], v[184:187], v[112:127]
    ds_read_b64_tr_b16 a[228:229], v1 offset:16960
    ds_read_b64_tr_b16 a[230:231], v1 offset:17472
    buffer_load_dwordx4 v13, s[12:15], s30 offen offset:1024 nt lds
    s_waitcnt lgkmcnt(8)
    v_mfma_f32_32x32x16_bf16 v[64:79], a[240:243], v[188:191], v[64:79]
    ds_read_b64_tr_b16 a[232:233], v1 offset:17024
    ds_read_b64_tr_b16 a[234:235], v1 offset:17536
    v_exp_f32 v24, v136
    v_exp_f32 v25, v137
    v_mfma_f32_32x32x16_bf16 v[80:95], a[244:247], v[188:191], v[80:95]
    ds_read_b64_tr_b16 a[236:237], v1 offset:17088
    ds_read_b64_tr_b16 a[238:239], v1 offset:17600
    buffer_load_dwordx4 v14, s[12:15], s29 offen offset:2112 nt lds
    v_add_f32 v28, v28, v24
    v_cvt_pk_bf16_f32 v180, v24, v25
    v_add_f32 v29, v29, v25
    s_waitcnt lgkmcnt(8)
    v_mfma_f32_32x32x16_bf16 v[96:111], a[248:251], v[188:191], v[96:111]
    ds_read_b64_tr_b16 a[240:241], v1 offset:25344
    ds_read_b64_tr_b16 a[242:243], v1 offset:25856
    v_mfma_f32_32x32x16_bf16 v[112:127], a[252:255], v[188:191], v[112:127]
    ds_read_b64_tr_b16 a[244:245], v1 offset:25408
    ds_read_b64_tr_b16 a[246:247], v1 offset:25920
    buffer_load_dwordx4 v14, s[12:15], s30 offen offset:3136 nt lds
    v_exp_f32 v26, v138
    v_exp_f32 v27, v139
    s_waitcnt lgkmcnt(8)
    v_mfma_f32_32x32x16_bf16 v[192:207], a[224:227], a[128:131], v[192:207]
    ds_read_b64_tr_b16 a[248:249], v1 offset:25472
    ds_read_b64_tr_b16 a[250:251], v1 offset:25984
    v_add_f32 v28, v28, v26
    v_cvt_pk_bf16_f32 v181, v26, v27
    v_add_f32 v29, v29, v27
    v_mfma_f32_32x32x16_bf16 v[208:223], a[228:231], a[128:131], v[208:223]
    ds_read_b64_tr_b16 a[252:253], v1 offset:25536
    ds_read_b64_tr_b16 a[254:255], v1 offset:26048
    s_waitcnt lgkmcnt(8)
    v_mfma_f32_32x32x16_bf16 v[224:239], a[232:235], a[128:131], v[224:239]
    ds_read_b64_tr_b16 a[224:225], v1 offset:17920
    ds_read_b64_tr_b16 a[226:227], v1 offset:18432
    v_exp_f32 v24, v140
    v_exp_f32 v25, v141
    v_mfma_f32_32x32x16_bf16 v[240:255], a[236:239], a[128:131], v[240:255]
    ds_read_b64_tr_b16 a[228:229], v1 offset:17984
    ds_read_b64_tr_b16 a[230:231], v1 offset:18496
    v_add_f32 v28, v28, v24
    v_cvt_pk_bf16_f32 v182, v24, v25
    v_add_f32 v29, v29, v25
    s_waitcnt lgkmcnt(8)
    v_mfma_f32_32x32x16_bf16 v[192:207], a[240:243], a[132:135], v[192:207]
    ds_read_b64_tr_b16 a[232:233], v1 offset:18048
    ds_read_b64_tr_b16 a[234:235], v1 offset:18560
    v_mfma_f32_32x32x16_bf16 v[208:223], a[244:247], a[132:135], v[208:223]
    ds_read_b64_tr_b16 a[236:237], v1 offset:18112
    ds_read_b64_tr_b16 a[238:239], v1 offset:18624
    v_exp_f32 v26, v142
    v_exp_f32 v27, v143
    s_waitcnt lgkmcnt(8)
    v_mfma_f32_32x32x16_bf16 v[224:239], a[248:251], a[132:135], v[224:239]
    ds_read_b64_tr_b16 a[240:241], v1 offset:26368
    ds_read_b64_tr_b16 a[242:243], v1 offset:26880
    v_add_f32 v28, v28, v26
    v_cvt_pk_bf16_f32 v183, v26, v27
    v_add_f32 v29, v29, v27
    v_mfma_f32_32x32x16_bf16 v[240:255], a[252:255], a[132:135], v[240:255]
    ds_read_b64_tr_b16 a[244:245], v1 offset:26432
    ds_read_b64_tr_b16 a[246:247], v1 offset:26944
    v_add_f32 v28, v28, v29
    v_cmp_nge_f32 vcc, s32, v28
    s_cbranch_vccnz L_rs10
L_back10:
    v_add_f32 v22, v22, v28
    s_waitcnt lgkmcnt(8)
    v_mfma_f32_32x32x16_bf16 v[192:207], a[224:227], a[136:139], v[192:207]
    ds_read_b64_tr_b16 a[248:249], v1 offset:26496
    ds_read_b64_tr_b16 a[250:251], v1 offset:27008
    s_waitcnt vmcnt(24)
    s_barrier
    s_add_u32 m0, s24, 0
    s_mov_b32 s93, 114688
    s_mov_b32 s95, 121856
    v_exp_f32 v24, v144
    v_exp_f32 v25, v145
    v_mfma_f32_32x32x16_bf16 v[208:223], a[228:231], a[136:139], v[208:223]
    ds_read_b64_tr_b16 a[252:253], v1 offset:26560
    ds_read_b64_tr_b16 a[254:255], v1 offset:27072
    buffer_load_dwordx4 v15, s[8:11], s93 offen nt lds
    s_waitcnt lgkmcnt(8)
    v_mfma_f32_32x32x16_bf16 v[224:239], a[232:235], a[136:139], v[224:239]
    ds_read_b128 a[224:227], v7 offset:34816
    v_cvt_pk_bf16_f32 v184, v24, v25
    v_add_f32 v28, v24, v25
    v_mfma_f32_32x32x16_bf16 v[240:255], a[236:239], a[136:139], v[240:255]
    ds_read_b128 a[228:231], v10 offset:34816
    buffer_load_dwordx4 v15, s[8:11], s95 offen offset:1024 nt lds
    s_waitcnt lgkmcnt(6)
    v_mfma_f32_32x32x16_bf16 v[192:207], a[240:243], a[140:143], v[192:207]
    ds_read_b128 a[232:235], v7 offset:34880
    v_exp_f32 v26, v146
    v_exp_f32 v27, v147
    v_mfma_f32_32x32x16_bf16 v[208:223], a[244:247], a[140:143], v[208:223]
    ds_read_b128 a[236:239], v10 offset:34880
    buffer_load_dwordx4 v16, s[8:11], s93 offen offset:2112 nt lds
    s_waitcnt lgkmcnt(4)
    v_mfma_f32_32x32x16_bf16 v[224:239], a[248:251], a[140:143], v[224:239]
    ds_read_b128 a[240:243], v7 offset:34944
    v_cvt_pk_bf16_f32 v185, v26, v27
    v_add_f32 v29, v26, v27
    v_mfma_f32_32x32x16_bf16 v[240:255], a[252:255], a[140:143], v[240:255]
    ds_read_b128 a[244:247], v10 offset:34944
    buffer_load_dwordx4 v16, s[8:11], s95 offen offset:3136 nt lds
    s_waitcnt lgkmcnt(4)
    v_mfma_f32_32x32x16_bf16 v[128:143], a[224:227], v[32:35], v[160:175]
    ds_read_b128 a[248:251], v7 offset:35008
    v_exp_f32 v24, v148
    v_exp_f32 v25, v149
    v_mfma_f32_32x32x16_bf16 v[128:143], a[228:231], v[36:39], v[128:143]
    ds_read_b128 a[252:255], v10 offset:35008
    s_waitcnt lgkmcnt(4)
    v_mfma_f32_32x32x16_bf16 v[128:143], a[232:235], v[40:43], v[128:143]
    ds_read_b64_tr_b16 a[224:225], v4 offset:33792
    ds_read_b64_tr_b16 a[226:227], v4 offset:34304
    v_add_f32 v28, v28, v24
    v_cvt_pk_bf16_f32 v186, v24, v25
    v_add_f32 v29, v29, v25
    v_mfma_f32_32x32x16_bf16 v[128:143], a[236:239], v[44:47], v[128:143]
    ds_read_b64_tr_b16 a[228:229], v4 offset:33856
    ds_read_b64_tr_b16 a[230:231], v4 offset:34368
    s_waitcnt lgkmcnt(6)
    v_mfma_f32_32x32x16_bf16 v[128:143], a[240:243], v[48:51], v[128:143]
    ds_read_b64_tr_b16 a[232:233], v4 offset:33920
    ds_read_b64_tr_b16 a[234:235], v4 offset:34432
    v_exp_f32 v26, v150
    v_exp_f32 v27, v151
    v_mfma_f32_32x32x16_bf16 v[128:143], a[244:247], v[52:55], v[128:143]
    ds_read_b64_tr_b16 a[236:237], v4 offset:33984
    ds_read_b64_tr_b16 a[238:239], v4 offset:34496
    s_waitcnt lgkmcnt(8)
    v_mfma_f32_32x32x16_bf16 v[128:143], a[248:251], v[56:59], v[128:143]
    ds_read_b64_tr_b16 a[240:241], v4 offset:42240
    ds_read_b64_tr_b16 a[242:243], v4 offset:42752
    v_add_f32 v28, v28, v26
    v_cvt_pk_bf16_f32 v187, v26, v27
    v_add_f32 v29, v29, v27
    v_mfma_f32_32x32x16_bf16 v[128:143], a[252:255], v[60:63], v[128:143]
    ds_read_b64_tr_b16 a[244:245], v4 offset:42304
    ds_read_b64_tr_b16 a[246:247], v4 offset:42816
    s_waitcnt lgkmcnt(8)
    v_mfma_f32_32x32x16_bf16 v[64:79], a[224:227], v[176:179], v[64:79]
    ds_read_b64_tr_b16 a[248:249], v4 offset:42368
    ds_read_b64_tr_b16 a[250:251], v4 offset:42880
    s_waitcnt vmcnt(24)
    s_barrier
    s_add_u32 m0, s24, 16896
    s_mov_b32 s29, 1049088
    s_mov_b32 s30, 1310208
    v_exp_f32 v24, v152
    v_exp_f32 v25, v153
    v_mfma_f32_32x32x16_bf16 v[80:95], a[228:231], v[176:179], v[80:95]
    ds_read_b64_tr_b16 a[252:253], v4 offset:42432
    ds_read_b64_tr_b16 a[254:255], v4 offset:42944
    buffer_load_dwordx4 v13, s[12:15], s29 offen nt lds
    s_waitcnt lgkmcnt(8)
    v_mfma_f32_32x32x16_bf16 v[96:111], a[232:235], v[176:179], v[96:111]
    ds_read_b64_tr_b16 a[224:225], v2 offset:0
    ds_read_b64_tr_b16 a[226:227], v2 offset:512
    v_add_f32 v28, v28, v24
    v_cvt_pk_bf16_f32 v188, v24, v25
    v_add_f32 v29, v29, v25
    v_mfma_f32_32x32x16_bf16 v[112:127], a[236:239], v[176:179], v[112:127]
    ds_read_b64_tr_b16 a[228:229], v2 offset:8448
    ds_read_b64_tr_b16 a[230:231], v2 offset:8960
    buffer_load_dwordx4 v13, s[12:15], s30 offen offset:1024 nt lds
    s_waitcnt lgkmcnt(8)
    v_mfma_f32_32x32x16_bf16 v[64:79], a[240:243], v[180:183], v[64:79]
    ds_read_b64_tr_b16 a[232:233], v2 offset:1024
    ds_read_b64_tr_b16 a[234:235], v2 offset:1536
    v_exp_f32 v26, v154
    v_exp_f32 v27, v155
    v_mfma_f32_32x32x16_bf16 v[80:95], a[244:247], v[180:183], v[80:95]
    ds_read_b64_tr_b16 a[236:237], v2 offset:9472
    ds_read_b64_tr_b16 a[238:239], v2 offset:9984
    buffer_load_dwordx4 v14, s[12:15], s29 offen offset:2112 nt lds
    s_waitcnt lgkmcnt(8)
    v_mfma_f32_32x32x16_bf16 v[96:111], a[248:251], v[180:183], v[96:111]
    ds_read_b64_tr_b16 a[240:241], v2 offset:64
    ds_read_b64_tr_b16 a[242:243], v2 offset:576
    v_add_f32 v28, v28, v26
    v_cvt_pk_bf16_f32 v189, v26, v27
    v_add_f32 v29, v29, v27
    v_mfma_f32_32x32x16_bf16 v[112:127], a[252:255], v[180:183], v[112:127]
    ds_read_b64_tr_b16 a[244:245], v2 offset:8512
    ds_read_b64_tr_b16 a[246:247], v2 offset:9024
    buffer_load_dwordx4 v14, s[12:15], s30 offen offset:3136 nt lds
    s_waitcnt lgkmcnt(8)
    v_mfma_f32_32x32x16_bf16 v[192:207], a[224:227], a[144:147], v[192:207]
    ds_read_b64_tr_b16 a[248:249], v2 offset:1088
    ds_read_b64_tr_b16 a[250:251], v2 offset:1600
    v_exp_f32 v24, v156
    v_exp_f32 v25, v157
    v_mfma_f32_32x32x16_bf16 v[192:207], a[228:231], a[148:151], v[192:207]
    ds_read_b64_tr_b16 a[252:253], v2 offset:9536
    ds_read_b64_tr_b16 a[254:255], v2 offset:10048
    s_waitcnt lgkmcnt(8)
    v_mfma_f32_32x32x16_bf16 v[192:207], a[232:235], a[152:155], v[192:207]
    ds_read_b64_tr_b16 a[224:225], v2 offset:128
    ds_read_b64_tr_b16 a[226:227], v2 offset:640
    v_add_f32 v28, v28, v24
    v_cvt_pk_bf16_f32 v190, v24, v25
    v_add_f32 v29, v29, v25
    v_mfma_f32_32x32x16_bf16 v[192:207], a[236:239], a[156:159], v[192:207]
    ds_read_b64_tr_b16 a[228:229], v2 offset:8576
    ds_read_b64_tr_b16 a[230:231], v2 offset:9088
    s_waitcnt lgkmcnt(8)
    v_mfma_f32_32x32x16_bf16 v[208:223], a[240:243], a[144:147], v[208:223]
    ds_read_b64_tr_b16 a[232:233], v2 offset:1152
    ds_read_b64_tr_b16 a[234:235], v2 offset:1664
    v_exp_f32 v26, v158
    v_exp_f32 v27, v159
    v_mfma_f32_32x32x16_bf16 v[208:223], a[244:247], a[148:151], v[208:223]
    ds_read_b64_tr_b16 a[236:237], v2 offset:9600
    ds_read_b64_tr_b16 a[238:239], v2 offset:10112
    s_waitcnt lgkmcnt(8)
    v_mfma_f32_32x32x16_bf16 v[208:223], a[248:251], a[152:155], v[208:223]
    ds_read_b64_tr_b16 a[240:241], v2 offset:192
    ds_read_b64_tr_b16 a[242:243], v2 offset:704
    v_add_f32 v28, v28, v26
    v_cvt_pk_bf16_f32 v191, v26, v27
    v_add_f32 v29, v29, v27
    v_mfma_f32_32x32x16_bf16 v[208:223], a[252:255], a[156:159], v[208:223]
    ds_read_b64_tr_b16 a[244:245], v2 offset:8640
    ds_read_b64_tr_b16 a[246:247], v2 offset:9152
    v_add_f32 v28, v28, v29
    v_cmp_nge_f32 vcc, s32, v28
    s_cbranch_vccnz L_rs11
L_back11:
    v_add_f32 v22, v22, v28
    v_mul_f32 v192, s33, v192
    v_mul_f32 v193, s33, v193
    v_cvt_pk_bf16_f32 v192, v192, v193
    s_waitcnt lgkmcnt(8)
    v_mfma_f32_32x32x16_bf16 v[224:239], a[224:227], a[144:147], v[224:239]
    ds_read_b64_tr_b16 a[248:249], v2 offset:1216
    ds_read_b64_tr_b16 a[250:251], v2 offset:1728
    s_waitcnt vmcnt(24)
    s_barrier
    s_add_u32 m0, s24, 33792
    s_mov_b32 s93, 131072
    s_mov_b32 s95, 138240
    v_exp_f32 v24, v128
    v_exp_f32 v25, v129
    v_accvgpr_write_b32 a160, v192
    v_mul_f32 v194, s33, v194
    v_mfma_f32_32x32x16_bf16 v[224:239], a[228:231], a[148:151], v[224:239]
    ds_read_b64_tr_b16 a[252:253], v2 offset:9664
    ds_read_b64_tr_b16 a[254:255], v2 offset:10176
    buffer_load_dwordx4 v17, s[4:7], s93 offen nt lds
    v_cvt_pk_bf16_f32 v176, v24, v25
    v_add_f32 v28, v24, v25
    v_mul_f32 v195, s33, v195
    v_cvt_pk_bf16_f32 v194, v194, v195
    v_accvgpr_write_b32 a161, v194
    s_waitcnt lgkmcnt(8)
    v_mfma_f32_32x32x16_bf16 v[224:239], a[232:235], a[152:155], v[224:239]
    ds_read_b128 a[224:227], v8 offset:17920
    v_mul_f32 v196, s33, v196
    v_mul_f32 v197, s33, v197
    v_mfma_f32_32x32x16_bf16 v[224:239], a[236:239], a[156:159], v[224:239]
    ds_read_b128 a[228:231], v11 offset:17920
    buffer_load_dwordx4 v17, s[4:7], s95 offen offset:1024 nt lds
    v_exp_f32 v26, v130
    v_exp_f32 v27, v131
    v_cvt_pk_bf16_f32 v196, v196, v197
    v_accvgpr_write_b32 a162, v196
    v_mul_f32 v198, s33, v198
    s_waitcnt lgkmcnt(6)
    v_mfma_f32_32x32x16_bf16 v[240:255], a[240:243], a[144:147], v[240:255]
    ds_read_b128 a[232:235], v8 offset:17984
    v_cvt_pk_bf16_f32 v177, v26, v27
    v_add_f32 v29, v26, v27
    v_mul_f32 v199, s33, v199
    v_cvt_pk_bf16_f32 v198, v198, v199
    v_mfma_f32_32x32x16_bf16 v[240:255], a[244:247], a[148:151], v[240:255]
    ds_read_b128 a[236:239], v11 offset:17984
    buffer_load_dwordx4 v18, s[4:7], s93 offen offset:2112 nt lds
    v_accvgpr_write_b32 a163, v198
    v_mul_f32 v200, s33, v200
    v_mul_f32 v201, s33, v201
    s_waitcnt lgkmcnt(4)
    v_mfma_f32_32x32x16_bf16 v[240:255], a[248:251], a[152:155], v[240:255]
    ds_read_b128 a[240:243], v8 offset:18048
    v_exp_f32 v24, v132
    v_exp_f32 v25, v133
    v_cvt_pk_bf16_f32 v200, v200, v201
    v_accvgpr_write_b32 a164, v200
    v_mfma_f32_32x32x16_bf16 v[240:255], a[252:255], a[156:159], v[240:255]
    ds_read_b128 a[244:247], v11 offset:18048
    buffer_load_dwordx4 v18, s[4:7], s95 offen offset:3136 nt lds
    v_add_f32 v28, v28, v24
    v_cvt_pk_bf16_f32 v178, v24, v25
    v_add_f32 v29, v29, v25
    v_mul_f32 v202, s33, v202
    v_mul_f32 v203, s33, v203
    v_cvt_pk_bf16_f32 v202, v202, v203
    s_waitcnt lgkmcnt(4)
    v_mfma_f32_32x32x16_bf16 v[144:159], a[224:227], v[32:35], v[160:175]
    ds_read_b128 a[248:251], v8 offset:18112
    v_accvgpr_write_b32 a165, v202
    v_mul_f32 v204, s33, v204
    v_mfma_f32_32x32x16_bf16 v[144:159], a[228:231], v[36:39], v[144:159]
    ds_read_b128 a[252:255], v11 offset:18112
    v_exp_f32 v26, v134
    v_exp_f32 v27, v135
    v_mul_f32 v205, s33, v205
    v_cvt_pk_bf16_f32 v204, v204, v205
    v_accvgpr_write_b32 a166, v204
    s_waitcnt lgkmcnt(4)
    v_mfma_f32_32x32x16_bf16 v[144:159], a[232:235], v[40:43], v[144:159]
    ds_read_b64_tr_b16 a[224:225], v5 offset:16896
    ds_read_b64_tr_b16 a[226:227], v5 offset:17408
    v_add_f32 v28, v28, v26
    v_cvt_pk_bf16_f32 v179, v26, v27
    v_add_f32 v29, v29, v27
    v_mul_f32 v206, s33, v206
    v_mul_f32 v207, s33, v207
    v_mfma_f32_32x32x16_bf16 v[144:159], a[236:239], v[44:47], v[144:159]
    ds_read_b64_tr_b16 a[228:229], v5 offset:16960
    ds_read_b64_tr_b16 a[230:231], v5 offset:17472
    v_cvt_pk_bf16_f32 v206, v206, v207
    v_accvgpr_write_b32 a167, v206
    s_waitcnt lgkmcnt(6)
    v_mfma_f32_32x32x16_bf16 v[144:159], a[240:243], v[48:51], v[144:159]
    ds_read_b64_tr_b16 a[232:233], v5 offset:17024
    ds_read_b64_tr_b16 a[234:235], v5 offset:17536
    v_exp_f32 v24, v136
    v_exp_f32 v25, v137
    v_mul_f32 v208, s33, v208
    v_mul_f32 v209, s33, v209
    v_cvt_pk_bf16_f32 v208, v208, v209
    v_mfma_f32_32x32x16_bf16 v[144:159], a[244:247], v[52:55], v[144:159]
    ds_read_b64_tr_b16 a[236:237], v5 offset:17088
    ds_read_b64_tr_b16 a[238:239], v5 offset:17600
    v_add_f32 v28, v28, v24
    v_cvt_pk_bf16_f32 v180, v24, v25
    v_add_f32 v29, v29, v25
    v_accvgpr_write_b32 a168, v208
    v_mul_f32 v210, s33, v210
    s_waitcnt lgkmcnt(8)
    v_mfma_f32_32x32x16_bf16 v[144:159], a[248:251], v[56:59], v[144:159]
    ds_read_b64_tr_b16 a[240:241], v5 offset:25344
    ds_read_b64_tr_b16 a[242:243], v5 offset:25856
    v_mul_f32 v211, s33, v211
    v_cvt_pk_bf16_f32 v210, v210, v211
    v_accvgpr_write_b32 a169, v210
    v_mfma_f32_32x32x16_bf16 v[144:159], a[252:255], v[60:63], v[144:159]
    ds_read_b64_tr_b16 a[244:245], v5 offset:25408
    ds_read_b64_tr_b16 a[246:247], v5 offset:25920
    v_exp_f32 v26, v138
    v_exp_f32 v27, v139
    v_mul_f32 v212, s33, v212
    v_mul_f32 v213, s33, v213
    s_waitcnt lgkmcnt(8)
    v_mfma_f32_32x32x16_bf16 v[64:79], a[224:227], v[184:187], v[64:79]
    ds_read_b64_tr_b16 a[248:249], v5 offset:25472
    ds_read_b64_tr_b16 a[250:251], v5 offset:25984
    s_waitcnt vmcnt(24)
    s_barrier
    s_add_u32 m0, s24, 50688
    s_mov_b32 s29, 1573376
    s_mov_b32 s30, 1834496
    v_add_f32 v28, v28, v26
    v_cvt_pk_bf16_f32 v181, v26, v27
    v_add_f32 v29, v29, v27
    v_cvt_pk_bf16_f32 v212, v212, v213
    v_accvgpr_write_b32 a170, v212
    v_mul_f32 v214, s33, v214
    v_mfma_f32_32x32x16_bf16 v[80:95], a[228:231], v[184:187], v[80:95]
    ds_read_b64_tr_b16 a[252:253], v5 offset:25536
    ds_read_b64_tr_b16 a[254:255], v5 offset:26048
    buffer_load_dwordx4 v13, s[12:15], s29 offen nt lds
    v_mul_f32 v215, s33, v215
    v_cvt_pk_bf16_f32 v214, v214, v215
    s_waitcnt lgkmcnt(8)
    v_mfma_f32_32x32x16_bf16 v[96:111], a[232:235], v[184:187], v[96:111]
    ds_read_b128 a[224:227], v8 offset:34816
    v_exp_f32 v24, v140
    v_exp_f32 v25, v141
    v_accvgpr_write_b32 a171, v214
    v_mul_f32 v216, s33, v216
    v_mul_f32 v217, s33, v217
    v_mfma_f32_32x32x16_bf16 v[112:127], a[236:239], v[184:187], v[112:127]
    ds_read_b128 a[228:231], v11 offset:34816
    buffer_load_dwordx4 v13, s[12:15], s30 offen offset:1024 nt lds
    v_add_f32 v28, v28, v24
    v_cvt_pk_bf16_f32 v182, v24, v25
    v_add_f32 v29, v29, v25
    v_cvt_pk_bf16_f32 v216, v216, v217
    v_accvgpr_write_b32 a172, v216
    s_waitcnt lgkmcnt(6)
    v_mfma_f32_32x32x16_bf16 v[64:79], a[240:243], v[188:191], v[64:79]
    ds_read_b128 a[232:235], v8 offset:34880
    v_mul_f32 v218, s33, v218
    v_mul_f32 v219, s33, v219
    v_cvt_pk_bf16_f32 v218, v218, v219
    v_mfma_f32_32x32x16_bf16 v[80:95], a[244:247], v[188:191], v[80:95]
    ds_read_b128 a[236:239], v11 offset:34880
    buffer_load_dwordx4 v14, s[12:15], s29 offen offset:2112 nt lds
    v_exp_f32 v26, v142
    v_exp_f32 v27, v143
    v_accvgpr_write_b32 a173, v218
    v_mul_f32 v220, s33, v220
    s_waitcnt lgkmcnt(4)
    v_mfma_f32_32x32x16_bf16 v[96:111], a[248:251], v[188:191], v[96:111]
    ds_read_b128 a[240:243], v8 offset:34944
    v_add_f32 v28, v28, v26
    v_cvt_pk_bf16_f32 v183, v26, v27
    v_add_f32 v29, v29, v27
    v_mul_f32 v221, s33, v221
    v_cvt_pk_bf16_f32 v220, v220, v221
    v_accvgpr_write_b32 a174, v220
    v_mfma_f32_32x32x16_bf16 v[112:127], a[252:255], v[188:191], v[112:127]
    ds_read_b128 a[244:247], v11 offset:34944
    buffer_load_dwordx4 v14, s[12:15], s30 offen offset:3136 nt lds
    v_add_f32 v28, v28, v29
    v_cmp_nge_f32 vcc, s32, v28
    s_cbranch_vccnz L_rs12
L_back12:
    v_add_f32 v22, v22, v28
    v_mul_f32 v222, s33, v222
    v_mul_f32 v223, s33, v223
    s_waitcnt lgkmcnt(4)
    v_mfma_f32_32x32x16_bf16 v[128:143], a[224:227], v[32:35], v[160:175]
    ds_read_b128 a[248:251], v8 offset:35008
    v_exp_f32 v24, v144
    v_exp_f32 v25, v145
    v_cvt_pk_bf16_f32 v222, v222, v223
    v_accvgpr_write_b32 a175, v222
    v_mfma_f32_32x32x16_bf16 v[128:143], a[228:231], v[36:39], v[128:143]
    ds_read_b128 a[252:255], v11 offset:35008
    v_cvt_pk_bf16_f32 v184, v24, v25
    v_add_f32 v28, v24, v25
    v_mul_f32 v224, s33, v224
    v_mul_f32 v225, s33, v225
    v_cvt_pk_bf16_f32 v224, v224, v225
    s_waitcnt lgkmcnt(4)
    v_mfma_f32_32x32x16_bf16 v[128:143], a[232:235], v[40:43], v[128:143]
    ds_read_b64_tr_b16 a[224:225], v5 offset:33792
    ds_read_b64_tr_b16 a[226:227], v5 offset:34304
    v_accvgpr_write_b32 a176, v224
    v_mul_f32 v226, s33, v226
    v_mfma_f32_32x32x16_bf16 v[128:143], a[236:239], v[44:47], v[128:143]
    ds_read_b64_tr_b16 a[228:229], v5 offset:33856
    ds_read_b64_tr_b16 a[230:231], v5 offset:34368
    v_exp_f32 v26, v146
    v_exp_f32 v27, v147
    v_mul_f32 v227, s33, v227
    v_cvt_pk_bf16_f32 v226, v226, v227
    v_accvgpr_write_b32 a177, v226
    s_waitcnt lgkmcnt(6)
    v_mfma_f32_32x32x16_bf16 v[128:143], a[240:243], v[48:51], v[128:143]
    ds_read_b64_tr_b16 a[232:233], v5 offset:33920
    ds_read_b64_tr_b16 a[234:235], v5 offset:34432
    v_cvt_pk_bf16_f32 v185, v26, v27
    v_add_f32 v29, v26, v27
    v_mul_f32 v228, s33, v228
    v_mul_f32 v229, s33, v229
    v_mfma_f32_32x32x16_bf16 v[128:143], a[244:247], v[52:55], v[128:143]
    ds_read_b64_tr_b16 a[236:237], v5 offset:33984
    ds_read_b64_tr_b16 a[238:239], v5 offset:34496
    v_cvt_pk_bf16_f32 v228, v228, v229
    v_accvgpr_write_b32 a178, v228
    v_mul_f32 v230, s33, v230
    s_waitcnt lgkmcnt(8)
    v_mfma_f32_32x32x16_bf16 v[128:143], a[248:251], v[56:59], v[128:143]
    ds_read_b64_tr_b16 a[240:241], v5 offset:42240
    ds_read_b64_tr_b16 a[242:243], v5 offset:42752
    v_exp_f32 v24, v148
    v_exp_f32 v25, v149
    v_mul_f32 v231, s33, v231
    v_cvt_pk_bf16_f32 v230, v230, v231
    v_mfma_f32_32x32x16_bf16 v[128:143], a[252:255], v[60:63], v[128:143]
    ds_read_b64_tr_b16 a[244:245], v5 offset:42304
    ds_read_b64_tr_b16 a[246:247], v5 offset:42816
    v_add_f32 v28, v28, v24
    v_cvt_pk_bf16_f32 v186, v24, v25
    v_add_f32 v29, v29, v25
    v_accvgpr_write_b32 a179, v230
    v_mul_f32 v232, s33, v232
    v_mul_f32 v233, s33, v233
    s_waitcnt lgkmcnt(8)
    v_mfma_f32_32x32x16_bf16 v[64:79], a[224:227], v[176:179], v[64:79]
    ds_read_b64_tr_b16 a[248:249], v5 offset:42368
    ds_read_b64_tr_b16 a[250:251], v5 offset:42880
    s_waitcnt vmcnt(24)
    s_barrier
    s_add_u32 m0, s24, 67584
    s_mov_b32 s93, 131072
    s_mov_b32 s95, 146432
    v_cvt_pk_bf16_f32 v232, v232, v233
    v_accvgpr_write_b32 a180, v232
    v_mfma_f32_32x32x16_bf16 v[80:95], a[228:231], v[176:179], v[80:95]
    ds_read_b64_tr_b16 a[252:253], v5 offset:42432
    ds_read_b64_tr_b16 a[254:255], v5 offset:42944
    buffer_load_dwordx4 v15, s[8:11], s93 offen nt lds
    v_exp_f32 v26, v150
    v_exp_f32 v27, v151
    v_mul_f32 v234, s33, v234
    v_mul_f32 v235, s33, v235
    v_cvt_pk_bf16_f32 v234, v234, v235
    s_waitcnt lgkmcnt(8)
    v_mfma_f32_32x32x16_bf16 v[96:111], a[232:235], v[176:179], v[96:111]
    ds_read_b64_tr_b16 a[224:225], v3 offset:0
    ds_read_b64_tr_b16 a[226:227], v3 offset:512
    v_add_f32 v28, v28, v26
    v_cvt_pk_bf16_f32 v187, v26, v27
    v_add_f32 v29, v29, v27
    v_accvgpr_write_b32 a181, v234
    v_mul_f32 v236, s33, v236
    v_mfma_f32_32x32x16_bf16 v[112:127], a[236:239], v[176:179], v[112:127]
    ds_read_b64_tr_b16 a[228:229], v3 offset:8448
    ds_read_b64_tr_b16 a[230:231], v3 offset:8960
    buffer_load_dwordx4 v17, s[4:7], s95 offen offset:1024 nt lds
    v_mul_f32 v237, s33, v237
    v_cvt_pk_bf16_f32 v236, v236, v237
    v_accvgpr_write_b32 a182, v236
    s_waitcnt lgkmcnt(8)
    v_mfma_f32_32x32x16_bf16 v[64:79], a[240:243], v[180:183], v[64:79]
    ds_read_b64_tr_b16 a[232:233], v3 offset:1024
    ds_read_b64_tr_b16 a[234:235], v3 offset:1536
    v_exp_f32 v24, v152
    v_exp_f32 v25, v153
    v_mul_f32 v238, s33, v238
    v_mul_f32 v239, s33, v239
    v_mfma_f32_32x32x16_bf16 v[80:95], a[244:247], v[180:183], v[80:95]
    ds_read_b64_tr_b16 a[236:237], v3 offset:9472
    ds_read_b64_tr_b16 a[238:239], v3 offset:9984
    buffer_load_dwordx4 v16, s[8:11], s93 offen offset:2112 nt lds
    v_add_f32 v28, v28, v24
    v_cvt_pk_bf16_f32 v188, v24, v25
    v_add_f32 v29, v29, v25
    v_cvt_pk_bf16_f32 v238, v238, v239
    v_accvgpr_write_b32 a183, v238
    s_waitcnt lgkmcnt(8)
    v_mfma_f32_32x32x16_bf16 v[96:111], a[248:251], v[180:183], v[96:111]
    ds_read_b64_tr_b16 a[240:241], v3 offset:64
    ds_read_b64_tr_b16 a[242:243], v3 offset:576
    v_mul_f32 v240, s33, v240
    v_mul_f32 v241, s33, v241
    v_cvt_pk_bf16_f32 v240, v240, v241
    v_mfma_f32_32x32x16_bf16 v[112:127], a[252:255], v[180:183], v[112:127]
    ds_read_b64_tr_b16 a[244:245], v3 offset:8512
    ds_read_b64_tr_b16 a[246:247], v3 offset:9024
    buffer_load_dwordx4 v18, s[4:7], s95 offen offset:3136 nt lds
    v_exp_f32 v26, v154
    v_exp_f32 v27, v155
    v_accvgpr_write_b32 a184, v240
    v_mul_f32 v242, s33, v242
    s_waitcnt lgkmcnt(8)
    v_mfma_f32_32x32x16_bf16 v[192:207], a[224:227], a[0:3], 0
    ds_read_b64_tr_b16 a[248:249], v3 offset:1088
    ds_read_b64_tr_b16 a[250:251], v3 offset:1600
    v_add_f32 v28, v28, v26
    v_cvt_pk_bf16_f32 v189, v26, v27
    v_add_f32 v29, v29, v27
    v_mul_f32 v243, s33, v243
    v_cvt_pk_bf16_f32 v242, v242, v243
    v_accvgpr_write_b32 a185, v242
    v_mfma_f32_32x32x16_bf16 v[192:207], a[228:231], a[4:7], v[192:207]
    ds_read_b64_tr_b16 a[252:253], v3 offset:9536
    ds_read_b64_tr_b16 a[254:255], v3 offset:10048
    v_mul_f32 v244, s33, v244
    v_mul_f32 v245, s33, v245
    s_waitcnt lgkmcnt(8)
    v_mfma_f32_32x32x16_bf16 v[192:207], a[232:235], a[8:11], v[192:207]
    ds_read_b64_tr_b16 a[224:225], v3 offset:128
    ds_read_b64_tr_b16 a[226:227], v3 offset:640
    v_exp_f32 v24, v156
    v_exp_f32 v25, v157
    v_cvt_pk_bf16_f32 v244, v244, v245
    v_accvgpr_write_b32 a186, v244
    v_mul_f32 v246, s33, v246
    v_mfma_f32_32x32x16_bf16 v[192:207], a[236:239], a[12:15], v[192:207]
    ds_read_b64_tr_b16 a[228:229], v3 offset:8576
    ds_read_b64_tr_b16 a[230:231], v3 offset:9088
    v_add_f32 v28, v28, v24
    v_cvt_pk_bf16_f32 v190, v24, v25
    v_add_f32 v29, v29, v25
    v_mul_f32 v247, s33, v247
    v_cvt_pk_bf16_f32 v246, v246, v247
    s_waitcnt lgkmcnt(8)
    v_mfma_f32_32x32x16_bf16 v[208:223], a[240:243], a[0:3], 0
    ds_read_b64_tr_b16 a[232:233], v3 offset:1152
    ds_read_b64_tr_b16 a[234:235], v3 offset:1664
    v_accvgpr_write_b32 a187, v246
    v_mul_f32 v248, s33, v248
    v_mul_f32 v249, s33, v249
    v_mfma_f32_32x32x16_bf16 v[208:223], a[244:247], a[4:7], v[208:223]
    ds_read_b64_tr_b16 a[236:237], v3 offset:9600
    ds_read_b64_tr_b16 a[238:239], v3 offset:10112
    v_exp_f32 v26, v158
    v_exp_f32 v27, v159
    v_cvt_pk_bf16_f32 v248, v248, v249
    v_accvgpr_write_b32 a188, v248
    s_waitcnt lgkmcnt(8)
    v_mfma_f32_32x32x16_bf16 v[208:223], a[248:251], a[8:11], v[208:223]
    ds_read_b64_tr_b16 a[240:241], v3 offset:192
    ds_read_b64_tr_b16 a[242:243], v3 offset:704
    v_add_f32 v28, v28, v26
    v_cvt_pk_bf16_f32 v191, v26, v27
    v_add_f32 v29, v29, v27
    v_mul_f32 v250, s33, v250
    v_mul_f32 v251, s33, v251
    v_cvt_pk_bf16_f32 v250, v250, v251
    v_mfma_f32_32x32x16_bf16 v[208:223], a[252:255], a[12:15], v[208:223]
    ds_read_b64_tr_b16 a[244:245], v3 offset:8640
    ds_read_b64_tr_b16 a[246:247], v3 offset:9152
    v_add_f32 v28, v28, v29
    v_cmp_nge_f32 vcc, s32, v28
    s_cbranch_vccnz L_rs13
L_back13:
    v_add_f32 v22, v22, v28
    v_accvgpr_write_b32 a189, v250
    v_mul_f32 v252, s33, v252
    s_waitcnt lgkmcnt(8)
    v_mfma_f32_32x32x16_bf16 v[224:239], a[224:227], a[0:3], 0
    ds_read_b64_tr_b16 a[248:249], v3 offset:1216
    ds_read_b64_tr_b16 a[250:251], v3 offset:1728
    s_waitcnt vmcnt(24)
    s_barrier
    s_add_u32 m0, s24, 84480
    s_mov_b32 s29, 2097664
    s_mov_b32 s30, 2358784
    v_exp_f32 v24, v128
    v_exp_f32 v25, v129
    v_mul_f32 v253, s33, v253
    v_cvt_pk_bf16_f32 v252, v252, v253
    v_accvgpr_write_b32 a190, v252
    v_mfma_f32_32x32x16_bf16 v[224:239], a[228:231], a[4:7], v[224:239]
    ds_read_b64_tr_b16 a[252:253], v3 offset:9664
    ds_read_b64_tr_b16 a[254:255], v3 offset:10176
    buffer_load_dwordx4 v13, s[12:15], s29 offen nt lds
    v_cvt_pk_bf16_f32 v176, v24, v25
    v_add_f32 v28, v24, v25
    v_mul_f32 v254, s33, v254
    v_mul_f32 v255, s33, v255
    s_waitcnt lgkmcnt(8)
    v_mfma_f32_32x32x16_bf16 v[224:239], a[232:235], a[8:11], v[224:239]
    ds_read_b128 a[224:227], v9 offset:17920
    v_cvt_pk_bf16_f32 v254, v254, v255
    v_accvgpr_write_b32 a191, v254
    v_mfma_f32_32x32x16_bf16 v[224:239], a[236:239], a[12:15], v[224:239]
    ds_read_b128 a[228:231], v12 offset:17920
    buffer_load_dwordx4 v13, s[12:15], s30 offen offset:1024 nt lds
    v_exp_f32 v26, v130
    v_exp_f32 v27, v131
    s_waitcnt lgkmcnt(6)
    v_mfma_f32_32x32x16_bf16 v[240:255], a[240:243], a[0:3], 0
    ds_read_b128 a[232:235], v9 offset:17984
    v_cvt_pk_bf16_f32 v177, v26, v27
    v_add_f32 v29, v26, v27
    v_mfma_f32_32x32x16_bf16 v[240:255], a[244:247], a[4:7], v[240:255]
    ds_read_b128 a[236:239], v12 offset:17984
    buffer_load_dwordx4 v14, s[12:15], s29 offen offset:2112 nt lds
    s_waitcnt lgkmcnt(4)
    v_mfma_f32_32x32x16_bf16 v[240:255], a[248:251], a[8:11], v[240:255]
    ds_read_b128 a[240:243], v9 offset:18048
    v_exp_f32 v24, v132
    v_exp_f32 v25, v133
    v_mfma_f32_32x32x16_bf16 v[240:255], a[252:255], a[12:15], v[240:255]
    ds_read_b128 a[244:247], v12 offset:18048
    buffer_load_dwordx4 v14, s[12:15], s30 offen offset:3136 nt lds
    v_add_f32 v28, v28, v24
    v_cvt_pk_bf16_f32 v178, v24, v25
    v_add_f32 v29, v29, v25
    s_waitcnt lgkmcnt(4)
    v_mfma_f32_32x32x16_bf16 v[144:159], a[224:227], v[32:35], v[160:175]
    ds_read_b128 a[248:251], v9 offset:18112
    v_mfma_f32_32x32x16_bf16 v[144:159], a[228:231], v[36:39], v[144:159]
    ds_read_b128 a[252:255], v12 offset:18112
    v_exp_f32 v26, v134
    v_exp_f32 v27, v135
    s_waitcnt lgkmcnt(4)
    v_mfma_f32_32x32x16_bf16 v[144:159], a[232:235], v[40:43], v[144:159]
    ds_read_b64_tr_b16 a[224:225], v6 offset:16896
    ds_read_b64_tr_b16 a[226:227], v6 offset:17408
    v_add_f32 v28, v28, v26
    v_cvt_pk_bf16_f32 v179, v26, v27
    v_add_f32 v29, v29, v27
    v_mfma_f32_32x32x16_bf16 v[144:159], a[236:239], v[44:47], v[144:159]
    ds_read_b64_tr_b16 a[228:229], v6 offset:16960
    ds_read_b64_tr_b16 a[230:231], v6 offset:17472
    s_waitcnt lgkmcnt(6)
    v_mfma_f32_32x32x16_bf16 v[144:159], a[240:243], v[48:51], v[144:159]
    ds_read_b64_tr_b16 a[232:233], v6 offset:17024
    ds_read_b64_tr_b16 a[234:235], v6 offset:17536
    v_exp_f32 v24, v136
    v_exp_f32 v25, v137
    v_mfma_f32_32x32x16_bf16 v[144:159], a[244:247], v[52:55], v[144:159]
    ds_read_b64_tr_b16 a[236:237], v6 offset:17088
    ds_read_b64_tr_b16 a[238:239], v6 offset:17600
    v_add_f32 v28, v28, v24
    v_cvt_pk_bf16_f32 v180, v24, v25
    v_add_f32 v29, v29, v25
    s_waitcnt lgkmcnt(8)
    v_mfma_f32_32x32x16_bf16 v[144:159], a[248:251], v[56:59], v[144:159]
    ds_read_b64_tr_b16 a[240:241], v6 offset:25344
    ds_read_b64_tr_b16 a[242:243], v6 offset:25856
    v_mfma_f32_32x32x16_bf16 v[144:159], a[252:255], v[60:63], v[144:159]
    ds_read_b64_tr_b16 a[244:245], v6 offset:25408
    ds_read_b64_tr_b16 a[246:247], v6 offset:25920
    v_exp_f32 v26, v138
    v_exp_f32 v27, v139
    s_waitcnt lgkmcnt(8)
    v_mfma_f32_32x32x16_bf16 v[64:79], a[224:227], v[184:187], v[64:79]
    ds_read_b64_tr_b16 a[248:249], v6 offset:25472
    ds_read_b64_tr_b16 a[250:251], v6 offset:25984
    s_waitcnt vmcnt(24)
    s_barrier
    s_add_u32 m0, s24, 101376
    s_mov_b32 s93, 139264
    s_mov_b32 s95, 154624
    v_add_f32 v28, v28, v26
    v_cvt_pk_bf16_f32 v181, v26, v27
    v_add_f32 v29, v29, v27
    v_mfma_f32_32x32x16_bf16 v[80:95], a[228:231], v[184:187], v[80:95]
    ds_read_b64_tr_b16 a[252:253], v6 offset:25536
    ds_read_b64_tr_b16 a[254:255], v6 offset:26048
    buffer_load_dwordx4 v15, s[8:11], s93 offen nt lds
    s_waitcnt lgkmcnt(8)
    v_mfma_f32_32x32x16_bf16 v[96:111], a[232:235], v[184:187], v[96:111]
    ds_read_b64_tr_b16 a[224:225], v3 offset:33792
    ds_read_b64_tr_b16 a[226:227], v3 offset:34304
    v_exp_f32 v24, v140
    v_exp_f32 v25, v141
    v_mfma_f32_32x32x16_bf16 v[112:127], a[236:239], v[184:187], v[112:127]
    ds_read_b64_tr_b16 a[228:229], v3 offset:33856
    ds_read_b64_tr_b16 a[230:231], v3 offset:34368
    buffer_load_dwordx4 v17, s[4:7], s95 offen offset:1024 nt lds
    v_add_f32 v28, v28, v24
    v_cvt_pk_bf16_f32 v182, v24, v25
    v_add_f32 v29, v29, v25
    s_waitcnt lgkmcnt(8)
    v_mfma_f32_32x32x16_bf16 v[64:79], a[240:243], v[188:191], v[64:79]
    ds_read_b64_tr_b16 a[232:233], v3 offset:33920
    ds_read_b64_tr_b16 a[234:235], v3 offset:34432
    v_mfma_f32_32x32x16_bf16 v[80:95], a[244:247], v[188:191], v[80:95]
    ds_read_b64_tr_b16 a[236:237], v3 offset:33984
    ds_read_b64_tr_b16 a[238:239], v3 offset:34496
    buffer_load_dwordx4 v16, s[8:11], s93 offen offset:2112 nt lds
    v_exp_f32 v26, v142
    v_exp_f32 v27, v143
    s_waitcnt lgkmcnt(8)
    v_mfma_f32_32x32x16_bf16 v[96:111], a[248:251], v[188:191], v[96:111]
    ds_read_b64_tr_b16 a[240:241], v3 offset:42240
    ds_read_b64_tr_b16 a[242:243], v3 offset:42752
    v_add_f32 v28, v28, v26
    v_cvt_pk_bf16_f32 v183, v26, v27
    v_add_f32 v29, v29, v27
    v_mfma_f32_32x32x16_bf16 v[112:127], a[252:255], v[188:191], v[112:127]
    ds_read_b64_tr_b16 a[244:245], v3 offset:42304
    ds_read_b64_tr_b16 a[246:247], v3 offset:42816
    buffer_load_dwordx4 v18, s[4:7], s95 offen offset:3136 nt lds
    v_add_f32 v28, v28, v29
    v_cmp_nge_f32 vcc, s32, v28
    s_cbranch_vccnz L_rs14
L_back14:
    v_add_f32 v22, v22, v28
    s_waitcnt lgkmcnt(8)
    v_mfma_f32_32x32x16_bf16 v[192:207], a[224:227], a[16:19], v[192:207]
    ds_read_b64_tr_b16 a[248:249], v3 offset:42368
    ds_read_b64_tr_b16 a[250:251], v3 offset:42880
    v_exp_f32 v24, v144
    v_exp_f32 v25, v145
    v_mfma_f32_32x32x16_bf16 v[208:223], a[228:231], a[16:19], v[208:223]
    ds_read_b64_tr_b16 a[252:253], v3 offset:42432
    ds_read_b64_tr_b16 a[254:255], v3 offset:42944
    v_cvt_pk_bf16_f32 v184, v24, v25
    v_add_f32 v28, v24, v25
    s_waitcnt lgkmcnt(8)
    v_mfma_f32_32x32x16_bf16 v[224:239], a[232:235], a[16:19], v[224:239]
    ds_read_b64_tr_b16 a[224:225], v3 offset:34816
    ds_read_b64_tr_b16 a[226:227], v3 offset:35328
    v_mfma_f32_32x32x16_bf16 v[240:255], a[236:239], a[16:19], v[240:255]
    ds_read_b64_tr_b16 a[228:229], v3 offset:34880
    ds_read_b64_tr_b16 a[230:231], v3 offset:35392
    v_exp_f32 v26, v146
    v_exp_f32 v27, v147
    s_waitcnt lgkmcnt(8)
    v_mfma_f32_32x32x16_bf16 v[192:207], a[240:243], a[20:23], v[192:207]
    ds_read_b64_tr_b16 a[232:233], v3 offset:34944
    ds_read_b64_tr_b16 a[234:235], v3 offset:35456
    v_cvt_pk_bf16_f32 v185, v26, v27
    v_add_f32 v29, v26, v27
    v_mfma_f32_32x32x16_bf16 v[208:223], a[244:247], a[20:23], v[208:223]
    ds_read_b64_tr_b16 a[236:237], v3 offset:35008
    ds_read_b64_tr_b16 a[238:239], v3 offset:35520
    s_waitcnt lgkmcnt(8)
    v_mfma_f32_32x32x16_bf16 v[224:239], a[248:251], a[20:23], v[224:239]
    ds_read_b64_tr_b16 a[240:241], v3 offset:43264
    ds_read_b64_tr_b16 a[242:243], v3 offset:43776
    v_exp_f32 v24, v148
    v_exp_f32 v25, v149
    v_mfma_f32_32x32x16_bf16 v[240:255], a[252:255], a[20:23], v[240:255]
    ds_read_b64_tr_b16 a[244:245], v3 offset:43328
    ds_read_b64_tr_b16 a[246:247], v3 offset:43840
    v_add_f32 v28, v28, v24
    v_cvt_pk_bf16_f32 v186, v24, v25
    v_add_f32 v29, v29, v25
    s_waitcnt lgkmcnt(8)
    v_mfma_f32_32x32x16_bf16 v[192:207], a[224:227], a[24:27], v[192:207]
    ds_read_b64_tr_b16 a[248:249], v3 offset:43392
    ds_read_b64_tr_b16 a[250:251], v3 offset:43904
    s_waitcnt vmcnt(24)
    s_barrier
    s_add_u32 m0, s24, 118272
    s_mov_b32 s93, 147456
    s_mov_b32 s95, 162816
    v_mfma_f32_32x32x16_bf16 v[208:223], a[228:231], a[24:27], v[208:223]
    ds_read_b64_tr_b16 a[252:253], v3 offset:43456
    ds_read_b64_tr_b16 a[254:255], v3 offset:43968
    buffer_load_dwordx4 v15, s[8:11], s93 offen nt lds
    v_exp_f32 v26, v150
    v_exp_f32 v27, v151
    s_waitcnt lgkmcnt(8)
    v_mfma_f32_32x32x16_bf16 v[224:239], a[232:235], a[24:27], v[224:239]
    ds_read_b64_tr_b16 a[224:225], v4 offset:0
    ds_read_b64_tr_b16 a[226:227], v4 offset:512
    v_add_f32 v28, v28, v26
    v_cvt_pk_bf16_f32 v187, v26, v27
    v_add_f32 v29, v29, v27
    v_mfma_f32_32x32x16_bf16 v[240:255], a[236:239], a[24:27], v[240:255]
    ds_read_b64_tr_b16 a[228:229], v4 offset:64
    ds_read_b64_tr_b16 a[230:231], v4 offset:576
    buffer_load_dwordx4 v17, s[4:7], s95 offen offset:1024 nt lds
    s_waitcnt lgkmcnt(8)
    v_mfma_f32_32x32x16_bf16 v[192:207], a[240:243], a[28:31], v[192:207]
    ds_read_b64_tr_b16 a[232:233], v4 offset:128
    ds_read_b64_tr_b16 a[234:235], v4 offset:640
    v_exp_f32 v24, v152
    v_exp_f32 v25, v153
    v_mfma_f32_32x32x16_bf16 v[208:223], a[244:247], a[28:31], v[208:223]
    ds_read_b64_tr_b16 a[236:237], v4 offset:192
    ds_read_b64_tr_b16 a[238:239], v4 offset:704
    buffer_load_dwordx4 v16, s[8:11], s93 offen offset:2112 nt lds
    v_add_f32 v28, v28, v24
    v_cvt_pk_bf16_f32 v188, v24, v25
    v_add_f32 v29, v29, v25
    s_waitcnt lgkmcnt(8)
    v_mfma_f32_32x32x16_bf16 v[224:239], a[248:251], a[28:31], v[224:239]
    ds_read_b64_tr_b16 a[240:241], v4 offset:8448
    ds_read_b64_tr_b16 a[242:243], v4 offset:8960
    v_mfma_f32_32x32x16_bf16 v[240:255], a[252:255], a[28:31], v[240:255]
    ds_read_b64_tr_b16 a[244:245], v4 offset:8512
    ds_read_b64_tr_b16 a[246:247], v4 offset:9024
    buffer_load_dwordx4 v18, s[4:7], s95 offen offset:3136 nt lds
    v_exp_f32 v26, v154
    v_exp_f32 v27, v155
    s_waitcnt lgkmcnt(8)
    v_mfma_f32_32x32x16_bf16 v[64:79], a[224:227], v[176:179], v[64:79]
    ds_read_b64_tr_b16 a[248:249], v4 offset:8576
    ds_read_b64_tr_b16 a[250:251], v4 offset:9088
    v_add_f32 v28, v28, v26
    v_cvt_pk_bf16_f32 v189, v26, v27
    v_add_f32 v29, v29, v27
    v_mfma_f32_32x32x16_bf16 v[80:95], a[228:231], v[176:179], v[80:95]
    ds_read_b64_tr_b16 a[252:253], v4 offset:8640
    ds_read_b64_tr_b16 a[254:255], v4 offset:9152
    s_waitcnt lgkmcnt(8)
    v_mfma_f32_32x32x16_bf16 v[96:111], a[232:235], v[176:179], v[96:111]
    ds_read_b64_tr_b16 a[224:225], v4 offset:1024
    ds_read_b64_tr_b16 a[226:227], v4 offset:1536
    v_exp_f32 v24, v156
    v_exp_f32 v25, v157
    v_mfma_f32_32x32x16_bf16 v[112:127], a[236:239], v[176:179], v[112:127]
    ds_read_b64_tr_b16 a[228:229], v4 offset:1088
    ds_read_b64_tr_b16 a[230:231], v4 offset:1600
    v_add_f32 v28, v28, v24
    v_cvt_pk_bf16_f32 v190, v24, v25
    v_add_f32 v29, v29, v25
    s_waitcnt lgkmcnt(8)
    v_mfma_f32_32x32x16_bf16 v[64:79], a[240:243], v[180:183], v[64:79]
    ds_read_b64_tr_b16 a[232:233], v4 offset:1152
    ds_read_b64_tr_b16 a[234:235], v4 offset:1664
    v_mfma_f32_32x32x16_bf16 v[80:95], a[244:247], v[180:183], v[80:95]
    ds_read_b64_tr_b16 a[236:237], v4 offset:1216
    ds_read_b64_tr_b16 a[238:239], v4 offset:1728
    v_exp_f32 v26, v158
    v_exp_f32 v27, v159
    s_waitcnt lgkmcnt(8)
    v_mfma_f32_32x32x16_bf16 v[96:111], a[248:251], v[180:183], v[96:111]
    ds_read_b64_tr_b16 a[240:241], v4 offset:9472
    ds_read_b64_tr_b16 a[242:243], v4 offset:9984
    v_add_f32 v28, v28, v26
    v_cvt_pk_bf16_f32 v191, v26, v27
    v_add_f32 v29, v29, v27
    v_mfma_f32_32x32x16_bf16 v[112:127], a[252:255], v[180:183], v[112:127]
    ds_read_b64_tr_b16 a[244:245], v4 offset:9536
    ds_read_b64_tr_b16 a[246:247], v4 offset:10048
    v_add_f32 v28, v28, v29
    v_cmp_nge_f32 vcc, s32, v28
    s_cbranch_vccnz L_rs15
L_back15:
    v_add_f32 v22, v22, v28
    s_waitcnt lgkmcnt(8)
    v_mfma_f32_32x32x16_bf16 v[64:79], a[224:227], v[184:187], v[64:79]
    ds_read_b64_tr_b16 a[248:249], v4 offset:9600
    ds_read_b64_tr_b16 a[250:251], v4 offset:10112
    s_waitcnt vmcnt(24)
    s_barrier
    s_add_u32 m0, s24, 135168
    s_mov_b32 s29, 2621952
    s_mov_b32 s30, 2883072
    v_mfma_f32_32x32x16_bf16 v[80:95], a[228:231], v[184:187], v[80:95]
    ds_read_b64_tr_b16 a[252:253], v4 offset:9664
    ds_read_b64_tr_b16 a[254:255], v4 offset:10176
    buffer_load_dwordx4 v13, s[12:15], s29 offen nt lds
    v_mov_b32 v31, v22
    s_waitcnt lgkmcnt(8)
    v_mfma_f32_32x32x16_bf16 v[96:111], a[232:235], v[184:187], v[96:111]
    ds_read_b64_tr_b16 a[224:225], v1 offset:16896
    ds_read_b64_tr_b16 a[226:227], v1 offset:17408
    v_permlane32_swap_b32 v22, v31
    v_mfma_f32_32x32x16_bf16 v[112:127], a[236:239], v[184:187], v[112:127]
    ds_read_b64_tr_b16 a[228:229], v1 offset:16960
    ds_read_b64_tr_b16 a[230:231], v1 offset:17472
    buffer_load_dwordx4 v13, s[12:15], s30 offen offset:1024 nt lds
    v_add_f32 v22, v22, v31
    s_waitcnt lgkmcnt(8)
    v_mfma_f32_32x32x16_bf16 v[64:79], a[240:243], v[188:191], v[64:79]
    ds_read_b64_tr_b16 a[232:233], v1 offset:17024
    ds_read_b64_tr_b16 a[234:235], v1 offset:17536
    v_rcp_f32 v23, v22
    v_mfma_f32_32x32x16_bf16 v[80:95], a[244:247], v[188:191], v[80:95]
    ds_read_b64_tr_b16 a[236:237], v1 offset:17088
    ds_read_b64_tr_b16 a[238:239], v1 offset:17600
    buffer_load_dwordx4 v14, s[12:15], s29 offen offset:2112 nt lds
    s_waitcnt lgkmcnt(8)
    v_mfma_f32_32x32x16_bf16 v[96:111], a[248:251], v[188:191], v[96:111]
    ds_read_b64_tr_b16 a[240:241], v1 offset:25344
    ds_read_b64_tr_b16 a[242:243], v1 offset:25856
    v_mfma_f32_32x32x16_bf16 v[112:127], a[252:255], v[188:191], v[112:127]
    ds_read_b64_tr_b16 a[244:245], v1 offset:25408
    ds_read_b64_tr_b16 a[246:247], v1 offset:25920
    buffer_load_dwordx4 v14, s[12:15], s30 offen offset:3136 nt lds
    s_waitcnt lgkmcnt(8)
    v_mfma_f32_32x32x16_bf16 v[192:207], a[224:227], a[32:35], v[192:207]
    ds_read_b64_tr_b16 a[248:249], v1 offset:25472
    ds_read_b64_tr_b16 a[250:251], v1 offset:25984
    v_mfma_f32_32x32x16_bf16 v[208:223], a[228:231], a[32:35], v[208:223]
    ds_read_b64_tr_b16 a[252:253], v1 offset:25536
    ds_read_b64_tr_b16 a[254:255], v1 offset:26048
    v_mul_f32 v64, v64, v23
    v_mul_f32 v65, v65, v23
    v_cvt_pk_bf16_f32 v32, v64, v65
    v_accvgpr_read_b32 v30, a192
    s_lshr_b32 s23, s24, 10
    s_add_u32 s23, s23, 156160
    s_waitcnt lgkmcnt(8)
    v_mfma_f32_32x32x16_bf16 v[224:239], a[232:235], a[32:35], v[224:239]
    ds_read_b64_tr_b16 a[224:225], v1 offset:17920
    ds_read_b64_tr_b16 a[226:227], v1 offset:18432
    v_mul_f32 v66, v66, v23
    v_mul_f32 v67, v67, v23
    v_cvt_pk_bf16_f32 v33, v66, v67
    v_mov_b32 v31, s23
    v_readfirstlane_b32 s23, v30
    v_mfma_f32_32x32x16_bf16 v[240:255], a[236:239], a[32:35], v[240:255]
    ds_read_b64_tr_b16 a[228:229], v1 offset:17984
    ds_read_b64_tr_b16 a[230:231], v1 offset:18496
    v_mul_f32 v68, v68, v23
    v_mul_f32 v69, v69, v23
    v_cvt_pk_bf16_f32 v34, v68, v69
    s_cmp_eq_u32 s23, 0
    s_cselect_b32 s23, s100, s23
    v_mov_b32 v30, s23
    s_waitcnt lgkmcnt(8)
    v_mfma_f32_32x32x16_bf16 v[192:207], a[240:243], a[36:39], v[192:207]
    ds_read_b64_tr_b16 a[232:233], v1 offset:18048
    ds_read_b64_tr_b16 a[234:235], v1 offset:18560
    v_mul_f32 v70, v70, v23
    v_mul_f32 v71, v71, v23
    v_cvt_pk_bf16_f32 v35, v70, v71
    ds_write_b32 v31, v30
    v_mfma_f32_32x32x16_bf16 v[208:223], a[244:247], a[36:39], v[208:223]
    ds_read_b64_tr_b16 a[236:237], v1 offset:18112
    ds_read_b64_tr_b16 a[238:239], v1 offset:18624
    v_mul_f32 v72, v72, v23
    v_mul_f32 v73, v73, v23
    v_cvt_pk_bf16_f32 v36, v72, v73
    s_waitcnt lgkmcnt(9)
    v_mfma_f32_32x32x16_bf16 v[224:239], a[248:251], a[36:39], v[224:239]
    ds_read_b64_tr_b16 a[240:241], v1 offset:26368
    ds_read_b64_tr_b16 a[242:243], v1 offset:26880
    v_mul_f32 v74, v74, v23
    v_mul_f32 v75, v75, v23
    v_cvt_pk_bf16_f32 v37, v74, v75
    v_mfma_f32_32x32x16_bf16 v[240:255], a[252:255], a[36:39], v[240:255]
    ds_read_b64_tr_b16 a[244:245], v1 offset:26432
    ds_read_b64_tr_b16 a[246:247], v1 offset:26944
    v_mul_f32 v76, v76, v23
    v_mul_f32 v77, v77, v23
    v_cvt_pk_bf16_f32 v38, v76, v77
    s_waitcnt lgkmcnt(6)
    v_mfma_f32_32x32x16_bf16 v[192:207], a[224:227], a[40:43], v[192:207]
    ds_read_b64_tr_b16 a[248:249], v1 offset:26496
    ds_read_b64_tr_b16 a[250:251], v1 offset:27008
    s_waitcnt vmcnt(24)
    s_barrier
    s_add_u32 m0, s24, 0
    s_mov_b32 s93, 155648
    s_mov_b32 s95, 171008
    v_mul_f32 v78, v78, v23
    v_mul_f32 v79, v79, v23
    v_cvt_pk_bf16_f32 v39, v78, v79
    v_mfma_f32_32x32x16_bf16 v[208:223], a[228:231], a[40:43], v[208:223]
    ds_read_b64_tr_b16 a[252:253], v1 offset:26560
    ds_read_b64_tr_b16 a[254:255], v1 offset:27072
    buffer_load_dwordx4 v15, s[8:11], s93 offen nt lds
    v_mul_f32 v80, v80, v23
    v_mul_f32 v81, v81, v23
    s_waitcnt lgkmcnt(8)
    v_mfma_f32_32x32x16_bf16 v[224:239], a[232:235], a[40:43], v[224:239]
    ds_read_b128 a[224:227], v7 offset:33792
    v_cvt_pk_bf16_f32 v40, v80, v81
    v_mul_f32 v82, v82, v23
    v_mul_f32 v83, v83, v23
    v_mfma_f32_32x32x16_bf16 v[240:255], a[236:239], a[40:43], v[240:255]
    ds_read_b128 a[228:231], v10 offset:33792
    buffer_load_dwordx4 v17, s[4:7], s95 offen offset:1024 nt lds
    v_cvt_pk_bf16_f32 v41, v82, v83
    v_mul_f32 v84, v84, v23
    v_mul_f32 v85, v85, v23
    s_waitcnt lgkmcnt(6)
    v_mfma_f32_32x32x16_bf16 v[192:207], a[240:243], a[44:47], v[192:207]
    ds_read_b128 a[232:235], v7 offset:33856
    v_cvt_pk_bf16_f32 v42, v84, v85
    v_mul_f32 v86, v86, v23
    v_mul_f32 v87, v87, v23
    v_mfma_f32_32x32x16_bf16 v[208:223], a[244:247], a[44:47], v[208:223]
    ds_read_b128 a[236:239], v10 offset:33856
    buffer_load_dwordx4 v16, s[8:11], s93 offen offset:2112 nt lds
    v_cvt_pk_bf16_f32 v43, v86, v87
    v_mul_f32 v88, v88, v23
    v_mul_f32 v89, v89, v23
    s_waitcnt lgkmcnt(4)
    v_mfma_f32_32x32x16_bf16 v[224:239], a[248:251], a[44:47], v[224:239]
    ds_read_b128 a[240:243], v7 offset:33920
    v_cvt_pk_bf16_f32 v44, v88, v89
    v_mul_f32 v90, v90, v23
    v_mul_f32 v91, v91, v23
    v_mfma_f32_32x32x16_bf16 v[240:255], a[252:255], a[44:47], v[240:255]
    ds_read_b128 a[244:247], v10 offset:33920
    buffer_load_dwordx4 v18, s[4:7], s95 offen offset:3136 nt lds
    v_cvt_pk_bf16_f32 v45, v90, v91
    v_mul_f32 v92, v92, v23
    v_mul_f32 v93, v93, v23
    s_waitcnt lgkmcnt(4)
    v_mfma_f32_32x32x16_bf16 v[128:143], a[224:227], a[160:163], 0
    ds_read_b128 a[248:251], v7 offset:33984
    v_cvt_pk_bf16_f32 v46, v92, v93
    v_mul_f32 v94, v94, v23
    v_mul_f32 v95, v95, v23
    v_mfma_f32_32x32x16_bf16 v[128:143], a[228:231], a[164:167], v[128:143]
    ds_read_b128 a[252:255], v10 offset:33984
    v_cvt_pk_bf16_f32 v47, v94, v95
    v_mul_f32 v96, v96, v23
    s_waitcnt lgkmcnt(4)
    v_mfma_f32_32x32x16_bf16 v[128:143], a[232:235], a[168:171], v[128:143]
    ds_read_b128 a[224:227], v7 offset:34816
    v_mul_f32 v97, v97, v23
    v_cvt_pk_bf16_f32 v48, v96, v97
    v_mul_f32 v98, v98, v23
    v_mfma_f32_32x32x16_bf16 v[128:143], a[236:239], a[172:175], v[128:143]
    ds_read_b128 a[228:231], v10 offset:34816
    v_mul_f32 v99, v99, v23
    v_cvt_pk_bf16_f32 v49, v98, v99
    v_mul_f32 v100, v100, v23
    s_waitcnt lgkmcnt(4)
    v_mfma_f32_32x32x16_bf16 v[128:143], a[240:243], a[176:179], v[128:143]
    ds_read_b128 a[232:235], v7 offset:34880
    v_mul_f32 v101, v101, v23
    v_cvt_pk_bf16_f32 v50, v100, v101
    v_mul_f32 v102, v102, v23
    v_mfma_f32_32x32x16_bf16 v[128:143], a[244:247], a[180:183], v[128:143]
    ds_read_b128 a[236:239], v10 offset:34880
    v_mul_f32 v103, v103, v23
    v_cvt_pk_bf16_f32 v51, v102, v103
    v_mul_f32 v104, v104, v23
    s_waitcnt lgkmcnt(4)
    v_mfma_f32_32x32x16_bf16 v[128:143], a[248:251], a[184:187], v[128:143]
    ds_read_b128 a[240:243], v7 offset:34944
    v_mul_f32 v105, v105, v23
    v_cvt_pk_bf16_f32 v52, v104, v105
    v_mul_f32 v106, v106, v23
    v_mfma_f32_32x32x16_bf16 v[128:143], a[252:255], a[188:191], v[128:143]
    ds_read_b128 a[244:247], v10 offset:34944
    v_mul_f32 v107, v107, v23
    v_cvt_pk_bf16_f32 v53, v106, v107
    v_mul_f32 v108, v108, v23
    s_waitcnt lgkmcnt(4)
    v_mfma_f32_32x32x16_bf16 v[144:159], a[224:227], a[160:163], 0
    ds_read_b128 a[248:251], v7 offset:35008
    s_waitcnt vmcnt(24)
    s_barrier
    s_add_u32 m0, s24, 16896
    s_mov_b32 s29, 3146240
    s_mov_b32 s30, 3407360
    v_mul_f32 v109, v109, v23
    v_cvt_pk_bf16_f32 v54, v108, v109
    v_mul_f32 v110, v110, v23
    v_mfma_f32_32x32x16_bf16 v[144:159], a[228:231], a[164:167], v[144:159]
    ds_read_b128 a[252:255], v10 offset:35008
    buffer_load_dwordx4 v13, s[12:15], s29 offen nt lds
    v_mul_f32 v111, v111, v23
    v_cvt_pk_bf16_f32 v55, v110, v111
    s_waitcnt lgkmcnt(4)
    v_mfma_f32_32x32x16_bf16 v[144:159], a[232:235], a[168:171], v[144:159]
    ds_read_b64_tr_b16 a[224:225], v2 offset:0
    ds_read_b64_tr_b16 a[226:227], v2 offset:512
    v_max3_f32 v30, v128, v129, v130
    v_max3_f32 v31, v131, v132, v133
    v_max3_f32 v30, v30, v134, v135
    v_max3_f32 v31, v31, v136, v137
    v_max3_f32 v30, v30, v138, v139
    v_max3_f32 v31, v31, v140, v141
    v_max3_f32 v30, v30, v142, v143
    v_mfma_f32_32x32x16_bf16 v[144:159], a[236:239], a[172:175], v[144:159]
    ds_read_b64_tr_b16 a[228:229], v2 offset:64
    ds_read_b64_tr_b16 a[230:231], v2 offset:576
    buffer_load_dwordx4 v13, s[12:15], s30 offen offset:1024 nt lds
    v_max_f32 v30, v30, v31
    v_mov_b32 v31, v30
    s_nop 1
    v_permlane32_swap_b32 v30, v31
    v_max_f32 v30, v30, v31
    v_sub_f32 v30, 0, v30
    v_add_f32 v128, v128, v30
    s_waitcnt lgkmcnt(6)
    v_mfma_f32_32x32x16_bf16 v[144:159], a[240:243], a[176:179], v[144:159]
    ds_read_b64_tr_b16 a[232:233], v2 offset:128
    ds_read_b64_tr_b16 a[234:235], v2 offset:640
    v_add_f32 v129, v129, v30
    v_add_f32 v130, v130, v30
    v_add_f32 v131, v131, v30
    v_add_f32 v132, v132, v30
    v_add_f32 v133, v133, v30
    v_add_f32 v134, v134, v30
    v_mfma_f32_32x32x16_bf16 v[144:159], a[244:247], a[180:183], v[144:159]
    ds_read_b64_tr_b16 a[236:237], v2 offset:192
    ds_read_b64_tr_b16 a[238:239], v2 offset:704
    buffer_load_dwordx4 v14, s[12:15], s29 offen offset:2112 nt lds
    v_add_f32 v135, v135, v30
    v_add_f32 v136, v136, v30
    v_add_f32 v137, v137, v30
    v_add_f32 v138, v138, v30
    v_add_f32 v139, v139, v30
    v_add_f32 v140, v140, v30
    s_waitcnt lgkmcnt(8)
    v_mfma_f32_32x32x16_bf16 v[144:159], a[248:251], a[184:187], v[144:159]
    ds_read_b64_tr_b16 a[240:241], v2 offset:8448
    ds_read_b64_tr_b16 a[242:243], v2 offset:8960
    v_add_f32 v141, v141, v30
    v_add_f32 v142, v142, v30
    v_add_f32 v143, v143, v30
    v_exp_f32 v24, v128
    v_exp_f32 v25, v129
    s_nop 0
    v_cvt_pk_bf16_f32 v176, v24, v25
    v_mfma_f32_32x32x16_bf16 v[144:159], a[252:255], a[188:191], v[144:159]
    ds_read_b64_tr_b16 a[244:245], v2 offset:8512
    ds_read_b64_tr_b16 a[246:247], v2 offset:9024
    buffer_load_dwordx4 v14, s[12:15], s30 offen offset:3136 nt lds
    v_add_f32 v28, v24, v25
    v_exp_f32 v26, v130
    v_exp_f32 v27, v131
    s_nop 0
    v_cvt_pk_bf16_f32 v177, v26, v27
    v_add_f32 v29, v26, v27
    v_exp_f32 v24, v132
    v_exp_f32 v25, v133
    s_waitcnt lgkmcnt(8)
    v_mfma_f32_32x32x16_bf16 v[192:207], a[224:227], a[48:51], v[192:207]
    ds_read_b64_tr_b16 a[248:249], v2 offset:8576
    ds_read_b64_tr_b16 a[250:251], v2 offset:9088
    v_add_f32 v28, v28, v24
    v_cvt_pk_bf16_f32 v178, v24, v25
    v_add_f32 v29, v29, v25
    v_exp_f32 v26, v134
    v_exp_f32 v27, v135
    v_add_f32 v28, v28, v26
    v_mfma_f32_32x32x16_bf16 v[208:223], a[228:231], a[48:51], v[208:223]
    ds_read_b64_tr_b16 a[252:253], v2 offset:8640
    ds_read_b64_tr_b16 a[254:255], v2 offset:9152
    v_cvt_pk_bf16_f32 v179, v26, v27
    v_add_f32 v29, v29, v27
    v_exp_f32 v24, v136
    v_exp_f32 v25, v137
    v_add_f32 v28, v28, v24
    v_cvt_pk_bf16_f32 v180, v24, v25
    s_waitcnt lgkmcnt(8)
    v_mfma_f32_32x32x16_bf16 v[224:239], a[232:235], a[48:51], v[224:239]
    ds_read_b64_tr_b16 a[224:225], v2 offset:1024
    ds_read_b64_tr_b16 a[226:227], v2 offset:1536
    v_add_f32 v29, v29, v25
    v_exp_f32 v26, v138
    v_exp_f32 v27, v139
    v_add_f32 v28, v28, v26
    v_cvt_pk_bf16_f32 v181, v26, v27
    v_add_f32 v29, v29, v27
    v_mfma_f32_32x32x16_bf16 v[240:255], a[236:239], a[48:51], v[240:255]
    ds_read_b64_tr_b16 a[228:229], v2 offset:1088
    ds_read_b64_tr_b16 a[230:231], v2 offset:1600
    v_exp_f32 v24, v140
    v_exp_f32 v25, v141
    v_add_f32 v28, v28, v24
    v_cvt_pk_bf16_f32 v182, v24, v25
    v_add_f32 v29, v29, v25
    v_exp_f32 v26, v142
    s_waitcnt lgkmcnt(8)
    v_mfma_f32_32x32x16_bf16 v[192:207], a[240:243], a[52:55], v[192:207]
    ds_read_b64_tr_b16 a[232:233], v2 offset:1152
    ds_read_b64_tr_b16 a[234:235], v2 offset:1664
    v_exp_f32 v27, v143
    v_add_f32 v28, v28, v26
    v_cvt_pk_bf16_f32 v183, v26, v27
    v_add_f32 v29, v29, v27
    v_add_f32 v22, v28, v29
    v_mov_b32 v160, v30
    v_mov_b32 v161, v30
    v_mfma_f32_32x32x16_bf16 v[208:223], a[244:247], a[52:55], v[208:223]
    ds_read_b64_tr_b16 a[236:237], v2 offset:1216
    ds_read_b64_tr_b16 a[238:239], v2 offset:1728
    v_mov_b32 v162, v30
    v_mov_b32 v163, v30
    v_mov_b32 v164, v30
    v_mov_b32 v165, v30
    v_mov_b32 v166, v30
    v_mov_b32 v167, v30
    s_waitcnt lgkmcnt(8)
    v_mfma_f32_32x32x16_bf16 v[224:239], a[248:251], a[52:55], v[224:239]
    ds_read_b64_tr_b16 a[240:241], v2 offset:9472
    ds_read_b64_tr_b16 a[242:243], v2 offset:9984
    v_mov_b32 v168, v30
    v_mov_b32 v169, v30
    v_mov_b32 v170, v30
    v_mov_b32 v171, v30
    v_mov_b32 v172, v30
    v_mov_b32 v173, v30
    v_mfma_f32_32x32x16_bf16 v[240:255], a[252:255], a[52:55], v[240:255]
    ds_read_b64_tr_b16 a[244:245], v2 offset:9536
    ds_read_b64_tr_b16 a[246:247], v2 offset:10048
    v_mov_b32 v174, v30
    v_mov_b32 v175, v30
    v_add_f32 v144, v144, v30
    v_add_f32 v145, v145, v30
    v_add_f32 v146, v146, v30
    v_add_f32 v147, v147, v30
    s_waitcnt lgkmcnt(8)
    v_mfma_f32_32x32x16_bf16 v[192:207], a[224:227], a[56:59], v[192:207]
    ds_read_b64_tr_b16 a[248:249], v2 offset:9600
    ds_read_b64_tr_b16 a[250:251], v2 offset:10112
    s_waitcnt vmcnt(24)
    s_barrier
    s_add_u32 m0, s24, 33792
    s_mov_b32 s93, 163840
    s_mov_b32 s95, 179200
    v_add_f32 v148, v148, v30
    v_add_f32 v149, v149, v30
    v_add_f32 v150, v150, v30
    v_add_f32 v151, v151, v30
    v_add_f32 v152, v152, v30
    v_add_f32 v153, v153, v30
    v_mfma_f32_32x32x16_bf16 v[208:223], a[228:231], a[56:59], v[208:223]
    ds_read_b64_tr_b16 a[252:253], v2 offset:9664
    ds_read_b64_tr_b16 a[254:255], v2 offset:10176
    buffer_load_dwordx4 v15, s[8:11], s93 offen nt lds
    v_add_f32 v154, v154, v30
    v_add_f32 v155, v155, v30
    v_add_f32 v156, v156, v30
    v_add_f32 v157, v157, v30
    v_add_f32 v158, v158, v30
    v_add_f32 v159, v159, v30
    s_waitcnt lgkmcnt(8)
    v_mfma_f32_32x32x16_bf16 v[224:239], a[232:235], a[56:59], v[224:239]
    ds_read_b128 a[224:227], v8 offset:17920
    v_mul_f32 v112, v112, v23
    v_mul_f32 v113, v113, v23
    v_cvt_pk_bf16_f32 v56, v112, v113
    v_mul_f32 v114, v114, v23
    v_mfma_f32_32x32x16_bf16 v[240:255], a[236:239], a[56:59], v[240:255]
    ds_read_b128 a[228:231], v11 offset:17920
    buffer_load_dwordx4 v17, s[4:7], s95 offen offset:1024 nt lds
    v_mul_f32 v115, v115, v23
    v_cvt_pk_bf16_f32 v57, v114, v115
    v_mul_f32 v116, v116, v23
    v_mul_f32 v117, v117, v23
    s_waitcnt lgkmcnt(6)
    v_mfma_f32_32x32x16_bf16 v[192:207], a[240:243], a[60:63], v[192:207]
    ds_read_b128 a[232:235], v8 offset:17984
    v_cvt_pk_bf16_f32 v58, v116, v117
    v_mul_f32 v118, v118, v23
    v_mul_f32 v119, v119, v23
    v_cvt_pk_bf16_f32 v59, v118, v119
    v_mfma_f32_32x32x16_bf16 v[208:223], a[244:247], a[60:63], v[208:223]
    ds_read_b128 a[236:239], v11 offset:17984
    buffer_load_dwordx4 v16, s[8:11], s93 offen offset:2112 nt lds
    v_mul_f32 v120, v120, v23
    v_mul_f32 v121, v121, v23
    v_cvt_pk_bf16_f32 v60, v120, v121
    v_mul_f32 v122, v122, v23
    s_waitcnt lgkmcnt(4)
    v_mfma_f32_32x32x16_bf16 v[224:239], a[248:251], a[60:63], v[224:239]
    ds_read_b128 a[240:243], v8 offset:18048
    v_mul_f32 v123, v123, v23
    v_cvt_pk_bf16_f32 v61, v122, v123
    v_mul_f32 v124, v124, v23
    v_mul_f32 v125, v125, v23
    v_mfma_f32_32x32x16_bf16 v[240:255], a[252:255], a[60:63], v[240:255]
    ds_read_b128 a[244:247], v11 offset:18048
    buffer_load_dwordx4 v18, s[4:7], s95 offen offset:3136 nt lds
    v_cvt_pk_bf16_f32 v62, v124, v125
    v_mul_f32 v126, v126, v23
    v_mul_f32 v127, v127, v23
    v_cvt_pk_bf16_f32 v63, v126, v127
    s_waitcnt lgkmcnt(4)
    v_mfma_f32_32x32x16_bf16 v[128:143], a[224:227], a[160:163], v[160:175]
    ds_read_b128 a[248:251], v8 offset:18112
    v_exp_f32 v24, v144
    v_exp_f32 v25, v145
    v_mfma_f32_32x32x16_bf16 v[128:143], a[228:231], a[164:167], v[128:143]
    ds_read_b128 a[252:255], v11 offset:18112
    v_cvt_pk_bf16_f32 v184, v24, v25
    v_add_f32 v28, v24, v25
    s_waitcnt lgkmcnt(4)
    v_mfma_f32_32x32x16_bf16 v[128:143], a[232:235], a[168:171], v[128:143]
    ds_read_b64_tr_b16 a[224:225], v5 offset:16896
    ds_read_b64_tr_b16 a[226:227], v5 offset:17408
    v_mfma_f32_32x32x16_bf16 v[128:143], a[236:239], a[172:175], v[128:143]
    ds_read_b64_tr_b16 a[228:229], v5 offset:16960
    ds_read_b64_tr_b16 a[230:231], v5 offset:17472
    v_exp_f32 v26, v146
    v_exp_f32 v27, v147
    s_waitcnt lgkmcnt(6)
    v_mfma_f32_32x32x16_bf16 v[128:143], a[240:243], a[176:179], v[128:143]
    ds_read_b64_tr_b16 a[232:233], v5 offset:17024
    ds_read_b64_tr_b16 a[234:235], v5 offset:17536
    v_cvt_pk_bf16_f32 v185, v26, v27
    v_add_f32 v29, v26, v27
    v_mfma_f32_32x32x16_bf16 v[128:143], a[244:247], a[180:183], v[128:143]
    ds_read_b64_tr_b16 a[236:237], v5 offset:17088
    ds_read_b64_tr_b16 a[238:239], v5 offset:17600
    s_waitcnt lgkmcnt(8)
    v_mfma_f32_32x32x16_bf16 v[128:143], a[248:251], a[184:187], v[128:143]
    ds_read_b64_tr_b16 a[240:241], v5 offset:25344
    ds_read_b64_tr_b16 a[242:243], v5 offset:25856
    v_exp_f32 v24, v148
    v_exp_f32 v25, v149
    v_mfma_f32_32x32x16_bf16 v[128:143], a[252:255], a[188:191], v[128:143]
    ds_read_b64_tr_b16 a[244:245], v5 offset:25408
    ds_read_b64_tr_b16 a[246:247], v5 offset:25920
    v_add_f32 v28, v28, v24
    v_cvt_pk_bf16_f32 v186, v24, v25
    v_add_f32 v29, v29, v25
    s_waitcnt lgkmcnt(8)
    v_mfma_f32_32x32x16_bf16 v[64:79], a[224:227], v[176:179], 0
    ds_read_b64_tr_b16 a[248:249], v5 offset:25472
    ds_read_b64_tr_b16 a[250:251], v5 offset:25984
    s_waitcnt vmcnt(24)
    s_barrier
    s_add_u32 m0, s24, 50688
    s_mov_b32 s93, 172032
    s_mov_b32 s95, 187392
    v_mfma_f32_32x32x16_bf16 v[80:95], a[228:231], v[176:179], 0
    ds_read_b64_tr_b16 a[252:253], v5 offset:25536
    ds_read_b64_tr_b16 a[254:255], v5 offset:26048
    buffer_load_dwordx4 v15, s[8:11], s93 offen nt lds
    v_exp_f32 v26, v150
    v_exp_f32 v27, v151
    s_waitcnt lgkmcnt(8)
    v_mfma_f32_32x32x16_bf16 v[96:111], a[232:235], v[176:179], 0
    ds_read_b64_tr_b16 a[224:225], v2 offset:33792
    ds_read_b64_tr_b16 a[226:227], v2 offset:34304
    v_add_f32 v28, v28, v26
    v_cvt_pk_bf16_f32 v187, v26, v27
    v_add_f32 v29, v29, v27
    v_mfma_f32_32x32x16_bf16 v[112:127], a[236:239], v[176:179], 0
    ds_read_b64_tr_b16 a[228:229], v2 offset:33856
    ds_read_b64_tr_b16 a[230:231], v2 offset:34368
    buffer_load_dwordx4 v17, s[4:7], s95 offen offset:1024 nt lds
    s_waitcnt lgkmcnt(8)
    v_mfma_f32_32x32x16_bf16 v[64:79], a[240:243], v[180:183], v[64:79]
    ds_read_b64_tr_b16 a[232:233], v2 offset:33920
    ds_read_b64_tr_b16 a[234:235], v2 offset:34432
    v_exp_f32 v24, v152
    v_exp_f32 v25, v153
    v_mfma_f32_32x32x16_bf16 v[80:95], a[244:247], v[180:183], v[80:95]
    ds_read_b64_tr_b16 a[236:237], v2 offset:33984
    ds_read_b64_tr_b16 a[238:239], v2 offset:34496
    buffer_load_dwordx4 v16, s[8:11], s93 offen offset:2112 nt lds
    v_add_f32 v28, v28, v24
    v_cvt_pk_bf16_f32 v188, v24, v25
    v_add_f32 v29, v29, v25
    s_waitcnt lgkmcnt(8)
    v_mfma_f32_32x32x16_bf16 v[96:111], a[248:251], v[180:183], v[96:111]
    ds_read_b64_tr_b16 a[240:241], v2 offset:42240
    ds_read_b64_tr_b16 a[242:243], v2 offset:42752
    v_mfma_f32_32x32x16_bf16 v[112:127], a[252:255], v[180:183], v[112:127]
    ds_read_b64_tr_b16 a[244:245], v2 offset:42304
    ds_read_b64_tr_b16 a[246:247], v2 offset:42816
    buffer_load_dwordx4 v18, s[4:7], s95 offen offset:3136 nt lds
    v_exp_f32 v26, v154
    v_exp_f32 v27, v155
    s_waitcnt lgkmcnt(8)
    v_mfma_f32_32x32x16_bf16 v[192:207], a[224:227], a[64:67], v[192:207]
    ds_read_b64_tr_b16 a[248:249], v2 offset:42368
    ds_read_b64_tr_b16 a[250:251], v2 offset:42880
    v_add_f32 v28, v28, v26
    v_cvt_pk_bf16_f32 v189, v26, v27
    v_add_f32 v29, v29, v27
    v_mfma_f32_32x32x16_bf16 v[208:223], a[228:231], a[64:67], v[208:223]
    ds_read_b64_tr_b16 a[252:253], v2 offset:42432
    ds_read_b64_tr_b16 a[254:255], v2 offset:42944
    s_waitcnt lgkmcnt(8)
    v_mfma_f32_32x32x16_bf16 v[224:239], a[232:235], a[64:67], v[224:239]
    ds_read_b64_tr_b16 a[224:225], v2 offset:34816
    ds_read_b64_tr_b16 a[226:227], v2 offset:35328
    v_exp_f32 v24, v156
    v_exp_f32 v25, v157
    v_mfma_f32_32x32x16_bf16 v[240:255], a[236:239], a[64:67], v[240:255]
    ds_read_b64_tr_b16 a[228:229], v2 offset:34880
    ds_read_b64_tr_b16 a[230:231], v2 offset:35392
    v_add_f32 v28, v28, v24
    v_cvt_pk_bf16_f32 v190, v24, v25
    v_add_f32 v29, v29, v25
    s_waitcnt lgkmcnt(8)
    v_mfma_f32_32x32x16_bf16 v[192:207], a[240:243], a[68:71], v[192:207]
    ds_read_b64_tr_b16 a[232:233], v2 offset:34944
    ds_read_b64_tr_b16 a[234:235], v2 offset:35456
    v_mfma_f32_32x32x16_bf16 v[208:223], a[244:247], a[68:71], v[208:223]
    ds_read_b64_tr_b16 a[236:237], v2 offset:35008
    ds_read_b64_tr_b16 a[238:239], v2 offset:35520
    v_exp_f32 v26, v158
    v_exp_f32 v27, v159
    s_waitcnt lgkmcnt(8)
    v_mfma_f32_32x32x16_bf16 v[224:239], a[248:251], a[68:71], v[224:239]
    ds_read_b64_tr_b16 a[240:241], v2 offset:43264
    ds_read_b64_tr_b16 a[242:243], v2 offset:43776
    v_add_f32 v28, v28, v26
    v_cvt_pk_bf16_f32 v191, v26, v27
    v_add_f32 v29, v29, v27
    v_mfma_f32_32x32x16_bf16 v[240:255], a[252:255], a[68:71], v[240:255]
    ds_read_b64_tr_b16 a[244:245], v2 offset:43328
    ds_read_b64_tr_b16 a[246:247], v2 offset:43840
    v_add_f32 v28, v28, v29
    v_cmp_nge_f32 vcc, s32, v28
    s_cbranch_vccnz L_rs17
L_back17:
    v_add_f32 v22, v22, v28
    s_waitcnt lgkmcnt(8)
    v_mfma_f32_32x32x16_bf16 v[192:207], a[224:227], a[72:75], v[192:207]
    ds_read_b64_tr_b16 a[248:249], v2 offset:43392
    ds_read_b64_tr_b16 a[250:251], v2 offset:43904
    s_waitcnt vmcnt(24)
    s_barrier
    s_add_u32 m0, s24, 67584
    s_mov_b32 s29, 3670528
    s_mov_b32 s30, 3931648
    v_exp_f32 v24, v128
    v_exp_f32 v25, v129
    v_mfma_f32_32x32x16_bf16 v[208:223], a[228:231], a[72:75], v[208:223]
    ds_read_b64_tr_b16 a[252:253], v2 offset:43456
    ds_read_b64_tr_b16 a[254:255], v2 offset:43968
    buffer_load_dwordx4 v13, s[12:15], s29 offen nt lds
    v_cvt_pk_bf16_f32 v176, v24, v25
    v_add_f32 v28, v24, v25
    s_waitcnt lgkmcnt(8)
    v_mfma_f32_32x32x16_bf16 v[224:239], a[232:235], a[72:75], v[224:239]
    ds_read_b128 a[224:227], v9 offset:1024
    v_mfma_f32_32x32x16_bf16 v[240:255], a[236:239], a[72:75], v[240:255]
    ds_read_b128 a[228:231], v12 offset:1024
    buffer_load_dwordx4 v13, s[12:15], s30 offen offset:1024 nt lds
    v_exp_f32 v26, v130
    v_exp_f32 v27, v131
    s_waitcnt lgkmcnt(6)
    v_mfma_f32_32x32x16_bf16 v[192:207], a[240:243], a[76:79], v[192:207]
    ds_read_b128 a[232:235], v9 offset:1088
    v_cvt_pk_bf16_f32 v177, v26, v27
    v_add_f32 v29, v26, v27
    v_mfma_f32_32x32x16_bf16 v[208:223], a[244:247], a[76:79], v[208:223]
    ds_read_b128 a[236:239], v12 offset:1088
    buffer_load_dwordx4 v14, s[12:15], s29 offen offset:2112 nt lds
    s_waitcnt lgkmcnt(4)
    v_mfma_f32_32x32x16_bf16 v[224:239], a[248:251], a[76:79], v[224:239]
    ds_read_b128 a[240:243], v9 offset:1152
    v_exp_f32 v24, v132
    v_exp_f32 v25, v133
    v_mfma_f32_32x32x16_bf16 v[240:255], a[252:255], a[76:79], v[240:255]
    ds_read_b128 a[244:247], v12 offset:1152
    buffer_load_dwordx4 v14, s[12:15], s30 offen offset:3136 nt lds
    v_add_f32 v28, v28, v24
    v_cvt_pk_bf16_f32 v178, v24, v25
    v_add_f32 v29, v29, v25
    s_waitcnt lgkmcnt(4)
    v_mfma_f32_32x32x16_bf16 v[144:159], a[224:227], a[160:163], v[160:175]
    ds_read_b128 a[248:251], v9 offset:1216
    v_mfma_f32_32x32x16_bf16 v[144:159], a[228:231], a[164:167], v[144:159]
    ds_read_b128 a[252:255], v12 offset:1216
    v_exp_f32 v26, v134
    v_exp_f32 v27, v135
    s_waitcnt lgkmcnt(4)
    v_mfma_f32_32x32x16_bf16 v[144:159], a[232:235], a[168:171], v[144:159]
    ds_read_b64_tr_b16 a[224:225], v6 offset:0
    ds_read_b64_tr_b16 a[226:227], v6 offset:512
    v_add_f32 v28, v28, v26
    v_cvt_pk_bf16_f32 v179, v26, v27
    v_add_f32 v29, v29, v27
    v_mfma_f32_32x32x16_bf16 v[144:159], a[236:239], a[172:175], v[144:159]
    ds_read_b64_tr_b16 a[228:229], v6 offset:64
    ds_read_b64_tr_b16 a[230:231], v6 offset:576
    s_waitcnt lgkmcnt(6)
    v_mfma_f32_32x32x16_bf16 v[144:159], a[240:243], a[176:179], v[144:159]
    ds_read_b64_tr_b16 a[232:233], v6 offset:128
    ds_read_b64_tr_b16 a[234:235], v6 offset:640
    v_exp_f32 v24, v136
    v_exp_f32 v25, v137
    v_mfma_f32_32x32x16_bf16 v[144:159], a[244:247], a[180:183], v[144:159]
    ds_read_b64_tr_b16 a[236:237], v6 offset:192
    ds_read_b64_tr_b16 a[238:239], v6 offset:704
    v_add_f32 v28, v28, v24
    v_cvt_pk_bf16_f32 v180, v24, v25
    v_add_f32 v29, v29, v25
    s_waitcnt lgkmcnt(8)
    v_mfma_f32_32x32x16_bf16 v[144:159], a[248:251], a[184:187], v[144:159]
    ds_read_b64_tr_b16 a[240:241], v6 offset:8448
    ds_read_b64_tr_b16 a[242:243], v6 offset:8960
    v_mfma_f32_32x32x16_bf16 v[144:159], a[252:255], a[188:191], v[144:159]
    ds_read_b64_tr_b16 a[244:245], v6 offset:8512
    ds_read_b64_tr_b16 a[246:247], v6 offset:9024
    v_exp_f32 v26, v138
    v_exp_f32 v27, v139
    s_waitcnt lgkmcnt(8)
    v_mfma_f32_32x32x16_bf16 v[64:79], a[224:227], v[184:187], v[64:79]
    ds_read_b64_tr_b16 a[248:249], v6 offset:8576
    ds_read_b64_tr_b16 a[250:251], v6 offset:9088
    s_waitcnt vmcnt(24)
    s_barrier
    s_add_u32 m0, s24, 84480
    s_mov_b32 s93, 180224
    s_mov_b32 s95, 195584
    v_add_f32 v28, v28, v26
    v_cvt_pk_bf16_f32 v181, v26, v27
    v_add_f32 v29, v29, v27
    v_mfma_f32_32x32x16_bf16 v[80:95], a[228:231], v[184:187], v[80:95]
    ds_read_b64_tr_b16 a[252:253], v6 offset:8640
    ds_read_b64_tr_b16 a[254:255], v6 offset:9152
    buffer_load_dwordx4 v15, s[8:11], s93 offen nt lds
    s_waitcnt lgkmcnt(8)
    v_mfma_f32_32x32x16_bf16 v[96:111], a[232:235], v[184:187], v[96:111]
    ds_read_b128 a[224:227], v9 offset:17920
    v_exp_f32 v24, v140
    v_exp_f32 v25, v141
    v_mfma_f32_32x32x16_bf16 v[112:127], a[236:239], v[184:187], v[112:127]
    ds_read_b128 a[228:231], v12 offset:17920
    buffer_load_dwordx4 v17, s[4:7], s95 offen offset:1024 nt lds
    v_add_f32 v28, v28, v24
    v_cvt_pk_bf16_f32 v182, v24, v25
    v_add_f32 v29, v29, v25
    s_waitcnt lgkmcnt(6)
    v_mfma_f32_32x32x16_bf16 v[64:79], a[240:243], v[188:191], v[64:79]
    ds_read_b128 a[232:235], v9 offset:17984
    v_mfma_f32_32x32x16_bf16 v[80:95], a[244:247], v[188:191], v[80:95]
    ds_read_b128 a[236:239], v12 offset:17984
    buffer_load_dwordx4 v16, s[8:11], s93 offen offset:2112 nt lds
    v_exp_f32 v26, v142
    v_exp_f32 v27, v143
    s_waitcnt lgkmcnt(4)
    v_mfma_f32_32x32x16_bf16 v[96:111], a[248:251], v[188:191], v[96:111]
    ds_read_b128 a[240:243], v9 offset:18048
    v_add_f32 v28, v28, v26
    v_cvt_pk_bf16_f32 v183, v26, v27
    v_add_f32 v29, v29, v27
    v_mfma_f32_32x32x16_bf16 v[112:127], a[252:255], v[188:191], v[112:127]
    ds_read_b128 a[244:247], v12 offset:18048
    buffer_load_dwordx4 v18, s[4:7], s95 offen offset:3136 nt lds
    v_add_f32 v28, v28, v29
    v_cmp_nge_f32 vcc, s32, v28
    s_cbranch_vccnz L_rs18
L_back18:
    v_add_f32 v22, v22, v28
    s_waitcnt lgkmcnt(4)
    v_mfma_f32_32x32x16_bf16 v[128:143], a[224:227], a[160:163], v[160:175]
    ds_read_b128 a[248:251], v9 offset:18112
    v_exp_f32 v24, v144
    v_exp_f32 v25, v145
    v_mfma_f32_32x32x16_bf16 v[128:143], a[228:231], a[164:167], v[128:143]
    ds_read_b128 a[252:255], v12 offset:18112
    v_cvt_pk_bf16_f32 v184, v24, v25
    v_add_f32 v28, v24, v25
    s_waitcnt lgkmcnt(4)
    v_mfma_f32_32x32x16_bf16 v[128:143], a[232:235], a[168:171], v[128:143]
    ds_read_b64_tr_b16 a[224:225], v6 offset:16896
    ds_read_b64_tr_b16 a[226:227], v6 offset:17408
    v_mfma_f32_32x32x16_bf16 v[128:143], a[236:239], a[172:175], v[128:143]
    ds_read_b64_tr_b16 a[228:229], v6 offset:16960
    ds_read_b64_tr_b16 a[230:231], v6 offset:17472
    v_exp_f32 v26, v146
    v_exp_f32 v27, v147
    s_waitcnt lgkmcnt(6)
    v_mfma_f32_32x32x16_bf16 v[128:143], a[240:243], a[176:179], v[128:143]
    ds_read_b64_tr_b16 a[232:233], v6 offset:17024
    ds_read_b64_tr_b16 a[234:235], v6 offset:17536
    v_cvt_pk_bf16_f32 v185, v26, v27
    v_add_f32 v29, v26, v27
    v_mfma_f32_32x32x16_bf16 v[128:143], a[244:247], a[180:183], v[128:143]
    ds_read_b64_tr_b16 a[236:237], v6 offset:17088
    ds_read_b64_tr_b16 a[238:239], v6 offset:17600
    s_waitcnt lgkmcnt(8)
    v_mfma_f32_32x32x16_bf16 v[128:143], a[248:251], a[184:187], v[128:143]
    ds_read_b64_tr_b16 a[240:241], v6 offset:25344
    ds_read_b64_tr_b16 a[242:243], v6 offset:25856
    v_exp_f32 v24, v148
    v_exp_f32 v25, v149
    v_mfma_f32_32x32x16_bf16 v[128:143], a[252:255], a[188:191], v[128:143]
    ds_read_b64_tr_b16 a[244:245], v6 offset:25408
    ds_read_b64_tr_b16 a[246:247], v6 offset:25920
    v_add_f32 v28, v28, v24
    v_cvt_pk_bf16_f32 v186, v24, v25
    v_add_f32 v29, v29, v25
    s_waitcnt lgkmcnt(8)
    v_mfma_f32_32x32x16_bf16 v[64:79], a[224:227], v[176:179], v[64:79]
    ds_read_b64_tr_b16 a[248:249], v6 offset:25472
    ds_read_b64_tr_b16 a[250:251], v6 offset:25984
    s_waitcnt vmcnt(24)
    s_barrier
    s_add_u32 m0, s24, 101376
    s_mov_b32 s29, 4194816
    s_mov_b32 s30, 4455936
    v_mfma_f32_32x32x16_bf16 v[80:95], a[228:231], v[176:179], v[80:95]
    ds_read_b64_tr_b16 a[252:253], v6 offset:25536
    ds_read_b64_tr_b16 a[254:255], v6 offset:26048
    buffer_load_dwordx4 v13, s[12:15], s29 offen nt lds
    v_exp_f32 v26, v150
    v_exp_f32 v27, v151
    s_waitcnt lgkmcnt(8)
    v_mfma_f32_32x32x16_bf16 v[96:111], a[232:235], v[176:179], v[96:111]
    ds_read_b64_tr_b16 a[224:225], v3 offset:33792
    ds_read_b64_tr_b16 a[226:227], v3 offset:34304
    v_add_f32 v28, v28, v26
    v_cvt_pk_bf16_f32 v187, v26, v27
    v_add_f32 v29, v29, v27
    v_mfma_f32_32x32x16_bf16 v[112:127], a[236:239], v[176:179], v[112:127]
    ds_read_b64_tr_b16 a[228:229], v3 offset:33856
    ds_read_b64_tr_b16 a[230:231], v3 offset:34368
    buffer_load_dwordx4 v13, s[12:15], s30 offen offset:1024 nt lds
    s_waitcnt lgkmcnt(8)
    v_mfma_f32_32x32x16_bf16 v[64:79], a[240:243], v[180:183], v[64:79]
    ds_read_b64_tr_b16 a[232:233], v3 offset:33920
    ds_read_b64_tr_b16 a[234:235], v3 offset:34432
    v_exp_f32 v24, v152
    v_exp_f32 v25, v153
    v_mfma_f32_32x32x16_bf16 v[80:95], a[244:247], v[180:183], v[80:95]
    ds_read_b64_tr_b16 a[236:237], v3 offset:33984
    ds_read_b64_tr_b16 a[238:239], v3 offset:34496
    buffer_load_dwordx4 v14, s[12:15], s29 offen offset:2112 nt lds
    v_add_f32 v28, v28, v24
    v_cvt_pk_bf16_f32 v188, v24, v25
    v_add_f32 v29, v29, v25
    s_waitcnt lgkmcnt(8)
    v_mfma_f32_32x32x16_bf16 v[96:111], a[248:251], v[180:183], v[96:111]
    ds_read_b64_tr_b16 a[240:241], v3 offset:42240
    ds_read_b64_tr_b16 a[242:243], v3 offset:42752
    v_mfma_f32_32x32x16_bf16 v[112:127], a[252:255], v[180:183], v[112:127]
    ds_read_b64_tr_b16 a[244:245], v3 offset:42304
    ds_read_b64_tr_b16 a[246:247], v3 offset:42816
    buffer_load_dwordx4 v14, s[12:15], s30 offen offset:3136 nt lds
    v_exp_f32 v26, v154
    v_exp_f32 v27, v155
    s_waitcnt lgkmcnt(8)
    v_mfma_f32_32x32x16_bf16 v[192:207], a[224:227], a[80:83], v[192:207]
    ds_read_b64_tr_b16 a[248:249], v3 offset:42368
    ds_read_b64_tr_b16 a[250:251], v3 offset:42880
    v_add_f32 v28, v28, v26
    v_cvt_pk_bf16_f32 v189, v26, v27
    v_add_f32 v29, v29, v27
    v_mfma_f32_32x32x16_bf16 v[208:223], a[228:231], a[80:83], v[208:223]
    ds_read_b64_tr_b16 a[252:253], v3 offset:42432
    ds_read_b64_tr_b16 a[254:255], v3 offset:42944
    s_waitcnt lgkmcnt(8)
    v_mfma_f32_32x32x16_bf16 v[224:239], a[232:235], a[80:83], v[224:239]
    ds_read_b64_tr_b16 a[224:225], v3 offset:34816
    ds_read_b64_tr_b16 a[226:227], v3 offset:35328
    v_exp_f32 v24, v156
    v_exp_f32 v25, v157
    v_mfma_f32_32x32x16_bf16 v[240:255], a[236:239], a[80:83], v[240:255]
    ds_read_b64_tr_b16 a[228:229], v3 offset:34880
    ds_read_b64_tr_b16 a[230:231], v3 offset:35392
    v_add_f32 v28, v28, v24
    v_cvt_pk_bf16_f32 v190, v24, v25
    v_add_f32 v29, v29, v25
    s_waitcnt lgkmcnt(8)
    v_mfma_f32_32x32x16_bf16 v[192:207], a[240:243], a[84:87], v[192:207]
    ds_read_b64_tr_b16 a[232:233], v3 offset:34944
    ds_read_b64_tr_b16 a[234:235], v3 offset:35456
    v_mfma_f32_32x32x16_bf16 v[208:223], a[244:247], a[84:87], v[208:223]
    ds_read_b64_tr_b16 a[236:237], v3 offset:35008
    ds_read_b64_tr_b16 a[238:239], v3 offset:35520
    v_exp_f32 v26, v158
    v_exp_f32 v27, v159
    s_waitcnt lgkmcnt(8)
    v_mfma_f32_32x32x16_bf16 v[224:239], a[248:251], a[84:87], v[224:239]
    ds_read_b64_tr_b16 a[240:241], v3 offset:43264
    ds_read_b64_tr_b16 a[242:243], v3 offset:43776
    v_add_f32 v28, v28, v26
    v_cvt_pk_bf16_f32 v191, v26, v27
    v_add_f32 v29, v29, v27
    v_mfma_f32_32x32x16_bf16 v[240:255], a[252:255], a[84:87], v[240:255]
    ds_read_b64_tr_b16 a[244:245], v3 offset:43328
    ds_read_b64_tr_b16 a[246:247], v3 offset:43840
    v_add_f32 v28, v28, v29
    v_cmp_nge_f32 vcc, s32, v28
    s_cbranch_vccnz L_rs19
L_back19:
    v_add_f32 v22, v22, v28
    s_waitcnt lgkmcnt(8)
    v_mfma_f32_32x32x16_bf16 v[192:207], a[224:227], a[88:91], v[192:207]
    ds_read_b64_tr_b16 a[248:249], v3 offset:43392
    ds_read_b64_tr_b16 a[250:251], v3 offset:43904
    s_waitcnt vmcnt(24)
    s_barrier
    s_add_u32 m0, s24, 118272
    s_mov_b32 s93, 188416
    s_mov_b32 s95, 203776
    v_exp_f32 v24, v128
    v_exp_f32 v25, v129
    v_mfma_f32_32x32x16_bf16 v[208:223], a[228:231], a[88:91], v[208:223]
    ds_read_b64_tr_b16 a[252:253], v3 offset:43456
    ds_read_b64_tr_b16 a[254:255], v3 offset:43968
    buffer_load_dwordx4 v15, s[8:11], s93 offen nt lds
    s_waitcnt lgkmcnt(8)
    v_mfma_f32_32x32x16_bf16 v[224:239], a[232:235], a[88:91], v[224:239]
    ds_read_b128 a[224:227], v7 offset:1024
    v_cvt_pk_bf16_f32 v176, v24, v25
    v_add_f32 v28, v24, v25
    v_mfma_f32_32x32x16_bf16 v[240:255], a[236:239], a[88:91], v[240:255]
    ds_read_b128 a[228:231], v10 offset:1024
    buffer_load_dwordx4 v17, s[4:7], s95 offen offset:1024 nt lds
    s_waitcnt lgkmcnt(6)
    v_mfma_f32_32x32x16_bf16 v[192:207], a[240:243], a[92:95], v[192:207]
    ds_read_b128 a[232:235], v7 offset:1088
    v_exp_f32 v26, v130
    v_exp_f32 v27, v131
    v_mfma_f32_32x32x16_bf16 v[208:223], a[244:247], a[92:95], v[208:223]
    ds_read_b128 a[236:239], v10 offset:1088
    buffer_load_dwordx4 v16, s[8:11], s93 offen offset:2112 nt lds
    s_waitcnt lgkmcnt(4)
    v_mfma_f32_32x32x16_bf16 v[224:239], a[248:251], a[92:95], v[224:239]
    ds_read_b128 a[240:243], v7 offset:1152
    v_cvt_pk_bf16_f32 v177, v26, v27
    v_add_f32 v29, v26, v27
    v_mfma_f32_32x32x16_bf16 v[240:255], a[252:255], a[92:95], v[240:255]
    ds_read_b128 a[244:247], v10 offset:1152
    buffer_load_dwordx4 v18, s[4:7], s95 offen offset:3136 nt lds
    s_waitcnt lgkmcnt(4)
    v_mfma_f32_32x32x16_bf16 v[144:159], a[224:227], a[160:163], v[160:175]
    ds_read_b128 a[248:251], v7 offset:1216
    v_exp_f32 v24, v132
    v_exp_f32 v25, v133
    v_mfma_f32_32x32x16_bf16 v[144:159], a[228:231], a[164:167], v[144:159]
    ds_read_b128 a[252:255], v10 offset:1216
    s_waitcnt lgkmcnt(4)
    v_mfma_f32_32x32x16_bf16 v[144:159], a[232:235], a[168:171], v[144:159]
    ds_read_b64_tr_b16 a[224:225], v4 offset:0
    ds_read_b64_tr_b16 a[226:227], v4 offset:512
    v_add_f32 v28, v28, v24
    v_cvt_pk_bf16_f32 v178, v24, v25
    v_add_f32 v29, v29, v25
    v_mfma_f32_32x32x16_bf16 v[144:159], a[236:239], a[172:175], v[144:159]
    ds_read_b64_tr_b16 a[228:229], v4 offset:64
    ds_read_b64_tr_b16 a[230:231], v4 offset:576
    s_waitcnt lgkmcnt(6)
    v_mfma_f32_32x32x16_bf16 v[144:159], a[240:243], a[176:179], v[144:159]
    ds_read_b64_tr_b16 a[232:233], v4 offset:128
    ds_read_b64_tr_b16 a[234:235], v4 offset:640
    v_exp_f32 v26, v134
    v_exp_f32 v27, v135
    v_mfma_f32_32x32x16_bf16 v[144:159], a[244:247], a[180:183], v[144:159]
    ds_read_b64_tr_b16 a[236:237], v4 offset:192
    ds_read_b64_tr_b16 a[238:239], v4 offset:704
    s_waitcnt lgkmcnt(8)
    v_mfma_f32_32x32x16_bf16 v[144:159], a[248:251], a[184:187], v[144:159]
    ds_read_b64_tr_b16 a[240:241], v4 offset:8448
    ds_read_b64_tr_b16 a[242:243], v4 offset:8960
    v_add_f32 v28, v28, v26
    v_cvt_pk_bf16_f32 v179, v26, v27
    v_add_f32 v29, v29, v27
    v_mfma_f32_32x32x16_bf16 v[144:159], a[252:255], a[188:191], v[144:159]
    ds_read_b64_tr_b16 a[244:245], v4 offset:8512
    ds_read_b64_tr_b16 a[246:247], v4 offset:9024
    s_waitcnt lgkmcnt(8)
    v_mfma_f32_32x32x16_bf16 v[64:79], a[224:227], v[184:187], v[64:79]
    ds_read_b64_tr_b16 a[248:249], v4 offset:8576
    ds_read_b64_tr_b16 a[250:251], v4 offset:9088
    s_waitcnt vmcnt(24)
    s_barrier
    s_add_u32 m0, s24, 135168
    s_mov_b32 s29, 4719104
    s_mov_b32 s30, 4980224
    v_exp_f32 v24, v136
    v_exp_f32 v25, v137
    v_mfma_f32_32x32x16_bf16 v[80:95], a[228:231], v[184:187], v[80:95]
    ds_read_b64_tr_b16 a[252:253], v4 offset:8640
    ds_read_b64_tr_b16 a[254:255], v4 offset:9152
    buffer_load_dwordx4 v13, s[12:15], s29 offen nt lds
    s_waitcnt lgkmcnt(8)
    v_mfma_f32_32x32x16_bf16 v[96:111], a[232:235], v[184:187], v[96:111]
    ds_read_b64_tr_b16 a[224:225], v1 offset:16896
    ds_read_b64_tr_b16 a[226:227], v1 offset:17408
    v_add_f32 v28, v28, v24
    v_cvt_pk_bf16_f32 v180, v24, v25
    v_add_f32 v29, v29, v25
    v_mfma_f32_32x32x16_bf16 v[112:127], a[236:239], v[184:187], v[112:127]
    ds_read_b64_tr_b16 a[228:229], v1 offset:16960
    ds_read_b64_tr_b16 a[230:231], v1 offset:17472
    buffer_load_dwordx4 v13, s[12:15], s30 offen offset:1024 nt lds
    s_waitcnt lgkmcnt(8)
    v_mfma_f32_32x32x16_bf16 v[64:79], a[240:243], v[188:191], v[64:79]
    ds_read_b64_tr_b16 a[232:233], v1 offset:17024
    ds_read_b64_tr_b16 a[234:235], v1 offset:17536
    v_exp_f32 v26, v138
    v_exp_f32 v27, v139
    v_mfma_f32_32x32x16_bf16 v[80:95], a[244:247], v[188:191], v[80:95]
    ds_read_b64_tr_b16 a[236:237], v1 offset:17088
    ds_read_b64_tr_b16 a[238:239], v1 offset:17600
    buffer_load_dwordx4 v14, s[12:15], s29 offen offset:2112 nt lds
    s_waitcnt lgkmcnt(8)
    v_mfma_f32_32x32x16_bf16 v[96:111], a[248:251], v[188:191], v[96:111]
    ds_read_b64_tr_b16 a[240:241], v1 offset:25344
    ds_read_b64_tr_b16 a[242:243], v1 offset:25856
    v_add_f32 v28, v28, v26
    v_cvt_pk_bf16_f32 v181, v26, v27
    v_add_f32 v29, v29, v27
    v_mfma_f32_32x32x16_bf16 v[112:127], a[252:255], v[188:191], v[112:127]
    ds_read_b64_tr_b16 a[244:245], v1 offset:25408
    ds_read_b64_tr_b16 a[246:247], v1 offset:25920
    buffer_load_dwordx4 v14, s[12:15], s30 offen offset:3136 nt lds
    s_waitcnt lgkmcnt(8)
    v_mfma_f32_32x32x16_bf16 v[192:207], a[224:227], a[96:99], v[192:207]
    ds_read_b64_tr_b16 a[248:249], v1 offset:25472
    ds_read_b64_tr_b16 a[250:251], v1 offset:25984
    v_exp_f32 v24, v140
    v_exp_f32 v25, v141
    v_mfma_f32_32x32x16_bf16 v[208:223], a[228:231], a[96:99], v[208:223]
    ds_read_b64_tr_b16 a[252:253], v1 offset:25536
    ds_read_b64_tr_b16 a[254:255], v1 offset:26048
    s_waitcnt lgkmcnt(8)
    v_mfma_f32_32x32x16_bf16 v[224:239], a[232:235], a[96:99], v[224:239]
    ds_read_b64_tr_b16 a[224:225], v1 offset:17920
    ds_read_b64_tr_b16 a[226:227], v1 offset:18432
    v_add_f32 v28, v28, v24
    v_cvt_pk_bf16_f32 v182, v24, v25
    v_add_f32 v29, v29, v25
    v_mfma_f32_32x32x16_bf16 v[240:255], a[236:239], a[96:99], v[240:255]
    ds_read_b64_tr_b16 a[228:229], v1 offset:17984
    ds_read_b64_tr_b16 a[230:231], v1 offset:18496
    s_waitcnt lgkmcnt(8)
    v_mfma_f32_32x32x16_bf16 v[192:207], a[240:243], a[100:103], v[192:207]
    ds_read_b64_tr_b16 a[232:233], v1 offset:18048
    ds_read_b64_tr_b16 a[234:235], v1 offset:18560
    v_exp_f32 v26, v142
    v_exp_f32 v27, v143
    v_mfma_f32_32x32x16_bf16 v[208:223], a[244:247], a[100:103], v[208:223]
    ds_read_b64_tr_b16 a[236:237], v1 offset:18112
    ds_read_b64_tr_b16 a[238:239], v1 offset:18624
    s_waitcnt lgkmcnt(8)
    v_mfma_f32_32x32x16_bf16 v[224:239], a[248:251], a[100:103], v[224:239]
    ds_read_b64_tr_b16 a[240:241], v1 offset:26368
    ds_read_b64_tr_b16 a[242:243], v1 offset:26880
    v_add_f32 v28, v28, v26
    v_cvt_pk_bf16_f32 v183, v26, v27
    v_add_f32 v29, v29, v27
    v_mfma_f32_32x32x16_bf16 v[240:255], a[252:255], a[100:103], v[240:255]
    ds_read_b64_tr_b16 a[244:245], v1 offset:26432
    ds_read_b64_tr_b16 a[246:247], v1 offset:26944
    v_add_f32 v28, v28, v29
    v_cmp_nge_f32 vcc, s32, v28
    s_cbranch_vccnz L_rs20
L_back20:
    v_add_f32 v22, v22, v28
    s_waitcnt lgkmcnt(8)
    v_mfma_f32_32x32x16_bf16 v[192:207], a[224:227], a[104:107], v[192:207]
    ds_read_b64_tr_b16 a[248:249], v1 offset:26496
    ds_read_b64_tr_b16 a[250:251], v1 offset:27008
    s_waitcnt vmcnt(24)
    s_barrier
    s_add_u32 m0, s24, 0
    s_mov_b32 s93, 196608
    s_mov_b32 s95, 211968
    v_exp_f32 v24, v144
    v_exp_f32 v25, v145
    v_mfma_f32_32x32x16_bf16 v[208:223], a[228:231], a[104:107], v[208:223]
    ds_read_b64_tr_b16 a[252:253], v1 offset:26560
    ds_read_b64_tr_b16 a[254:255], v1 offset:27072
    buffer_load_dwordx4 v15, s[8:11], s93 offen nt lds
    v_cvt_pk_bf16_f32 v184, v24, v25
    v_add_f32 v28, v24, v25
    s_waitcnt lgkmcnt(8)
    v_mfma_f32_32x32x16_bf16 v[224:239], a[232:235], a[104:107], v[224:239]
    ds_read_b128 a[224:227], v7 offset:34816
    v_mfma_f32_32x32x16_bf16 v[240:255], a[236:239], a[104:107], v[240:255]
    ds_read_b128 a[228:231], v10 offset:34816
    buffer_load_dwordx4 v17, s[4:7], s95 offen offset:1024 nt lds
    v_exp_f32 v26, v146
    v_exp_f32 v27, v147
    s_waitcnt lgkmcnt(6)
    v_mfma_f32_32x32x16_bf16 v[192:207], a[240:243], a[108:111], v[192:207]
    ds_read_b128 a[232:235], v7 offset:34880
    v_cvt_pk_bf16_f32 v185, v26, v27
    v_add_f32 v29, v26, v27
    v_mfma_f32_32x32x16_bf16 v[208:223], a[244:247], a[108:111], v[208:223]
    ds_read_b128 a[236:239], v10 offset:34880
    buffer_load_dwordx4 v16, s[8:11], s93 offen offset:2112 nt lds
    s_waitcnt lgkmcnt(4)
    v_mfma_f32_32x32x16_bf16 v[224:239], a[248:251], a[108:111], v[224:239]
    ds_read_b128 a[240:243], v7 offset:34944
    v_exp_f32 v24, v148
    v_exp_f32 v25, v149
    v_mfma_f32_32x32x16_bf16 v[240:255], a[252:255], a[108:111], v[240:255]
    ds_read_b128 a[244:247], v10 offset:34944
    buffer_load_dwordx4 v18, s[4:7], s95 offen offset:3136 nt lds
    v_add_f32 v28, v28, v24
    v_cvt_pk_bf16_f32 v186, v24, v25
    v_add_f32 v29, v29, v25
    s_waitcnt lgkmcnt(4)
    v_mfma_f32_32x32x16_bf16 v[128:143], a[224:227], a[160:163], v[160:175]
    ds_read_b128 a[248:251], v7 offset:35008
    v_mfma_f32_32x32x16_bf16 v[128:143], a[228:231], a[164:167], v[128:143]
    ds_read_b128 a[252:255], v10 offset:35008
    v_exp_f32 v26, v150
    v_exp_f32 v27, v151
    s_waitcnt lgkmcnt(4)
    v_mfma_f32_32x32x16_bf16 v[128:143], a[232:235], a[168:171], v[128:143]
    ds_read_b64_tr_b16 a[224:225], v4 offset:33792
    ds_read_b64_tr_b16 a[226:227], v4 offset:34304
    v_add_f32 v28, v28, v26
    v_cvt_pk_bf16_f32 v187, v26, v27
    v_add_f32 v29, v29, v27
    v_mfma_f32_32x32x16_bf16 v[128:143], a[236:239], a[172:175], v[128:143]
    ds_read_b64_tr_b16 a[228:229], v4 offset:33856
    ds_read_b64_tr_b16 a[230:231], v4 offset:34368
    s_waitcnt lgkmcnt(6)
    v_mfma_f32_32x32x16_bf16 v[128:143], a[240:243], a[176:179], v[128:143]
    ds_read_b64_tr_b16 a[232:233], v4 offset:33920
    ds_read_b64_tr_b16 a[234:235], v4 offset:34432
    v_exp_f32 v24, v152
    v_exp_f32 v25, v153
    v_mfma_f32_32x32x16_bf16 v[128:143], a[244:247], a[180:183], v[128:143]
    ds_read_b64_tr_b16 a[236:237], v4 offset:33984
    ds_read_b64_tr_b16 a[238:239], v4 offset:34496
    v_add_f32 v28, v28, v24
    v_cvt_pk_bf16_f32 v188, v24, v25
    v_add_f32 v29, v29, v25
    s_waitcnt lgkmcnt(8)
    v_mfma_f32_32x32x16_bf16 v[128:143], a[248:251], a[184:187], v[128:143]
    ds_read_b64_tr_b16 a[240:241], v4 offset:42240
    ds_read_b64_tr_b16 a[242:243], v4 offset:42752
    v_mfma_f32_32x32x16_bf16 v[128:143], a[252:255], a[188:191], v[128:143]
    ds_read_b64_tr_b16 a[244:245], v4 offset:42304
    ds_read_b64_tr_b16 a[246:247], v4 offset:42816
    v_exp_f32 v26, v154
    v_exp_f32 v27, v155
    s_waitcnt lgkmcnt(8)
    v_mfma_f32_32x32x16_bf16 v[64:79], a[224:227], v[176:179], v[64:79]
    ds_read_b64_tr_b16 a[248:249], v4 offset:42368
    ds_read_b64_tr_b16 a[250:251], v4 offset:42880
    s_waitcnt vmcnt(24)
    s_barrier
    s_add_u32 m0, s24, 16896
    s_mov_b32 s93, 204800
    s_mov_b32 s95, 220160
    v_add_f32 v28, v28, v26
    v_cvt_pk_bf16_f32 v189, v26, v27
    v_add_f32 v29, v29, v27
    v_mfma_f32_32x32x16_bf16 v[80:95], a[228:231], v[176:179], v[80:95]
    ds_read_b64_tr_b16 a[252:253], v4 offset:42432
    ds_read_b64_tr_b16 a[254:255], v4 offset:42944
    buffer_load_dwordx4 v15, s[8:11], s93 offen nt lds
    s_waitcnt lgkmcnt(8)
    v_mfma_f32_32x32x16_bf16 v[96:111], a[232:235], v[176:179], v[96:111]
    ds_read_b128 a[224:227], v8 offset:1024
    v_exp_f32 v24, v156
    v_exp_f32 v25, v157
    v_mfma_f32_32x32x16_bf16 v[112:127], a[236:239], v[176:179], v[112:127]
    ds_read_b128 a[228:231], v11 offset:1024
    buffer_load_dwordx4 v17, s[4:7], s95 offen offset:1024 nt lds
    v_add_f32 v28, v28, v24
    v_cvt_pk_bf16_f32 v190, v24, v25
    v_add_f32 v29, v29, v25
    s_waitcnt lgkmcnt(6)
    v_mfma_f32_32x32x16_bf16 v[64:79], a[240:243], v[180:183], v[64:79]
    ds_read_b128 a[232:235], v8 offset:1088
    v_mfma_f32_32x32x16_bf16 v[80:95], a[244:247], v[180:183], v[80:95]
    ds_read_b128 a[236:239], v11 offset:1088
    buffer_load_dwordx4 v16, s[8:11], s93 offen offset:2112 nt lds
    v_exp_f32 v26, v158
    v_exp_f32 v27, v159
    s_waitcnt lgkmcnt(4)
    v_mfma_f32_32x32x16_bf16 v[96:111], a[248:251], v[180:183], v[96:111]
    ds_read_b128 a[240:243], v8 offset:1152
    v_add_f32 v28, v28, v26
    v_cvt_pk_bf16_f32 v191, v26, v27
    v_add_f32 v29, v29, v27
    v_mfma_f32_32x32x16_bf16 v[112:127], a[252:255], v[180:183], v[112:127]
    ds_read_b128 a[244:247], v11 offset:1152
    buffer_load_dwordx4 v18, s[4:7], s95 offen offset:3136 nt lds
    v_add_f32 v28, v28, v29
    v_cmp_nge_f32 vcc, s32, v28
    s_cbranch_vccnz L_rs21
L_back21:
    v_add_f32 v22, v22, v28
    s_waitcnt lgkmcnt(4)
    v_mfma_f32_32x32x16_bf16 v[144:159], a[224:227], a[160:163], v[160:175]
    ds_read_b128 a[248:251], v8 offset:1216
    v_exp_f32 v24, v128
    v_exp_f32 v25, v129
    v_mfma_f32_32x32x16_bf16 v[144:159], a[228:231], a[164:167], v[144:159]
    ds_read_b128 a[252:255], v11 offset:1216
    v_cvt_pk_bf16_f32 v176, v24, v25
    v_add_f32 v28, v24, v25
    s_waitcnt lgkmcnt(4)
    v_mfma_f32_32x32x16_bf16 v[144:159], a[232:235], a[168:171], v[144:159]
    ds_read_b64_tr_b16 a[224:225], v5 offset:0
    ds_read_b64_tr_b16 a[226:227], v5 offset:512
    v_mfma_f32_32x32x16_bf16 v[144:159], a[236:239], a[172:175], v[144:159]
    ds_read_b64_tr_b16 a[228:229], v5 offset:64
    ds_read_b64_tr_b16 a[230:231], v5 offset:576
    v_exp_f32 v26, v130
    v_exp_f32 v27, v131
    s_waitcnt lgkmcnt(6)
    v_mfma_f32_32x32x16_bf16 v[144:159], a[240:243], a[176:179], v[144:159]
    ds_read_b64_tr_b16 a[232:233], v5 offset:128
    ds_read_b64_tr_b16 a[234:235], v5 offset:640
    v_cvt_pk_bf16_f32 v177, v26, v27
    v_add_f32 v29, v26, v27
    v_mfma_f32_32x32x16_bf16 v[144:159], a[244:247], a[180:183], v[144:159]
    ds_read_b64_tr_b16 a[236:237], v5 offset:192
    ds_read_b64_tr_b16 a[238:239], v5 offset:704
    s_waitcnt lgkmcnt(8)
    v_mfma_f32_32x32x16_bf16 v[144:159], a[248:251], a[184:187], v[144:159]
    ds_read_b64_tr_b16 a[240:241], v5 offset:8448
    ds_read_b64_tr_b16 a[242:243], v5 offset:8960
    v_exp_f32 v24, v132
    v_exp_f32 v25, v133
    v_mfma_f32_32x32x16_bf16 v[144:159], a[252:255], a[188:191], v[144:159]
    ds_read_b64_tr_b16 a[244:245], v5 offset:8512
    ds_read_b64_tr_b16 a[246:247], v5 offset:9024
    v_add_f32 v28, v28, v24
    v_cvt_pk_bf16_f32 v178, v24, v25
    v_add_f32 v29, v29, v25
    s_waitcnt lgkmcnt(8)
    v_mfma_f32_32x32x16_bf16 v[64:79], a[224:227], v[184:187], v[64:79]
    ds_read_b64_tr_b16 a[248:249], v5 offset:8576
    ds_read_b64_tr_b16 a[250:251], v5 offset:9088
    s_waitcnt vmcnt(24)
    s_barrier
    s_add_u32 m0, s24, 33792
    s_mov_b32 s29, 768
    s_mov_b32 s30, 261888
    v_mfma_f32_32x32x16_bf16 v[80:95], a[228:231], v[184:187], v[80:95]
    ds_read_b64_tr_b16 a[252:253], v5 offset:8640
    ds_read_b64_tr_b16 a[254:255], v5 offset:9152
    buffer_load_dwordx4 v13, s[12:15], s29 offen nt lds
    v_exp_f32 v26, v134
    v_exp_f32 v27, v135
    s_waitcnt lgkmcnt(8)
    v_mfma_f32_32x32x16_bf16 v[96:111], a[232:235], v[184:187], v[96:111]
    ds_read_b64_tr_b16 a[224:225], v2 offset:16896
    ds_read_b64_tr_b16 a[226:227], v2 offset:17408
    v_add_f32 v28, v28, v26
    v_cvt_pk_bf16_f32 v179, v26, v27
    v_add_f32 v29, v29, v27
    v_mfma_f32_32x32x16_bf16 v[112:127], a[236:239], v[184:187], v[112:127]
    ds_read_b64_tr_b16 a[228:229], v2 offset:16960
    ds_read_b64_tr_b16 a[230:231], v2 offset:17472
    buffer_load_dwordx4 v13, s[12:15], s30 offen offset:1024 nt lds
    s_waitcnt lgkmcnt(8)
    v_mfma_f32_32x32x16_bf16 v[64:79], a[240:243], v[188:191], v[64:79]
    ds_read_b64_tr_b16 a[232:233], v2 offset:17024
    ds_read_b64_tr_b16 a[234:235], v2 offset:17536
    v_exp_f32 v24, v136
    v_exp_f32 v25, v137
    v_mfma_f32_32x32x16_bf16 v[80:95], a[244:247], v[188:191], v[80:95]
    ds_read_b64_tr_b16 a[236:237], v2 offset:17088
    ds_read_b64_tr_b16 a[238:239], v2 offset:17600
    buffer_load_dwordx4 v14, s[12:15], s29 offen offset:2112 nt lds
    v_add_f32 v28, v28, v24
    v_cvt_pk_bf16_f32 v180, v24, v25
    v_add_f32 v29, v29, v25
    s_waitcnt lgkmcnt(8)
    v_mfma_f32_32x32x16_bf16 v[96:111], a[248:251], v[188:191], v[96:111]
    ds_read_b64_tr_b16 a[240:241], v2 offset:25344
    ds_read_b64_tr_b16 a[242:243], v2 offset:25856
    v_mfma_f32_32x32x16_bf16 v[112:127], a[252:255], v[188:191], v[112:127]
    ds_read_b64_tr_b16 a[244:245], v2 offset:25408
    ds_read_b64_tr_b16 a[246:247], v2 offset:25920
    buffer_load_dwordx4 v14, s[12:15], s30 offen offset:3136 nt lds
    v_exp_f32 v26, v138
    v_exp_f32 v27, v139
    s_waitcnt lgkmcnt(8)
    v_mfma_f32_32x32x16_bf16 v[192:207], a[224:227], a[112:115], v[192:207]
    ds_read_b64_tr_b16 a[248:249], v2 offset:25472
    ds_read_b64_tr_b16 a[250:251], v2 offset:25984
    v_add_f32 v28, v28, v26
    v_cvt_pk_bf16_f32 v181, v26, v27
    v_add_f32 v29, v29, v27
    v_mfma_f32_32x32x16_bf16 v[208:223], a[228:231], a[112:115], v[208:223]
    ds_read_b64_tr_b16 a[252:253], v2 offset:25536
    ds_read_b64_tr_b16 a[254:255], v2 offset:26048
    s_waitcnt lgkmcnt(8)
    v_mfma_f32_32x32x16_bf16 v[224:239], a[232:235], a[112:115], v[224:239]
    ds_read_b64_tr_b16 a[224:225], v2 offset:17920
    ds_read_b64_tr_b16 a[226:227], v2 offset:18432
    v_exp_f32 v24, v140
    v_exp_f32 v25, v141
    v_mfma_f32_32x32x16_bf16 v[240:255], a[236:239], a[112:115], v[240:255]
    ds_read_b64_tr_b16 a[228:229], v2 offset:17984
    ds_read_b64_tr_b16 a[230:231], v2 offset:18496
    v_add_f32 v28, v28, v24
    v_cvt_pk_bf16_f32 v182, v24, v25
    v_add_f32 v29, v29, v25
    s_waitcnt lgkmcnt(8)
    v_mfma_f32_32x32x16_bf16 v[192:207], a[240:243], a[116:119], v[192:207]
    ds_read_b64_tr_b16 a[232:233], v2 offset:18048
    ds_read_b64_tr_b16 a[234:235], v2 offset:18560
    v_mfma_f32_32x32x16_bf16 v[208:223], a[244:247], a[116:119], v[208:223]
    ds_read_b64_tr_b16 a[236:237], v2 offset:18112
    ds_read_b64_tr_b16 a[238:239], v2 offset:18624
    v_exp_f32 v26, v142
    v_exp_f32 v27, v143
    s_waitcnt lgkmcnt(8)
    v_mfma_f32_32x32x16_bf16 v[224:239], a[248:251], a[116:119], v[224:239]
    ds_read_b64_tr_b16 a[240:241], v2 offset:26368
    ds_read_b64_tr_b16 a[242:243], v2 offset:26880
    v_add_f32 v28, v28, v26
    v_cvt_pk_bf16_f32 v183, v26, v27
    v_add_f32 v29, v29, v27
    v_mfma_f32_32x32x16_bf16 v[240:255], a[252:255], a[116:119], v[240:255]
    ds_read_b64_tr_b16 a[244:245], v2 offset:26432
    ds_read_b64_tr_b16 a[246:247], v2 offset:26944
    v_add_f32 v28, v28, v29
    v_cmp_nge_f32 vcc, s32, v28
    s_cbranch_vccnz L_rs22
L_back22:
    v_add_f32 v22, v22, v28
    s_waitcnt lgkmcnt(8)
    v_mfma_f32_32x32x16_bf16 v[192:207], a[224:227], a[120:123], v[192:207]
    ds_read_b64_tr_b16 a[248:249], v2 offset:26496
    ds_read_b64_tr_b16 a[250:251], v2 offset:27008
    s_waitcnt vmcnt(24)
    s_barrier
    s_add_u32 m0, s24, 50688
    s_mov_b32 s93, 212992
    s_mov_b32 s95, 228352
    v_exp_f32 v24, v144
    v_exp_f32 v25, v145
    v_mfma_f32_32x32x16_bf16 v[208:223], a[228:231], a[120:123], v[208:223]
    ds_read_b64_tr_b16 a[252:253], v2 offset:26560
    ds_read_b64_tr_b16 a[254:255], v2 offset:27072
    buffer_load_dwordx4 v15, s[8:11], s93 offen nt lds
    s_waitcnt lgkmcnt(8)
    v_mfma_f32_32x32x16_bf16 v[224:239], a[232:235], a[120:123], v[224:239]
    ds_read_b128 a[224:227], v8 offset:34816
    v_cvt_pk_bf16_f32 v184, v24, v25
    v_add_f32 v28, v24, v25
    v_mfma_f32_32x32x16_bf16 v[240:255], a[236:239], a[120:123], v[240:255]
    ds_read_b128 a[228:231], v11 offset:34816
    buffer_load_dwordx4 v17, s[4:7], s95 offen offset:1024 nt lds
    s_waitcnt lgkmcnt(6)
    v_mfma_f32_32x32x16_bf16 v[192:207], a[240:243], a[124:127], v[192:207]
    ds_read_b128 a[232:235], v8 offset:34880
    v_exp_f32 v26, v146
    v_exp_f32 v27, v147
    v_mfma_f32_32x32x16_bf16 v[208:223], a[244:247], a[124:127], v[208:223]
    ds_read_b128 a[236:239], v11 offset:34880
    buffer_load_dwordx4 v16, s[8:11], s93 offen offset:2112 nt lds
    s_waitcnt lgkmcnt(4)
    v_mfma_f32_32x32x16_bf16 v[224:239], a[248:251], a[124:127], v[224:239]
    ds_read_b128 a[240:243], v8 offset:34944
    v_cvt_pk_bf16_f32 v185, v26, v27
    v_add_f32 v29, v26, v27
    v_mfma_f32_32x32x16_bf16 v[240:255], a[252:255], a[124:127], v[240:255]
    ds_read_b128 a[244:247], v11 offset:34944
    buffer_load_dwordx4 v18, s[4:7], s95 offen offset:3136 nt lds
    s_waitcnt lgkmcnt(4)
    v_mfma_f32_32x32x16_bf16 v[128:143], a[224:227], a[160:163], v[160:175]
    ds_read_b128 a[248:251], v8 offset:35008
    v_exp_f32 v24, v148
    v_exp_f32 v25, v149
    v_mfma_f32_32x32x16_bf16 v[128:143], a[228:231], a[164:167], v[128:143]
    ds_read_b128 a[252:255], v11 offset:35008
    s_waitcnt lgkmcnt(4)
    v_mfma_f32_32x32x16_bf16 v[128:143], a[232:235], a[168:171], v[128:143]
    ds_read_b64_tr_b16 a[224:225], v5 offset:33792
    ds_read_b64_tr_b16 a[226:227], v5 offset:34304
    v_add_f32 v28, v28, v24
    v_cvt_pk_bf16_f32 v186, v24, v25
    v_add_f32 v29, v29, v25
    v_mfma_f32_32x32x16_bf16 v[128:143], a[236:239], a[172:175], v[128:143]
    ds_read_b64_tr_b16 a[228:229], v5 offset:33856
    ds_read_b64_tr_b16 a[230:231], v5 offset:34368
    s_waitcnt lgkmcnt(6)
    v_mfma_f32_32x32x16_bf16 v[128:143], a[240:243], a[176:179], v[128:143]
    ds_read_b64_tr_b16 a[232:233], v5 offset:33920
    ds_read_b64_tr_b16 a[234:235], v5 offset:34432
    v_exp_f32 v26, v150
    v_exp_f32 v27, v151
    v_mfma_f32_32x32x16_bf16 v[128:143], a[244:247], a[180:183], v[128:143]
    ds_read_b64_tr_b16 a[236:237], v5 offset:33984
    ds_read_b64_tr_b16 a[238:239], v5 offset:34496
    s_waitcnt lgkmcnt(8)
    v_mfma_f32_32x32x16_bf16 v[128:143], a[248:251], a[184:187], v[128:143]
    ds_read_b64_tr_b16 a[240:241], v5 offset:42240
    ds_read_b64_tr_b16 a[242:243], v5 offset:42752
    v_add_f32 v28, v28, v26
    v_cvt_pk_bf16_f32 v187, v26, v27
    v_add_f32 v29, v29, v27
    v_mfma_f32_32x32x16_bf16 v[128:143], a[252:255], a[188:191], v[128:143]
    ds_read_b64_tr_b16 a[244:245], v5 offset:42304
    ds_read_b64_tr_b16 a[246:247], v5 offset:42816
    s_waitcnt lgkmcnt(8)
    v_mfma_f32_32x32x16_bf16 v[64:79], a[224:227], v[176:179], v[64:79]
    ds_read_b64_tr_b16 a[248:249], v5 offset:42368
    ds_read_b64_tr_b16 a[250:251], v5 offset:42880
    s_waitcnt vmcnt(24)
    s_barrier
    s_add_u32 m0, s24, 67584
    s_mov_b32 s29, 525056
    s_mov_b32 s30, 786176
    v_exp_f32 v24, v152
    v_exp_f32 v25, v153
    v_mfma_f32_32x32x16_bf16 v[80:95], a[228:231], v[176:179], v[80:95]
    ds_read_b64_tr_b16 a[252:253], v5 offset:42432
    ds_read_b64_tr_b16 a[254:255], v5 offset:42944
    buffer_load_dwordx4 v13, s[12:15], s29 offen nt lds
    s_waitcnt lgkmcnt(8)
    v_mfma_f32_32x32x16_bf16 v[96:111], a[232:235], v[176:179], v[96:111]
    ds_read_b64_tr_b16 a[224:225], v3 offset:0
    ds_read_b64_tr_b16 a[226:227], v3 offset:512
    v_add_f32 v28, v28, v24
    v_cvt_pk_bf16_f32 v188, v24, v25
    v_add_f32 v29, v29, v25
    v_mfma_f32_32x32x16_bf16 v[112:127], a[236:239], v[176:179], v[112:127]
    ds_read_b64_tr_b16 a[228:229], v3 offset:64
    ds_read_b64_tr_b16 a[230:231], v3 offset:576
    buffer_load_dwordx4 v13, s[12:15], s30 offen offset:1024 nt lds
    s_waitcnt lgkmcnt(8)
    v_mfma_f32_32x32x16_bf16 v[64:79], a[240:243], v[180:183], v[64:79]
    ds_read_b64_tr_b16 a[232:233], v3 offset:128
    ds_read_b64_tr_b16 a[234:235], v3 offset:640
    v_exp_f32 v26, v154
    v_exp_f32 v27, v155
    v_mfma_f32_32x32x16_bf16 v[80:95], a[244:247], v[180:183], v[80:95]
    ds_read_b64_tr_b16 a[236:237], v3 offset:192
    ds_read_b64_tr_b16 a[238:239], v3 offset:704
    buffer_load_dwordx4 v14, s[12:15], s29 offen offset:2112 nt lds
    s_waitcnt lgkmcnt(8)
    v_mfma_f32_32x32x16_bf16 v[96:111], a[248:251], v[180:183], v[96:111]
    ds_read_b64_tr_b16 a[240:241], v3 offset:8448
    ds_read_b64_tr_b16 a[242:243], v3 offset:8960
    v_add_f32 v28, v28, v26
    v_cvt_pk_bf16_f32 v189, v26, v27
    v_add_f32 v29, v29, v27
    v_mfma_f32_32x32x16_bf16 v[112:127], a[252:255], v[180:183], v[112:127]
    ds_read_b64_tr_b16 a[244:245], v3 offset:8512
    ds_read_b64_tr_b16 a[246:247], v3 offset:9024
    buffer_load_dwordx4 v14, s[12:15], s30 offen offset:3136 nt lds
    s_waitcnt lgkmcnt(8)
    v_mfma_f32_32x32x16_bf16 v[192:207], a[224:227], a[128:131], v[192:207]
    ds_read_b64_tr_b16 a[248:249], v3 offset:8576
    ds_read_b64_tr_b16 a[250:251], v3 offset:9088
    v_exp_f32 v24, v156
    v_exp_f32 v25, v157
    v_mfma_f32_32x32x16_bf16 v[208:223], a[228:231], a[128:131], v[208:223]
    ds_read_b64_tr_b16 a[252:253], v3 offset:8640
    ds_read_b64_tr_b16 a[254:255], v3 offset:9152
    s_waitcnt lgkmcnt(8)
    v_mfma_f32_32x32x16_bf16 v[224:239], a[232:235], a[128:131], v[224:239]
    ds_read_b64_tr_b16 a[224:225], v3 offset:1024
    ds_read_b64_tr_b16 a[226:227], v3 offset:1536
    v_add_f32 v28, v28, v24
    v_cvt_pk_bf16_f32 v190, v24, v25
    v_add_f32 v29, v29, v25
    v_mfma_f32_32x32x16_bf16 v[240:255], a[236:239], a[128:131], v[240:255]
    ds_read_b64_tr_b16 a[228:229], v3 offset:1088
    ds_read_b64_tr_b16 a[230:231], v3 offset:1600
    s_waitcnt lgkmcnt(8)
    v_mfma_f32_32x32x16_bf16 v[192:207], a[240:243], a[132:135], v[192:207]
    ds_read_b64_tr_b16 a[232:233], v3 offset:1152
    ds_read_b64_tr_b16 a[234:235], v3 offset:1664
    v_exp_f32 v26, v158
    v_exp_f32 v27, v159
    v_mfma_f32_32x32x16_bf16 v[208:223], a[244:247], a[132:135], v[208:223]
    ds_read_b64_tr_b16 a[236:237], v3 offset:1216
    ds_read_b64_tr_b16 a[238:239], v3 offset:1728
    s_waitcnt lgkmcnt(8)
    v_mfma_f32_32x32x16_bf16 v[224:239], a[248:251], a[132:135], v[224:239]
    ds_read_b64_tr_b16 a[240:241], v3 offset:9472
    ds_read_b64_tr_b16 a[242:243], v3 offset:9984
    v_add_f32 v28, v28, v26
    v_cvt_pk_bf16_f32 v191, v26, v27
    v_add_f32 v29, v29, v27
    v_mfma_f32_32x32x16_bf16 v[240:255], a[252:255], a[132:135], v[240:255]
    ds_read_b64_tr_b16 a[244:245], v3 offset:9536
    ds_read_b64_tr_b16 a[246:247], v3 offset:10048
    v_add_f32 v28, v28, v29
    v_cmp_nge_f32 vcc, s32, v28
    s_cbranch_vccnz L_rs23
L_back23:
    v_add_f32 v22, v22, v28
    s_waitcnt lgkmcnt(8)
    v_mfma_f32_32x32x16_bf16 v[192:207], a[224:227], a[136:139], v[192:207]
    ds_read_b64_tr_b16 a[248:249], v3 offset:9600
    ds_read_b64_tr_b16 a[250:251], v3 offset:10112
    s_waitcnt vmcnt(24)
    s_barrier
    s_add_u32 m0, s24, 84480
    s_mov_b32 s93, 221184
    s_mov_b32 s95, 236544
    v_exp_f32 v24, v128
    v_exp_f32 v25, v129
    v_mfma_f32_32x32x16_bf16 v[208:223], a[228:231], a[136:139], v[208:223]
    ds_read_b64_tr_b16 a[252:253], v3 offset:9664
    ds_read_b64_tr_b16 a[254:255], v3 offset:10176
    buffer_load_dwordx4 v15, s[8:11], s93 offen nt lds
    s_waitcnt lgkmcnt(8)
    v_mfma_f32_32x32x16_bf16 v[224:239], a[232:235], a[136:139], v[224:239]
    ds_read_b128 a[224:227], v9 offset:17920
    v_cvt_pk_bf16_f32 v176, v24, v25
    v_add_f32 v28, v24, v25
    v_mfma_f32_32x32x16_bf16 v[240:255], a[236:239], a[136:139], v[240:255]
    ds_read_b128 a[228:231], v12 offset:17920
    buffer_load_dwordx4 v17, s[4:7], s95 offen offset:1024 nt lds
    s_waitcnt lgkmcnt(6)
    v_mfma_f32_32x32x16_bf16 v[192:207], a[240:243], a[140:143], v[192:207]
    ds_read_b128 a[232:235], v9 offset:17984
    v_exp_f32 v26, v130
    v_exp_f32 v27, v131
    v_mfma_f32_32x32x16_bf16 v[208:223], a[244:247], a[140:143], v[208:223]
    ds_read_b128 a[236:239], v12 offset:17984
    buffer_load_dwordx4 v16, s[8:11], s93 offen offset:2112 nt lds
    s_waitcnt lgkmcnt(4)
    v_mfma_f32_32x32x16_bf16 v[224:239], a[248:251], a[140:143], v[224:239]
    ds_read_b128 a[240:243], v9 offset:18048
    v_cvt_pk_bf16_f32 v177, v26, v27
    v_add_f32 v29, v26, v27
    v_mfma_f32_32x32x16_bf16 v[240:255], a[252:255], a[140:143], v[240:255]
    ds_read_b128 a[244:247], v12 offset:18048
    buffer_load_dwordx4 v18, s[4:7], s95 offen offset:3136 nt lds
    s_waitcnt lgkmcnt(4)
    v_mfma_f32_32x32x16_bf16 v[144:159], a[224:227], a[160:163], v[160:175]
    ds_read_b128 a[248:251], v9 offset:18112
    v_exp_f32 v24, v132
    v_exp_f32 v25, v133
    v_mfma_f32_32x32x16_bf16 v[144:159], a[228:231], a[164:167], v[144:159]
    ds_read_b128 a[252:255], v12 offset:18112
    s_waitcnt lgkmcnt(4)
    v_mfma_f32_32x32x16_bf16 v[144:159], a[232:235], a[168:171], v[144:159]
    ds_read_b64_tr_b16 a[224:225], v6 offset:16896
    ds_read_b64_tr_b16 a[226:227], v6 offset:17408
    v_add_f32 v28, v28, v24
    v_cvt_pk_bf16_f32 v178, v24, v25
    v_add_f32 v29, v29, v25
    v_mfma_f32_32x32x16_bf16 v[144:159], a[236:239], a[172:175], v[144:159]
    ds_read_b64_tr_b16 a[228:229], v6 offset:16960
    ds_read_b64_tr_b16 a[230:231], v6 offset:17472
    s_waitcnt lgkmcnt(6)
    v_mfma_f32_32x32x16_bf16 v[144:159], a[240:243], a[176:179], v[144:159]
    ds_read_b64_tr_b16 a[232:233], v6 offset:17024
    ds_read_b64_tr_b16 a[234:235], v6 offset:17536
    v_exp_f32 v26, v134
    v_exp_f32 v27, v135
    v_mfma_f32_32x32x16_bf16 v[144:159], a[244:247], a[180:183], v[144:159]
    ds_read_b64_tr_b16 a[236:237], v6 offset:17088
    ds_read_b64_tr_b16 a[238:239], v6 offset:17600
    s_waitcnt lgkmcnt(8)
    v_mfma_f32_32x32x16_bf16 v[144:159], a[248:251], a[184:187], v[144:159]
    ds_read_b64_tr_b16 a[240:241], v6 offset:25344
    ds_read_b64_tr_b16 a[242:243], v6 offset:25856
    v_add_f32 v28, v28, v26
    v_cvt_pk_bf16_f32 v179, v26, v27
    v_add_f32 v29, v29, v27
    v_mfma_f32_32x32x16_bf16 v[144:159], a[252:255], a[188:191], v[144:159]
    ds_read_b64_tr_b16 a[244:245], v6 offset:25408
    ds_read_b64_tr_b16 a[246:247], v6 offset:25920
    s_waitcnt lgkmcnt(8)
    v_mfma_f32_32x32x16_bf16 v[64:79], a[224:227], v[184:187], v[64:79]
    ds_read_b64_tr_b16 a[248:249], v6 offset:25472
    ds_read_b64_tr_b16 a[250:251], v6 offset:25984
    s_waitcnt vmcnt(24)
    s_barrier
    s_add_u32 m0, s24, 101376
    s_mov_b32 s93, 229376
    s_mov_b32 s95, 244736
    v_exp_f32 v24, v136
    v_exp_f32 v25, v137
    v_mfma_f32_32x32x16_bf16 v[80:95], a[228:231], v[184:187], v[80:95]
    ds_read_b64_tr_b16 a[252:253], v6 offset:25536
    ds_read_b64_tr_b16 a[254:255], v6 offset:26048
    buffer_load_dwordx4 v15, s[8:11], s93 offen nt lds
    s_waitcnt lgkmcnt(8)
    v_mfma_f32_32x32x16_bf16 v[96:111], a[232:235], v[184:187], v[96:111]
    ds_read_b64_tr_b16 a[224:225], v3 offset:33792
    ds_read_b64_tr_b16 a[226:227], v3 offset:34304
    v_add_f32 v28, v28, v24
    v_cvt_pk_bf16_f32 v180, v24, v25
    v_add_f32 v29, v29, v25
    v_mfma_f32_32x32x16_bf16 v[112:127], a[236:239], v[184:187], v[112:127]
    ds_read_b64_tr_b16 a[228:229], v3 offset:42240
    ds_read_b64_tr_b16 a[230:231], v3 offset:42752
    buffer_load_dwordx4 v17, s[4:7], s95 offen offset:1024 nt lds
    s_waitcnt lgkmcnt(8)
    v_mfma_f32_32x32x16_bf16 v[64:79], a[240:243], v[188:191], v[64:79]
    ds_read_b64_tr_b16 a[232:233], v3 offset:34816
    ds_read_b64_tr_b16 a[234:235], v3 offset:35328
    v_exp_f32 v26, v138
    v_exp_f32 v27, v139
    v_mfma_f32_32x32x16_bf16 v[80:95], a[244:247], v[188:191], v[80:95]
    ds_read_b64_tr_b16 a[236:237], v3 offset:43264
    ds_read_b64_tr_b16 a[238:239], v3 offset:43776
    buffer_load_dwordx4 v16, s[8:11], s93 offen offset:2112 nt lds
    s_waitcnt lgkmcnt(8)
    v_mfma_f32_32x32x16_bf16 v[96:111], a[248:251], v[188:191], v[96:111]
    ds_read_b64_tr_b16 a[240:241], v3 offset:33856
    ds_read_b64_tr_b16 a[242:243], v3 offset:34368
    v_add_f32 v28, v28, v26
    v_cvt_pk_bf16_f32 v181, v26, v27
    v_add_f32 v29, v29, v27
    v_mfma_f32_32x32x16_bf16 v[112:127], a[252:255], v[188:191], v[112:127]
    ds_read_b64_tr_b16 a[244:245], v3 offset:42304
    ds_read_b64_tr_b16 a[246:247], v3 offset:42816
    buffer_load_dwordx4 v18, s[4:7], s95 offen offset:3136 nt lds
    s_waitcnt lgkmcnt(8)
    v_mfma_f32_32x32x16_bf16 v[192:207], a[224:227], a[144:147], v[192:207]
    ds_read_b64_tr_b16 a[248:249], v3 offset:34880
    ds_read_b64_tr_b16 a[250:251], v3 offset:35392
    v_exp_f32 v24, v140
    v_exp_f32 v25, v141
    v_mfma_f32_32x32x16_bf16 v[192:207], a[228:231], a[148:151], v[192:207]
    ds_read_b64_tr_b16 a[252:253], v3 offset:43328
    ds_read_b64_tr_b16 a[254:255], v3 offset:43840
    s_waitcnt lgkmcnt(8)
    v_mfma_f32_32x32x16_bf16 v[192:207], a[232:235], a[152:155], v[192:207]
    ds_read_b64_tr_b16 a[224:225], v3 offset:33920
    ds_read_b64_tr_b16 a[226:227], v3 offset:34432
    v_add_f32 v28, v28, v24
    v_cvt_pk_bf16_f32 v182, v24, v25
    v_add_f32 v29, v29, v25
    v_mfma_f32_32x32x16_bf16 v[192:207], a[236:239], a[156:159], v[192:207]
    ds_read_b64_tr_b16 a[228:229], v3 offset:42368
    ds_read_b64_tr_b16 a[230:231], v3 offset:42880
    s_waitcnt lgkmcnt(8)
    v_mfma_f32_32x32x16_bf16 v[208:223], a[240:243], a[144:147], v[208:223]
    ds_read_b64_tr_b16 a[232:233], v3 offset:34944
    ds_read_b64_tr_b16 a[234:235], v3 offset:35456
    v_exp_f32 v26, v142
    v_exp_f32 v27, v143
    v_mfma_f32_32x32x16_bf16 v[208:223], a[244:247], a[148:151], v[208:223]
    ds_read_b64_tr_b16 a[236:237], v3 offset:43392
    ds_read_b64_tr_b16 a[238:239], v3 offset:43904
    s_waitcnt lgkmcnt(8)
    v_mfma_f32_32x32x16_bf16 v[208:223], a[248:251], a[152:155], v[208:223]
    ds_read_b64_tr_b16 a[240:241], v3 offset:33984
    ds_read_b64_tr_b16 a[242:243], v3 offset:34496
    v_add_f32 v28, v28, v26
    v_cvt_pk_bf16_f32 v183, v26, v27
    v_add_f32 v29, v29, v27
    v_mfma_f32_32x32x16_bf16 v[208:223], a[252:255], a[156:159], v[208:223]
    ds_read_b64_tr_b16 a[244:245], v3 offset:42432
    ds_read_b64_tr_b16 a[246:247], v3 offset:42944
    v_add_f32 v28, v28, v29
    v_cmp_nge_f32 vcc, s32, v28
    s_cbranch_vccnz L_rs24
L_back24:
    v_add_f32 v22, v22, v28
    v_mul_f32 v192, s33, v192
    v_mul_f32 v193, s33, v193
    v_cvt_pk_bf16_f32 v192, v192, v193
    s_waitcnt lgkmcnt(8)
    v_mfma_f32_32x32x16_bf16 v[224:239], a[224:227], a[144:147], v[224:239]
    ds_read_b64_tr_b16 a[248:249], v3 offset:35008
    ds_read_b64_tr_b16 a[250:251], v3 offset:35520
    s_waitcnt vmcnt(24)
    s_barrier
    s_add_u32 m0, s24, 118272
    s_mov_b32 s29, 1049344
    s_mov_b32 s30, 1310464
    v_exp_f32 v24, v144
    v_exp_f32 v25, v145
    v_accvgpr_write_b32 a192, v192
    v_mul_f32 v194, s33, v194
    v_mfma_f32_32x32x16_bf16 v[224:239], a[228:231], a[148:151], v[224:239]
    ds_read_b64_tr_b16 a[252:253], v3 offset:43456
    ds_read_b64_tr_b16 a[254:255], v3 offset:43968
    buffer_load_dwordx4 v13, s[12:15], s29 offen nt lds
    v_cvt_pk_bf16_f32 v184, v24, v25
    v_add_f32 v28, v24, v25
    v_mul_f32 v195, s33, v195
    v_cvt_pk_bf16_f32 v194, v194, v195
    v_accvgpr_write_b32 a193, v194
    s_waitcnt lgkmcnt(8)
    v_mfma_f32_32x32x16_bf16 v[224:239], a[232:235], a[152:155], v[224:239]
    ds_read_b128 a[224:227], v7 offset:1024
    v_mul_f32 v196, s33, v196
    v_mul_f32 v197, s33, v197
    v_mfma_f32_32x32x16_bf16 v[224:239], a[236:239], a[156:159], v[224:239]
    ds_read_b128 a[228:231], v10 offset:1024
    buffer_load_dwordx4 v13, s[12:15], s30 offen offset:1024 nt lds
    v_exp_f32 v26, v146
    v_exp_f32 v27, v147
    v_cvt_pk_bf16_f32 v196, v196, v197
    v_accvgpr_write_b32 a194, v196
    v_mul_f32 v198, s33, v198
    s_waitcnt lgkmcnt(6)
    v_mfma_f32_32x32x16_bf16 v[240:255], a[240:243], a[144:147], v[240:255]
    ds_read_b128 a[232:235], v7 offset:1088
    v_cvt_pk_bf16_f32 v185, v26, v27
    v_add_f32 v29, v26, v27
    v_mul_f32 v199, s33, v199
    v_cvt_pk_bf16_f32 v198, v198, v199
    v_mfma_f32_32x32x16_bf16 v[240:255], a[244:247], a[148:151], v[240:255]
    ds_read_b128 a[236:239], v10 offset:1088
    buffer_load_dwordx4 v14, s[12:15], s29 offen offset:2112 nt lds
    v_accvgpr_write_b32 a195, v198
    v_mul_f32 v200, s33, v200
    v_mul_f32 v201, s33, v201
    s_waitcnt lgkmcnt(4)
    v_mfma_f32_32x32x16_bf16 v[240:255], a[248:251], a[152:155], v[240:255]
    ds_read_b128 a[240:243], v7 offset:1152
    v_exp_f32 v24, v148
    v_exp_f32 v25, v149
    v_cvt_pk_bf16_f32 v200, v200, v201
    v_accvgpr_write_b32 a196, v200
    v_mfma_f32_32x32x16_bf16 v[240:255], a[252:255], a[156:159], v[240:255]
    ds_read_b128 a[244:247], v10 offset:1152
    buffer_load_dwordx4 v14, s[12:15], s30 offen offset:3136 nt lds
    v_add_f32 v28, v28, v24
    v_cvt_pk_bf16_f32 v186, v24, v25
    v_add_f32 v29, v29, v25
    v_mul_f32 v202, s33, v202
    v_mul_f32 v203, s33, v203
    v_cvt_pk_bf16_f32 v202, v202, v203
    s_waitcnt lgkmcnt(4)
    v_mfma_f32_32x32x16_bf16 v[128:143], a[224:227], a[160:163], v[160:175]
    ds_read_b128 a[248:251], v7 offset:1216
    v_accvgpr_write_b32 a197, v202
    v_mul_f32 v204, s33, v204
    v_mfma_f32_32x32x16_bf16 v[128:143], a[228:231], a[164:167], v[128:143]
    ds_read_b128 a[252:255], v10 offset:1216
    v_exp_f32 v26, v150
    v_exp_f32 v27, v151
    v_mul_f32 v205, s33, v205
    v_cvt_pk_bf16_f32 v204, v204, v205
    v_accvgpr_write_b32 a198, v204
    s_waitcnt lgkmcnt(4)
    v_mfma_f32_32x32x16_bf16 v[128:143], a[232:235], a[168:171], v[128:143]
    ds_read_b64_tr_b16 a[224:225], v4 offset:0
    ds_read_b64_tr_b16 a[226:227], v4 offset:512
    v_add_f32 v28, v28, v26
    v_cvt_pk_bf16_f32 v187, v26, v27
    v_add_f32 v29, v29, v27
    v_mul_f32 v206, s33, v206
    v_mul_f32 v207, s33, v207
    v_mfma_f32_32x32x16_bf16 v[128:143], a[236:239], a[172:175], v[128:143]
    ds_read_b64_tr_b16 a[228:229], v4 offset:64
    ds_read_b64_tr_b16 a[230:231], v4 offset:576
    v_cvt_pk_bf16_f32 v206, v206, v207
    v_accvgpr_write_b32 a199, v206
    s_waitcnt lgkmcnt(6)
    v_mfma_f32_32x32x16_bf16 v[128:143], a[240:243], a[176:179], v[128:143]
    ds_read_b64_tr_b16 a[232:233], v4 offset:128
    ds_read_b64_tr_b16 a[234:235], v4 offset:640
    v_exp_f32 v24, v152
    v_exp_f32 v25, v153
    v_mul_f32 v208, s33, v208
    v_mul_f32 v209, s33, v209
    v_cvt_pk_bf16_f32 v208, v208, v209
    v_mfma_f32_32x32x16_bf16 v[128:143], a[244:247], a[180:183], v[128:143]
    ds_read_b64_tr_b16 a[236:237], v4 offset:192
    ds_read_b64_tr_b16 a[238:239], v4 offset:704
    v_add_f32 v28, v28, v24
    v_cvt_pk_bf16_f32 v188, v24, v25
    v_add_f32 v29, v29, v25
    v_accvgpr_write_b32 a200, v208
    v_mul_f32 v210, s33, v210
    s_waitcnt lgkmcnt(8)
    v_mfma_f32_32x32x16_bf16 v[128:143], a[248:251], a[184:187], v[128:143]
    ds_read_b64_tr_b16 a[240:241], v4 offset:8448
    ds_read_b64_tr_b16 a[242:243], v4 offset:8960
    v_mul_f32 v211, s33, v211
    v_cvt_pk_bf16_f32 v210, v210, v211
    v_accvgpr_write_b32 a201, v210
    v_mfma_f32_32x32x16_bf16 v[128:143], a[252:255], a[188:191], v[128:143]
    ds_read_b64_tr_b16 a[244:245], v4 offset:8512
    ds_read_b64_tr_b16 a[246:247], v4 offset:9024
    v_exp_f32 v26, v154
    v_exp_f32 v27, v155
    v_mul_f32 v212, s33, v212
    v_mul_f32 v213, s33, v213
    s_waitcnt lgkmcnt(8)
    v_mfma_f32_32x32x16_bf16 v[64:79], a[224:227], v[176:179], v[64:79]
    ds_read_b64_tr_b16 a[248:249], v4 offset:8576
    ds_read_b64_tr_b16 a[250:251], v4 offset:9088
    s_waitcnt vmcnt(24)
    s_barrier
    s_add_u32 m0, s24, 135168
    s_mov_b32 s93, 237568
    s_mov_b32 s95, 252928
    v_add_f32 v28, v28, v26
    v_cvt_pk_bf16_f32 v189, v26, v27
    v_add_f32 v29, v29, v27
    v_cvt_pk_bf16_f32 v212, v212, v213
    v_accvgpr_write_b32 a202, v212
    v_mul_f32 v214, s33, v214
    v_mfma_f32_32x32x16_bf16 v[80:95], a[228:231], v[176:179], v[80:95]
    ds_read_b64_tr_b16 a[252:253], v4 offset:8640
    ds_read_b64_tr_b16 a[254:255], v4 offset:9152
    buffer_load_dwordx4 v15, s[8:11], s93 offen nt lds
    v_mul_f32 v215, s33, v215
    v_cvt_pk_bf16_f32 v214, v214, v215
    s_waitcnt lgkmcnt(8)
    v_mfma_f32_32x32x16_bf16 v[96:111], a[232:235], v[176:179], v[96:111]
    ds_read_b128 a[224:227], v7 offset:17920
    v_exp_f32 v24, v156
    v_exp_f32 v25, v157
    v_accvgpr_write_b32 a203, v214
    v_mul_f32 v216, s33, v216
    v_mul_f32 v217, s33, v217
    v_mfma_f32_32x32x16_bf16 v[112:127], a[236:239], v[176:179], v[112:127]
    ds_read_b128 a[228:231], v10 offset:17920
    buffer_load_dwordx4 v17, s[4:7], s95 offen offset:1024 nt lds
    v_add_f32 v28, v28, v24
    v_cvt_pk_bf16_f32 v190, v24, v25
    v_add_f32 v29, v29, v25
    v_cvt_pk_bf16_f32 v216, v216, v217
    v_accvgpr_write_b32 a204, v216
    s_waitcnt lgkmcnt(6)
    v_mfma_f32_32x32x16_bf16 v[64:79], a[240:243], v[180:183], v[64:79]
    ds_read_b128 a[232:235], v7 offset:17984
    v_mul_f32 v218, s33, v218
    v_mul_f32 v219, s33, v219
    v_cvt_pk_bf16_f32 v218, v218, v219
    v_mfma_f32_32x32x16_bf16 v[80:95], a[244:247], v[180:183], v[80:95]
    ds_read_b128 a[236:239], v10 offset:17984
    buffer_load_dwordx4 v16, s[8:11], s93 offen offset:2112 nt lds
    v_exp_f32 v26, v158
    v_exp_f32 v27, v159
    v_accvgpr_write_b32 a205, v218
    v_mul_f32 v220, s33, v220
    s_waitcnt lgkmcnt(4)
    v_mfma_f32_32x32x16_bf16 v[96:111], a[248:251], v[180:183], v[96:111]
    ds_read_b128 a[240:243], v7 offset:18048
    v_add_f32 v28, v28, v26
    v_cvt_pk_bf16_f32 v191, v26, v27
    v_add_f32 v29, v29, v27
    v_mul_f32 v221, s33, v221
    v_cvt_pk_bf16_f32 v220, v220, v221
    v_accvgpr_write_b32 a206, v220
    v_mfma_f32_32x32x16_bf16 v[112:127], a[252:255], v[180:183], v[112:127]
    ds_read_b128 a[244:247], v10 offset:18048
    buffer_load_dwordx4 v18, s[4:7], s95 offen offset:3136 nt lds
    v_add_f32 v28, v28, v29
    v_cmp_nge_f32 vcc, s32, v28
    s_cbranch_vccnz L_rs25
L_back25:
    v_add_f32 v22, v22, v28
    v_mul_f32 v222, s33, v222
    v_mul_f32 v223, s33, v223
    s_waitcnt lgkmcnt(4)
    v_mfma_f32_32x32x16_bf16 v[144:159], a[224:227], a[160:163], v[160:175]
    ds_read_b128 a[248:251], v7 offset:18112
    v_exp_f32 v24, v128
    v_exp_f32 v25, v129
    v_cvt_pk_bf16_f32 v222, v222, v223
    v_accvgpr_write_b32 a207, v222
    v_mfma_f32_32x32x16_bf16 v[144:159], a[228:231], a[164:167], v[144:159]
    ds_read_b128 a[252:255], v10 offset:18112
    v_cvt_pk_bf16_f32 v176, v24, v25
    v_add_f32 v28, v24, v25
    v_mul_f32 v224, s33, v224
    v_mul_f32 v225, s33, v225
    v_cvt_pk_bf16_f32 v224, v224, v225
    s_waitcnt lgkmcnt(4)
    v_mfma_f32_32x32x16_bf16 v[144:159], a[232:235], a[168:171], v[144:159]
    ds_read_b64_tr_b16 a[224:225], v4 offset:16896
    ds_read_b64_tr_b16 a[226:227], v4 offset:17408
    v_accvgpr_write_b32 a208, v224
    v_mul_f32 v226, s33, v226
    v_mfma_f32_32x32x16_bf16 v[144:159], a[236:239], a[172:175], v[144:159]
    ds_read_b64_tr_b16 a[228:229], v4 offset:16960
    ds_read_b64_tr_b16 a[230:231], v4 offset:17472
    v_exp_f32 v26, v130
    v_exp_f32 v27, v131
    v_mul_f32 v227, s33, v227
    v_cvt_pk_bf16_f32 v226, v226, v227
    v_accvgpr_write_b32 a209, v226
    s_waitcnt lgkmcnt(6)
    v_mfma_f32_32x32x16_bf16 v[144:159], a[240:243], a[176:179], v[144:159]
    ds_read_b64_tr_b16 a[232:233], v4 offset:17024
    ds_read_b64_tr_b16 a[234:235], v4 offset:17536
    v_cvt_pk_bf16_f32 v177, v26, v27
    v_add_f32 v29, v26, v27
    v_mul_f32 v228, s33, v228
    v_mul_f32 v229, s33, v229
    v_mfma_f32_32x32x16_bf16 v[144:159], a[244:247], a[180:183], v[144:159]
    ds_read_b64_tr_b16 a[236:237], v4 offset:17088
    ds_read_b64_tr_b16 a[238:239], v4 offset:17600
    v_cvt_pk_bf16_f32 v228, v228, v229
    v_accvgpr_write_b32 a210, v228
    v_mul_f32 v230, s33, v230
    s_waitcnt lgkmcnt(8)
    v_mfma_f32_32x32x16_bf16 v[144:159], a[248:251], a[184:187], v[144:159]
    ds_read_b64_tr_b16 a[240:241], v4 offset:25344
    ds_read_b64_tr_b16 a[242:243], v4 offset:25856
    v_exp_f32 v24, v132
    v_exp_f32 v25, v133
    v_mul_f32 v231, s33, v231
    v_cvt_pk_bf16_f32 v230, v230, v231
    v_mfma_f32_32x32x16_bf16 v[144:159], a[252:255], a[188:191], v[144:159]
    ds_read_b64_tr_b16 a[244:245], v4 offset:25408
    ds_read_b64_tr_b16 a[246:247], v4 offset:25920
    v_add_f32 v28, v28, v24
    v_cvt_pk_bf16_f32 v178, v24, v25
    v_add_f32 v29, v29, v25
    v_accvgpr_write_b32 a211, v230
    v_mul_f32 v232, s33, v232
    v_mul_f32 v233, s33, v233
    s_waitcnt lgkmcnt(8)
    v_mfma_f32_32x32x16_bf16 v[64:79], a[224:227], v[184:187], v[64:79]
    ds_read_b64_tr_b16 a[248:249], v4 offset:25472
    ds_read_b64_tr_b16 a[250:251], v4 offset:25984
    s_waitcnt vmcnt(24)
    s_barrier
    s_add_u32 m0, s24, 0
    s_mov_b32 s29, 1573632
    s_mov_b32 s30, 1834752
    v_cvt_pk_bf16_f32 v232, v232, v233
    v_accvgpr_write_b32 a212, v232
    v_mfma_f32_32x32x16_bf16 v[80:95], a[228:231], v[184:187], v[80:95]
    ds_read_b64_tr_b16 a[252:253], v4 offset:25536
    ds_read_b64_tr_b16 a[254:255], v4 offset:26048
    buffer_load_dwordx4 v13, s[12:15], s29 offen nt lds
    v_exp_f32 v26, v134
    v_exp_f32 v27, v135
    v_mul_f32 v234, s33, v234
    v_mul_f32 v235, s33, v235
    v_cvt_pk_bf16_f32 v234, v234, v235
    s_waitcnt lgkmcnt(8)
    v_mfma_f32_32x32x16_bf16 v[96:111], a[232:235], v[184:187], v[96:111]
    ds_read_b64_tr_b16 a[224:225], v1 offset:33792
    ds_read_b64_tr_b16 a[226:227], v1 offset:34304
    v_add_f32 v28, v28, v26
    v_cvt_pk_bf16_f32 v179, v26, v27
    v_add_f32 v29, v29, v27
    v_accvgpr_write_b32 a213, v234
    v_mul_f32 v236, s33, v236
    v_mfma_f32_32x32x16_bf16 v[112:127], a[236:239], v[184:187], v[112:127]
    ds_read_b64_tr_b16 a[228:229], v1 offset:42240
    ds_read_b64_tr_b16 a[230:231], v1 offset:42752
    buffer_load_dwordx4 v13, s[12:15], s30 offen offset:1024 nt lds
    v_mul_f32 v237, s33, v237
    v_cvt_pk_bf16_f32 v236, v236, v237
    v_accvgpr_write_b32 a214, v236
    s_waitcnt lgkmcnt(8)
    v_mfma_f32_32x32x16_bf16 v[64:79], a[240:243], v[188:191], v[64:79]
    ds_read_b64_tr_b16 a[232:233], v1 offset:34816
    ds_read_b64_tr_b16 a[234:235], v1 offset:35328
    v_exp_f32 v24, v136
    v_exp_f32 v25, v137
    v_mul_f32 v238, s33, v238
    v_mul_f32 v239, s33, v239
    v_mfma_f32_32x32x16_bf16 v[80:95], a[244:247], v[188:191], v[80:95]
    ds_read_b64_tr_b16 a[236:237], v1 offset:43264
    ds_read_b64_tr_b16 a[238:239], v1 offset:43776
    buffer_load_dwordx4 v14, s[12:15], s29 offen offset:2112 nt lds
    v_add_f32 v28, v28, v24
    v_cvt_pk_bf16_f32 v180, v24, v25
    v_add_f32 v29, v29, v25
    v_cvt_pk_bf16_f32 v238, v238, v239
    v_accvgpr_write_b32 a215, v238
    s_waitcnt lgkmcnt(8)
    v_mfma_f32_32x32x16_bf16 v[96:111], a[248:251], v[188:191], v[96:111]
    ds_read_b64_tr_b16 a[240:241], v1 offset:33856
    ds_read_b64_tr_b16 a[242:243], v1 offset:34368
    v_mul_f32 v240, s33, v240
    v_mul_f32 v241, s33, v241
    v_cvt_pk_bf16_f32 v240, v240, v241
    v_mfma_f32_32x32x16_bf16 v[112:127], a[252:255], v[188:191], v[112:127]
    ds_read_b64_tr_b16 a[244:245], v1 offset:42304
    ds_read_b64_tr_b16 a[246:247], v1 offset:42816
    buffer_load_dwordx4 v14, s[12:15], s30 offen offset:3136 nt lds
    v_exp_f32 v26, v138
    v_exp_f32 v27, v139
    v_accvgpr_write_b32 a216, v240
    v_mul_f32 v242, s33, v242
    s_waitcnt lgkmcnt(8)
    v_mfma_f32_32x32x16_bf16 v[192:207], a[224:227], a[0:3], 0
    ds_read_b64_tr_b16 a[248:249], v1 offset:34880
    ds_read_b64_tr_b16 a[250:251], v1 offset:35392
    v_add_f32 v28, v28, v26
    v_cvt_pk_bf16_f32 v181, v26, v27
    v_add_f32 v29, v29, v27
    v_mul_f32 v243, s33, v243
    v_cvt_pk_bf16_f32 v242, v242, v243
    v_accvgpr_write_b32 a217, v242
    v_mfma_f32_32x32x16_bf16 v[192:207], a[228:231], a[4:7], v[192:207]
    ds_read_b64_tr_b16 a[252:253], v1 offset:43328
    ds_read_b64_tr_b16 a[254:255], v1 offset:43840
    v_mul_f32 v244, s33, v244
    v_mul_f32 v245, s33, v245
    s_waitcnt lgkmcnt(8)
    v_mfma_f32_32x32x16_bf16 v[192:207], a[232:235], a[8:11], v[192:207]
    ds_read_b64_tr_b16 a[224:225], v1 offset:33920
    ds_read_b64_tr_b16 a[226:227], v1 offset:34432
    v_exp_f32 v24, v140
    v_exp_f32 v25, v141
    v_cvt_pk_bf16_f32 v244, v244, v245
    v_accvgpr_write_b32 a218, v244
    v_mul_f32 v246, s33, v246
    v_mfma_f32_32x32x16_bf16 v[192:207], a[236:239], a[12:15], v[192:207]
    ds_read_b64_tr_b16 a[228:229], v1 offset:42368
    ds_read_b64_tr_b16 a[230:231], v1 offset:42880
    v_add_f32 v28, v28, v24
    v_cvt_pk_bf16_f32 v182, v24, v25
    v_add_f32 v29, v29, v25
    v_mul_f32 v247, s33, v247
    v_cvt_pk_bf16_f32 v246, v246, v247
    s_waitcnt lgkmcnt(8)
    v_mfma_f32_32x32x16_bf16 v[208:223], a[240:243], a[0:3], 0
    ds_read_b64_tr_b16 a[232:233], v1 offset:34944
    ds_read_b64_tr_b16 a[234:235], v1 offset:35456
    v_accvgpr_write_b32 a219, v246
    v_mul_f32 v248, s33, v248
    v_mul_f32 v249, s33, v249
    v_mfma_f32_32x32x16_bf16 v[208:223], a[244:247], a[4:7], v[208:223]
    ds_read_b64_tr_b16 a[236:237], v1 offset:43392
    ds_read_b64_tr_b16 a[238:239], v1 offset:43904
    v_exp_f32 v26, v142
    v_exp_f32 v27, v143
    v_cvt_pk_bf16_f32 v248, v248, v249
    v_accvgpr_write_b32 a220, v248
    s_waitcnt lgkmcnt(8)
    v_mfma_f32_32x32x16_bf16 v[208:223], a[248:251], a[8:11], v[208:223]
    ds_read_b64_tr_b16 a[240:241], v1 offset:33984
    ds_read_b64_tr_b16 a[242:243], v1 offset:34496
    v_add_f32 v28, v28, v26
    v_cvt_pk_bf16_f32 v183, v26, v27
    v_add_f32 v29, v29, v27
    v_mul_f32 v250, s33, v250
    v_mul_f32 v251, s33, v251
    v_cvt_pk_bf16_f32 v250, v250, v251
    v_mfma_f32_32x32x16_bf16 v[208:223], a[252:255], a[12:15], v[208:223]
    ds_read_b64_tr_b16 a[244:245], v1 offset:42432
    ds_read_b64_tr_b16 a[246:247], v1 offset:42944
    v_add_f32 v28, v28, v29
    v_cmp_nge_f32 vcc, s32, v28
    s_cbranch_vccnz L_rs26
L_back26:
    v_add_f32 v22, v22, v28
    v_accvgpr_write_b32 a221, v250
    v_mul_f32 v252, s33, v252
    s_waitcnt lgkmcnt(8)
    v_mfma_f32_32x32x16_bf16 v[224:239], a[224:227], a[0:3], 0
    ds_read_b64_tr_b16 a[248:249], v1 offset:35008
    ds_read_b64_tr_b16 a[250:251], v1 offset:35520
    s_waitcnt vmcnt(24)
    s_barrier
    s_add_u32 m0, s24, 16896
    s_mov_b32 s93, 245760
    s_mov_b32 s95, 252928
    v_exp_f32 v24, v144
    v_exp_f32 v25, v145
    v_mul_f32 v253, s33, v253
    v_cvt_pk_bf16_f32 v252, v252, v253
    v_accvgpr_write_b32 a222, v252
    v_mfma_f32_32x32x16_bf16 v[224:239], a[228:231], a[4:7], v[224:239]
    ds_read_b64_tr_b16 a[252:253], v1 offset:43456
    ds_read_b64_tr_b16 a[254:255], v1 offset:43968
    buffer_load_dwordx4 v15, s[8:11], s93 offen nt lds
    v_mul_f32 v254, s33, v254
    v_mul_f32 v255, s33, v255
    s_waitcnt lgkmcnt(8)
    v_mfma_f32_32x32x16_bf16 v[224:239], a[232:235], a[8:11], v[224:239]
    ds_read_b128 a[224:227], v8 offset:1024
    v_cvt_pk_bf16_f32 v184, v24, v25
    v_add_f32 v28, v24, v25
    v_cvt_pk_bf16_f32 v254, v254, v255
    v_accvgpr_write_b32 a223, v254
    v_mfma_f32_32x32x16_bf16 v[224:239], a[236:239], a[12:15], v[224:239]
    ds_read_b128 a[228:231], v11 offset:1024
    buffer_load_dwordx4 v15, s[8:11], s95 offen offset:1024 nt lds
    s_waitcnt lgkmcnt(6)
    v_mfma_f32_32x32x16_bf16 v[240:255], a[240:243], a[0:3], 0
    ds_read_b128 a[232:235], v8 offset:1088
    v_exp_f32 v26, v146
    v_exp_f32 v27, v147
    v_mfma_f32_32x32x16_bf16 v[240:255], a[244:247], a[4:7], v[240:255]
    ds_read_b128 a[236:239], v11 offset:1088
    buffer_load_dwordx4 v16, s[8:11], s93 offen offset:2112 nt lds
    s_waitcnt lgkmcnt(4)
    v_mfma_f32_32x32x16_bf16 v[240:255], a[248:251], a[8:11], v[240:255]
    ds_read_b128 a[240:243], v8 offset:1152
    v_cvt_pk_bf16_f32 v185, v26, v27
    v_add_f32 v29, v26, v27
    v_mfma_f32_32x32x16_bf16 v[240:255], a[252:255], a[12:15], v[240:255]
    ds_read_b128 a[244:247], v11 offset:1152
    buffer_load_dwordx4 v16, s[8:11], s95 offen offset:3136 nt lds
    s_waitcnt lgkmcnt(4)
    v_mfma_f32_32x32x16_bf16 v[128:143], a[224:227], a[160:163], v[160:175]
    ds_read_b128 a[248:251], v8 offset:1216
    v_exp_f32 v24, v148
    v_exp_f32 v25, v149
    v_mfma_f32_32x32x16_bf16 v[128:143], a[228:231], a[164:167], v[128:143]
    ds_read_b128 a[252:255], v11 offset:1216
    s_waitcnt lgkmcnt(4)
    v_mfma_f32_32x32x16_bf16 v[128:143], a[232:235], a[168:171], v[128:143]
    ds_read_b64_tr_b16 a[224:225], v5 offset:0
    ds_read_b64_tr_b16 a[226:227], v5 offset:512
    v_add_f32 v28, v28, v24
    v_cvt_pk_bf16_f32 v186, v24, v25
    v_add_f32 v29, v29, v25
    v_mfma_f32_32x32x16_bf16 v[128:143], a[236:239], a[172:175], v[128:143]
    ds_read_b64_tr_b16 a[228:229], v5 offset:64
    ds_read_b64_tr_b16 a[230:231], v5 offset:576
    s_waitcnt lgkmcnt(6)
    v_mfma_f32_32x32x16_bf16 v[128:143], a[240:243], a[176:179], v[128:143]
    ds_read_b64_tr_b16 a[232:233], v5 offset:128
    ds_read_b64_tr_b16 a[234:235], v5 offset:640
    v_exp_f32 v26, v150
    v_exp_f32 v27, v151
    v_mfma_f32_32x32x16_bf16 v[128:143], a[244:247], a[180:183], v[128:143]
    ds_read_b64_tr_b16 a[236:237], v5 offset:192
    ds_read_b64_tr_b16 a[238:239], v5 offset:704
    s_waitcnt lgkmcnt(8)
    v_mfma_f32_32x32x16_bf16 v[128:143], a[248:251], a[184:187], v[128:143]
    ds_read_b64_tr_b16 a[240:241], v5 offset:8448
    ds_read_b64_tr_b16 a[242:243], v5 offset:8960
    v_add_f32 v28, v28, v26
    v_cvt_pk_bf16_f32 v187, v26, v27
    v_add_f32 v29, v29, v27
    v_mfma_f32_32x32x16_bf16 v[128:143], a[252:255], a[188:191], v[128:143]
    ds_read_b64_tr_b16 a[244:245], v5 offset:8512
    ds_read_b64_tr_b16 a[246:247], v5 offset:9024
    s_waitcnt lgkmcnt(8)
    v_mfma_f32_32x32x16_bf16 v[64:79], a[224:227], v[176:179], v[64:79]
    ds_read_b64_tr_b16 a[248:249], v5 offset:8576
    ds_read_b64_tr_b16 a[250:251], v5 offset:9088
    s_waitcnt vmcnt(24)
    s_barrier
    s_add_u32 m0, s24, 33792
    s_mov_b32 s29, 2097920
    s_mov_b32 s30, 2359040
    v_exp_f32 v24, v152
    v_exp_f32 v25, v153
    v_mfma_f32_32x32x16_bf16 v[80:95], a[228:231], v[176:179], v[80:95]
    ds_read_b64_tr_b16 a[252:253], v5 offset:8640
    ds_read_b64_tr_b16 a[254:255], v5 offset:9152
    buffer_load_dwordx4 v13, s[12:15], s29 offen nt lds
    s_waitcnt lgkmcnt(8)
    v_mfma_f32_32x32x16_bf16 v[96:111], a[232:235], v[176:179], v[96:111]
    ds_read_b64_tr_b16 a[224:225], v2 offset:16896
    ds_read_b64_tr_b16 a[226:227], v2 offset:17408
    v_add_f32 v28, v28, v24
    v_cvt_pk_bf16_f32 v188, v24, v25
    v_add_f32 v29, v29, v25
    v_mfma_f32_32x32x16_bf16 v[112:127], a[236:239], v[176:179], v[112:127]
    ds_read_b64_tr_b16 a[228:229], v2 offset:16960
    ds_read_b64_tr_b16 a[230:231], v2 offset:17472
    buffer_load_dwordx4 v13, s[12:15], s30 offen offset:1024 nt lds
    s_waitcnt lgkmcnt(8)
    v_mfma_f32_32x32x16_bf16 v[64:79], a[240:243], v[180:183], v[64:79]
    ds_read_b64_tr_b16 a[232:233], v2 offset:17024
    ds_read_b64_tr_b16 a[234:235], v2 offset:17536
    v_exp_f32 v26, v154
    v_exp_f32 v27, v155
    v_mfma_f32_32x32x16_bf16 v[80:95], a[244:247], v[180:183], v[80:95]
    ds_read_b64_tr_b16 a[236:237], v2 offset:17088
    ds_read_b64_tr_b16 a[238:239], v2 offset:17600
    buffer_load_dwordx4 v14, s[12:15], s29 offen offset:2112 nt lds
    s_waitcnt lgkmcnt(8)
    v_mfma_f32_32x32x16_bf16 v[96:111], a[248:251], v[180:183], v[96:111]
    ds_read_b64_tr_b16 a[240:241], v2 offset:25344
    ds_read_b64_tr_b16 a[242:243], v2 offset:25856
    v_add_f32 v28, v28, v26
    v_cvt_pk_bf16_f32 v189, v26, v27
    v_add_f32 v29, v29, v27
    v_mfma_f32_32x32x16_bf16 v[112:127], a[252:255], v[180:183], v[112:127]
    ds_read_b64_tr_b16 a[244:245], v2 offset:25408
    ds_read_b64_tr_b16 a[246:247], v2 offset:25920
    buffer_load_dwordx4 v14, s[12:15], s30 offen offset:3136 nt lds
    s_waitcnt lgkmcnt(8)
    v_mfma_f32_32x32x16_bf16 v[192:207], a[224:227], a[16:19], v[192:207]
    ds_read_b64_tr_b16 a[248:249], v2 offset:25472
    ds_read_b64_tr_b16 a[250:251], v2 offset:25984
    v_exp_f32 v24, v156
    v_exp_f32 v25, v157
    v_mfma_f32_32x32x16_bf16 v[208:223], a[228:231], a[16:19], v[208:223]
    ds_read_b64_tr_b16 a[252:253], v2 offset:25536
    ds_read_b64_tr_b16 a[254:255], v2 offset:26048
    s_waitcnt lgkmcnt(8)
    v_mfma_f32_32x32x16_bf16 v[224:239], a[232:235], a[16:19], v[224:239]
    ds_read_b64_tr_b16 a[224:225], v2 offset:17920
    ds_read_b64_tr_b16 a[226:227], v2 offset:18432
    v_add_f32 v28, v28, v24
    v_cvt_pk_bf16_f32 v190, v24, v25
    v_add_f32 v29, v29, v25
    v_mfma_f32_32x32x16_bf16 v[240:255], a[236:239], a[16:19], v[240:255]
    ds_read_b64_tr_b16 a[228:229], v2 offset:17984
    ds_read_b64_tr_b16 a[230:231], v2 offset:18496
    s_waitcnt lgkmcnt(8)
    v_mfma_f32_32x32x16_bf16 v[192:207], a[240:243], a[20:23], v[192:207]
    ds_read_b64_tr_b16 a[232:233], v2 offset:18048
    ds_read_b64_tr_b16 a[234:235], v2 offset:18560
    v_exp_f32 v26, v158
    v_exp_f32 v27, v159
    v_mfma_f32_32x32x16_bf16 v[208:223], a[244:247], a[20:23], v[208:223]
    ds_read_b64_tr_b16 a[236:237], v2 offset:18112
    ds_read_b64_tr_b16 a[238:239], v2 offset:18624
    s_waitcnt lgkmcnt(8)
    v_mfma_f32_32x32x16_bf16 v[224:239], a[248:251], a[20:23], v[224:239]
    ds_read_b64_tr_b16 a[240:241], v2 offset:26368
    ds_read_b64_tr_b16 a[242:243], v2 offset:26880
    v_add_f32 v28, v28, v26
    v_cvt_pk_bf16_f32 v191, v26, v27
    v_add_f32 v29, v29, v27
    v_mfma_f32_32x32x16_bf16 v[240:255], a[252:255], a[20:23], v[240:255]
    ds_read_b64_tr_b16 a[244:245], v2 offset:26432
    ds_read_b64_tr_b16 a[246:247], v2 offset:26944
    v_add_f32 v28, v28, v29
    v_cmp_nge_f32 vcc, s32, v28
    s_cbranch_vccnz L_rs27
L_back27:
    v_add_f32 v22, v22, v28
    s_waitcnt lgkmcnt(8)
    v_mfma_f32_32x32x16_bf16 v[192:207], a[224:227], a[24:27], v[192:207]
    ds_read_b64_tr_b16 a[248:249], v2 offset:26496
    ds_read_b64_tr_b16 a[250:251], v2 offset:27008
    s_waitcnt vmcnt(24)
    s_barrier
    s_add_u32 m0, s24, 50688
    s_mov_b32 s93, 262144
    s_mov_b32 s95, 269312
    v_exp_f32 v24, v128
    v_exp_f32 v25, v129
    v_mfma_f32_32x32x16_bf16 v[208:223], a[228:231], a[24:27], v[208:223]
    ds_read_b64_tr_b16 a[252:253], v2 offset:26560
    ds_read_b64_tr_b16 a[254:255], v2 offset:27072
    buffer_load_dwordx4 v17, s[4:7], s93 offen nt lds
    v_cvt_pk_bf16_f32 v176, v24, v25
    v_add_f32 v28, v24, v25
    s_waitcnt lgkmcnt(8)
    v_mfma_f32_32x32x16_bf16 v[224:239], a[232:235], a[24:27], v[224:239]
    ds_read_b128 a[224:227], v8 offset:34816
    v_mfma_f32_32x32x16_bf16 v[240:255], a[236:239], a[24:27], v[240:255]
    ds_read_b128 a[228:231], v11 offset:34816
    buffer_load_dwordx4 v17, s[4:7], s95 offen offset:1024 nt lds
    v_exp_f32 v26, v130
    v_exp_f32 v27, v131
    s_waitcnt lgkmcnt(6)
    v_mfma_f32_32x32x16_bf16 v[192:207], a[240:243], a[28:31], v[192:207]
    ds_read_b128 a[232:235], v8 offset:34880
    v_cvt_pk_bf16_f32 v177, v26, v27
    v_add_f32 v29, v26, v27
    v_mfma_f32_32x32x16_bf16 v[208:223], a[244:247], a[28:31], v[208:223]
    ds_read_b128 a[236:239], v11 offset:34880
    buffer_load_dwordx4 v18, s[4:7], s93 offen offset:2112 nt lds
    s_waitcnt lgkmcnt(4)
    v_mfma_f32_32x32x16_bf16 v[224:239], a[248:251], a[28:31], v[224:239]
    ds_read_b128 a[240:243], v8 offset:34944
    v_exp_f32 v24, v132
    v_exp_f32 v25, v133
    v_mfma_f32_32x32x16_bf16 v[240:255], a[252:255], a[28:31], v[240:255]
    ds_read_b128 a[244:247], v11 offset:34944
    buffer_load_dwordx4 v18, s[4:7], s95 offen offset:3136 nt lds
    v_add_f32 v28, v28, v24
    v_cvt_pk_bf16_f32 v178, v24, v25
    v_add_f32 v29, v29, v25
    s_waitcnt lgkmcnt(4)
    v_mfma_f32_32x32x16_bf16 v[144:159], a[224:227], a[160:163], v[160:175]
    ds_read_b128 a[248:251], v8 offset:35008
    v_mfma_f32_32x32x16_bf16 v[144:159], a[228:231], a[164:167], v[144:159]
    ds_read_b128 a[252:255], v11 offset:35008
    v_exp_f32 v26, v134
    v_exp_f32 v27, v135
    s_waitcnt lgkmcnt(4)
    v_mfma_f32_32x32x16_bf16 v[144:159], a[232:235], a[168:171], v[144:159]
    ds_read_b64_tr_b16 a[224:225], v5 offset:33792
    ds_read_b64_tr_b16 a[226:227], v5 offset:34304
    v_add_f32 v28, v28, v26
    v_cvt_pk_bf16_f32 v179, v26, v27
    v_add_f32 v29, v29, v27
    v_mfma_f32_32x32x16_bf16 v[144:159], a[236:239], a[172:175], v[144:159]
    ds_read_b64_tr_b16 a[228:229], v5 offset:33856
    ds_read_b64_tr_b16 a[230:231], v5 offset:34368
    s_waitcnt lgkmcnt(6)
    v_mfma_f32_32x32x16_bf16 v[144:159], a[240:243], a[176:179], v[144:159]
    ds_read_b64_tr_b16 a[232:233], v5 offset:33920
    ds_read_b64_tr_b16 a[234:235], v5 offset:34432
    v_exp_f32 v24, v136
    v_exp_f32 v25, v137
    v_mfma_f32_32x32x16_bf16 v[144:159], a[244:247], a[180:183], v[144:159]
    ds_read_b64_tr_b16 a[236:237], v5 offset:33984
    ds_read_b64_tr_b16 a[238:239], v5 offset:34496
    v_add_f32 v28, v28, v24
    v_cvt_pk_bf16_f32 v180, v24, v25
    v_add_f32 v29, v29, v25
    s_waitcnt lgkmcnt(8)
    v_mfma_f32_32x32x16_bf16 v[144:159], a[248:251], a[184:187], v[144:159]
    ds_read_b64_tr_b16 a[240:241], v5 offset:42240
    ds_read_b64_tr_b16 a[242:243], v5 offset:42752
    v_mfma_f32_32x32x16_bf16 v[144:159], a[252:255], a[188:191], v[144:159]
    ds_read_b64_tr_b16 a[244:245], v5 offset:42304
    ds_read_b64_tr_b16 a[246:247], v5 offset:42816
    v_exp_f32 v26, v138
    v_exp_f32 v27, v139
    s_waitcnt lgkmcnt(8)
    v_mfma_f32_32x32x16_bf16 v[64:79], a[224:227], v[184:187], v[64:79]
    ds_read_b64_tr_b16 a[248:249], v5 offset:42368
    ds_read_b64_tr_b16 a[250:251], v5 offset:42880
    s_waitcnt vmcnt(24)
    s_barrier
    s_add_u32 m0, s24, 67584
    s_mov_b32 s29, 2622208
    s_mov_b32 s30, 2883328
    v_add_f32 v28, v28, v26
    v_cvt_pk_bf16_f32 v181, v26, v27
    v_add_f32 v29, v29, v27
    v_mfma_f32_32x32x16_bf16 v[80:95], a[228:231], v[184:187], v[80:95]
    ds_read_b64_tr_b16 a[252:253], v5 offset:42432
    ds_read_b64_tr_b16 a[254:255], v5 offset:42944
    buffer_load_dwordx4 v13, s[12:15], s29 offen nt lds
    s_waitcnt lgkmcnt(8)
    v_mfma_f32_32x32x16_bf16 v[96:111], a[232:235], v[184:187], v[96:111]
    ds_read_b128 a[224:227], v9 offset:1024
    v_exp_f32 v24, v140
    v_exp_f32 v25, v141
    v_mfma_f32_32x32x16_bf16 v[112:127], a[236:239], v[184:187], v[112:127]
    ds_read_b128 a[228:231], v12 offset:1024
    buffer_load_dwordx4 v13, s[12:15], s30 offen offset:1024 nt lds
    v_add_f32 v28, v28, v24
    v_cvt_pk_bf16_f32 v182, v24, v25
    v_add_f32 v29, v29, v25
    s_waitcnt lgkmcnt(6)
    v_mfma_f32_32x32x16_bf16 v[64:79], a[240:243], v[188:191], v[64:79]
    ds_read_b128 a[232:235], v9 offset:1088
    v_mfma_f32_32x32x16_bf16 v[80:95], a[244:247], v[188:191], v[80:95]
    ds_read_b128 a[236:239], v12 offset:1088
    buffer_load_dwordx4 v14, s[12:15], s29 offen offset:2112 nt lds
    v_exp_f32 v26, v142
    v_exp_f32 v27, v143
    s_waitcnt lgkmcnt(4)
    v_mfma_f32_32x32x16_bf16 v[96:111], a[248:251], v[188:191], v[96:111]
    ds_read_b128 a[240:243], v9 offset:1152
    v_add_f32 v28, v28, v26
    v_cvt_pk_bf16_f32 v183, v26, v27
    v_add_f32 v29, v29, v27
    v_mfma_f32_32x32x16_bf16 v[112:127], a[252:255], v[188:191], v[112:127]
    ds_read_b128 a[244:247], v12 offset:1152
    buffer_load_dwordx4 v14, s[12:15], s30 offen offset:3136 nt lds
    v_add_f32 v28, v28, v29
    v_cmp_nge_f32 vcc, s32, v28
    s_cbranch_vccnz L_rs28
L_back28:
    v_add_f32 v22, v22, v28
    s_waitcnt lgkmcnt(4)
    v_mfma_f32_32x32x16_bf16 v[128:143], a[224:227], a[160:163], v[160:175]
    ds_read_b128 a[248:251], v9 offset:1216
    v_exp_f32 v24, v144
    v_exp_f32 v25, v145
    v_mfma_f32_32x32x16_bf16 v[128:143], a[228:231], a[164:167], v[128:143]
    ds_read_b128 a[252:255], v12 offset:1216
    v_cvt_pk_bf16_f32 v184, v24, v25
    v_add_f32 v28, v24, v25
    s_waitcnt lgkmcnt(4)
    v_mfma_f32_32x32x16_bf16 v[128:143], a[232:235], a[168:171], v[128:143]
    ds_read_b64_tr_b16 a[224:225], v6 offset:0
    ds_read_b64_tr_b16 a[226:227], v6 offset:512
    v_mfma_f32_32x32x16_bf16 v[128:143], a[236:239], a[172:175], v[128:143]
    ds_read_b64_tr_b16 a[228:229], v6 offset:64
    ds_read_b64_tr_b16 a[230:231], v6 offset:576
    v_exp_f32 v26, v146
    v_exp_f32 v27, v147
    s_waitcnt lgkmcnt(6)
    v_mfma_f32_32x32x16_bf16 v[128:143], a[240:243], a[176:179], v[128:143]
    ds_read_b64_tr_b16 a[232:233], v6 offset:128
    ds_read_b64_tr_b16 a[234:235], v6 offset:640
    v_cvt_pk_bf16_f32 v185, v26, v27
    v_add_f32 v29, v26, v27
    v_mfma_f32_32x32x16_bf16 v[128:143], a[244:247], a[180:183], v[128:143]
    ds_read_b64_tr_b16 a[236:237], v6 offset:192
    ds_read_b64_tr_b16 a[238:239], v6 offset:704
    s_waitcnt lgkmcnt(8)
    v_mfma_f32_32x32x16_bf16 v[128:143], a[248:251], a[184:187], v[128:143]
    ds_read_b64_tr_b16 a[240:241], v6 offset:8448
    ds_read_b64_tr_b16 a[242:243], v6 offset:8960
    v_exp_f32 v24, v148
    v_exp_f32 v25, v149
    v_mfma_f32_32x32x16_bf16 v[128:143], a[252:255], a[188:191], v[128:143]
    ds_read_b64_tr_b16 a[244:245], v6 offset:8512
    ds_read_b64_tr_b16 a[246:247], v6 offset:9024
    v_add_f32 v28, v28, v24
    v_cvt_pk_bf16_f32 v186, v24, v25
    v_add_f32 v29, v29, v25
    s_waitcnt lgkmcnt(8)
    v_mfma_f32_32x32x16_bf16 v[64:79], a[224:227], v[176:179], v[64:79]
    ds_read_b64_tr_b16 a[248:249], v6 offset:8576
    ds_read_b64_tr_b16 a[250:251], v6 offset:9088
    s_waitcnt vmcnt(24)
    s_barrier
    s_add_u32 m0, s24, 84480
    s_mov_b32 s93, 262144
    s_mov_b32 s95, 277504
    v_mfma_f32_32x32x16_bf16 v[80:95], a[228:231], v[176:179], v[80:95]
    ds_read_b64_tr_b16 a[252:253], v6 offset:8640
    ds_read_b64_tr_b16 a[254:255], v6 offset:9152
    buffer_load_dwordx4 v15, s[8:11], s93 offen nt lds
    v_exp_f32 v26, v150
    v_exp_f32 v27, v151
    s_waitcnt lgkmcnt(8)
    v_mfma_f32_32x32x16_bf16 v[96:111], a[232:235], v[176:179], v[96:111]
    ds_read_b64_tr_b16 a[224:225], v3 offset:16896
    ds_read_b64_tr_b16 a[226:227], v3 offset:17408
    v_add_f32 v28, v28, v26
    v_cvt_pk_bf16_f32 v187, v26, v27
    v_add_f32 v29, v29, v27
    v_mfma_f32_32x32x16_bf16 v[112:127], a[236:239], v[176:179], v[112:127]
    ds_read_b64_tr_b16 a[228:229], v3 offset:16960
    ds_read_b64_tr_b16 a[230:231], v3 offset:17472
    buffer_load_dwordx4 v17, s[4:7], s95 offen offset:1024 nt lds
    s_waitcnt lgkmcnt(8)
    v_mfma_f32_32x32x16_bf16 v[64:79], a[240:243], v[180:183], v[64:79]
    ds_read_b64_tr_b16 a[232:233], v3 offset:17024
    ds_read_b64_tr_b16 a[234:235], v3 offset:17536
    v_exp_f32 v24, v152
    v_exp_f32 v25, v153
    v_mfma_f32_32x32x16_bf16 v[80:95], a[244:247], v[180:183], v[80:95]
    ds_read_b64_tr_b16 a[236:237], v3 offset:17088
    ds_read_b64_tr_b16 a[238:239], v3 offset:17600
    buffer_load_dwordx4 v16, s[8:11], s93 offen offset:2112 nt lds
    v_add_f32 v28, v28, v24
    v_cvt_pk_bf16_f32 v188, v24, v25
    v_add_f32 v29, v29, v25
    s_waitcnt lgkmcnt(8)
    v_mfma_f32_32x32x16_bf16 v[96:111], a[248:251], v[180:183], v[96:111]
    ds_read_b64_tr_b16 a[240:241], v3 offset:25344
    ds_read_b64_tr_b16 a[242:243], v3 offset:25856
    v_mfma_f32_32x32x16_bf16 v[112:127], a[252:255], v[180:183], v[112:127]
    ds_read_b64_tr_b16 a[244:245], v3 offset:25408
    ds_read_b64_tr_b16 a[246:247], v3 offset:25920
    buffer_load_dwordx4 v18, s[4:7], s95 offen offset:3136 nt lds
    v_exp_f32 v26, v154
    v_exp_f32 v27, v155
    s_waitcnt lgkmcnt(8)
    v_mfma_f32_32x32x16_bf16 v[192:207], a[224:227], a[32:35], v[192:207]
    ds_read_b64_tr_b16 a[248:249], v3 offset:25472
    ds_read_b64_tr_b16 a[250:251], v3 offset:25984
    v_add_f32 v28, v28, v26
    v_cvt_pk_bf16_f32 v189, v26, v27
    v_add_f32 v29, v29, v27
    v_mfma_f32_32x32x16_bf16 v[208:223], a[228:231], a[32:35], v[208:223]
    ds_read_b64_tr_b16 a[252:253], v3 offset:25536
    ds_read_b64_tr_b16 a[254:255], v3 offset:26048
    s_waitcnt lgkmcnt(8)
    v_mfma_f32_32x32x16_bf16 v[224:239], a[232:235], a[32:35], v[224:239]
    ds_read_b64_tr_b16 a[224:225], v3 offset:17920
    ds_read_b64_tr_b16 a[226:227], v3 offset:18432
    v_exp_f32 v24, v156
    v_exp_f32 v25, v157
    v_mfma_f32_32x32x16_bf16 v[240:255], a[236:239], a[32:35], v[240:255]
    ds_read_b64_tr_b16 a[228:229], v3 offset:17984
    ds_read_b64_tr_b16 a[230:231], v3 offset:18496
    v_add_f32 v28, v28, v24
    v_cvt_pk_bf16_f32 v190, v24, v25
    v_add_f32 v29, v29, v25
    s_waitcnt lgkmcnt(8)
    v_mfma_f32_32x32x16_bf16 v[192:207], a[240:243], a[36:39], v[192:207]
    ds_read_b64_tr_b16 a[232:233], v3 offset:18048
    ds_read_b64_tr_b16 a[234:235], v3 offset:18560
    v_mfma_f32_32x32x16_bf16 v[208:223], a[244:247], a[36:39], v[208:223]
    ds_read_b64_tr_b16 a[236:237], v3 offset:18112
    ds_read_b64_tr_b16 a[238:239], v3 offset:18624
    v_exp_f32 v26, v158
    v_exp_f32 v27, v159
    s_waitcnt lgkmcnt(8)
    v_mfma_f32_32x32x16_bf16 v[224:239], a[248:251], a[36:39], v[224:239]
    ds_read_b64_tr_b16 a[240:241], v3 offset:26368
    ds_read_b64_tr_b16 a[242:243], v3 offset:26880
    v_add_f32 v28, v28, v26
    v_cvt_pk_bf16_f32 v191, v26, v27
    v_add_f32 v29, v29, v27
    v_mfma_f32_32x32x16_bf16 v[240:255], a[252:255], a[36:39], v[240:255]
    ds_read_b64_tr_b16 a[244:245], v3 offset:26432
    ds_read_b64_tr_b16 a[246:247], v3 offset:26944
    v_add_f32 v28, v28, v29
    v_cmp_nge_f32 vcc, s32, v28
    s_cbranch_vccnz L_rs29
L_back29:
    v_add_f32 v22, v22, v28
    s_waitcnt lgkmcnt(8)
    v_mfma_f32_32x32x16_bf16 v[192:207], a[224:227], a[40:43], v[192:207]
    ds_read_b64_tr_b16 a[248:249], v3 offset:26496
    ds_read_b64_tr_b16 a[250:251], v3 offset:27008
    s_waitcnt vmcnt(24)
    s_barrier
    s_add_u32 m0, s24, 101376
    s_mov_b32 s29, 3146496
    s_mov_b32 s30, 3407616
    v_exp_f32 v24, v128
    v_exp_f32 v25, v129
    v_mfma_f32_32x32x16_bf16 v[208:223], a[228:231], a[40:43], v[208:223]
    ds_read_b64_tr_b16 a[252:253], v3 offset:26560
    ds_read_b64_tr_b16 a[254:255], v3 offset:27072
    buffer_load_dwordx4 v13, s[12:15], s29 offen nt lds
    v_cvt_pk_bf16_f32 v176, v24, v25
    v_add_f32 v28, v24, v25
    s_waitcnt lgkmcnt(8)
    v_mfma_f32_32x32x16_bf16 v[224:239], a[232:235], a[40:43], v[224:239]
    ds_read_b128 a[224:227], v9 offset:34816
    v_mfma_f32_32x32x16_bf16 v[240:255], a[236:239], a[40:43], v[240:255]
    ds_read_b128 a[228:231], v12 offset:34816
    buffer_load_dwordx4 v13, s[12:15], s30 offen offset:1024 nt lds
    v_exp_f32 v26, v130
    v_exp_f32 v27, v131
    s_waitcnt lgkmcnt(6)
    v_mfma_f32_32x32x16_bf16 v[192:207], a[240:243], a[44:47], v[192:207]
    ds_read_b128 a[232:235], v9 offset:34880
    v_cvt_pk_bf16_f32 v177, v26, v27
    v_add_f32 v29, v26, v27
    v_mfma_f32_32x32x16_bf16 v[208:223], a[244:247], a[44:47], v[208:223]
    ds_read_b128 a[236:239], v12 offset:34880
    buffer_load_dwordx4 v14, s[12:15], s29 offen offset:2112 nt lds
    s_waitcnt lgkmcnt(4)
    v_mfma_f32_32x32x16_bf16 v[224:239], a[248:251], a[44:47], v[224:239]
    ds_read_b128 a[240:243], v9 offset:34944
    v_exp_f32 v24, v132
    v_exp_f32 v25, v133
    v_mfma_f32_32x32x16_bf16 v[240:255], a[252:255], a[44:47], v[240:255]
    ds_read_b128 a[244:247], v12 offset:34944
    buffer_load_dwordx4 v14, s[12:15], s30 offen offset:3136 nt lds
    v_add_f32 v28, v28, v24
    v_cvt_pk_bf16_f32 v178, v24, v25
    v_add_f32 v29, v29, v25
    s_waitcnt lgkmcnt(4)
    v_mfma_f32_32x32x16_bf16 v[144:159], a[224:227], a[160:163], v[160:175]
    ds_read_b128 a[248:251], v9 offset:35008
    v_mfma_f32_32x32x16_bf16 v[144:159], a[228:231], a[164:167], v[144:159]
    ds_read_b128 a[252:255], v12 offset:35008
    v_exp_f32 v26, v134
    v_exp_f32 v27, v135
    s_waitcnt lgkmcnt(4)
    v_mfma_f32_32x32x16_bf16 v[144:159], a[232:235], a[168:171], v[144:159]
    ds_read_b64_tr_b16 a[224:225], v6 offset:33792
    ds_read_b64_tr_b16 a[226:227], v6 offset:34304
    v_add_f32 v28, v28, v26
    v_cvt_pk_bf16_f32 v179, v26, v27
    v_add_f32 v29, v29, v27
    v_mfma_f32_32x32x16_bf16 v[144:159], a[236:239], a[172:175], v[144:159]
    ds_read_b64_tr_b16 a[228:229], v6 offset:33856
    ds_read_b64_tr_b16 a[230:231], v6 offset:34368
    s_waitcnt lgkmcnt(6)
    v_mfma_f32_32x32x16_bf16 v[144:159], a[240:243], a[176:179], v[144:159]
    ds_read_b64_tr_b16 a[232:233], v6 offset:33920
    ds_read_b64_tr_b16 a[234:235], v6 offset:34432
    v_exp_f32 v24, v136
    v_exp_f32 v25, v137
    v_mfma_f32_32x32x16_bf16 v[144:159], a[244:247], a[180:183], v[144:159]
    ds_read_b64_tr_b16 a[236:237], v6 offset:33984
    ds_read_b64_tr_b16 a[238:239], v6 offset:34496
    v_add_f32 v28, v28, v24
    v_cvt_pk_bf16_f32 v180, v24, v25
    v_add_f32 v29, v29, v25
    s_waitcnt lgkmcnt(8)
    v_mfma_f32_32x32x16_bf16 v[144:159], a[248:251], a[184:187], v[144:159]
    ds_read_b64_tr_b16 a[240:241], v6 offset:42240
    ds_read_b64_tr_b16 a[242:243], v6 offset:42752
    v_mfma_f32_32x32x16_bf16 v[144:159], a[252:255], a[188:191], v[144:159]
    ds_read_b64_tr_b16 a[244:245], v6 offset:42304
    ds_read_b64_tr_b16 a[246:247], v6 offset:42816
    v_exp_f32 v26, v138
    v_exp_f32 v27, v139
    s_waitcnt lgkmcnt(8)
    v_mfma_f32_32x32x16_bf16 v[64:79], a[224:227], v[184:187], v[64:79]
    ds_read_b64_tr_b16 a[248:249], v6 offset:42368
    ds_read_b64_tr_b16 a[250:251], v6 offset:42880
    s_waitcnt vmcnt(24)
    s_barrier
    s_add_u32 m0, s24, 118272
    s_mov_b32 s93, 270336
    s_mov_b32 s95, 285696
    v_add_f32 v28, v28, v26
    v_cvt_pk_bf16_f32 v181, v26, v27
    v_add_f32 v29, v29, v27
    v_mfma_f32_32x32x16_bf16 v[80:95], a[228:231], v[184:187], v[80:95]
    ds_read_b64_tr_b16 a[252:253], v6 offset:42432
    ds_read_b64_tr_b16 a[254:255], v6 offset:42944
    buffer_load_dwordx4 v15, s[8:11], s93 offen nt lds
    s_waitcnt lgkmcnt(8)
    v_mfma_f32_32x32x16_bf16 v[96:111], a[232:235], v[184:187], v[96:111]
    ds_read_b64_tr_b16 a[224:225], v1 offset:0
    ds_read_b64_tr_b16 a[226:227], v1 offset:512
    v_exp_f32 v24, v140
    v_exp_f32 v25, v141
    v_mfma_f32_32x32x16_bf16 v[112:127], a[236:239], v[184:187], v[112:127]
    ds_read_b64_tr_b16 a[228:229], v1 offset:64
    ds_read_b64_tr_b16 a[230:231], v1 offset:576
    buffer_load_dwordx4 v17, s[4:7], s95 offen offset:1024 nt lds
    v_add_f32 v28, v28, v24
    v_cvt_pk_bf16_f32 v182, v24, v25
    v_add_f32 v29, v29, v25
    s_waitcnt lgkmcnt(8)
    v_mfma_f32_32x32x16_bf16 v[64:79], a[240:243], v[188:191], v[64:79]
    ds_read_b64_tr_b16 a[232:233], v1 offset:128
    ds_read_b64_tr_b16 a[234:235], v1 offset:640
    v_mfma_f32_32x32x16_bf16 v[80:95], a[244:247], v[188:191], v[80:95]
    ds_read_b64_tr_b16 a[236:237], v1 offset:192
    ds_read_b64_tr_b16 a[238:239], v1 offset:704
    buffer_load_dwordx4 v16, s[8:11], s93 offen offset:2112 nt lds
    v_exp_f32 v26, v142
    v_exp_f32 v27, v143
    s_waitcnt lgkmcnt(8)
    v_mfma_f32_32x32x16_bf16 v[96:111], a[248:251], v[188:191], v[96:111]
    ds_read_b64_tr_b16 a[240:241], v1 offset:8448
    ds_read_b64_tr_b16 a[242:243], v1 offset:8960
    v_add_f32 v28, v28, v26
    v_cvt_pk_bf16_f32 v183, v26, v27
    v_add_f32 v29, v29, v27
    v_mfma_f32_32x32x16_bf16 v[112:127], a[252:255], v[188:191], v[112:127]
    ds_read_b64_tr_b16 a[244:245], v1 offset:8512
    ds_read_b64_tr_b16 a[246:247], v1 offset:9024
    buffer_load_dwordx4 v18, s[4:7], s95 offen offset:3136 nt lds
    v_add_f32 v28, v28, v29
    v_cmp_nge_f32 vcc, s32, v28
    s_cbranch_vccnz L_rs30
L_back30:
    v_add_f32 v22, v22, v28
    s_waitcnt lgkmcnt(8)
    v_mfma_f32_32x32x16_bf16 v[192:207], a[224:227], a[48:51], v[192:207]
    ds_read_b64_tr_b16 a[248:249], v1 offset:8576
    ds_read_b64_tr_b16 a[250:251], v1 offset:9088
    v_exp_f32 v24, v144
    v_exp_f32 v25, v145
    v_mfma_f32_32x32x16_bf16 v[208:223], a[228:231], a[48:51], v[208:223]
    ds_read_b64_tr_b16 a[252:253], v1 offset:8640
    ds_read_b64_tr_b16 a[254:255], v1 offset:9152
    v_cvt_pk_bf16_f32 v184, v24, v25
    v_add_f32 v28, v24, v25
    s_waitcnt lgkmcnt(8)
    v_mfma_f32_32x32x16_bf16 v[224:239], a[232:235], a[48:51], v[224:239]
    ds_read_b64_tr_b16 a[224:225], v1 offset:1024
    ds_read_b64_tr_b16 a[226:227], v1 offset:1536
    v_mfma_f32_32x32x16_bf16 v[240:255], a[236:239], a[48:51], v[240:255]
    ds_read_b64_tr_b16 a[228:229], v1 offset:1088
    ds_read_b64_tr_b16 a[230:231], v1 offset:1600
    v_exp_f32 v26, v146
    v_exp_f32 v27, v147
    s_waitcnt lgkmcnt(8)
    v_mfma_f32_32x32x16_bf16 v[192:207], a[240:243], a[52:55], v[192:207]
    ds_read_b64_tr_b16 a[232:233], v1 offset:1152
    ds_read_b64_tr_b16 a[234:235], v1 offset:1664
    v_cvt_pk_bf16_f32 v185, v26, v27
    v_add_f32 v29, v26, v27
    v_mfma_f32_32x32x16_bf16 v[208:223], a[244:247], a[52:55], v[208:223]
    ds_read_b64_tr_b16 a[236:237], v1 offset:1216
    ds_read_b64_tr_b16 a[238:239], v1 offset:1728
    s_waitcnt lgkmcnt(8)
    v_mfma_f32_32x32x16_bf16 v[224:239], a[248:251], a[52:55], v[224:239]
    ds_read_b64_tr_b16 a[240:241], v1 offset:9472
    ds_read_b64_tr_b16 a[242:243], v1 offset:9984
    v_exp_f32 v24, v148
    v_exp_f32 v25, v149
    v_mfma_f32_32x32x16_bf16 v[240:255], a[252:255], a[52:55], v[240:255]
    ds_read_b64_tr_b16 a[244:245], v1 offset:9536
    ds_read_b64_tr_b16 a[246:247], v1 offset:10048
    v_add_f32 v28, v28, v24
    v_cvt_pk_bf16_f32 v186, v24, v25
    v_add_f32 v29, v29, v25
    s_waitcnt lgkmcnt(8)
    v_mfma_f32_32x32x16_bf16 v[192:207], a[224:227], a[56:59], v[192:207]
    ds_read_b64_tr_b16 a[248:249], v1 offset:9600
    ds_read_b64_tr_b16 a[250:251], v1 offset:10112
    s_waitcnt vmcnt(24)
    s_barrier
    s_add_u32 m0, s24, 135168
    s_mov_b32 s93, 278528
    s_mov_b32 s95, 293888
    v_mfma_f32_32x32x16_bf16 v[208:223], a[228:231], a[56:59], v[208:223]
    ds_read_b64_tr_b16 a[252:253], v1 offset:9664
    ds_read_b64_tr_b16 a[254:255], v1 offset:10176
    buffer_load_dwordx4 v15, s[8:11], s93 offen nt lds
    v_exp_f32 v26, v150
    v_exp_f32 v27, v151
    s_waitcnt lgkmcnt(8)
    v_mfma_f32_32x32x16_bf16 v[224:239], a[232:235], a[56:59], v[224:239]
    ds_read_b64_tr_b16 a[224:225], v4 offset:16896
    ds_read_b64_tr_b16 a[226:227], v4 offset:17408
    v_add_f32 v28, v28, v26
    v_cvt_pk_bf16_f32 v187, v26, v27
    v_add_f32 v29, v29, v27
    v_mfma_f32_32x32x16_bf16 v[240:255], a[236:239], a[56:59], v[240:255]
    ds_read_b64_tr_b16 a[228:229], v4 offset:16960
    ds_read_b64_tr_b16 a[230:231], v4 offset:17472
    buffer_load_dwordx4 v17, s[4:7], s95 offen offset:1024 nt lds
    s_waitcnt lgkmcnt(8)
    v_mfma_f32_32x32x16_bf16 v[192:207], a[240:243], a[60:63], v[192:207]
    ds_read_b64_tr_b16 a[232:233], v4 offset:17024
    ds_read_b64_tr_b16 a[234:235], v4 offset:17536
    v_exp_f32 v24, v152
    v_exp_f32 v25, v153
    v_mfma_f32_32x32x16_bf16 v[208:223], a[244:247], a[60:63], v[208:223]
    ds_read_b64_tr_b16 a[236:237], v4 offset:17088
    ds_read_b64_tr_b16 a[238:239], v4 offset:17600
    buffer_load_dwordx4 v16, s[8:11], s93 offen offset:2112 nt lds
    v_add_f32 v28, v28, v24
    v_cvt_pk_bf16_f32 v188, v24, v25
    v_add_f32 v29, v29, v25
    s_waitcnt lgkmcnt(8)
    v_mfma_f32_32x32x16_bf16 v[224:239], a[248:251], a[60:63], v[224:239]
    ds_read_b64_tr_b16 a[240:241], v4 offset:25344
    ds_read_b64_tr_b16 a[242:243], v4 offset:25856
    v_mfma_f32_32x32x16_bf16 v[240:255], a[252:255], a[60:63], v[240:255]
    ds_read_b64_tr_b16 a[244:245], v4 offset:25408
    ds_read_b64_tr_b16 a[246:247], v4 offset:25920
    buffer_load_dwordx4 v18, s[4:7], s95 offen offset:3136 nt lds
    v_exp_f32 v26, v154
    v_exp_f32 v27, v155
    s_waitcnt lgkmcnt(8)
    v_mfma_f32_32x32x16_bf16 v[64:79], a[224:227], v[176:179], v[64:79]
    ds_read_b64_tr_b16 a[248:249], v4 offset:25472
    ds_read_b64_tr_b16 a[250:251], v4 offset:25984
    v_add_f32 v28, v28, v26
    v_cvt_pk_bf16_f32 v189, v26, v27
    v_add_f32 v29, v29, v27
    v_mfma_f32_32x32x16_bf16 v[80:95], a[228:231], v[176:179], v[80:95]
    ds_read_b64_tr_b16 a[252:253], v4 offset:25536
    ds_read_b64_tr_b16 a[254:255], v4 offset:26048
    s_waitcnt lgkmcnt(8)
    v_mfma_f32_32x32x16_bf16 v[96:111], a[232:235], v[176:179], v[96:111]
    ds_read_b64_tr_b16 a[224:225], v4 offset:17920
    ds_read_b64_tr_b16 a[226:227], v4 offset:18432
    v_exp_f32 v24, v156
    v_exp_f32 v25, v157
    v_mfma_f32_32x32x16_bf16 v[112:127], a[236:239], v[176:179], v[112:127]
    ds_read_b64_tr_b16 a[228:229], v4 offset:17984
    ds_read_b64_tr_b16 a[230:231], v4 offset:18496
    v_add_f32 v28, v28, v24
    v_cvt_pk_bf16_f32 v190, v24, v25
    v_add_f32 v29, v29, v25
    s_waitcnt lgkmcnt(8)
    v_mfma_f32_32x32x16_bf16 v[64:79], a[240:243], v[180:183], v[64:79]
    ds_read_b64_tr_b16 a[232:233], v4 offset:18048
    ds_read_b64_tr_b16 a[234:235], v4 offset:18560
    v_mfma_f32_32x32x16_bf16 v[80:95], a[244:247], v[180:183], v[80:95]
    ds_read_b64_tr_b16 a[236:237], v4 offset:18112
    ds_read_b64_tr_b16 a[238:239], v4 offset:18624
    v_exp_f32 v26, v158
    v_exp_f32 v27, v159
    s_waitcnt lgkmcnt(8)
    v_mfma_f32_32x32x16_bf16 v[96:111], a[248:251], v[180:183], v[96:111]
    ds_read_b64_tr_b16 a[240:241], v4 offset:26368
    ds_read_b64_tr_b16 a[242:243], v4 offset:26880
    v_add_f32 v28, v28, v26
    v_cvt_pk_bf16_f32 v191, v26, v27
    v_add_f32 v29, v29, v27
    v_mfma_f32_32x32x16_bf16 v[112:127], a[252:255], v[180:183], v[112:127]
    ds_read_b64_tr_b16 a[244:245], v4 offset:26432
    ds_read_b64_tr_b16 a[246:247], v4 offset:26944
    v_add_f32 v28, v28, v29
    v_cmp_nge_f32 vcc, s32, v28
    s_cbranch_vccnz L_rs31
L_back31:
    v_add_f32 v22, v22, v28
    s_waitcnt lgkmcnt(8)
    v_mfma_f32_32x32x16_bf16 v[64:79], a[224:227], v[184:187], v[64:79]
    ds_read_b64_tr_b16 a[248:249], v4 offset:26496
    ds_read_b64_tr_b16 a[250:251], v4 offset:27008
    s_waitcnt vmcnt(24)
    s_barrier
    s_add_u32 m0, s24, 0
    s_mov_b32 s29, 3670784
    s_mov_b32 s30, 3931904
    v_mfma_f32_32x32x16_bf16 v[80:95], a[228:231], v[184:187], v[80:95]
    ds_read_b64_tr_b16 a[252:253], v4 offset:26560
    ds_read_b64_tr_b16 a[254:255], v4 offset:27072
    buffer_load_dwordx4 v13, s[12:15], s29 offen nt lds
    v_mov_b32 v31, v22
    s_waitcnt lgkmcnt(8)
    v_mfma_f32_32x32x16_bf16 v[96:111], a[232:235], v[184:187], v[96:111]
    ds_read_b64_tr_b16 a[224:225], v1 offset:33792
    ds_read_b64_tr_b16 a[226:227], v1 offset:34304
    v_permlane32_swap_b32 v22, v31
    v_mfma_f32_32x32x16_bf16 v[112:127], a[236:239], v[184:187], v[112:127]
    ds_read_b64_tr_b16 a[228:229], v1 offset:33856
    ds_read_b64_tr_b16 a[230:231], v1 offset:34368
    buffer_load_dwordx4 v13, s[12:15], s30 offen offset:1024 nt lds
    v_add_f32 v22, v22, v31
    s_waitcnt lgkmcnt(8)
    v_mfma_f32_32x32x16_bf16 v[64:79], a[240:243], v[188:191], v[64:79]
    ds_read_b64_tr_b16 a[232:233], v1 offset:33920
    ds_read_b64_tr_b16 a[234:235], v1 offset:34432
    v_rcp_f32 v23, v22
    v_mfma_f32_32x32x16_bf16 v[80:95], a[244:247], v[188:191], v[80:95]
    ds_read_b64_tr_b16 a[236:237], v1 offset:33984
    ds_read_b64_tr_b16 a[238:239], v1 offset:34496
    buffer_load_dwordx4 v14, s[12:15], s29 offen offset:2112 nt lds
    s_waitcnt lgkmcnt(8)
    v_mfma_f32_32x32x16_bf16 v[96:111], a[248:251], v[188:191], v[96:111]
    ds_read_b64_tr_b16 a[240:241], v1 offset:42240
    ds_read_b64_tr_b16 a[242:243], v1 offset:42752
    v_mfma_f32_32x32x16_bf16 v[112:127], a[252:255], v[188:191], v[112:127]
    ds_read_b64_tr_b16 a[244:245], v1 offset:42304
    ds_read_b64_tr_b16 a[246:247], v1 offset:42816
    buffer_load_dwordx4 v14, s[12:15], s30 offen offset:3136 nt lds
    s_waitcnt lgkmcnt(8)
    v_mfma_f32_32x32x16_bf16 v[192:207], a[224:227], a[64:67], v[192:207]
    ds_read_b64_tr_b16 a[248:249], v1 offset:42368
    ds_read_b64_tr_b16 a[250:251], v1 offset:42880
    v_mfma_f32_32x32x16_bf16 v[208:223], a[228:231], a[64:67], v[208:223]
    ds_read_b64_tr_b16 a[252:253], v1 offset:42432
    ds_read_b64_tr_b16 a[254:255], v1 offset:42944
    v_mul_f32 v64, v64, v23
    v_mul_f32 v65, v65, v23
    v_cvt_pk_bf16_f32 v64, v64, v65
    v_accvgpr_write_b32 a160, v64
    v_mov_b32 v31, 156160
    s_waitcnt lgkmcnt(8)
    v_mfma_f32_32x32x16_bf16 v[224:239], a[232:235], a[64:67], v[224:239]
    ds_read_b64_tr_b16 a[224:225], v1 offset:34816
    ds_read_b64_tr_b16 a[226:227], v1 offset:35328
    v_mul_f32 v66, v66, v23
    v_mul_f32 v67, v67, v23
    v_cvt_pk_bf16_f32 v66, v66, v67
    v_accvgpr_write_b32 a161, v66
    ds_read_b32 v30, v31
    v_mfma_f32_32x32x16_bf16 v[240:255], a[236:239], a[64:67], v[240:255]
    ds_read_b64_tr_b16 a[228:229], v1 offset:34880
    ds_read_b64_tr_b16 a[230:231], v1 offset:35392
    v_mul_f32 v68, v68, v23
    v_mul_f32 v69, v69, v23
    v_cvt_pk_bf16_f32 v68, v68, v69
    v_accvgpr_write_b32 a162, v68
    s_waitcnt lgkmcnt(9)
    v_mfma_f32_32x32x16_bf16 v[192:207], a[240:243], a[68:71], v[192:207]
    ds_read_b64_tr_b16 a[232:233], v1 offset:34944
    ds_read_b64_tr_b16 a[234:235], v1 offset:35456
    v_mul_f32 v70, v70, v23
    v_mul_f32 v71, v71, v23
    v_cvt_pk_bf16_f32 v70, v70, v71
    v_accvgpr_write_b32 a163, v70
    v_mfma_f32_32x32x16_bf16 v[208:223], a[244:247], a[68:71], v[208:223]
    ds_read_b64_tr_b16 a[236:237], v1 offset:35008
    ds_read_b64_tr_b16 a[238:239], v1 offset:35520
    v_mul_f32 v72, v72, v23
    v_mul_f32 v73, v73, v23
    v_cvt_pk_bf16_f32 v72, v72, v73
    v_accvgpr_write_b32 a164, v72
    s_waitcnt lgkmcnt(9)
    v_mfma_f32_32x32x16_bf16 v[224:239], a[248:251], a[68:71], v[224:239]
    ds_read_b64_tr_b16 a[240:241], v1 offset:43264
    ds_read_b64_tr_b16 a[242:243], v1 offset:43776
    v_mul_f32 v74, v74, v23
    v_mul_f32 v75, v75, v23
    v_cvt_pk_bf16_f32 v74, v74, v75
    v_accvgpr_write_b32 a165, v74
    s_waitcnt lgkmcnt(8)
    v_readfirstlane_b32 s100, v30
    v_mfma_f32_32x32x16_bf16 v[240:255], a[252:255], a[68:71], v[240:255]
    ds_read_b64_tr_b16 a[244:245], v1 offset:43328
    ds_read_b64_tr_b16 a[246:247], v1 offset:43840
    v_mul_f32 v76, v76, v23
    v_mul_f32 v77, v77, v23
    v_cvt_pk_bf16_f32 v76, v76, v77
    s_waitcnt lgkmcnt(8)
    v_mfma_f32_32x32x16_bf16 v[192:207], a[224:227], a[72:75], v[192:207]
    ds_read_b64_tr_b16 a[248:249], v1 offset:43392
    ds_read_b64_tr_b16 a[250:251], v1 offset:43904
    s_waitcnt vmcnt(24)
    s_barrier
    s_add_u32 m0, s24, 16896
    s_mov_b32 s93, 286720
    s_mov_b32 s95, 302080
    v_accvgpr_write_b32 a166, v76
    v_mul_f32 v78, v78, v23
    v_mul_f32 v79, v79, v23
    v_cvt_pk_bf16_f32 v78, v78, v79
    s_xor_b32 s101, s100, 0x5bd1e995
    s_brev_b32 s101, s101
    v_mfma_f32_32x32x16_bf16 v[208:223], a[228:231], a[72:75], v[208:223]
    ds_read_b64_tr_b16 a[252:253], v1 offset:43456
    ds_read_b64_tr_b16 a[254:255], v1 offset:43968
    buffer_load_dwordx4 v15, s[8:11], s93 offen nt lds
    v_accvgpr_write_b32 a167, v78
    v_mul_f32 v80, v80, v23
    v_mul_f32 v81, v81, v23
    v_cvt_pk_bf16_f32 v80, v80, v81
    s_waitcnt lgkmcnt(8)
    v_mfma_f32_32x32x16_bf16 v[224:239], a[232:235], a[72:75], v[224:239]
    ds_read_b128 a[224:227], v8 offset:0
    v_accvgpr_write_b32 a168, v80
    v_mul_f32 v82, v82, v23
    v_mul_f32 v83, v83, v23
    v_cvt_pk_bf16_f32 v82, v82, v83
    v_mfma_f32_32x32x16_bf16 v[240:255], a[236:239], a[72:75], v[240:255]
    ds_read_b128 a[228:231], v11 offset:0
    buffer_load_dwordx4 v17, s[4:7], s95 offen offset:1024 nt lds
    v_accvgpr_write_b32 a169, v82
    v_mul_f32 v84, v84, v23
    v_mul_f32 v85, v85, v23
    v_cvt_pk_bf16_f32 v84, v84, v85
    s_waitcnt lgkmcnt(6)
    v_mfma_f32_32x32x16_bf16 v[192:207], a[240:243], a[76:79], v[192:207]
    ds_read_b128 a[232:235], v8 offset:64
    v_accvgpr_write_b32 a170, v84
    v_mul_f32 v86, v86, v23
    v_mul_f32 v87, v87, v23
    v_cvt_pk_bf16_f32 v86, v86, v87
    v_mfma_f32_32x32x16_bf16 v[208:223], a[244:247], a[76:79], v[208:223]
    ds_read_b128 a[236:239], v11 offset:64
    buffer_load_dwordx4 v16, s[8:11], s93 offen offset:2112 nt lds
    v_accvgpr_write_b32 a171, v86
    v_mul_f32 v88, v88, v23
    v_mul_f32 v89, v89, v23
    s_waitcnt lgkmcnt(4)
    v_mfma_f32_32x32x16_bf16 v[224:239], a[248:251], a[76:79], v[224:239]
    ds_read_b128 a[240:243], v8 offset:128
    v_cvt_pk_bf16_f32 v88, v88, v89
    v_accvgpr_write_b32 a172, v88
    v_mul_f32 v90, v90, v23
    v_mul_f32 v91, v91, v23
    v_mfma_f32_32x32x16_bf16 v[240:255], a[252:255], a[76:79], v[240:255]
    ds_read_b128 a[244:247], v11 offset:128
    buffer_load_dwordx4 v18, s[4:7], s95 offen offset:3136 nt lds
    v_cvt_pk_bf16_f32 v90, v90, v91
    v_accvgpr_write_b32 a173, v90
    v_mul_f32 v92, v92, v23
    v_mul_f32 v93, v93, v23
    s_waitcnt lgkmcnt(4)
    v_mfma_f32_32x32x16_bf16 v[128:143], a[224:227], a[192:195], 0
    ds_read_b128 a[248:251], v8 offset:192
    v_cvt_pk_bf16_f32 v92, v92, v93
    v_accvgpr_write_b32 a174, v92
    v_mul_f32 v94, v94, v23
    v_mul_f32 v95, v95, v23
    v_mfma_f32_32x32x16_bf16 v[128:143], a[228:231], a[196:199], v[128:143]
    ds_read_b128 a[252:255], v11 offset:192
    v_cvt_pk_bf16_f32 v94, v94, v95
    v_accvgpr_write_b32 a175, v94
    v_mul_f32 v96, v96, v23
    v_mul_f32 v97, v97, v23
    s_waitcnt lgkmcnt(4)
    v_mfma_f32_32x32x16_bf16 v[128:143], a[232:235], a[200:203], v[128:143]
    ds_read_b128 a[224:227], v8 offset:1024
    v_cvt_pk_bf16_f32 v96, v96, v97
    v_accvgpr_write_b32 a176, v96
    v_mul_f32 v98, v98, v23
    v_mul_f32 v99, v99, v23
    v_mfma_f32_32x32x16_bf16 v[128:143], a[236:239], a[204:207], v[128:143]
    ds_read_b128 a[228:231], v11 offset:1024
    v_cvt_pk_bf16_f32 v98, v98, v99
    v_accvgpr_write_b32 a177, v98
    v_mul_f32 v100, v100, v23
    s_waitcnt lgkmcnt(4)
    v_mfma_f32_32x32x16_bf16 v[128:143], a[240:243], a[208:211], v[128:143]
    ds_read_b128 a[232:235], v8 offset:1088
    v_mul_f32 v101, v101, v23
    v_cvt_pk_bf16_f32 v100, v100, v101
    v_accvgpr_write_b32 a178, v100
    v_mul_f32 v102, v102, v23
    v_mfma_f32_32x32x16_bf16 v[128:143], a[244:247], a[212:215], v[128:143]
    ds_read_b128 a[236:239], v11 offset:1088
    v_mul_f32 v103, v103, v23
    v_cvt_pk_bf16_f32 v102, v102, v103
    v_accvgpr_write_b32 a179, v102
    v_mul_f32 v104, v104, v23
    s_waitcnt lgkmcnt(4)
    v_mfma_f32_32x32x16_bf16 v[128:143], a[248:251], a[216:219], v[128:143]
    ds_read_b128 a[240:243], v8 offset:1152
    v_mul_f32 v105, v105, v23
    v_cvt_pk_bf16_f32 v104, v104, v105
    v_accvgpr_write_b32 a180, v104
    v_mul_f32 v106, v106, v23
    v_mfma_f32_32x32x16_bf16 v[128:143], a[252:255], a[220:223], v[128:143]
    ds_read_b128 a[244:247], v11 offset:1152
    v_mul_f32 v107, v107, v23
    v_cvt_pk_bf16_f32 v106, v106, v107
    v_accvgpr_write_b32 a181, v106
    v_mul_f32 v108, v108, v23
    s_waitcnt lgkmcnt(4)
    v_mfma_f32_32x32x16_bf16 v[144:159], a[224:227], a[192:195], 0
    ds_read_b128 a[248:251], v8 offset:1216
    s_waitcnt vmcnt(24)
    s_barrier
    s_add_u32 m0, s24, 33792
    s_mov_b32 s29, 4195072
    s_mov_b32 s30, 4456192
    v_mul_f32 v109, v109, v23
    v_cvt_pk_bf16_f32 v108, v108, v109
    v_accvgpr_write_b32 a182, v108
    v_mul_f32 v110, v110, v23
    v_mfma_f32_32x32x16_bf16 v[144:159], a[228:231], a[196:199], v[144:159]
    ds_read_b128 a[252:255], v11 offset:1216
    buffer_load_dwordx4 v13, s[12:15], s29 offen nt lds
    v_mul_f32 v111, v111, v23
    v_cvt_pk_bf16_f32 v110, v110, v111
    v_accvgpr_write_b32 a183, v110
    s_waitcnt lgkmcnt(4)
    v_mfma_f32_32x32x16_bf16 v[144:159], a[232:235], a[200:203], v[144:159]
    ds_read_b64_tr_b16 a[224:225], v2 offset:16896
    ds_read_b64_tr_b16 a[226:227], v2 offset:17408
    v_max3_f32 v30, v128, v129, v130
    v_max3_f32 v31, v131, v132, v133
    v_max3_f32 v30, v30, v134, v135
    v_max3_f32 v31, v31, v136, v137
    v_max3_f32 v30, v30, v138, v139
    v_max3_f32 v31, v31, v140, v141
    v_max3_f32 v30, v30, v142, v143
    v_mfma_f32_32x32x16_bf16 v[144:159], a[236:239], a[204:207], v[144:159]
    ds_read_b64_tr_b16 a[228:229], v2 offset:16960
    ds_read_b64_tr_b16 a[230:231], v2 offset:17472
    buffer_load_dwordx4 v13, s[12:15], s30 offen offset:1024 nt lds
    v_max_f32 v30, v30, v31
    v_mov_b32 v31, v30
    s_nop 1
    v_permlane32_swap_b32 v30, v31
    v_max_f32 v30, v30, v31
    v_sub_f32 v30, 0, v30
    v_add_f32 v128, v128, v30
    s_waitcnt lgkmcnt(6)
    v_mfma_f32_32x32x16_bf16 v[144:159], a[240:243], a[208:211], v[144:159]
    ds_read_b64_tr_b16 a[232:233], v2 offset:17024
    ds_read_b64_tr_b16 a[234:235], v2 offset:17536
    v_add_f32 v129, v129, v30
    v_add_f32 v130, v130, v30
    v_add_f32 v131, v131, v30
    v_add_f32 v132, v132, v30
    v_add_f32 v133, v133, v30
    v_add_f32 v134, v134, v30
    v_mfma_f32_32x32x16_bf16 v[144:159], a[244:247], a[212:215], v[144:159]
    ds_read_b64_tr_b16 a[236:237], v2 offset:17088
    ds_read_b64_tr_b16 a[238:239], v2 offset:17600
    buffer_load_dwordx4 v14, s[12:15], s29 offen offset:2112 nt lds
    v_add_f32 v135, v135, v30
    v_add_f32 v136, v136, v30
    v_add_f32 v137, v137, v30
    v_add_f32 v138, v138, v30
    v_add_f32 v139, v139, v30
    v_add_f32 v140, v140, v30
    s_waitcnt lgkmcnt(8)
    v_mfma_f32_32x32x16_bf16 v[144:159], a[248:251], a[216:219], v[144:159]
    ds_read_b64_tr_b16 a[240:241], v2 offset:25344
    ds_read_b64_tr_b16 a[242:243], v2 offset:25856
    v_add_f32 v141, v141, v30
    v_add_f32 v142, v142, v30
    v_add_f32 v143, v143, v30
    v_exp_f32 v24, v128
    v_exp_f32 v25, v129
    s_nop 0
    v_cvt_pk_bf16_f32 v176, v24, v25
    v_mfma_f32_32x32x16_bf16 v[144:159], a[252:255], a[220:223], v[144:159]
    ds_read_b64_tr_b16 a[244:245], v2 offset:25408
    ds_read_b64_tr_b16 a[246:247], v2 offset:25920
    buffer_load_dwordx4 v14, s[12:15], s30 offen offset:3136 nt lds
    v_add_f32 v28, v24, v25
    v_exp_f32 v26, v130
    v_exp_f32 v27, v131
    s_nop 0
    v_cvt_pk_bf16_f32 v177, v26, v27
    v_add_f32 v29, v26, v27
    v_exp_f32 v24, v132
    v_exp_f32 v25, v133
    s_waitcnt lgkmcnt(8)
    v_mfma_f32_32x32x16_bf16 v[192:207], a[224:227], a[80:83], v[192:207]
    ds_read_b64_tr_b16 a[248:249], v2 offset:25472
    ds_read_b64_tr_b16 a[250:251], v2 offset:25984
    v_add_f32 v28, v28, v24
    v_cvt_pk_bf16_f32 v178, v24, v25
    v_add_f32 v29, v29, v25
    v_exp_f32 v26, v134
    v_exp_f32 v27, v135
    v_add_f32 v28, v28, v26
    v_mfma_f32_32x32x16_bf16 v[208:223], a[228:231], a[80:83], v[208:223]
    ds_read_b64_tr_b16 a[252:253], v2 offset:25536
    ds_read_b64_tr_b16 a[254:255], v2 offset:26048
    v_cvt_pk_bf16_f32 v179, v26, v27
    v_add_f32 v29, v29, v27
    v_exp_f32 v24, v136
    v_exp_f32 v25, v137
    v_add_f32 v28, v28, v24
    v_cvt_pk_bf16_f32 v180, v24, v25
    s_waitcnt lgkmcnt(8)
    v_mfma_f32_32x32x16_bf16 v[224:239], a[232:235], a[80:83], v[224:239]
    ds_read_b64_tr_b16 a[224:225], v2 offset:17920
    ds_read_b64_tr_b16 a[226:227], v2 offset:18432
    v_add_f32 v29, v29, v25
    v_exp_f32 v26, v138
    v_exp_f32 v27, v139
    v_add_f32 v28, v28, v26
    v_cvt_pk_bf16_f32 v181, v26, v27
    v_add_f32 v29, v29, v27
    v_mfma_f32_32x32x16_bf16 v[240:255], a[236:239], a[80:83], v[240:255]
    ds_read_b64_tr_b16 a[228:229], v2 offset:17984
    ds_read_b64_tr_b16 a[230:231], v2 offset:18496
    v_exp_f32 v24, v140
    v_exp_f32 v25, v141
    v_add_f32 v28, v28, v24
    v_cvt_pk_bf16_f32 v182, v24, v25
    v_add_f32 v29, v29, v25
    v_exp_f32 v26, v142
    s_waitcnt lgkmcnt(8)
    v_mfma_f32_32x32x16_bf16 v[192:207], a[240:243], a[84:87], v[192:207]
    ds_read_b64_tr_b16 a[232:233], v2 offset:18048
    ds_read_b64_tr_b16 a[234:235], v2 offset:18560
    v_exp_f32 v27, v143
    v_add_f32 v28, v28, v26
    v_cvt_pk_bf16_f32 v183, v26, v27
    v_add_f32 v29, v29, v27
    v_add_f32 v22, v28, v29
    v_mov_b32 v160, v30
    v_mov_b32 v161, v30
    v_mfma_f32_32x32x16_bf16 v[208:223], a[244:247], a[84:87], v[208:223]
    ds_read_b64_tr_b16 a[236:237], v2 offset:18112
    ds_read_b64_tr_b16 a[238:239], v2 offset:18624
    v_mov_b32 v162, v30
    v_mov_b32 v163, v30
    v_mov_b32 v164, v30
    v_mov_b32 v165, v30
    v_mov_b32 v166, v30
    v_mov_b32 v167, v30
    s_waitcnt lgkmcnt(8)
    v_mfma_f32_32x32x16_bf16 v[224:239], a[248:251], a[84:87], v[224:239]
    ds_read_b64_tr_b16 a[240:241], v2 offset:26368
    ds_read_b64_tr_b16 a[242:243], v2 offset:26880
    v_mov_b32 v168, v30
    v_mov_b32 v169, v30
    v_mov_b32 v170, v30
    v_mov_b32 v171, v30
    v_mov_b32 v172, v30
    v_mov_b32 v173, v30
    v_mfma_f32_32x32x16_bf16 v[240:255], a[252:255], a[84:87], v[240:255]
    ds_read_b64_tr_b16 a[244:245], v2 offset:26432
    ds_read_b64_tr_b16 a[246:247], v2 offset:26944
    v_mov_b32 v174, v30
    v_mov_b32 v175, v30
    v_add_f32 v144, v144, v30
    v_add_f32 v145, v145, v30
    v_add_f32 v146, v146, v30
    v_add_f32 v147, v147, v30
    s_waitcnt lgkmcnt(8)
    v_mfma_f32_32x32x16_bf16 v[192:207], a[224:227], a[88:91], v[192:207]
    ds_read_b64_tr_b16 a[248:249], v2 offset:26496
    ds_read_b64_tr_b16 a[250:251], v2 offset:27008
    s_waitcnt vmcnt(24)
    s_barrier
    s_add_u32 m0, s24, 50688
    s_mov_b32 s93, 294912
    s_mov_b32 s95, 310272
    v_add_f32 v148, v148, v30
    v_add_f32 v149, v149, v30
    v_add_f32 v150, v150, v30
    v_add_f32 v151, v151, v30
    v_add_f32 v152, v152, v30
    v_add_f32 v153, v153, v30
    v_mfma_f32_32x32x16_bf16 v[208:223], a[228:231], a[88:91], v[208:223]
    ds_read_b64_tr_b16 a[252:253], v2 offset:26560
    ds_read_b64_tr_b16 a[254:255], v2 offset:27072
    buffer_load_dwordx4 v15, s[8:11], s93 offen nt lds
    v_add_f32 v154, v154, v30
    v_add_f32 v155, v155, v30
    v_add_f32 v156, v156, v30
    v_add_f32 v157, v157, v30
    v_add_f32 v158, v158, v30
    v_add_f32 v159, v159, v30
    s_waitcnt lgkmcnt(8)
    v_mfma_f32_32x32x16_bf16 v[224:239], a[232:235], a[88:91], v[224:239]
    ds_read_b128 a[224:227], v8 offset:34816
    v_mul_f32 v112, v112, v23
    v_mul_f32 v113, v113, v23
    v_cvt_pk_bf16_f32 v112, v112, v113
    v_accvgpr_write_b32 a184, v112
    v_mul_f32 v114, v114, v23
    v_mul_f32 v115, v115, v23
    v_mfma_f32_32x32x16_bf16 v[240:255], a[236:239], a[88:91], v[240:255]
    ds_read_b128 a[228:231], v11 offset:34816
    buffer_load_dwordx4 v17, s[4:7], s95 offen offset:1024 nt lds
    v_cvt_pk_bf16_f32 v114, v114, v115
    v_accvgpr_write_b32 a185, v114
    v_mul_f32 v116, v116, v23
    v_mul_f32 v117, v117, v23
    v_cvt_pk_bf16_f32 v116, v116, v117
    s_waitcnt lgkmcnt(6)
    v_mfma_f32_32x32x16_bf16 v[192:207], a[240:243], a[92:95], v[192:207]
    ds_read_b128 a[232:235], v8 offset:34880
    v_accvgpr_write_b32 a186, v116
    v_mul_f32 v118, v118, v23
    v_mul_f32 v119, v119, v23
    v_cvt_pk_bf16_f32 v118, v118, v119
    v_accvgpr_write_b32 a187, v118
    v_mfma_f32_32x32x16_bf16 v[208:223], a[244:247], a[92:95], v[208:223]
    ds_read_b128 a[236:239], v11 offset:34880
    buffer_load_dwordx4 v16, s[8:11], s93 offen offset:2112 nt lds
    v_mul_f32 v120, v120, v23
    v_mul_f32 v121, v121, v23
    v_cvt_pk_bf16_f32 v120, v120, v121
    v_accvgpr_write_b32 a188, v120
    v_mul_f32 v122, v122, v23
    v_mul_f32 v123, v123, v23
    s_waitcnt lgkmcnt(4)
    v_mfma_f32_32x32x16_bf16 v[224:239], a[248:251], a[92:95], v[224:239]
    ds_read_b128 a[240:243], v8 offset:34944
    v_cvt_pk_bf16_f32 v122, v122, v123
    v_accvgpr_write_b32 a189, v122
    v_mul_f32 v124, v124, v23
    v_mul_f32 v125, v125, v23
    v_cvt_pk_bf16_f32 v124, v124, v125
    v_mfma_f32_32x32x16_bf16 v[240:255], a[252:255], a[92:95], v[240:255]
    ds_read_b128 a[244:247], v11 offset:34944
    buffer_load_dwordx4 v18, s[4:7], s95 offen offset:3136 nt lds
    v_accvgpr_write_b32 a190, v124
    v_mul_f32 v126, v126, v23
    v_mul_f32 v127, v127, v23
    v_cvt_pk_bf16_f32 v126, v126, v127
    v_accvgpr_write_b32 a191, v126
    s_waitcnt lgkmcnt(4)
    v_mfma_f32_32x32x16_bf16 v[128:143], a[224:227], a[192:195], v[160:175]
    ds_read_b128 a[248:251], v8 offset:35008
    v_exp_f32 v24, v144
    v_exp_f32 v25, v145
    v_mfma_f32_32x32x16_bf16 v[128:143], a[228:231], a[196:199], v[128:143]
    ds_read_b128 a[252:255], v11 offset:35008
    v_cvt_pk_bf16_f32 v184, v24, v25
    v_add_f32 v28, v24, v25
    s_waitcnt lgkmcnt(4)
    v_mfma_f32_32x32x16_bf16 v[128:143], a[232:235], a[200:203], v[128:143]
    ds_read_b64_tr_b16 a[224:225], v5 offset:33792
    ds_read_b64_tr_b16 a[226:227], v5 offset:34304
    v_mfma_f32_32x32x16_bf16 v[128:143], a[236:239], a[204:207], v[128:143]
    ds_read_b64_tr_b16 a[228:229], v5 offset:33856
    ds_read_b64_tr_b16 a[230:231], v5 offset:34368
    v_exp_f32 v26, v146
    v_exp_f32 v27, v147
    s_waitcnt lgkmcnt(6)
    v_mfma_f32_32x32x16_bf16 v[128:143], a[240:243], a[208:211], v[128:143]
    ds_read_b64_tr_b16 a[232:233], v5 offset:33920
    ds_read_b64_tr_b16 a[234:235], v5 offset:34432
    v_cvt_pk_bf16_f32 v185, v26, v27
    v_add_f32 v29, v26, v27
    v_mfma_f32_32x32x16_bf16 v[128:143], a[244:247], a[212:215], v[128:143]
    ds_read_b64_tr_b16 a[236:237], v5 offset:33984
    ds_read_b64_tr_b16 a[238:239], v5 offset:34496
    s_waitcnt lgkmcnt(8)
    v_mfma_f32_32x32x16_bf16 v[128:143], a[248:251], a[216:219], v[128:143]
    ds_read_b64_tr_b16 a[240:241], v5 offset:42240
    ds_read_b64_tr_b16 a[242:243], v5 offset:42752
    v_exp_f32 v24, v148
    v_exp_f32 v25, v149
    v_mfma_f32_32x32x16_bf16 v[128:143], a[252:255], a[220:223], v[128:143]
    ds_read_b64_tr_b16 a[244:245], v5 offset:42304
    ds_read_b64_tr_b16 a[246:247], v5 offset:42816
    v_add_f32 v28, v28, v24
    v_cvt_pk_bf16_f32 v186, v24, v25
    v_add_f32 v29, v29, v25
    s_waitcnt lgkmcnt(8)
    v_mfma_f32_32x32x16_bf16 v[64:79], a[224:227], v[176:179], 0
    ds_read_b64_tr_b16 a[248:249], v5 offset:42368
    ds_read_b64_tr_b16 a[250:251], v5 offset:42880
    s_waitcnt vmcnt(24)
    s_barrier
    s_add_u32 m0, s24, 67584
    s_mov_b32 s93, 303104
    s_mov_b32 s95, 318464
    v_mfma_f32_32x32x16_bf16 v[80:95], a[228:231], v[176:179], 0
    ds_read_b64_tr_b16 a[252:253], v5 offset:42432
    ds_read_b64_tr_b16 a[254:255], v5 offset:42944
    buffer_load_dwordx4 v15, s[8:11], s93 offen nt lds
    v_exp_f32 v26, v150
    v_exp_f32 v27, v151
    s_waitcnt lgkmcnt(8)
    v_mfma_f32_32x32x16_bf16 v[96:111], a[232:235], v[176:179], 0
    ds_read_b64_tr_b16 a[224:225], v3 offset:0
    ds_read_b64_tr_b16 a[226:227], v3 offset:512
    v_add_f32 v28, v28, v26
    v_cvt_pk_bf16_f32 v187, v26, v27
    v_add_f32 v29, v29, v27
    v_mfma_f32_32x32x16_bf16 v[112:127], a[236:239], v[176:179], 0
    ds_read_b64_tr_b16 a[228:229], v3 offset:64
    ds_read_b64_tr_b16 a[230:231], v3 offset:576
    buffer_load_dwordx4 v17, s[4:7], s95 offen offset:1024 nt lds
    s_waitcnt lgkmcnt(8)
    v_mfma_f32_32x32x16_bf16 v[64:79], a[240:243], v[180:183], v[64:79]
    ds_read_b64_tr_b16 a[232:233], v3 offset:128
    ds_read_b64_tr_b16 a[234:235], v3 offset:640
    v_exp_f32 v24, v152
    v_exp_f32 v25, v153
    v_mfma_f32_32x32x16_bf16 v[80:95], a[244:247], v[180:183], v[80:95]
    ds_read_b64_tr_b16 a[236:237], v3 offset:192
    ds_read_b64_tr_b16 a[238:239], v3 offset:704
    buffer_load_dwordx4 v16, s[8:11], s93 offen offset:2112 nt lds
    v_add_f32 v28, v28, v24
    v_cvt_pk_bf16_f32 v188, v24, v25
    v_add_f32 v29, v29, v25
    s_waitcnt lgkmcnt(8)
    v_mfma_f32_32x32x16_bf16 v[96:111], a[248:251], v[180:183], v[96:111]
    ds_read_b64_tr_b16 a[240:241], v3 offset:8448
    ds_read_b64_tr_b16 a[242:243], v3 offset:8960
    v_mfma_f32_32x32x16_bf16 v[112:127], a[252:255], v[180:183], v[112:127]
    ds_read_b64_tr_b16 a[244:245], v3 offset:8512
    ds_read_b64_tr_b16 a[246:247], v3 offset:9024
    buffer_load_dwordx4 v18, s[4:7], s95 offen offset:3136 nt lds
    v_exp_f32 v26, v154
    v_exp_f32 v27, v155
    s_waitcnt lgkmcnt(8)
    v_mfma_f32_32x32x16_bf16 v[192:207], a[224:227], a[96:99], v[192:207]
    ds_read_b64_tr_b16 a[248:249], v3 offset:8576
    ds_read_b64_tr_b16 a[250:251], v3 offset:9088
    v_add_f32 v28, v28, v26
    v_cvt_pk_bf16_f32 v189, v26, v27
    v_add_f32 v29, v29, v27
    v_mfma_f32_32x32x16_bf16 v[208:223], a[228:231], a[96:99], v[208:223]
    ds_read_b64_tr_b16 a[252:253], v3 offset:8640
    ds_read_b64_tr_b16 a[254:255], v3 offset:9152
    s_waitcnt lgkmcnt(8)
    v_mfma_f32_32x32x16_bf16 v[224:239], a[232:235], a[96:99], v[224:239]
    ds_read_b64_tr_b16 a[224:225], v3 offset:1024
    ds_read_b64_tr_b16 a[226:227], v3 offset:1536
    v_exp_f32 v24, v156
    v_exp_f32 v25, v157
    v_mfma_f32_32x32x16_bf16 v[240:255], a[236:239], a[96:99], v[240:255]
    ds_read_b64_tr_b16 a[228:229], v3 offset:1088
    ds_read_b64_tr_b16 a[230:231], v3 offset:1600
    v_add_f32 v28, v28, v24
    v_cvt_pk_bf16_f32 v190, v24, v25
    v_add_f32 v29, v29, v25
    s_waitcnt lgkmcnt(8)
    v_mfma_f32_32x32x16_bf16 v[192:207], a[240:243], a[100:103], v[192:207]
    ds_read_b64_tr_b16 a[232:233], v3 offset:1152
    ds_read_b64_tr_b16 a[234:235], v3 offset:1664
    v_mfma_f32_32x32x16_bf16 v[208:223], a[244:247], a[100:103], v[208:223]
    ds_read_b64_tr_b16 a[236:237], v3 offset:1216
    ds_read_b64_tr_b16 a[238:239], v3 offset:1728
    v_exp_f32 v26, v158
    v_exp_f32 v27, v159
    s_waitcnt lgkmcnt(8)
    v_mfma_f32_32x32x16_bf16 v[224:239], a[248:251], a[100:103], v[224:239]
    ds_read_b64_tr_b16 a[240:241], v3 offset:9472
    ds_read_b64_tr_b16 a[242:243], v3 offset:9984
    v_add_f32 v28, v28, v26
    v_cvt_pk_bf16_f32 v191, v26, v27
    v_add_f32 v29, v29, v27
    v_mfma_f32_32x32x16_bf16 v[240:255], a[252:255], a[100:103], v[240:255]
    ds_read_b64_tr_b16 a[244:245], v3 offset:9536
    ds_read_b64_tr_b16 a[246:247], v3 offset:10048
    v_add_f32 v28, v28, v29
    v_cmp_nge_f32 vcc, s32, v28
    s_cbranch_vccnz L_rs33
L_back33:
    v_add_f32 v22, v22, v28
    s_waitcnt lgkmcnt(8)
    v_mfma_f32_32x32x16_bf16 v[192:207], a[224:227], a[104:107], v[192:207]
    ds_read_b64_tr_b16 a[248:249], v3 offset:9600
    ds_read_b64_tr_b16 a[250:251], v3 offset:10112
    s_waitcnt vmcnt(24)
    s_barrier
    s_add_u32 m0, s24, 84480
    s_mov_b32 s29, 4719360
    s_mov_b32 s30, 4980480
    v_exp_f32 v24, v128
    v_exp_f32 v25, v129
    v_mfma_f32_32x32x16_bf16 v[208:223], a[228:231], a[104:107], v[208:223]
    ds_read_b64_tr_b16 a[252:253], v3 offset:9664
    ds_read_b64_tr_b16 a[254:255], v3 offset:10176
    buffer_load_dwordx4 v13, s[12:15], s29 offen nt lds
    v_cvt_pk_bf16_f32 v176, v24, v25
    v_add_f32 v28, v24, v25
    s_waitcnt lgkmcnt(8)
    v_mfma_f32_32x32x16_bf16 v[224:239], a[232:235], a[104:107], v[224:239]
    ds_read_b128 a[224:227], v9 offset:17920
    v_mfma_f32_32x32x16_bf16 v[240:255], a[236:239], a[104:107], v[240:255]
    ds_read_b128 a[228:231], v12 offset:17920
    buffer_load_dwordx4 v13, s[12:15], s30 offen offset:1024 nt lds
    v_exp_f32 v26, v130
    v_exp_f32 v27, v131
    s_waitcnt lgkmcnt(6)
    v_mfma_f32_32x32x16_bf16 v[192:207], a[240:243], a[108:111], v[192:207]
    ds_read_b128 a[232:235], v9 offset:17984
    v_cvt_pk_bf16_f32 v177, v26, v27
    v_add_f32 v29, v26, v27
    v_mfma_f32_32x32x16_bf16 v[208:223], a[244:247], a[108:111], v[208:223]
    ds_read_b128 a[236:239], v12 offset:17984
    buffer_load_dwordx4 v14, s[12:15], s29 offen offset:2112 nt lds
    s_waitcnt lgkmcnt(4)
    v_mfma_f32_32x32x16_bf16 v[224:239], a[248:251], a[108:111], v[224:239]
    ds_read_b128 a[240:243], v9 offset:18048
    v_exp_f32 v24, v132
    v_exp_f32 v25, v133
    v_mfma_f32_32x32x16_bf16 v[240:255], a[252:255], a[108:111], v[240:255]
    ds_read_b128 a[244:247], v12 offset:18048
    buffer_load_dwordx4 v14, s[12:15], s30 offen offset:3136 nt lds
    v_add_f32 v28, v28, v24
    v_cvt_pk_bf16_f32 v178, v24, v25
    v_add_f32 v29, v29, v25
    s_waitcnt lgkmcnt(4)
    v_mfma_f32_32x32x16_bf16 v[144:159], a[224:227], a[192:195], v[160:175]
    ds_read_b128 a[248:251], v9 offset:18112
    v_mfma_f32_32x32x16_bf16 v[144:159], a[228:231], a[196:199], v[144:159]
    ds_read_b128 a[252:255], v12 offset:18112
    v_exp_f32 v26, v134
    v_exp_f32 v27, v135
    s_waitcnt lgkmcnt(4)
    v_mfma_f32_32x32x16_bf16 v[144:159], a[232:235], a[200:203], v[144:159]
    ds_read_b64_tr_b16 a[224:225], v6 offset:16896
    ds_read_b64_tr_b16 a[226:227], v6 offset:17408
    v_add_f32 v28, v28, v26
    v_cvt_pk_bf16_f32 v179, v26, v27
    v_add_f32 v29, v29, v27
    v_mfma_f32_32x32x16_bf16 v[144:159], a[236:239], a[204:207], v[144:159]
    ds_read_b64_tr_b16 a[228:229], v6 offset:16960
    ds_read_b64_tr_b16 a[230:231], v6 offset:17472
    s_waitcnt lgkmcnt(6)
    v_mfma_f32_32x32x16_bf16 v[144:159], a[240:243], a[208:211], v[144:159]
    ds_read_b64_tr_b16 a[232:233], v6 offset:17024
    ds_read_b64_tr_b16 a[234:235], v6 offset:17536
    v_exp_f32 v24, v136
    v_exp_f32 v25, v137
    v_mfma_f32_32x32x16_bf16 v[144:159], a[244:247], a[212:215], v[144:159]
    ds_read_b64_tr_b16 a[236:237], v6 offset:17088
    ds_read_b64_tr_b16 a[238:239], v6 offset:17600
    v_add_f32 v28, v28, v24
    v_cvt_pk_bf16_f32 v180, v24, v25
    v_add_f32 v29, v29, v25
    s_waitcnt lgkmcnt(8)
    v_mfma_f32_32x32x16_bf16 v[144:159], a[248:251], a[216:219], v[144:159]
    ds_read_b64_tr_b16 a[240:241], v6 offset:25344
    ds_read_b64_tr_b16 a[242:243], v6 offset:25856
    v_mfma_f32_32x32x16_bf16 v[144:159], a[252:255], a[220:223], v[144:159]
    ds_read_b64_tr_b16 a[244:245], v6 offset:25408
    ds_read_b64_tr_b16 a[246:247], v6 offset:25920
    v_exp_f32 v26, v138
    v_exp_f32 v27, v139
    s_waitcnt lgkmcnt(8)
    v_mfma_f32_32x32x16_bf16 v[64:79], a[224:227], v[184:187], v[64:79]
    ds_read_b64_tr_b16 a[248:249], v6 offset:25472
    ds_read_b64_tr_b16 a[250:251], v6 offset:25984
    s_waitcnt vmcnt(24)
    s_barrier
    s_add_u32 m0, s24, 101376
    s_mov_b32 s93, 311296
    s_mov_b32 s95, 326656
    v_add_f32 v28, v28, v26
    v_cvt_pk_bf16_f32 v181, v26, v27
    v_add_f32 v29, v29, v27
    v_mfma_f32_32x32x16_bf16 v[80:95], a[228:231], v[184:187], v[80:95]
    ds_read_b64_tr_b16 a[252:253], v6 offset:25536
    ds_read_b64_tr_b16 a[254:255], v6 offset:26048
    buffer_load_dwordx4 v15, s[8:11], s93 offen nt lds
    s_waitcnt lgkmcnt(8)
    v_mfma_f32_32x32x16_bf16 v[96:111], a[232:235], v[184:187], v[96:111]
    ds_read_b128 a[224:227], v9 offset:34816
    v_exp_f32 v24, v140
    v_exp_f32 v25, v141
    v_mfma_f32_32x32x16_bf16 v[112:127], a[236:239], v[184:187], v[112:127]
    ds_read_b128 a[228:231], v12 offset:34816
    buffer_load_dwordx4 v17, s[4:7], s95 offen offset:1024 nt lds
    v_add_f32 v28, v28, v24
    v_cvt_pk_bf16_f32 v182, v24, v25
    v_add_f32 v29, v29, v25
    s_waitcnt lgkmcnt(6)
    v_mfma_f32_32x32x16_bf16 v[64:79], a[240:243], v[188:191], v[64:79]
    ds_read_b128 a[232:235], v9 offset:34880
    v_mfma_f32_32x32x16_bf16 v[80:95], a[244:247], v[188:191], v[80:95]
    ds_read_b128 a[236:239], v12 offset:34880
    buffer_load_dwordx4 v16, s[8:11], s93 offen offset:2112 nt lds
    v_exp_f32 v26, v142
    v_exp_f32 v27, v143
    s_waitcnt lgkmcnt(4)
    v_mfma_f32_32x32x16_bf16 v[96:111], a[248:251], v[188:191], v[96:111]
    ds_read_b128 a[240:243], v9 offset:34944
    v_add_f32 v28, v28, v26
    v_cvt_pk_bf16_f32 v183, v26, v27
    v_add_f32 v29, v29, v27
    v_mfma_f32_32x32x16_bf16 v[112:127], a[252:255], v[188:191], v[112:127]
    ds_read_b128 a[244:247], v12 offset:34944
    buffer_load_dwordx4 v18, s[4:7], s95 offen offset:3136 nt lds
    v_add_f32 v28, v28, v29
    v_cmp_nge_f32 vcc, s32, v28
    s_cbranch_vccnz L_rs34
L_back34:
    v_add_f32 v22, v22, v28
    s_waitcnt lgkmcnt(4)
    v_mfma_f32_32x32x16_bf16 v[128:143], a[224:227], a[192:195], v[160:175]
    ds_read_b128 a[248:251], v9 offset:35008
    v_exp_f32 v24, v144
    v_exp_f32 v25, v145
    v_mfma_f32_32x32x16_bf16 v[128:143], a[228:231], a[196:199], v[128:143]
    ds_read_b128 a[252:255], v12 offset:35008
    v_cvt_pk_bf16_f32 v184, v24, v25
    v_add_f32 v28, v24, v25
    s_waitcnt lgkmcnt(4)
    v_mfma_f32_32x32x16_bf16 v[128:143], a[232:235], a[200:203], v[128:143]
    ds_read_b64_tr_b16 a[224:225], v6 offset:33792
    ds_read_b64_tr_b16 a[226:227], v6 offset:34304
    v_mfma_f32_32x32x16_bf16 v[128:143], a[236:239], a[204:207], v[128:143]
    ds_read_b64_tr_b16 a[228:229], v6 offset:33856
    ds_read_b64_tr_b16 a[230:231], v6 offset:34368
    v_exp_f32 v26, v146
    v_exp_f32 v27, v147
    s_waitcnt lgkmcnt(6)
    v_mfma_f32_32x32x16_bf16 v[128:143], a[240:243], a[208:211], v[128:143]
    ds_read_b64_tr_b16 a[232:233], v6 offset:33920
    ds_read_b64_tr_b16 a[234:235], v6 offset:34432
    v_cvt_pk_bf16_f32 v185, v26, v27
    v_add_f32 v29, v26, v27
    v_mfma_f32_32x32x16_bf16 v[128:143], a[244:247], a[212:215], v[128:143]
    ds_read_b64_tr_b16 a[236:237], v6 offset:33984
    ds_read_b64_tr_b16 a[238:239], v6 offset:34496
    s_waitcnt lgkmcnt(8)
    v_mfma_f32_32x32x16_bf16 v[128:143], a[248:251], a[216:219], v[128:143]
    ds_read_b64_tr_b16 a[240:241], v6 offset:42240
    ds_read_b64_tr_b16 a[242:243], v6 offset:42752
    v_exp_f32 v24, v148
    v_exp_f32 v25, v149
    v_mfma_f32_32x32x16_bf16 v[128:143], a[252:255], a[220:223], v[128:143]
    ds_read_b64_tr_b16 a[244:245], v6 offset:42304
    ds_read_b64_tr_b16 a[246:247], v6 offset:42816
    v_add_f32 v28, v28, v24
    v_cvt_pk_bf16_f32 v186, v24, v25
    v_add_f32 v29, v29, v25
    s_waitcnt lgkmcnt(8)
    v_mfma_f32_32x32x16_bf16 v[64:79], a[224:227], v[176:179], v[64:79]
    ds_read_b64_tr_b16 a[248:249], v6 offset:42368
    ds_read_b64_tr_b16 a[250:251], v6 offset:42880
    s_waitcnt vmcnt(24)
    s_barrier
    s_add_u32 m0, s24, 118272
    s_mov_b32 s29, 0
    s_mov_b32 s30, 39936
    v_mfma_f32_32x32x16_bf16 v[80:95], a[228:231], v[176:179], v[80:95]
    ds_read_b64_tr_b16 a[252:253], v6 offset:42432
    ds_read_b64_tr_b16 a[254:255], v6 offset:42944
    buffer_load_dwordx4 v19, s[16:19], s29 offen nt lds
    v_exp_f32 v26, v150
    v_exp_f32 v27, v151
    s_waitcnt lgkmcnt(8)
    v_mfma_f32_32x32x16_bf16 v[96:111], a[232:235], v[176:179], v[96:111]
    ds_read_b64_tr_b16 a[224:225], v1 offset:0
    ds_read_b64_tr_b16 a[226:227], v1 offset:512
    v_add_f32 v28, v28, v26
    v_cvt_pk_bf16_f32 v187, v26, v27
    v_add_f32 v29, v29, v27
    v_mfma_f32_32x32x16_bf16 v[112:127], a[236:239], v[176:179], v[112:127]
    ds_read_b64_tr_b16 a[228:229], v1 offset:64
    ds_read_b64_tr_b16 a[230:231], v1 offset:576
    buffer_load_dwordx4 v19, s[16:19], s30 offen offset:1024 nt lds
    s_waitcnt lgkmcnt(8)
    v_mfma_f32_32x32x16_bf16 v[64:79], a[240:243], v[180:183], v[64:79]
    ds_read_b64_tr_b16 a[232:233], v1 offset:128
    ds_read_b64_tr_b16 a[234:235], v1 offset:640
    v_exp_f32 v24, v152
    v_exp_f32 v25, v153
    v_mfma_f32_32x32x16_bf16 v[80:95], a[244:247], v[180:183], v[80:95]
    ds_read_b64_tr_b16 a[236:237], v1 offset:192
    ds_read_b64_tr_b16 a[238:239], v1 offset:704
    buffer_load_dwordx4 v20, s[16:19], s29 offen offset:2112 nt lds
    v_add_f32 v28, v28, v24
    v_cvt_pk_bf16_f32 v188, v24, v25
    v_add_f32 v29, v29, v25
    s_waitcnt lgkmcnt(8)
    v_mfma_f32_32x32x16_bf16 v[96:111], a[248:251], v[180:183], v[96:111]
    ds_read_b64_tr_b16 a[240:241], v1 offset:8448
    ds_read_b64_tr_b16 a[242:243], v1 offset:8960
    v_mfma_f32_32x32x16_bf16 v[112:127], a[252:255], v[180:183], v[112:127]
    ds_read_b64_tr_b16 a[244:245], v1 offset:8512
    ds_read_b64_tr_b16 a[246:247], v1 offset:9024
    buffer_load_dwordx4 v20, s[16:19], s30 offen offset:3136 nt lds
    v_exp_f32 v26, v154
    v_exp_f32 v27, v155
    s_waitcnt lgkmcnt(8)
    v_mfma_f32_32x32x16_bf16 v[192:207], a[224:227], a[112:115], v[192:207]
    ds_read_b64_tr_b16 a[248:249], v1 offset:8576
    ds_read_b64_tr_b16 a[250:251], v1 offset:9088
    v_add_f32 v28, v28, v26
    v_cvt_pk_bf16_f32 v189, v26, v27
    v_add_f32 v29, v29, v27
    v_mfma_f32_32x32x16_bf16 v[208:223], a[228:231], a[112:115], v[208:223]
    ds_read_b64_tr_b16 a[252:253], v1 offset:8640
    ds_read_b64_tr_b16 a[254:255], v1 offset:9152
    s_waitcnt lgkmcnt(8)
    v_mfma_f32_32x32x16_bf16 v[224:239], a[232:235], a[112:115], v[224:239]
    ds_read_b64_tr_b16 a[224:225], v1 offset:1024
    ds_read_b64_tr_b16 a[226:227], v1 offset:1536
    v_exp_f32 v24, v156
    v_exp_f32 v25, v157
    v_mfma_f32_32x32x16_bf16 v[240:255], a[236:239], a[112:115], v[240:255]
    ds_read_b64_tr_b16 a[228:229], v1 offset:1088
    ds_read_b64_tr_b16 a[230:231], v1 offset:1600
    v_add_f32 v28, v28, v24
    v_cvt_pk_bf16_f32 v190, v24, v25
    v_add_f32 v29, v29, v25
    s_waitcnt lgkmcnt(8)
    v_mfma_f32_32x32x16_bf16 v[192:207], a[240:243], a[116:119], v[192:207]
    ds_read_b64_tr_b16 a[232:233], v1 offset:1152
    ds_read_b64_tr_b16 a[234:235], v1 offset:1664
    v_mfma_f32_32x32x16_bf16 v[208:223], a[244:247], a[116:119], v[208:223]
    ds_read_b64_tr_b16 a[236:237], v1 offset:1216
    ds_read_b64_tr_b16 a[238:239], v1 offset:1728
    v_exp_f32 v26, v158
    v_exp_f32 v27, v159
    s_waitcnt lgkmcnt(8)
    v_mfma_f32_32x32x16_bf16 v[224:239], a[248:251], a[116:119], v[224:239]
    ds_read_b64_tr_b16 a[240:241], v1 offset:9472
    ds_read_b64_tr_b16 a[242:243], v1 offset:9984
    v_add_f32 v28, v28, v26
    v_cvt_pk_bf16_f32 v191, v26, v27
    v_add_f32 v29, v29, v27
    v_mfma_f32_32x32x16_bf16 v[240:255], a[252:255], a[116:119], v[240:255]
    ds_read_b64_tr_b16 a[244:245], v1 offset:9536
    ds_read_b64_tr_b16 a[246:247], v1 offset:10048
    v_add_f32 v28, v28, v29
    v_cmp_nge_f32 vcc, s32, v28
    s_cbranch_vccnz L_rs35
L_back35:
    v_add_f32 v22, v22, v28
    s_waitcnt lgkmcnt(8)
    v_mfma_f32_32x32x16_bf16 v[192:207], a[224:227], a[120:123], v[192:207]
    ds_read_b64_tr_b16 a[248:249], v1 offset:9600
    ds_read_b64_tr_b16 a[250:251], v1 offset:10112
    s_waitcnt vmcnt(24)
    s_barrier
    s_add_u32 m0, s24, 135168
    s_mov_b32 s93, 319488
    s_mov_b32 s95, 334848
    v_exp_f32 v24, v128
    v_exp_f32 v25, v129
    v_mfma_f32_32x32x16_bf16 v[208:223], a[228:231], a[120:123], v[208:223]
    ds_read_b64_tr_b16 a[252:253], v1 offset:9664
    ds_read_b64_tr_b16 a[254:255], v1 offset:10176
    buffer_load_dwordx4 v15, s[8:11], s93 offen nt lds
    s_waitcnt lgkmcnt(8)
    v_mfma_f32_32x32x16_bf16 v[224:239], a[232:235], a[120:123], v[224:239]
    ds_read_b128 a[224:227], v7 offset:17920
    v_cvt_pk_bf16_f32 v176, v24, v25
    v_add_f32 v28, v24, v25
    v_mfma_f32_32x32x16_bf16 v[240:255], a[236:239], a[120:123], v[240:255]
    ds_read_b128 a[228:231], v10 offset:17920
    buffer_load_dwordx4 v17, s[4:7], s95 offen offset:1024 nt lds
    s_waitcnt lgkmcnt(6)
    v_mfma_f32_32x32x16_bf16 v[192:207], a[240:243], a[124:127], v[192:207]
    ds_read_b128 a[232:235], v7 offset:17984
    v_exp_f32 v26, v130
    v_exp_f32 v27, v131
    v_mfma_f32_32x32x16_bf16 v[208:223], a[244:247], a[124:127], v[208:223]
    ds_read_b128 a[236:239], v10 offset:17984
    buffer_load_dwordx4 v16, s[8:11], s93 offen offset:2112 nt lds
    s_waitcnt lgkmcnt(4)
    v_mfma_f32_32x32x16_bf16 v[224:239], a[248:251], a[124:127], v[224:239]
    ds_read_b128 a[240:243], v7 offset:18048
    v_cvt_pk_bf16_f32 v177, v26, v27
    v_add_f32 v29, v26, v27
    v_mfma_f32_32x32x16_bf16 v[240:255], a[252:255], a[124:127], v[240:255]
    ds_read_b128 a[244:247], v10 offset:18048
    buffer_load_dwordx4 v18, s[4:7], s95 offen offset:3136 nt lds
    s_waitcnt lgkmcnt(4)
    v_mfma_f32_32x32x16_bf16 v[144:159], a[224:227], a[192:195], v[160:175]
    ds_read_b128 a[248:251], v7 offset:18112
    v_exp_f32 v24, v132
    v_exp_f32 v25, v133
    v_mfma_f32_32x32x16_bf16 v[144:159], a[228:231], a[196:199], v[144:159]
    ds_read_b128 a[252:255], v10 offset:18112
    s_waitcnt lgkmcnt(4)
    v_mfma_f32_32x32x16_bf16 v[144:159], a[232:235], a[200:203], v[144:159]
    ds_read_b64_tr_b16 a[224:225], v4 offset:16896
    ds_read_b64_tr_b16 a[226:227], v4 offset:17408
    v_add_f32 v28, v28, v24
    v_cvt_pk_bf16_f32 v178, v24, v25
    v_add_f32 v29, v29, v25
    v_mfma_f32_32x32x16_bf16 v[144:159], a[236:239], a[204:207], v[144:159]
    ds_read_b64_tr_b16 a[228:229], v4 offset:16960
    ds_read_b64_tr_b16 a[230:231], v4 offset:17472
    s_waitcnt lgkmcnt(6)
    v_mfma_f32_32x32x16_bf16 v[144:159], a[240:243], a[208:211], v[144:159]
    ds_read_b64_tr_b16 a[232:233], v4 offset:17024
    ds_read_b64_tr_b16 a[234:235], v4 offset:17536
    v_exp_f32 v26, v134
    v_exp_f32 v27, v135
    v_mfma_f32_32x32x16_bf16 v[144:159], a[244:247], a[212:215], v[144:159]
    ds_read_b64_tr_b16 a[236:237], v4 offset:17088
    ds_read_b64_tr_b16 a[238:239], v4 offset:17600
    s_waitcnt lgkmcnt(8)
    v_mfma_f32_32x32x16_bf16 v[144:159], a[248:251], a[216:219], v[144:159]
    ds_read_b64_tr_b16 a[240:241], v4 offset:25344
    ds_read_b64_tr_b16 a[242:243], v4 offset:25856
    v_add_f32 v28, v28, v26
    v_cvt_pk_bf16_f32 v179, v26, v27
    v_add_f32 v29, v29, v27
    v_mfma_f32_32x32x16_bf16 v[144:159], a[252:255], a[220:223], v[144:159]
    ds_read_b64_tr_b16 a[244:245], v4 offset:25408
    ds_read_b64_tr_b16 a[246:247], v4 offset:25920
    s_waitcnt lgkmcnt(8)
    v_mfma_f32_32x32x16_bf16 v[64:79], a[224:227], v[184:187], v[64:79]
    ds_read_b64_tr_b16 a[248:249], v4 offset:25472
    ds_read_b64_tr_b16 a[250:251], v4 offset:25984
    s_waitcnt vmcnt(24)
    s_barrier
    s_add_u32 m0, s24, 0
    s_mov_b32 s29, 81920
    s_mov_b32 s30, 121856
    v_exp_f32 v24, v136
    v_exp_f32 v25, v137
    v_mfma_f32_32x32x16_bf16 v[80:95], a[228:231], v[184:187], v[80:95]
    ds_read_b64_tr_b16 a[252:253], v4 offset:25536
    ds_read_b64_tr_b16 a[254:255], v4 offset:26048
    buffer_load_dwordx4 v19, s[16:19], s29 offen nt lds
    s_waitcnt lgkmcnt(8)
    v_mfma_f32_32x32x16_bf16 v[96:111], a[232:235], v[184:187], v[96:111]
    ds_read_b64_tr_b16 a[224:225], v1 offset:33792
    ds_read_b64_tr_b16 a[226:227], v1 offset:34304
    v_add_f32 v28, v28, v24
    v_cvt_pk_bf16_f32 v180, v24, v25
    v_add_f32 v29, v29, v25
    v_mfma_f32_32x32x16_bf16 v[112:127], a[236:239], v[184:187], v[112:127]
    ds_read_b64_tr_b16 a[228:229], v1 offset:33856
    ds_read_b64_tr_b16 a[230:231], v1 offset:34368
    buffer_load_dwordx4 v19, s[16:19], s30 offen offset:1024 nt lds
    s_waitcnt lgkmcnt(8)
    v_mfma_f32_32x32x16_bf16 v[64:79], a[240:243], v[188:191], v[64:79]
    ds_read_b64_tr_b16 a[232:233], v1 offset:33920
    ds_read_b64_tr_b16 a[234:235], v1 offset:34432
    v_exp_f32 v26, v138
    v_exp_f32 v27, v139
    v_mfma_f32_32x32x16_bf16 v[80:95], a[244:247], v[188:191], v[80:95]
    ds_read_b64_tr_b16 a[236:237], v1 offset:33984
    ds_read_b64_tr_b16 a[238:239], v1 offset:34496
    buffer_load_dwordx4 v20, s[16:19], s29 offen offset:2112 nt lds
    s_waitcnt lgkmcnt(8)
    v_mfma_f32_32x32x16_bf16 v[96:111], a[248:251], v[188:191], v[96:111]
    ds_read_b64_tr_b16 a[240:241], v1 offset:42240
    ds_read_b64_tr_b16 a[242:243], v1 offset:42752
    v_add_f32 v28, v28, v26
    v_cvt_pk_bf16_f32 v181, v26, v27
    v_add_f32 v29, v29, v27
    v_mfma_f32_32x32x16_bf16 v[112:127], a[252:255], v[188:191], v[112:127]
    ds_read_b64_tr_b16 a[244:245], v1 offset:42304
    ds_read_b64_tr_b16 a[246:247], v1 offset:42816
    buffer_load_dwordx4 v20, s[16:19], s30 offen offset:3136 nt lds
    s_waitcnt lgkmcnt(8)
    v_mfma_f32_32x32x16_bf16 v[192:207], a[224:227], a[128:131], v[192:207]
    ds_read_b64_tr_b16 a[248:249], v1 offset:42368
    ds_read_b64_tr_b16 a[250:251], v1 offset:42880
    v_exp_f32 v24, v140
    v_exp_f32 v25, v141
    v_mfma_f32_32x32x16_bf16 v[208:223], a[228:231], a[128:131], v[208:223]
    ds_read_b64_tr_b16 a[252:253], v1 offset:42432
    ds_read_b64_tr_b16 a[254:255], v1 offset:42944
    s_waitcnt lgkmcnt(8)
    v_mfma_f32_32x32x16_bf16 v[224:239], a[232:235], a[128:131], v[224:239]
    ds_read_b64_tr_b16 a[224:225], v1 offset:34816
    ds_read_b64_tr_b16 a[226:227], v1 offset:35328
    v_add_f32 v28, v28, v24
    v_cvt_pk_bf16_f32 v182, v24, v25
    v_add_f32 v29, v29, v25
    v_mfma_f32_32x32x16_bf16 v[240:255], a[236:239], a[128:131], v[240:255]
    ds_read_b64_tr_b16 a[228:229], v1 offset:34880
    ds_read_b64_tr_b16 a[230:231], v1 offset:35392
    s_waitcnt lgkmcnt(8)
    v_mfma_f32_32x32x16_bf16 v[192:207], a[240:243], a[132:135], v[192:207]
    ds_read_b64_tr_b16 a[232:233], v1 offset:34944
    ds_read_b64_tr_b16 a[234:235], v1 offset:35456
    v_exp_f32 v26, v142
    v_exp_f32 v27, v143
    v_mfma_f32_32x32x16_bf16 v[208:223], a[244:247], a[132:135], v[208:223]
    ds_read_b64_tr_b16 a[236:237], v1 offset:35008
    ds_read_b64_tr_b16 a[238:239], v1 offset:35520
    s_waitcnt lgkmcnt(8)
    v_mfma_f32_32x32x16_bf16 v[224:239], a[248:251], a[132:135], v[224:239]
    ds_read_b64_tr_b16 a[240:241], v1 offset:43264
    ds_read_b64_tr_b16 a[242:243], v1 offset:43776
    v_add_f32 v28, v28, v26
    v_cvt_pk_bf16_f32 v183, v26, v27
    v_add_f32 v29, v29, v27
    v_mfma_f32_32x32x16_bf16 v[240:255], a[252:255], a[132:135], v[240:255]
    ds_read_b64_tr_b16 a[244:245], v1 offset:43328
    ds_read_b64_tr_b16 a[246:247], v1 offset:43840
    v_add_f32 v28, v28, v29
    v_cmp_nge_f32 vcc, s32, v28
    s_cbranch_vccnz L_rs36
L_back36:
    v_add_f32 v22, v22, v28
    s_waitcnt lgkmcnt(8)
    v_mfma_f32_32x32x16_bf16 v[192:207], a[224:227], a[136:139], v[192:207]
    ds_read_b64_tr_b16 a[248:249], v1 offset:43392
    ds_read_b64_tr_b16 a[250:251], v1 offset:43904
    s_waitcnt vmcnt(24)
    s_barrier
    s_add_u32 m0, s24, 16896
    s_mov_b32 s93, 327680
    s_mov_b32 s95, 343040
    v_exp_f32 v24, v144
    v_exp_f32 v25, v145
    v_mfma_f32_32x32x16_bf16 v[208:223], a[228:231], a[136:139], v[208:223]
    ds_read_b64_tr_b16 a[252:253], v1 offset:43456
    ds_read_b64_tr_b16 a[254:255], v1 offset:43968
    buffer_load_dwordx4 v15, s[8:11], s93 offen nt lds
    v_cvt_pk_bf16_f32 v184, v24, v25
    v_add_f32 v28, v24, v25
    s_waitcnt lgkmcnt(8)
    v_mfma_f32_32x32x16_bf16 v[224:239], a[232:235], a[136:139], v[224:239]
    ds_read_b128 a[224:227], v8 offset:1024
    v_mfma_f32_32x32x16_bf16 v[240:255], a[236:239], a[136:139], v[240:255]
    ds_read_b128 a[228:231], v11 offset:1024
    buffer_load_dwordx4 v17, s[4:7], s95 offen offset:1024 nt lds
    v_exp_f32 v26, v146
    v_exp_f32 v27, v147
    s_waitcnt lgkmcnt(6)
    v_mfma_f32_32x32x16_bf16 v[192:207], a[240:243], a[140:143], v[192:207]
    ds_read_b128 a[232:235], v8 offset:1088
    v_cvt_pk_bf16_f32 v185, v26, v27
    v_add_f32 v29, v26, v27
    v_mfma_f32_32x32x16_bf16 v[208:223], a[244:247], a[140:143], v[208:223]
    ds_read_b128 a[236:239], v11 offset:1088
    buffer_load_dwordx4 v16, s[8:11], s93 offen offset:2112 nt lds
    s_waitcnt lgkmcnt(4)
    v_mfma_f32_32x32x16_bf16 v[224:239], a[248:251], a[140:143], v[224:239]
    ds_read_b128 a[240:243], v8 offset:1152
    v_exp_f32 v24, v148
    v_exp_f32 v25, v149
    v_mfma_f32_32x32x16_bf16 v[240:255], a[252:255], a[140:143], v[240:255]
    ds_read_b128 a[244:247], v11 offset:1152
    buffer_load_dwordx4 v18, s[4:7], s95 offen offset:3136 nt lds
    v_add_f32 v28, v28, v24
    v_cvt_pk_bf16_f32 v186, v24, v25
    v_add_f32 v29, v29, v25
    s_waitcnt lgkmcnt(4)
    v_mfma_f32_32x32x16_bf16 v[128:143], a[224:227], a[192:195], v[160:175]
    ds_read_b128 a[248:251], v8 offset:1216
    v_mfma_f32_32x32x16_bf16 v[128:143], a[228:231], a[196:199], v[128:143]
    ds_read_b128 a[252:255], v11 offset:1216
    v_exp_f32 v26, v150
    v_exp_f32 v27, v151
    s_waitcnt lgkmcnt(4)
    v_mfma_f32_32x32x16_bf16 v[128:143], a[232:235], a[200:203], v[128:143]
    ds_read_b64_tr_b16 a[224:225], v5 offset:0
    ds_read_b64_tr_b16 a[226:227], v5 offset:512
    v_add_f32 v28, v28, v26
    v_cvt_pk_bf16_f32 v187, v26, v27
    v_add_f32 v29, v29, v27
    v_mfma_f32_32x32x16_bf16 v[128:143], a[236:239], a[204:207], v[128:143]
    ds_read_b64_tr_b16 a[228:229], v5 offset:64
    ds_read_b64_tr_b16 a[230:231], v5 offset:576
    s_waitcnt lgkmcnt(6)
    v_mfma_f32_32x32x16_bf16 v[128:143], a[240:243], a[208:211], v[128:143]
    ds_read_b64_tr_b16 a[232:233], v5 offset:128
    ds_read_b64_tr_b16 a[234:235], v5 offset:640
    v_exp_f32 v24, v152
    v_exp_f32 v25, v153
    v_mfma_f32_32x32x16_bf16 v[128:143], a[244:247], a[212:215], v[128:143]
    ds_read_b64_tr_b16 a[236:237], v5 offset:192
    ds_read_b64_tr_b16 a[238:239], v5 offset:704
    v_add_f32 v28, v28, v24
    v_cvt_pk_bf16_f32 v188, v24, v25
    v_add_f32 v29, v29, v25
    s_waitcnt lgkmcnt(8)
    v_mfma_f32_32x32x16_bf16 v[128:143], a[248:251], a[216:219], v[128:143]
    ds_read_b64_tr_b16 a[240:241], v5 offset:8448
    ds_read_b64_tr_b16 a[242:243], v5 offset:8960
    v_mfma_f32_32x32x16_bf16 v[128:143], a[252:255], a[220:223], v[128:143]
    ds_read_b64_tr_b16 a[244:245], v5 offset:8512
    ds_read_b64_tr_b16 a[246:247], v5 offset:9024
    v_exp_f32 v26, v154
    v_exp_f32 v27, v155
    s_waitcnt lgkmcnt(8)
    v_mfma_f32_32x32x16_bf16 v[64:79], a[224:227], v[176:179], v[64:79]
    ds_read_b64_tr_b16 a[248:249], v5 offset:8576
    ds_read_b64_tr_b16 a[250:251], v5 offset:9088
    s_waitcnt vmcnt(24)
    s_barrier
    s_add_u32 m0, s24, 33792
    s_mov_b32 s93, 335872
    s_mov_b32 s95, 351232
    v_add_f32 v28, v28, v26
    v_cvt_pk_bf16_f32 v189, v26, v27
    v_add_f32 v29, v29, v27
    v_mfma_f32_32x32x16_bf16 v[80:95], a[228:231], v[176:179], v[80:95]
    ds_read_b64_tr_b16 a[252:253], v5 offset:8640
    ds_read_b64_tr_b16 a[254:255], v5 offset:9152
    buffer_load_dwordx4 v15, s[8:11], s93 offen nt lds
    s_waitcnt lgkmcnt(8)
    v_mfma_f32_32x32x16_bf16 v[96:111], a[232:235], v[176:179], v[96:111]
    ds_read_b128 a[224:227], v8 offset:17920
    v_exp_f32 v24, v156
    v_exp_f32 v25, v157
    v_mfma_f32_32x32x16_bf16 v[112:127], a[236:239], v[176:179], v[112:127]
    ds_read_b128 a[228:231], v11 offset:17920
    buffer_load_dwordx4 v17, s[4:7], s95 offen offset:1024 nt lds
    v_add_f32 v28, v28, v24
    v_cvt_pk_bf16_f32 v190, v24, v25
    v_add_f32 v29, v29, v25
    s_waitcnt lgkmcnt(6)
    v_mfma_f32_32x32x16_bf16 v[64:79], a[240:243], v[180:183], v[64:79]
    ds_read_b128 a[232:235], v8 offset:17984
    v_mfma_f32_32x32x16_bf16 v[80:95], a[244:247], v[180:183], v[80:95]
    ds_read_b128 a[236:239], v11 offset:17984
    buffer_load_dwordx4 v16, s[8:11], s93 offen offset:2112 nt lds
    v_exp_f32 v26, v158
    v_exp_f32 v27, v159
    s_waitcnt lgkmcnt(4)
    v_mfma_f32_32x32x16_bf16 v[96:111], a[248:251], v[180:183], v[96:111]
    ds_read_b128 a[240:243], v8 offset:18048
    v_add_f32 v28, v28, v26
    v_cvt_pk_bf16_f32 v191, v26, v27
    v_add_f32 v29, v29, v27
    v_mfma_f32_32x32x16_bf16 v[112:127], a[252:255], v[180:183], v[112:127]
    ds_read_b128 a[244:247], v11 offset:18048
    buffer_load_dwordx4 v18, s[4:7], s95 offen offset:3136 nt lds
    v_add_f32 v28, v28, v29
    v_cmp_nge_f32 vcc, s32, v28
    s_cbranch_vccnz L_rs37
L_back37:
    v_add_f32 v22, v22, v28
    s_waitcnt lgkmcnt(4)
    v_mfma_f32_32x32x16_bf16 v[144:159], a[224:227], a[192:195], v[160:175]
    ds_read_b128 a[248:251], v8 offset:18112
    v_exp_f32 v24, v128
    v_exp_f32 v25, v129
    v_mfma_f32_32x32x16_bf16 v[144:159], a[228:231], a[196:199], v[144:159]
    ds_read_b128 a[252:255], v11 offset:18112
    v_cvt_pk_bf16_f32 v176, v24, v25
    v_add_f32 v28, v24, v25
    s_waitcnt lgkmcnt(4)
    v_mfma_f32_32x32x16_bf16 v[144:159], a[232:235], a[200:203], v[144:159]
    ds_read_b64_tr_b16 a[224:225], v5 offset:16896
    ds_read_b64_tr_b16 a[226:227], v5 offset:17408
    v_mfma_f32_32x32x16_bf16 v[144:159], a[236:239], a[204:207], v[144:159]
    ds_read_b64_tr_b16 a[228:229], v5 offset:16960
    ds_read_b64_tr_b16 a[230:231], v5 offset:17472
    v_exp_f32 v26, v130
    v_exp_f32 v27, v131
    s_waitcnt lgkmcnt(6)
    v_mfma_f32_32x32x16_bf16 v[144:159], a[240:243], a[208:211], v[144:159]
    ds_read_b64_tr_b16 a[232:233], v5 offset:17024
    ds_read_b64_tr_b16 a[234:235], v5 offset:17536
    v_cvt_pk_bf16_f32 v177, v26, v27
    v_add_f32 v29, v26, v27
    v_mfma_f32_32x32x16_bf16 v[144:159], a[244:247], a[212:215], v[144:159]
    ds_read_b64_tr_b16 a[236:237], v5 offset:17088
    ds_read_b64_tr_b16 a[238:239], v5 offset:17600
    s_waitcnt lgkmcnt(8)
    v_mfma_f32_32x32x16_bf16 v[144:159], a[248:251], a[216:219], v[144:159]
    ds_read_b64_tr_b16 a[240:241], v5 offset:25344
    ds_read_b64_tr_b16 a[242:243], v5 offset:25856
    v_exp_f32 v24, v132
    v_exp_f32 v25, v133
    v_mfma_f32_32x32x16_bf16 v[144:159], a[252:255], a[220:223], v[144:159]
    ds_read_b64_tr_b16 a[244:245], v5 offset:25408
    ds_read_b64_tr_b16 a[246:247], v5 offset:25920
    v_add_f32 v28, v28, v24
    v_cvt_pk_bf16_f32 v178, v24, v25
    v_add_f32 v29, v29, v25
    s_waitcnt lgkmcnt(8)
    v_mfma_f32_32x32x16_bf16 v[64:79], a[224:227], v[184:187], v[64:79]
    ds_read_b64_tr_b16 a[248:249], v5 offset:25472
    ds_read_b64_tr_b16 a[250:251], v5 offset:25984
    s_waitcnt vmcnt(24)
    s_barrier
    s_add_u32 m0, s24, 50688
    s_mov_b32 s29, 163840
    s_mov_b32 s30, 203776
    v_mfma_f32_32x32x16_bf16 v[80:95], a[228:231], v[184:187], v[80:95]
    ds_read_b64_tr_b16 a[252:253], v5 offset:25536
    ds_read_b64_tr_b16 a[254:255], v5 offset:26048
    buffer_load_dwordx4 v19, s[16:19], s29 offen nt lds
    v_exp_f32 v26, v134
    v_exp_f32 v27, v135
    s_waitcnt lgkmcnt(8)
    v_mfma_f32_32x32x16_bf16 v[96:111], a[232:235], v[184:187], v[96:111]
    ds_read_b64_tr_b16 a[224:225], v2 offset:33792
    ds_read_b64_tr_b16 a[226:227], v2 offset:34304
    v_add_f32 v28, v28, v26
    v_cvt_pk_bf16_f32 v179, v26, v27
    v_add_f32 v29, v29, v27
    v_mfma_f32_32x32x16_bf16 v[112:127], a[236:239], v[184:187], v[112:127]
    ds_read_b64_tr_b16 a[228:229], v2 offset:42240
    ds_read_b64_tr_b16 a[230:231], v2 offset:42752
    buffer_load_dwordx4 v19, s[16:19], s30 offen offset:1024 nt lds
    s_waitcnt lgkmcnt(8)
    v_mfma_f32_32x32x16_bf16 v[64:79], a[240:243], v[188:191], v[64:79]
    ds_read_b64_tr_b16 a[232:233], v2 offset:34816
    ds_read_b64_tr_b16 a[234:235], v2 offset:35328
    v_exp_f32 v24, v136
    v_exp_f32 v25, v137
    v_mfma_f32_32x32x16_bf16 v[80:95], a[244:247], v[188:191], v[80:95]
    ds_read_b64_tr_b16 a[236:237], v2 offset:43264
    ds_read_b64_tr_b16 a[238:239], v2 offset:43776
    buffer_load_dwordx4 v20, s[16:19], s29 offen offset:2112 nt lds
    v_add_f32 v28, v28, v24
    v_cvt_pk_bf16_f32 v180, v24, v25
    v_add_f32 v29, v29, v25
    s_waitcnt lgkmcnt(8)
    v_mfma_f32_32x32x16_bf16 v[96:111], a[248:251], v[188:191], v[96:111]
    ds_read_b64_tr_b16 a[240:241], v2 offset:33856
    ds_read_b64_tr_b16 a[242:243], v2 offset:34368
    v_mfma_f32_32x32x16_bf16 v[112:127], a[252:255], v[188:191], v[112:127]
    ds_read_b64_tr_b16 a[244:245], v2 offset:42304
    ds_read_b64_tr_b16 a[246:247], v2 offset:42816
    buffer_load_dwordx4 v20, s[16:19], s30 offen offset:3136 nt lds
    v_exp_f32 v26, v138
    v_exp_f32 v27, v139
    s_waitcnt lgkmcnt(8)
    v_mfma_f32_32x32x16_bf16 v[192:207], a[224:227], a[144:147], v[192:207]
    ds_read_b64_tr_b16 a[248:249], v2 offset:34880
    ds_read_b64_tr_b16 a[250:251], v2 offset:35392
    v_add_f32 v28, v28, v26
    v_cvt_pk_bf16_f32 v181, v26, v27
    v_add_f32 v29, v29, v27
    v_mfma_f32_32x32x16_bf16 v[192:207], a[228:231], a[148:151], v[192:207]
    ds_read_b64_tr_b16 a[252:253], v2 offset:43328
    ds_read_b64_tr_b16 a[254:255], v2 offset:43840
    s_waitcnt lgkmcnt(8)
    v_mfma_f32_32x32x16_bf16 v[192:207], a[232:235], a[152:155], v[192:207]
    ds_read_b64_tr_b16 a[224:225], v2 offset:33920
    ds_read_b64_tr_b16 a[226:227], v2 offset:34432
    v_exp_f32 v24, v140
    v_exp_f32 v25, v141
    v_mfma_f32_32x32x16_bf16 v[192:207], a[236:239], a[156:159], v[192:207]
    ds_read_b64_tr_b16 a[228:229], v2 offset:42368
    ds_read_b64_tr_b16 a[230:231], v2 offset:42880
    v_add_f32 v28, v28, v24
    v_cvt_pk_bf16_f32 v182, v24, v25
    v_add_f32 v29, v29, v25
    s_waitcnt lgkmcnt(8)
    v_mfma_f32_32x32x16_bf16 v[208:223], a[240:243], a[144:147], v[208:223]
    ds_read_b64_tr_b16 a[232:233], v2 offset:34944
    ds_read_b64_tr_b16 a[234:235], v2 offset:35456
    v_mfma_f32_32x32x16_bf16 v[208:223], a[244:247], a[148:151], v[208:223]
    ds_read_b64_tr_b16 a[236:237], v2 offset:43392
    ds_read_b64_tr_b16 a[238:239], v2 offset:43904
    v_exp_f32 v26, v142
    v_exp_f32 v27, v143
    s_waitcnt lgkmcnt(8)
    v_mfma_f32_32x32x16_bf16 v[208:223], a[248:251], a[152:155], v[208:223]
    ds_read_b64_tr_b16 a[240:241], v2 offset:33984
    ds_read_b64_tr_b16 a[242:243], v2 offset:34496
    v_add_f32 v28, v28, v26
    v_cvt_pk_bf16_f32 v183, v26, v27
    v_add_f32 v29, v29, v27
    v_mfma_f32_32x32x16_bf16 v[208:223], a[252:255], a[156:159], v[208:223]
    ds_read_b64_tr_b16 a[244:245], v2 offset:42432
    ds_read_b64_tr_b16 a[246:247], v2 offset:42944
    v_add_f32 v28, v28, v29
    v_cmp_nge_f32 vcc, s32, v28
    s_cbranch_vccnz L_rs38
L_back38:
    v_add_f32 v22, v22, v28
    s_waitcnt lgkmcnt(8)
    v_mfma_f32_32x32x16_bf16 v[224:239], a[224:227], a[144:147], v[224:239]
    ds_read_b64_tr_b16 a[248:249], v2 offset:35008
    ds_read_b64_tr_b16 a[250:251], v2 offset:35520
    s_waitcnt vmcnt(24)
    s_barrier
    s_add_u32 m0, s24, 67584
    s_mov_b32 s93, 344064
    s_mov_b32 s95, 359424
    v_exp_f32 v24, v144
    v_exp_f32 v25, v145
    v_mfma_f32_32x32x16_bf16 v[224:239], a[228:231], a[148:151], v[224:239]
    ds_read_b64_tr_b16 a[252:253], v2 offset:43456
    ds_read_b64_tr_b16 a[254:255], v2 offset:43968
    buffer_load_dwordx4 v15, s[8:11], s93 offen nt lds
    s_waitcnt lgkmcnt(8)
    v_mfma_f32_32x32x16_bf16 v[224:239], a[232:235], a[152:155], v[224:239]
    ds_read_b128 a[224:227], v9 offset:1024
    v_cvt_pk_bf16_f32 v184, v24, v25
    v_add_f32 v28, v24, v25
    v_mfma_f32_32x32x16_bf16 v[224:239], a[236:239], a[156:159], v[224:239]
    ds_read_b128 a[228:231], v12 offset:1024
    buffer_load_dwordx4 v17, s[4:7], s95 offen offset:1024 nt lds
    s_waitcnt lgkmcnt(6)
    v_mfma_f32_32x32x16_bf16 v[240:255], a[240:243], a[144:147], v[240:255]
    ds_read_b128 a[232:235], v9 offset:1088
    v_exp_f32 v26, v146
    v_exp_f32 v27, v147
    v_mfma_f32_32x32x16_bf16 v[240:255], a[244:247], a[148:151], v[240:255]
    ds_read_b128 a[236:239], v12 offset:1088
    buffer_load_dwordx4 v16, s[8:11], s93 offen offset:2112 nt lds
    s_waitcnt lgkmcnt(4)
    v_mfma_f32_32x32x16_bf16 v[240:255], a[248:251], a[152:155], v[240:255]
    ds_read_b128 a[240:243], v9 offset:1152
    v_cvt_pk_bf16_f32 v185, v26, v27
    v_add_f32 v29, v26, v27
    v_mfma_f32_32x32x16_bf16 v[240:255], a[252:255], a[156:159], v[240:255]
    ds_read_b128 a[244:247], v12 offset:1152
    buffer_load_dwordx4 v18, s[4:7], s95 offen offset:3136 nt lds
    s_waitcnt lgkmcnt(4)
    v_mfma_f32_32x32x16_bf16 v[128:143], a[224:227], a[192:195], v[160:175]
    ds_read_b128 a[248:251], v9 offset:1216
    v_exp_f32 v24, v148
    v_exp_f32 v25, v149
    v_mfma_f32_32x32x16_bf16 v[128:143], a[228:231], a[196:199], v[128:143]
    ds_read_b128 a[252:255], v12 offset:1216
    s_waitcnt lgkmcnt(4)
    v_mfma_f32_32x32x16_bf16 v[128:143], a[232:235], a[200:203], v[128:143]
    ds_read_b64_tr_b16 a[224:225], v6 offset:0
    ds_read_b64_tr_b16 a[226:227], v6 offset:512
    v_add_f32 v28, v28, v24
    v_cvt_pk_bf16_f32 v186, v24, v25
    v_add_f32 v29, v29, v25
    v_mfma_f32_32x32x16_bf16 v[128:143], a[236:239], a[204:207], v[128:143]
    ds_read_b64_tr_b16 a[228:229], v6 offset:64
    ds_read_b64_tr_b16 a[230:231], v6 offset:576
    v_mul_f32 v192, s33, v192
    s_waitcnt lgkmcnt(6)
    v_mfma_f32_32x32x16_bf16 v[128:143], a[240:243], a[208:211], v[128:143]
    ds_read_b64_tr_b16 a[232:233], v6 offset:128
    ds_read_b64_tr_b16 a[234:235], v6 offset:640
    v_exp_f32 v26, v150
    v_exp_f32 v27, v151
    v_mul_f32 v193, s33, v193
    v_mfma_f32_32x32x16_bf16 v[128:143], a[244:247], a[212:215], v[128:143]
    ds_read_b64_tr_b16 a[236:237], v6 offset:192
    ds_read_b64_tr_b16 a[238:239], v6 offset:704
    v_cvt_pk_bf16_f32 v192, v192, v193
    s_waitcnt lgkmcnt(8)
    v_mfma_f32_32x32x16_bf16 v[128:143], a[248:251], a[216:219], v[128:143]
    ds_read_b64_tr_b16 a[240:241], v6 offset:8448
    ds_read_b64_tr_b16 a[242:243], v6 offset:8960
    v_add_f32 v28, v28, v26
    v_cvt_pk_bf16_f32 v187, v26, v27
    v_add_f32 v29, v29, v27
    v_mul_f32 v194, s33, v194
    v_mfma_f32_32x32x16_bf16 v[128:143], a[252:255], a[220:223], v[128:143]
    ds_read_b64_tr_b16 a[244:245], v6 offset:8512
    ds_read_b64_tr_b16 a[246:247], v6 offset:9024
    s_waitcnt lgkmcnt(8)
    v_mfma_f32_32x32x16_bf16 v[64:79], a[224:227], v[176:179], v[64:79]
    ds_read_b64_tr_b16 a[248:249], v6 offset:8576
    ds_read_b64_tr_b16 a[250:251], v6 offset:9088
    s_waitcnt vmcnt(24)
    s_barrier
    s_add_u32 m0, s24, 84480
    s_mov_b32 s29, 245760
    s_mov_b32 s30, 285696
    v_exp_f32 v24, v152
    v_exp_f32 v25, v153
    v_mul_f32 v195, s33, v195
    v_mfma_f32_32x32x16_bf16 v[80:95], a[228:231], v[176:179], v[80:95]
    ds_read_b64_tr_b16 a[252:253], v6 offset:8640
    ds_read_b64_tr_b16 a[254:255], v6 offset:9152
    buffer_load_dwordx4 v19, s[16:19], s29 offen nt lds
    v_cvt_pk_bf16_f32 v193, v194, v195
    s_waitcnt lgkmcnt(8)
    v_mfma_f32_32x32x16_bf16 v[96:111], a[232:235], v[176:179], v[96:111]
    ds_read_b64_tr_b16 a[224:225], v3 offset:16896
    ds_read_b64_tr_b16 a[226:227], v3 offset:17408
    v_add_f32 v28, v28, v24
    v_cvt_pk_bf16_f32 v188, v24, v25
    v_add_f32 v29, v29, v25
    v_mul_f32 v196, s33, v196
    v_mfma_f32_32x32x16_bf16 v[112:127], a[236:239], v[176:179], v[112:127]
    ds_read_b64_tr_b16 a[228:229], v3 offset:16960
    ds_read_b64_tr_b16 a[230:231], v3 offset:17472
    buffer_load_dwordx4 v19, s[16:19], s30 offen offset:1024 nt lds
    s_waitcnt lgkmcnt(8)
    v_mfma_f32_32x32x16_bf16 v[64:79], a[240:243], v[180:183], v[64:79]
    ds_read_b64_tr_b16 a[232:233], v3 offset:17024
    ds_read_b64_tr_b16 a[234:235], v3 offset:17536
    v_exp_f32 v26, v154
    v_exp_f32 v27, v155
    v_mul_f32 v197, s33, v197
    v_mfma_f32_32x32x16_bf16 v[80:95], a[244:247], v[180:183], v[80:95]
    ds_read_b64_tr_b16 a[236:237], v3 offset:17088
    ds_read_b64_tr_b16 a[238:239], v3 offset:17600
    buffer_load_dwordx4 v20, s[16:19], s29 offen offset:2112 nt lds
    v_cvt_pk_bf16_f32 v194, v196, v197
    s_waitcnt lgkmcnt(8)
    v_mfma_f32_32x32x16_bf16 v[96:111], a[248:251], v[180:183], v[96:111]
    ds_read_b64_tr_b16 a[240:241], v3 offset:25344
    ds_read_b64_tr_b16 a[242:243], v3 offset:25856
    v_add_f32 v28, v28, v26
    v_cvt_pk_bf16_f32 v189, v26, v27
    v_add_f32 v29, v29, v27
    v_mul_f32 v198, s33, v198
    v_mfma_f32_32x32x16_bf16 v[112:127], a[252:255], v[180:183], v[112:127]
    ds_read_b64_tr_b16 a[244:245], v3 offset:25408
    ds_read_b64_tr_b16 a[246:247], v3 offset:25920
    buffer_load_dwordx4 v20, s[16:19], s30 offen offset:3136 nt lds
    s_waitcnt lgkmcnt(8)
    v_mfma_f32_32x32x16_bf16 a[0:15], a[224:227], v[32:35], 0
    ds_read_b64_tr_b16 a[248:249], v3 offset:25472
    ds_read_b64_tr_b16 a[250:251], v3 offset:25984
    v_exp_f32 v24, v156
    v_exp_f32 v25, v157
    v_mul_f32 v199, s33, v199
    v_mfma_f32_32x32x16_bf16 a[16:31], a[228:231], v[32:35], 0
    ds_read_b64_tr_b16 a[252:253], v3 offset:25536
    ds_read_b64_tr_b16 a[254:255], v3 offset:26048
    v_cvt_pk_bf16_f32 v195, v198, v199
    s_waitcnt lgkmcnt(8)
    v_mfma_f32_32x32x16_bf16 a[32:47], a[232:235], v[32:35], 0
    ds_read_b64_tr_b16 a[224:225], v3 offset:17920
    ds_read_b64_tr_b16 a[226:227], v3 offset:18432
    v_add_f32 v28, v28, v24
    v_cvt_pk_bf16_f32 v190, v24, v25
    v_add_f32 v29, v29, v25
    v_mul_f32 v200, s33, v200
    v_mfma_f32_32x32x16_bf16 a[48:63], a[236:239], v[32:35], 0
    ds_read_b64_tr_b16 a[228:229], v3 offset:17984
    ds_read_b64_tr_b16 a[230:231], v3 offset:18496
    v_mul_f32 v201, s33, v201
    s_waitcnt lgkmcnt(8)
    v_mfma_f32_32x32x16_bf16 a[0:15], a[240:243], v[36:39], a[0:15]
    ds_read_b64_tr_b16 a[232:233], v3 offset:18048
    ds_read_b64_tr_b16 a[234:235], v3 offset:18560
    v_exp_f32 v26, v158
    v_exp_f32 v27, v159
    v_mfma_f32_32x32x16_bf16 a[16:31], a[244:247], v[36:39], a[16:31]
    ds_read_b64_tr_b16 a[236:237], v3 offset:18112
    ds_read_b64_tr_b16 a[238:239], v3 offset:18624
    v_cvt_pk_bf16_f32 v196, v200, v201
    s_waitcnt lgkmcnt(8)
    v_mfma_f32_32x32x16_bf16 a[32:47], a[248:251], v[36:39], a[32:47]
    ds_read_b64_tr_b16 a[240:241], v3 offset:26368
    ds_read_b64_tr_b16 a[242:243], v3 offset:26880
    v_add_f32 v28, v28, v26
    v_cvt_pk_bf16_f32 v191, v26, v27
    v_add_f32 v29, v29, v27
    v_mul_f32 v202, s33, v202
    v_mfma_f32_32x32x16_bf16 a[48:63], a[252:255], v[36:39], a[48:63]
    ds_read_b64_tr_b16 a[244:245], v3 offset:26432
    ds_read_b64_tr_b16 a[246:247], v3 offset:26944
    v_add_f32 v28, v28, v29
    v_cmp_nge_f32 vcc, s32, v28
    s_cbranch_vccnz L_rs39
L_back39:
    v_add_f32 v22, v22, v28
    v_mul_f32 v203, s33, v203
    s_waitcnt lgkmcnt(8)
    v_mfma_f32_32x32x16_bf16 a[0:15], a[224:227], v[40:43], a[0:15]
    ds_read_b64_tr_b16 a[248:249], v3 offset:26496
    ds_read_b64_tr_b16 a[250:251], v3 offset:27008
    s_waitcnt vmcnt(24)
    s_barrier
    s_add_u32 m0, s24, 101376
    s_mov_b32 s93, 352256
    s_mov_b32 s95, 367616
    v_exp_f32 v24, v128
    v_exp_f32 v25, v129
    v_mfma_f32_32x32x16_bf16 a[16:31], a[228:231], v[40:43], a[16:31]
    ds_read_b64_tr_b16 a[252:253], v3 offset:26560
    ds_read_b64_tr_b16 a[254:255], v3 offset:27072
    buffer_load_dwordx4 v15, s[8:11], s93 offen nt lds
    v_cvt_pk_bf16_f32 v197, v202, v203
    s_waitcnt lgkmcnt(8)
    v_mfma_f32_32x32x16_bf16 a[32:47], a[232:235], v[40:43], a[32:47]
    ds_read_b128 a[224:227], v9 offset:34816
    v_cvt_pk_bf16_f32 v176, v24, v25
    v_add_f32 v28, v24, v25
    v_mul_f32 v204, s33, v204
    v_mfma_f32_32x32x16_bf16 a[48:63], a[236:239], v[40:43], a[48:63]
    ds_read_b128 a[228:231], v12 offset:34816
    buffer_load_dwordx4 v17, s[4:7], s95 offen offset:1024 nt lds
    v_mul_f32 v205, s33, v205
    s_waitcnt lgkmcnt(6)
    v_mfma_f32_32x32x16_bf16 a[0:15], a[240:243], v[44:47], a[0:15]
    ds_read_b128 a[232:235], v9 offset:34880
    v_exp_f32 v26, v130
    v_exp_f32 v27, v131
    v_mfma_f32_32x32x16_bf16 a[16:31], a[244:247], v[44:47], a[16:31]
    ds_read_b128 a[236:239], v12 offset:34880
    buffer_load_dwordx4 v16, s[8:11], s93 offen offset:2112 nt lds
    v_cvt_pk_bf16_f32 v198, v204, v205
    s_waitcnt lgkmcnt(4)
    v_mfma_f32_32x32x16_bf16 a[32:47], a[248:251], v[44:47], a[32:47]
    ds_read_b128 a[240:243], v9 offset:34944
    v_cvt_pk_bf16_f32 v177, v26, v27
    v_add_f32 v29, v26, v27
    v_mul_f32 v206, s33, v206
    v_mfma_f32_32x32x16_bf16 a[48:63], a[252:255], v[44:47], a[48:63]
    ds_read_b128 a[244:247], v12 offset:34944
    buffer_load_dwordx4 v18, s[4:7], s95 offen offset:3136 nt lds
    v_mul_f32 v207, s33, v207
    s_waitcnt lgkmcnt(4)
    v_mfma_f32_32x32x16_bf16 v[144:159], a[224:227], a[192:195], v[160:175]
    ds_read_b128 a[248:251], v9 offset:35008
    v_exp_f32 v24, v132
    v_exp_f32 v25, v133
    v_cvt_pk_bf16_f32 v199, v206, v207
    v_mfma_f32_32x32x16_bf16 v[144:159], a[228:231], a[196:199], v[144:159]
    ds_read_b128 a[252:255], v12 offset:35008
    s_waitcnt lgkmcnt(4)
    v_mfma_f32_32x32x16_bf16 v[144:159], a[232:235], a[200:203], v[144:159]
    ds_read_b64_tr_b16 a[224:225], v6 offset:33792
    ds_read_b64_tr_b16 a[226:227], v6 offset:34304
    v_add_f32 v28, v28, v24
    v_cvt_pk_bf16_f32 v178, v24, v25
    v_add_f32 v29, v29, v25
    v_mul_f32 v208, s33, v208
    v_mfma_f32_32x32x16_bf16 v[144:159], a[236:239], a[204:207], v[144:159]
    ds_read_b64_tr_b16 a[228:229], v6 offset:33856
    ds_read_b64_tr_b16 a[230:231], v6 offset:34368
    v_mul_f32 v209, s33, v209
    s_waitcnt lgkmcnt(6)
    v_mfma_f32_32x32x16_bf16 v[144:159], a[240:243], a[208:211], v[144:159]
    ds_read_b64_tr_b16 a[232:233], v6 offset:33920
    ds_read_b64_tr_b16 a[234:235], v6 offset:34432
    v_exp_f32 v26, v134
    v_exp_f32 v27, v135
    v_cvt_pk_bf16_f32 v200, v208, v209
    v_mfma_f32_32x32x16_bf16 v[144:159], a[244:247], a[212:215], v[144:159]
    ds_read_b64_tr_b16 a[236:237], v6 offset:33984
    ds_read_b64_tr_b16 a[238:239], v6 offset:34496
    s_waitcnt lgkmcnt(8)
    v_mfma_f32_32x32x16_bf16 v[144:159], a[248:251], a[216:219], v[144:159]
    ds_read_b64_tr_b16 a[240:241], v6 offset:42240
    ds_read_b64_tr_b16 a[242:243], v6 offset:42752
    v_add_f32 v28, v28, v26
    v_cvt_pk_bf16_f32 v179, v26, v27
    v_add_f32 v29, v29, v27
    v_mul_f32 v210, s33, v210
    v_mfma_f32_32x32x16_bf16 v[144:159], a[252:255], a[220:223], v[144:159]
    ds_read_b64_tr_b16 a[244:245], v6 offset:42304
    ds_read_b64_tr_b16 a[246:247], v6 offset:42816
    v_mul_f32 v211, s33, v211
    s_waitcnt lgkmcnt(8)
    v_mfma_f32_32x32x16_bf16 v[64:79], a[224:227], v[184:187], v[64:79]
    ds_read_b64_tr_b16 a[248:249], v6 offset:42368
    ds_read_b64_tr_b16 a[250:251], v6 offset:42880
    s_waitcnt vmcnt(24)
    s_barrier
    s_add_u32 m0, s24, 118272
    s_mov_b32 s93, 360448
    s_mov_b32 s95, 375808
    v_exp_f32 v24, v136
    v_exp_f32 v25, v137
    v_cvt_pk_bf16_f32 v201, v210, v211
    v_mfma_f32_32x32x16_bf16 v[80:95], a[228:231], v[184:187], v[80:95]
    ds_read_b64_tr_b16 a[252:253], v6 offset:42432
    ds_read_b64_tr_b16 a[254:255], v6 offset:42944
    buffer_load_dwordx4 v15, s[8:11], s93 offen nt lds
    s_waitcnt lgkmcnt(8)
    v_mfma_f32_32x32x16_bf16 v[96:111], a[232:235], v[184:187], v[96:111]
    ds_read_b64_tr_b16 a[224:225], v1 offset:0
    ds_read_b64_tr_b16 a[226:227], v1 offset:512
    v_add_f32 v28, v28, v24
    v_cvt_pk_bf16_f32 v180, v24, v25
    v_add_f32 v29, v29, v25
    v_mul_f32 v212, s33, v212
    v_mfma_f32_32x32x16_bf16 v[112:127], a[236:239], v[184:187], v[112:127]
    ds_read_b64_tr_b16 a[228:229], v1 offset:64
    ds_read_b64_tr_b16 a[230:231], v1 offset:576
    buffer_load_dwordx4 v17, s[4:7], s95 offen offset:1024 nt lds
    v_mul_f32 v213, s33, v213
    s_waitcnt lgkmcnt(8)
    v_mfma_f32_32x32x16_bf16 v[64:79], a[240:243], v[188:191], v[64:79]
    ds_read_b64_tr_b16 a[232:233], v1 offset:128
    ds_read_b64_tr_b16 a[234:235], v1 offset:640
    v_exp_f32 v26, v138
    v_exp_f32 v27, v139
    v_cvt_pk_bf16_f32 v202, v212, v213
    v_mfma_f32_32x32x16_bf16 v[80:95], a[244:247], v[188:191], v[80:95]
    ds_read_b64_tr_b16 a[236:237], v1 offset:192
    ds_read_b64_tr_b16 a[238:239], v1 offset:704
    buffer_load_dwordx4 v16, s[8:11], s93 offen offset:2112 nt lds
    v_mul_f32 v214, s33, v214
    s_waitcnt lgkmcnt(8)
    v_mfma_f32_32x32x16_bf16 v[96:111], a[248:251], v[188:191], v[96:111]
    ds_read_b64_tr_b16 a[240:241], v1 offset:8448
    ds_read_b64_tr_b16 a[242:243], v1 offset:8960
    v_add_f32 v28, v28, v26
    v_cvt_pk_bf16_f32 v181, v26, v27
    v_add_f32 v29, v29, v27
    v_mfma_f32_32x32x16_bf16 v[112:127], a[252:255], v[188:191], v[112:127]
    ds_read_b64_tr_b16 a[244:245], v1 offset:8512
    ds_read_b64_tr_b16 a[246:247], v1 offset:9024
    buffer_load_dwordx4 v18, s[4:7], s95 offen offset:3136 nt lds
    v_mul_f32 v215, s33, v215
    s_waitcnt lgkmcnt(8)
    v_mfma_f32_32x32x16_bf16 a[0:15], a[224:227], v[48:51], a[0:15]
    ds_read_b64_tr_b16 a[248:249], v1 offset:8576
    ds_read_b64_tr_b16 a[250:251], v1 offset:9088
    v_exp_f32 v24, v140
    v_exp_f32 v25, v141
    v_cvt_pk_bf16_f32 v203, v214, v215
    v_mfma_f32_32x32x16_bf16 a[16:31], a[228:231], v[48:51], a[16:31]
    ds_read_b64_tr_b16 a[252:253], v1 offset:8640
    ds_read_b64_tr_b16 a[254:255], v1 offset:9152
    v_mul_f32 v216, s33, v216
    s_waitcnt lgkmcnt(8)
    v_mfma_f32_32x32x16_bf16 a[32:47], a[232:235], v[48:51], a[32:47]
    ds_read_b64_tr_b16 a[224:225], v1 offset:1024
    ds_read_b64_tr_b16 a[226:227], v1 offset:1536
    v_add_f32 v28, v28, v24
    v_cvt_pk_bf16_f32 v182, v24, v25
    v_add_f32 v29, v29, v25
    v_mfma_f32_32x32x16_bf16 a[48:63], a[236:239], v[48:51], a[48:63]
    ds_read_b64_tr_b16 a[228:229], v1 offset:1088
    ds_read_b64_tr_b16 a[230:231], v1 offset:1600
    v_mul_f32 v217, s33, v217
    s_waitcnt lgkmcnt(8)
    v_mfma_f32_32x32x16_bf16 a[0:15], a[240:243], v[52:55], a[0:15]
    ds_read_b64_tr_b16 a[232:233], v1 offset:1152
    ds_read_b64_tr_b16 a[234:235], v1 offset:1664
    v_exp_f32 v26, v142
    v_exp_f32 v27, v143
    v_cvt_pk_bf16_f32 v204, v216, v217
    v_mfma_f32_32x32x16_bf16 a[16:31], a[244:247], v[52:55], a[16:31]
    ds_read_b64_tr_b16 a[236:237], v1 offset:1216
    ds_read_b64_tr_b16 a[238:239], v1 offset:1728
    v_mul_f32 v218, s33, v218
    s_waitcnt lgkmcnt(8)
    v_mfma_f32_32x32x16_bf16 a[32:47], a[248:251], v[52:55], a[32:47]
    ds_read_b64_tr_b16 a[240:241], v1 offset:9472
    ds_read_b64_tr_b16 a[242:243], v1 offset:9984
    v_add_f32 v28, v28, v26
    v_cvt_pk_bf16_f32 v183, v26, v27
    v_add_f32 v29, v29, v27
    v_mfma_f32_32x32x16_bf16 a[48:63], a[252:255], v[52:55], a[48:63]
    ds_read_b64_tr_b16 a[244:245], v1 offset:9536
    ds_read_b64_tr_b16 a[246:247], v1 offset:10048
    v_add_f32 v28, v28, v29
    v_cmp_nge_f32 vcc, s32, v28
    s_cbranch_vccnz L_rs40
L_back40:
    v_add_f32 v22, v22, v28
    v_mul_f32 v219, s33, v219
    s_waitcnt lgkmcnt(8)
    v_mfma_f32_32x32x16_bf16 a[0:15], a[224:227], v[56:59], a[0:15]
    ds_read_b64_tr_b16 a[248:249], v1 offset:9600
    ds_read_b64_tr_b16 a[250:251], v1 offset:10112
    s_waitcnt vmcnt(24)
    s_barrier
    s_add_u32 m0, s24, 135168
    s_mov_b32 s29, 256
    s_mov_b32 s30, 40192
    v_exp_f32 v24, v144
    v_exp_f32 v25, v145
    v_cvt_pk_bf16_f32 v205, v218, v219
    v_mfma_f32_32x32x16_bf16 a[16:31], a[228:231], v[56:59], a[16:31]
    ds_read_b64_tr_b16 a[252:253], v1 offset:9664
    ds_read_b64_tr_b16 a[254:255], v1 offset:10176
    buffer_load_dwordx4 v19, s[16:19], s29 offen nt lds
    v_cvt_pk_bf16_f32 v184, v24, v25
    v_add_f32 v28, v24, v25
    v_mul_f32 v220, s33, v220
    s_waitcnt lgkmcnt(8)
    v_mfma_f32_32x32x16_bf16 a[32:47], a[232:235], v[56:59], a[32:47]
    ds_read_b128 a[224:227], v7 offset:17920
    v_mul_f32 v221, s33, v221
    v_mfma_f32_32x32x16_bf16 a[48:63], a[236:239], v[56:59], a[48:63]
    ds_read_b128 a[228:231], v10 offset:17920
    buffer_load_dwordx4 v19, s[16:19], s30 offen offset:1024 nt lds
    v_exp_f32 v26, v146
    v_exp_f32 v27, v147
    s_waitcnt lgkmcnt(6)
    v_mfma_f32_32x32x16_bf16 a[0:15], a[240:243], v[60:63], a[0:15]
    ds_read_b128 a[232:235], v7 offset:17984
    v_cvt_pk_bf16_f32 v185, v26, v27
    v_add_f32 v29, v26, v27
    v_cvt_pk_bf16_f32 v206, v220, v221
    v_mfma_f32_32x32x16_bf16 a[16:31], a[244:247], v[60:63], a[16:31]
    ds_read_b128 a[236:239], v10 offset:17984
    buffer_load_dwordx4 v20, s[16:19], s29 offen offset:2112 nt lds
    v_mul_f32 v222, s33, v222
    s_waitcnt lgkmcnt(4)
    v_mfma_f32_32x32x16_bf16 a[32:47], a[248:251], v[60:63], a[32:47]
    ds_read_b128 a[240:243], v7 offset:18048
    v_exp_f32 v24, v148
    v_exp_f32 v25, v149
    v_mul_f32 v223, s33, v223
    v_mfma_f32_32x32x16_bf16 a[48:63], a[252:255], v[60:63], a[48:63]
    ds_read_b128 a[244:247], v10 offset:18048
    buffer_load_dwordx4 v20, s[16:19], s30 offen offset:3136 nt lds
    v_add_f32 v28, v28, v24
    v_cvt_pk_bf16_f32 v186, v24, v25
    v_add_f32 v29, v29, v25
    s_waitcnt lgkmcnt(4)
    v_mfma_f32_32x32x16_bf16 v[128:143], a[224:227], a[192:195], v[160:175]
    ds_read_b128 a[248:251], v7 offset:18112
    v_cvt_pk_bf16_f32 v207, v222, v223
    v_mfma_f32_32x32x16_bf16 v[128:143], a[228:231], a[196:199], v[128:143]
    ds_read_b128 a[252:255], v10 offset:18112
    v_exp_f32 v26, v150
    v_exp_f32 v27, v151
    v_mul_f32 v224, s33, v224
    s_waitcnt lgkmcnt(4)
    v_mfma_f32_32x32x16_bf16 v[128:143], a[232:235], a[200:203], v[128:143]
    ds_read_b64_tr_b16 a[224:225], v4 offset:16896
    ds_read_b64_tr_b16 a[226:227], v4 offset:17408
    v_add_f32 v28, v28, v26
    v_cvt_pk_bf16_f32 v187, v26, v27
    v_add_f32 v29, v29, v27
    v_mul_f32 v225, s33, v225
    v_mfma_f32_32x32x16_bf16 v[128:143], a[236:239], a[204:207], v[128:143]
    ds_read_b64_tr_b16 a[228:229], v4 offset:16960
    ds_read_b64_tr_b16 a[230:231], v4 offset:17472
    s_waitcnt lgkmcnt(6)
    v_mfma_f32_32x32x16_bf16 v[128:143], a[240:243], a[208:211], v[128:143]
    ds_read_b64_tr_b16 a[232:233], v4 offset:17024
    ds_read_b64_tr_b16 a[234:235], v4 offset:17536
    v_exp_f32 v24, v152
    v_exp_f32 v25, v153
    v_cvt_pk_bf16_f32 v208, v224, v225
    v_mfma_f32_32x32x16_bf16 v[128:143], a[244:247], a[212:215], v[128:143]
    ds_read_b64_tr_b16 a[236:237], v4 offset:17088
    ds_read_b64_tr_b16 a[238:239], v4 offset:17600
    v_add_f32 v28, v28, v24
    v_cvt_pk_bf16_f32 v188, v24, v25
    v_add_f32 v29, v29, v25
    v_mul_f32 v226, s33, v226
    s_waitcnt lgkmcnt(8)
    v_mfma_f32_32x32x16_bf16 v[128:143], a[248:251], a[216:219], v[128:143]
    ds_read_b64_tr_b16 a[240:241], v4 offset:25344
    ds_read_b64_tr_b16 a[242:243], v4 offset:25856
    v_mul_f32 v227, s33, v227
    v_mfma_f32_32x32x16_bf16 v[128:143], a[252:255], a[220:223], v[128:143]
    ds_read_b64_tr_b16 a[244:245], v4 offset:25408
    ds_read_b64_tr_b16 a[246:247], v4 offset:25920
    v_exp_f32 v26, v154
    v_exp_f32 v27, v155
    s_waitcnt lgkmcnt(8)
    v_mfma_f32_32x32x16_bf16 v[64:79], a[224:227], v[176:179], v[64:79]
    ds_read_b64_tr_b16 a[248:249], v4 offset:25472
    ds_read_b64_tr_b16 a[250:251], v4 offset:25984
    s_waitcnt vmcnt(24)
    s_barrier
    s_add_u32 m0, s24, 0
    s_mov_b32 s93, 368640
    s_mov_b32 s95, 384000
    v_add_f32 v28, v28, v26
    v_cvt_pk_bf16_f32 v189, v26, v27
    v_add_f32 v29, v29, v27
    v_cvt_pk_bf16_f32 v209, v226, v227
    v_mfma_f32_32x32x16_bf16 v[80:95], a[228:231], v[176:179], v[80:95]
    ds_read_b64_tr_b16 a[252:253], v4 offset:25536
    ds_read_b64_tr_b16 a[254:255], v4 offset:26048
    buffer_load_dwordx4 v15, s[8:11], s93 offen nt lds
    v_mul_f32 v228, s33, v228
    s_waitcnt lgkmcnt(8)
    v_mfma_f32_32x32x16_bf16 v[96:111], a[232:235], v[176:179], v[96:111]
    ds_read_b128 a[224:227], v7 offset:34816
    v_exp_f32 v24, v156
    v_exp_f32 v25, v157
    v_mul_f32 v229, s33, v229
    v_mfma_f32_32x32x16_bf16 v[112:127], a[236:239], v[176:179], v[112:127]
    ds_read_b128 a[228:231], v10 offset:34816
    buffer_load_dwordx4 v17, s[4:7], s95 offen offset:1024 nt lds
    v_add_f32 v28, v28, v24
    v_cvt_pk_bf16_f32 v190, v24, v25
    v_add_f32 v29, v29, v25
    v_cvt_pk_bf16_f32 v210, v228, v229
    s_waitcnt lgkmcnt(6)
    v_mfma_f32_32x32x16_bf16 v[64:79], a[240:243], v[180:183], v[64:79]
    ds_read_b128 a[232:235], v7 offset:34880
    v_mfma_f32_32x32x16_bf16 v[80:95], a[244:247], v[180:183], v[80:95]
    ds_read_b128 a[236:239], v10 offset:34880
    buffer_load_dwordx4 v16, s[8:11], s93 offen offset:2112 nt lds
    v_exp_f32 v26, v158
    v_exp_f32 v27, v159
    v_mul_f32 v230, s33, v230
    s_waitcnt lgkmcnt(4)
    v_mfma_f32_32x32x16_bf16 v[96:111], a[248:251], v[180:183], v[96:111]
    ds_read_b128 a[240:243], v7 offset:34944
    v_add_f32 v28, v28, v26
    v_cvt_pk_bf16_f32 v191, v26, v27
    v_add_f32 v29, v29, v27
    v_mul_f32 v231, s33, v231
    v_mfma_f32_32x32x16_bf16 v[112:127], a[252:255], v[180:183], v[112:127]
    ds_read_b128 a[244:247], v10 offset:34944
    buffer_load_dwordx4 v18, s[4:7], s95 offen offset:3136 nt lds
    v_add_f32 v28, v28, v29
    v_cmp_nge_f32 vcc, s32, v28
    s_cbranch_vccnz L_rs41
L_back41:
    v_add_f32 v22, v22, v28
    v_cvt_pk_bf16_f32 v211, v230, v231
    s_waitcnt lgkmcnt(4)
    v_mfma_f32_32x32x16_bf16 v[144:159], a[224:227], a[192:195], v[160:175]
    ds_read_b128 a[248:251], v7 offset:35008
    v_exp_f32 v24, v128
    v_exp_f32 v25, v129
    v_mfma_f32_32x32x16_bf16 v[144:159], a[228:231], a[196:199], v[144:159]
    ds_read_b128 a[252:255], v10 offset:35008
    v_cvt_pk_bf16_f32 v176, v24, v25
    v_add_f32 v28, v24, v25
    v_mul_f32 v232, s33, v232
    s_waitcnt lgkmcnt(4)
    v_mfma_f32_32x32x16_bf16 v[144:159], a[232:235], a[200:203], v[144:159]
    ds_read_b64_tr_b16 a[224:225], v4 offset:33792
    ds_read_b64_tr_b16 a[226:227], v4 offset:34304
    v_mul_f32 v233, s33, v233
    v_mfma_f32_32x32x16_bf16 v[144:159], a[236:239], a[204:207], v[144:159]
    ds_read_b64_tr_b16 a[228:229], v4 offset:33856
    ds_read_b64_tr_b16 a[230:231], v4 offset:34368
    v_exp_f32 v26, v130
    v_exp_f32 v27, v131
    v_cvt_pk_bf16_f32 v212, v232, v233
    s_waitcnt lgkmcnt(6)
    v_mfma_f32_32x32x16_bf16 v[144:159], a[240:243], a[208:211], v[144:159]
    ds_read_b64_tr_b16 a[232:233], v4 offset:33920
    ds_read_b64_tr_b16 a[234:235], v4 offset:34432
    v_cvt_pk_bf16_f32 v177, v26, v27
    v_add_f32 v29, v26, v27
    v_mfma_f32_32x32x16_bf16 v[144:159], a[244:247], a[212:215], v[144:159]
    ds_read_b64_tr_b16 a[236:237], v4 offset:33984
    ds_read_b64_tr_b16 a[238:239], v4 offset:34496
    v_mul_f32 v234, s33, v234
    s_waitcnt lgkmcnt(8)
    v_mfma_f32_32x32x16_bf16 v[144:159], a[248:251], a[216:219], v[144:159]
    ds_read_b64_tr_b16 a[240:241], v4 offset:42240
    ds_read_b64_tr_b16 a[242:243], v4 offset:42752
    v_exp_f32 v24, v132
    v_exp_f32 v25, v133
    v_mul_f32 v235, s33, v235
    v_mfma_f32_32x32x16_bf16 v[144:159], a[252:255], a[220:223], v[144:159]
    ds_read_b64_tr_b16 a[244:245], v4 offset:42304
    ds_read_b64_tr_b16 a[246:247], v4 offset:42816
    v_add_f32 v28, v28, v24
    v_cvt_pk_bf16_f32 v178, v24, v25
    v_add_f32 v29, v29, v25
    v_cvt_pk_bf16_f32 v213, v234, v235
    s_waitcnt lgkmcnt(8)
    v_mfma_f32_32x32x16_bf16 v[64:79], a[224:227], v[184:187], v[64:79]
    ds_read_b64_tr_b16 a[248:249], v4 offset:42368
    ds_read_b64_tr_b16 a[250:251], v4 offset:42880
    s_waitcnt vmcnt(24)
    s_barrier
    s_add_u32 m0, s24, 16896
    s_mov_b32 s29, 82176
    s_mov_b32 s30, 122112
    v_mul_f32 v236, s33, v236
    v_mfma_f32_32x32x16_bf16 v[80:95], a[228:231], v[184:187], v[80:95]
    ds_read_b64_tr_b16 a[252:253], v4 offset:42432
    ds_read_b64_tr_b16 a[254:255], v4 offset:42944
    buffer_load_dwordx4 v19, s[16:19], s29 offen nt lds
    v_exp_f32 v26, v134
    v_exp_f32 v27, v135
    s_waitcnt lgkmcnt(8)
    v_mfma_f32_32x32x16_bf16 v[96:111], a[232:235], v[184:187], v[96:111]
    ds_read_b64_tr_b16 a[224:225], v2 offset:0
    ds_read_b64_tr_b16 a[226:227], v2 offset:512
    v_add_f32 v28, v28, v26
    v_cvt_pk_bf16_f32 v179, v26, v27
    v_add_f32 v29, v29, v27
    v_mul_f32 v237, s33, v237
    v_mfma_f32_32x32x16_bf16 v[112:127], a[236:239], v[184:187], v[112:127]
    ds_read_b64_tr_b16 a[228:229], v2 offset:64
    ds_read_b64_tr_b16 a[230:231], v2 offset:576
    buffer_load_dwordx4 v19, s[16:19], s30 offen offset:1024 nt lds
    v_cvt_pk_bf16_f32 v214, v236, v237
    s_waitcnt lgkmcnt(8)
    v_mfma_f32_32x32x16_bf16 v[64:79], a[240:243], v[188:191], v[64:79]
    ds_read_b64_tr_b16 a[232:233], v2 offset:128
    ds_read_b64_tr_b16 a[234:235], v2 offset:640
    v_exp_f32 v24, v136
    v_exp_f32 v25, v137
    v_mul_f32 v238, s33, v238
    v_mfma_f32_32x32x16_bf16 v[80:95], a[244:247], v[188:191], v[80:95]
    ds_read_b64_tr_b16 a[236:237], v2 offset:192
    ds_read_b64_tr_b16 a[238:239], v2 offset:704
    buffer_load_dwordx4 v20, s[16:19], s29 offen offset:2112 nt lds
    v_add_f32 v28, v28, v24
    v_cvt_pk_bf16_f32 v180, v24, v25
    v_add_f32 v29, v29, v25
    s_waitcnt lgkmcnt(8)
    v_mfma_f32_32x32x16_bf16 v[96:111], a[248:251], v[188:191], v[96:111]
    ds_read_b64_tr_b16 a[240:241], v2 offset:8448
    ds_read_b64_tr_b16 a[242:243], v2 offset:8960
    v_mul_f32 v239, s33, v239
    v_mfma_f32_32x32x16_bf16 v[112:127], a[252:255], v[188:191], v[112:127]
    ds_read_b64_tr_b16 a[244:245], v2 offset:8512
    ds_read_b64_tr_b16 a[246:247], v2 offset:9024
    buffer_load_dwordx4 v20, s[16:19], s30 offen offset:3136 nt lds
    v_exp_f32 v26, v138
    v_exp_f32 v27, v139
    v_cvt_pk_bf16_f32 v215, v238, v239
    s_waitcnt lgkmcnt(8)
    v_mfma_f32_32x32x16_bf16 a[0:15], a[224:227], a[160:163], a[0:15]
    ds_read_b64_tr_b16 a[248:249], v2 offset:8576
    ds_read_b64_tr_b16 a[250:251], v2 offset:9088
    v_add_f32 v28, v28, v26
    v_cvt_pk_bf16_f32 v181, v26, v27
    v_add_f32 v29, v29, v27
    v_mul_f32 v240, s33, v240
    v_mfma_f32_32x32x16_bf16 a[16:31], a[228:231], a[160:163], a[16:31]
    ds_read_b64_tr_b16 a[252:253], v2 offset:8640
    ds_read_b64_tr_b16 a[254:255], v2 offset:9152
    s_waitcnt lgkmcnt(8)
    v_mfma_f32_32x32x16_bf16 a[32:47], a[232:235], a[160:163], a[32:47]
    ds_read_b64_tr_b16 a[224:225], v2 offset:1024
    ds_read_b64_tr_b16 a[226:227], v2 offset:1536
    v_exp_f32 v24, v140
    v_exp_f32 v25, v141
    v_mul_f32 v241, s33, v241
    v_mfma_f32_32x32x16_bf16 a[48:63], a[236:239], a[160:163], a[48:63]
    ds_read_b64_tr_b16 a[228:229], v2 offset:1088
    ds_read_b64_tr_b16 a[230:231], v2 offset:1600
    v_add_f32 v28, v28, v24
    v_cvt_pk_bf16_f32 v182, v24, v25
    v_add_f32 v29, v29, v25
    v_cvt_pk_bf16_f32 v216, v240, v241
    s_waitcnt lgkmcnt(8)
    v_mfma_f32_32x32x16_bf16 a[0:15], a[240:243], a[164:167], a[0:15]
    ds_read_b64_tr_b16 a[232:233], v2 offset:1152
    ds_read_b64_tr_b16 a[234:235], v2 offset:1664
    v_mul_f32 v242, s33, v242
    v_mfma_f32_32x32x16_bf16 a[16:31], a[244:247], a[164:167], a[16:31]
    ds_read_b64_tr_b16 a[236:237], v2 offset:1216
    ds_read_b64_tr_b16 a[238:239], v2 offset:1728
    v_exp_f32 v26, v142
    v_exp_f32 v27, v143
    v_mul_f32 v243, s33, v243
    s_waitcnt lgkmcnt(8)
    v_mfma_f32_32x32x16_bf16 a[32:47], a[248:251], a[164:167], a[32:47]
    ds_read_b64_tr_b16 a[240:241], v2 offset:9472
    ds_read_b64_tr_b16 a[242:243], v2 offset:9984
    v_add_f32 v28, v28, v26
    v_cvt_pk_bf16_f32 v183, v26, v27
    v_add_f32 v29, v29, v27
    v_mfma_f32_32x32x16_bf16 a[48:63], a[252:255], a[164:167], a[48:63]
    ds_read_b64_tr_b16 a[244:245], v2 offset:9536
    ds_read_b64_tr_b16 a[246:247], v2 offset:10048
    v_add_f32 v28, v28, v29
    v_cmp_nge_f32 vcc, s32, v28
    s_cbranch_vccnz L_rs42
L_back42:
    v_add_f32 v22, v22, v28
    v_cvt_pk_bf16_f32 v217, v242, v243
    s_waitcnt lgkmcnt(8)
    v_mfma_f32_32x32x16_bf16 a[0:15], a[224:227], a[168:171], a[0:15]
    ds_read_b64_tr_b16 a[248:249], v2 offset:9600
    ds_read_b64_tr_b16 a[250:251], v2 offset:10112
    s_waitcnt vmcnt(24)
    s_barrier
    s_add_u32 m0, s24, 33792
    s_mov_b32 s93, 376832
    s_mov_b32 s95, 384000
    v_exp_f32 v24, v144
    v_exp_f32 v25, v145
    v_mul_f32 v244, s33, v244
    v_mfma_f32_32x32x16_bf16 a[16:31], a[228:231], a[168:171], a[16:31]
    ds_read_b64_tr_b16 a[252:253], v2 offset:9664
    ds_read_b64_tr_b16 a[254:255], v2 offset:10176
    buffer_load_dwordx4 v15, s[8:11], s93 offen nt lds
    v_mul_f32 v245, s33, v245
    s_waitcnt lgkmcnt(8)
    v_mfma_f32_32x32x16_bf16 a[32:47], a[232:235], a[168:171], a[32:47]
    ds_read_b128 a[224:227], v8 offset:17920
    v_cvt_pk_bf16_f32 v184, v24, v25
    v_add_f32 v28, v24, v25
    v_mfma_f32_32x32x16_bf16 a[48:63], a[236:239], a[168:171], a[48:63]
    ds_read_b128 a[228:231], v11 offset:17920
    buffer_load_dwordx4 v15, s[8:11], s95 offen offset:1024 nt lds
    v_cvt_pk_bf16_f32 v218, v244, v245
    s_waitcnt lgkmcnt(6)
    v_mfma_f32_32x32x16_bf16 a[0:15], a[240:243], a[172:175], a[0:15]
    ds_read_b128 a[232:235], v8 offset:17984
    v_exp_f32 v26, v146
    v_exp_f32 v27, v147
    v_mul_f32 v246, s33, v246
    v_mfma_f32_32x32x16_bf16 a[16:31], a[244:247], a[172:175], a[16:31]
    ds_read_b128 a[236:239], v11 offset:17984
    buffer_load_dwordx4 v16, s[8:11], s93 offen offset:2112 nt lds
    v_mul_f32 v247, s33, v247
    s_waitcnt lgkmcnt(4)
    v_mfma_f32_32x32x16_bf16 a[32:47], a[248:251], a[172:175], a[32:47]
    ds_read_b128 a[240:243], v8 offset:18048
    v_cvt_pk_bf16_f32 v185, v26, v27
    v_add_f32 v29, v26, v27
    v_mfma_f32_32x32x16_bf16 a[48:63], a[252:255], a[172:175], a[48:63]
    ds_read_b128 a[244:247], v11 offset:18048
    buffer_load_dwordx4 v16, s[8:11], s95 offen offset:3136 nt lds
    v_cvt_pk_bf16_f32 v219, v246, v247
    s_waitcnt lgkmcnt(4)
    v_mfma_f32_32x32x16_bf16 v[128:143], a[224:227], a[192:195], v[160:175]
    ds_read_b128 a[248:251], v8 offset:18112
    v_exp_f32 v24, v148
    v_exp_f32 v25, v149
    v_mul_f32 v248, s33, v248
    v_mfma_f32_32x32x16_bf16 v[128:143], a[228:231], a[196:199], v[128:143]
    ds_read_b128 a[252:255], v11 offset:18112
    v_mul_f32 v249, s33, v249
    s_waitcnt lgkmcnt(4)
    v_mfma_f32_32x32x16_bf16 v[128:143], a[232:235], a[200:203], v[128:143]
    ds_read_b64_tr_b16 a[224:225], v5 offset:16896
    ds_read_b64_tr_b16 a[226:227], v5 offset:17408
    v_add_f32 v28, v28, v24
    v_cvt_pk_bf16_f32 v186, v24, v25
    v_add_f32 v29, v29, v25
    v_cvt_pk_bf16_f32 v220, v248, v249
    v_mfma_f32_32x32x16_bf16 v[128:143], a[236:239], a[204:207], v[128:143]
    ds_read_b64_tr_b16 a[228:229], v5 offset:16960
    ds_read_b64_tr_b16 a[230:231], v5 offset:17472
    s_waitcnt lgkmcnt(6)
    v_mfma_f32_32x32x16_bf16 v[128:143], a[240:243], a[208:211], v[128:143]
    ds_read_b64_tr_b16 a[232:233], v5 offset:17024
    ds_read_b64_tr_b16 a[234:235], v5 offset:17536
    v_exp_f32 v26, v150
    v_exp_f32 v27, v151
    v_mul_f32 v250, s33, v250
    v_mfma_f32_32x32x16_bf16 v[128:143], a[244:247], a[212:215], v[128:143]
    ds_read_b64_tr_b16 a[236:237], v5 offset:17088
    ds_read_b64_tr_b16 a[238:239], v5 offset:17600
    v_mul_f32 v251, s33, v251
    s_waitcnt lgkmcnt(8)
    v_mfma_f32_32x32x16_bf16 v[128:143], a[248:251], a[216:219], v[128:143]
    ds_read_b64_tr_b16 a[240:241], v5 offset:25344
    ds_read_b64_tr_b16 a[242:243], v5 offset:25856
    v_add_f32 v28, v28, v26
    v_cvt_pk_bf16_f32 v187, v26, v27
    v_add_f32 v29, v29, v27
    v_cvt_pk_bf16_f32 v221, v250, v251
    v_mfma_f32_32x32x16_bf16 v[128:143], a[252:255], a[220:223], v[128:143]
    ds_read_b64_tr_b16 a[244:245], v5 offset:25408
    ds_read_b64_tr_b16 a[246:247], v5 offset:25920
    s_waitcnt lgkmcnt(8)
    v_mfma_f32_32x32x16_bf16 v[64:79], a[224:227], v[176:179], v[64:79]
    ds_read_b64_tr_b16 a[248:249], v5 offset:25472
    ds_read_b64_tr_b16 a[250:251], v5 offset:25984
    s_waitcnt vmcnt(24)
    s_barrier
    s_add_u32 m0, s24, 50688
    s_mov_b32 s29, 164096
    s_mov_b32 s30, 204032
    v_exp_f32 v24, v152
    v_exp_f32 v25, v153
    v_mul_f32 v252, s33, v252
    v_mfma_f32_32x32x16_bf16 v[80:95], a[228:231], v[176:179], v[80:95]
    ds_read_b64_tr_b16 a[252:253], v5 offset:25536
    ds_read_b64_tr_b16 a[254:255], v5 offset:26048
    buffer_load_dwordx4 v19, s[16:19], s29 offen nt lds
    v_mul_f32 v253, s33, v253
    s_waitcnt lgkmcnt(8)
    v_mfma_f32_32x32x16_bf16 v[96:111], a[232:235], v[176:179], v[96:111]
    ds_read_b64_tr_b16 a[224:225], v2 offset:33792
    ds_read_b64_tr_b16 a[226:227], v2 offset:34304
    v_add_f32 v28, v28, v24
    v_cvt_pk_bf16_f32 v188, v24, v25
    v_add_f32 v29, v29, v25
    v_cvt_pk_bf16_f32 v222, v252, v253
    v_mfma_f32_32x32x16_bf16 v[112:127], a[236:239], v[176:179], v[112:127]
    ds_read_b64_tr_b16 a[228:229], v2 offset:33856
    ds_read_b64_tr_b16 a[230:231], v2 offset:34368
    buffer_load_dwordx4 v19, s[16:19], s30 offen offset:1024 nt lds
    s_waitcnt lgkmcnt(8)
    v_mfma_f32_32x32x16_bf16 v[64:79], a[240:243], v[180:183], v[64:79]
    ds_read_b64_tr_b16 a[232:233], v2 offset:33920
    ds_read_b64_tr_b16 a[234:235], v2 offset:34432
    v_exp_f32 v26, v154
    v_exp_f32 v27, v155
    v_mul_f32 v254, s33, v254
    v_mfma_f32_32x32x16_bf16 v[80:95], a[244:247], v[180:183], v[80:95]
    ds_read_b64_tr_b16 a[236:237], v2 offset:33984
    ds_read_b64_tr_b16 a[238:239], v2 offset:34496
    buffer_load_dwordx4 v20, s[16:19], s29 offen offset:2112 nt lds
    v_mul_f32 v255, s33, v255
    s_waitcnt lgkmcnt(8)
    v_mfma_f32_32x32x16_bf16 v[96:111], a[248:251], v[180:183], v[96:111]
    ds_read_b64_tr_b16 a[240:241], v2 offset:42240
    ds_read_b64_tr_b16 a[242:243], v2 offset:42752
    v_add_f32 v28, v28, v26
    v_cvt_pk_bf16_f32 v189, v26, v27
    v_add_f32 v29, v29, v27
    v_cvt_pk_bf16_f32 v223, v254, v255
    v_mfma_f32_32x32x16_bf16 v[112:127], a[252:255], v[180:183], v[112:127]
    ds_read_b64_tr_b16 a[244:245], v2 offset:42304
    ds_read_b64_tr_b16 a[246:247], v2 offset:42816
    buffer_load_dwordx4 v20, s[16:19], s30 offen offset:3136 nt lds
    s_waitcnt lgkmcnt(8)
    v_mfma_f32_32x32x16_bf16 a[0:15], a[224:227], a[176:179], a[0:15]
    ds_read_b64_tr_b16 a[248:249], v2 offset:42368
    ds_read_b64_tr_b16 a[250:251], v2 offset:42880
    v_exp_f32 v24, v156
    v_exp_f32 v25, v157
    v_mfma_f32_32x32x16_bf16 a[16:31], a[228:231], a[176:179], a[16:31]
    ds_read_b64_tr_b16 a[252:253], v2 offset:42432
    ds_read_b64_tr_b16 a[254:255], v2 offset:42944
    s_waitcnt lgkmcnt(8)
    v_mfma_f32_32x32x16_bf16 a[32:47], a[232:235], a[176:179], a[32:47]
    ds_read_b64_tr_b16 a[224:225], v2 offset:34816
    ds_read_b64_tr_b16 a[226:227], v2 offset:35328
    v_add_f32 v28, v28, v24
    v_cvt_pk_bf16_f32 v190, v24, v25
    v_add_f32 v29, v29, v25
    v_mfma_f32_32x32x16_bf16 a[48:63], a[236:239], a[176:179], a[48:63]
    ds_read_b64_tr_b16 a[228:229], v2 offset:34880
    ds_read_b64_tr_b16 a[230:231], v2 offset:35392
    s_waitcnt lgkmcnt(8)
    v_mfma_f32_32x32x16_bf16 a[0:15], a[240:243], a[180:183], a[0:15]
    ds_read_b64_tr_b16 a[232:233], v2 offset:34944
    ds_read_b64_tr_b16 a[234:235], v2 offset:35456
    v_exp_f32 v26, v158
    v_exp_f32 v27, v159
    v_mfma_f32_32x32x16_bf16 a[16:31], a[244:247], a[180:183], a[16:31]
    ds_read_b64_tr_b16 a[236:237], v2 offset:35008
    ds_read_b64_tr_b16 a[238:239], v2 offset:35520
    s_waitcnt lgkmcnt(8)
    v_mfma_f32_32x32x16_bf16 a[32:47], a[248:251], a[180:183], a[32:47]
    ds_read_b64_tr_b16 a[240:241], v2 offset:43264
    ds_read_b64_tr_b16 a[242:243], v2 offset:43776
    v_add_f32 v28, v28, v26
    v_cvt_pk_bf16_f32 v191, v26, v27
    v_add_f32 v29, v29, v27
    v_mfma_f32_32x32x16_bf16 a[48:63], a[252:255], a[180:183], a[48:63]
    ds_read_b64_tr_b16 a[244:245], v2 offset:43328
    ds_read_b64_tr_b16 a[246:247], v2 offset:43840
    v_add_f32 v28, v28, v29
    v_cmp_nge_f32 vcc, s32, v28
    s_cbranch_vccnz L_rs43
L_back43:
    v_add_f32 v22, v22, v28
    s_waitcnt lgkmcnt(8)
    v_mfma_f32_32x32x16_bf16 a[0:15], a[224:227], a[184:187], a[0:15]
    ds_read_b64_tr_b16 a[248:249], v2 offset:43392
    ds_read_b64_tr_b16 a[250:251], v2 offset:43904
    s_waitcnt vmcnt(24)
    s_barrier
    s_add_u32 m0, s24, 67584
    s_mov_b32 s93, 393216
    s_mov_b32 s95, 400384
    v_exp_f32 v24, v128
    v_exp_f32 v25, v129
    v_mfma_f32_32x32x16_bf16 a[16:31], a[228:231], a[184:187], a[16:31]
    ds_read_b64_tr_b16 a[252:253], v2 offset:43456
    ds_read_b64_tr_b16 a[254:255], v2 offset:43968
    buffer_load_dwordx4 v17, s[4:7], s93 offen nt lds
    v_cvt_pk_bf16_f32 v176, v24, v25
    v_add_f32 v28, v24, v25
    s_waitcnt lgkmcnt(8)
    v_mfma_f32_32x32x16_bf16 a[32:47], a[232:235], a[184:187], a[32:47]
    ds_read_b128 a[224:227], v9 offset:1024
    v_mfma_f32_32x32x16_bf16 a[48:63], a[236:239], a[184:187], a[48:63]
    ds_read_b128 a[228:231], v12 offset:1024
    buffer_load_dwordx4 v17, s[4:7], s95 offen offset:1024 nt lds
    v_exp_f32 v26, v130
    v_exp_f32 v27, v131
    s_waitcnt lgkmcnt(6)
    v_mfma_f32_32x32x16_bf16 a[0:15], a[240:243], a[188:191], a[0:15]
    ds_read_b128 a[232:235], v9 offset:1088
    v_cvt_pk_bf16_f32 v177, v26, v27
    v_add_f32 v29, v26, v27
    v_mfma_f32_32x32x16_bf16 a[16:31], a[244:247], a[188:191], a[16:31]
    ds_read_b128 a[236:239], v12 offset:1088
    buffer_load_dwordx4 v18, s[4:7], s93 offen offset:2112 nt lds
    s_waitcnt lgkmcnt(4)
    v_mfma_f32_32x32x16_bf16 a[32:47], a[248:251], a[188:191], a[32:47]
    ds_read_b128 a[240:243], v9 offset:1152
    v_exp_f32 v24, v132
    v_exp_f32 v25, v133
    v_mfma_f32_32x32x16_bf16 a[48:63], a[252:255], a[188:191], a[48:63]
    ds_read_b128 a[244:247], v12 offset:1152
    buffer_load_dwordx4 v18, s[4:7], s95 offen offset:3136 nt lds
    v_add_f32 v28, v28, v24
    v_cvt_pk_bf16_f32 v178, v24, v25
    v_add_f32 v29, v29, v25
    s_waitcnt lgkmcnt(4)
    v_mfma_f32_32x32x16_bf16 v[144:159], a[224:227], a[192:195], v[160:175]
    ds_read_b128 a[248:251], v9 offset:1216
    v_mfma_f32_32x32x16_bf16 v[144:159], a[228:231], a[196:199], v[144:159]
    ds_read_b128 a[252:255], v12 offset:1216
    v_exp_f32 v26, v134
    v_exp_f32 v27, v135
    s_waitcnt lgkmcnt(4)
    v_mfma_f32_32x32x16_bf16 v[144:159], a[232:235], a[200:203], v[144:159]
    ds_read_b64_tr_b16 a[224:225], v6 offset:0
    ds_read_b64_tr_b16 a[226:227], v6 offset:512
    v_add_f32 v28, v28, v26
    v_cvt_pk_bf16_f32 v179, v26, v27
    v_add_f32 v29, v29, v27
    v_mfma_f32_32x32x16_bf16 v[144:159], a[236:239], a[204:207], v[144:159]
    ds_read_b64_tr_b16 a[228:229], v6 offset:64
    ds_read_b64_tr_b16 a[230:231], v6 offset:576
    v_accvgpr_read_b32 v13, a0
    v_accvgpr_read_b32 v14, a1
    s_waitcnt lgkmcnt(6)
    v_mfma_f32_32x32x16_bf16 v[144:159], a[240:243], a[208:211], v[144:159]
    ds_read_b64_tr_b16 a[232:233], v6 offset:128
    ds_read_b64_tr_b16 a[234:235], v6 offset:640
    v_exp_f32 v24, v136
    v_exp_f32 v25, v137
    v_cvt_pk_bf16_f32 v13, v13, v14
    v_mfma_f32_32x32x16_bf16 v[144:159], a[244:247], a[212:215], v[144:159]
    ds_read_b64_tr_b16 a[236:237], v6 offset:192
    ds_read_b64_tr_b16 a[238:239], v6 offset:704
    v_add_f32 v28, v28, v24
    v_cvt_pk_bf16_f32 v180, v24, v25
    v_add_f32 v29, v29, v25
    v_accvgpr_write_b32 a128, v13
    v_accvgpr_read_b32 v13, a2
    s_waitcnt lgkmcnt(8)
    v_mfma_f32_32x32x16_bf16 v[144:159], a[248:251], a[216:219], v[144:159]
    ds_read_b64_tr_b16 a[240:241], v6 offset:8448
    ds_read_b64_tr_b16 a[242:243], v6 offset:8960
    v_accvgpr_read_b32 v14, a3
    v_mfma_f32_32x32x16_bf16 v[144:159], a[252:255], a[220:223], v[144:159]
    ds_read_b64_tr_b16 a[244:245], v6 offset:8512
    ds_read_b64_tr_b16 a[246:247], v6 offset:9024
    v_exp_f32 v26, v138
    v_exp_f32 v27, v139
    v_cvt_pk_bf16_f32 v13, v13, v14
    s_waitcnt lgkmcnt(8)
    v_mfma_f32_32x32x16_bf16 v[64:79], a[224:227], v[184:187], v[64:79]
    ds_read_b64_tr_b16 a[248:249], v6 offset:8576
    ds_read_b64_tr_b16 a[250:251], v6 offset:9088
    s_waitcnt vmcnt(24)
    s_barrier
    s_add_u32 m0, s24, 84480
    s_mov_b32 s29, 246016
    s_mov_b32 s30, 285952
    v_add_f32 v28, v28, v26
    v_cvt_pk_bf16_f32 v181, v26, v27
    v_add_f32 v29, v29, v27
    v_accvgpr_write_b32 a129, v13
    v_accvgpr_read_b32 v13, a4
    v_mfma_f32_32x32x16_bf16 v[80:95], a[228:231], v[184:187], v[80:95]
    ds_read_b64_tr_b16 a[252:253], v6 offset:8640
    ds_read_b64_tr_b16 a[254:255], v6 offset:9152
    buffer_load_dwordx4 v19, s[16:19], s29 offen nt lds
    v_accvgpr_read_b32 v14, a5
    s_waitcnt lgkmcnt(8)
    v_mfma_f32_32x32x16_bf16 v[96:111], a[232:235], v[184:187], v[96:111]
    ds_read_b128 a[224:227], v9 offset:17920
    v_exp_f32 v24, v140
    v_exp_f32 v25, v141
    v_cvt_pk_bf16_f32 v13, v13, v14
    v_accvgpr_write_b32 a130, v13
    v_mfma_f32_32x32x16_bf16 v[112:127], a[236:239], v[184:187], v[112:127]
    ds_read_b128 a[228:231], v12 offset:17920
    buffer_load_dwordx4 v19, s[16:19], s30 offen offset:1024 nt lds
    v_add_f32 v28, v28, v24
    v_cvt_pk_bf16_f32 v182, v24, v25
    v_add_f32 v29, v29, v25
    v_accvgpr_read_b32 v13, a6
    s_waitcnt lgkmcnt(6)
    v_mfma_f32_32x32x16_bf16 v[64:79], a[240:243], v[188:191], v[64:79]
    ds_read_b128 a[232:235], v9 offset:17984
    v_accvgpr_read_b32 v14, a7
    v_mfma_f32_32x32x16_bf16 v[80:95], a[244:247], v[188:191], v[80:95]
    ds_read_b128 a[236:239], v12 offset:17984
    buffer_load_dwordx4 v20, s[16:19], s29 offen offset:2112 nt lds
    v_exp_f32 v26, v142
    v_exp_f32 v27, v143
    v_cvt_pk_bf16_f32 v13, v13, v14
    v_accvgpr_write_b32 a131, v13
    s_waitcnt lgkmcnt(4)
    v_mfma_f32_32x32x16_bf16 v[96:111], a[248:251], v[188:191], v[96:111]
    ds_read_b128 a[240:243], v9 offset:18048
    v_add_f32 v28, v28, v26
    v_cvt_pk_bf16_f32 v183, v26, v27
    v_add_f32 v29, v29, v27
    v_accvgpr_read_b32 v13, a8
    v_mfma_f32_32x32x16_bf16 v[112:127], a[252:255], v[188:191], v[112:127]
    ds_read_b128 a[244:247], v12 offset:18048
    buffer_load_dwordx4 v20, s[16:19], s30 offen offset:3136 nt lds
    v_add_f32 v28, v28, v29
    v_cmp_nge_f32 vcc, s32, v28
    s_cbranch_vccnz L_rs44
L_back44:
    v_add_f32 v22, v22, v28
    v_accvgpr_read_b32 v14, a9
    s_waitcnt lgkmcnt(4)
    v_mfma_f32_32x32x16_bf16 v[128:143], a[224:227], a[192:195], v[160:175]
    ds_read_b128 a[248:251], v9 offset:18112
    v_exp_f32 v24, v144
    v_exp_f32 v25, v145
    v_cvt_pk_bf16_f32 v13, v13, v14
    v_accvgpr_write_b32 a132, v13
    v_mfma_f32_32x32x16_bf16 v[128:143], a[228:231], a[196:199], v[128:143]
    ds_read_b128 a[252:255], v12 offset:18112
    v_cvt_pk_bf16_f32 v184, v24, v25
    v_add_f32 v28, v24, v25
    v_accvgpr_read_b32 v13, a10
    s_waitcnt lgkmcnt(4)
    v_mfma_f32_32x32x16_bf16 v[128:143], a[232:235], a[200:203], v[128:143]
    ds_read_b64_tr_b16 a[224:225], v6 offset:16896
    ds_read_b64_tr_b16 a[226:227], v6 offset:17408
    v_accvgpr_read_b32 v14, a11
    v_cvt_pk_bf16_f32 v13, v13, v14
    v_mfma_f32_32x32x16_bf16 v[128:143], a[236:239], a[204:207], v[128:143]
    ds_read_b64_tr_b16 a[228:229], v6 offset:16960
    ds_read_b64_tr_b16 a[230:231], v6 offset:17472
    v_exp_f32 v26, v146
    v_exp_f32 v27, v147
    v_accvgpr_write_b32 a133, v13
    s_waitcnt lgkmcnt(6)
    v_mfma_f32_32x32x16_bf16 v[128:143], a[240:243], a[208:211], v[128:143]
    ds_read_b64_tr_b16 a[232:233], v6 offset:17024
    ds_read_b64_tr_b16 a[234:235], v6 offset:17536
    v_cvt_pk_bf16_f32 v185, v26, v27
    v_add_f32 v29, v26, v27
    v_accvgpr_read_b32 v13, a12
    v_mfma_f32_32x32x16_bf16 v[128:143], a[244:247], a[212:215], v[128:143]
    ds_read_b64_tr_b16 a[236:237], v6 offset:17088
    ds_read_b64_tr_b16 a[238:239], v6 offset:17600
    v_accvgpr_read_b32 v14, a13
    v_cvt_pk_bf16_f32 v13, v13, v14
    s_waitcnt lgkmcnt(8)
    v_mfma_f32_32x32x16_bf16 v[128:143], a[248:251], a[216:219], v[128:143]
    ds_read_b64_tr_b16 a[240:241], v6 offset:25344
    ds_read_b64_tr_b16 a[242:243], v6 offset:25856
    v_exp_f32 v24, v148
    v_exp_f32 v25, v149
    v_accvgpr_write_b32 a134, v13
    v_mfma_f32_32x32x16_bf16 v[128:143], a[252:255], a[220:223], v[128:143]
    ds_read_b64_tr_b16 a[244:245], v6 offset:25408
    ds_read_b64_tr_b16 a[246:247], v6 offset:25920
    v_add_f32 v28, v28, v24
    v_cvt_pk_bf16_f32 v186, v24, v25
    v_add_f32 v29, v29, v25
    v_accvgpr_read_b32 v13, a14
    s_waitcnt lgkmcnt(8)
    v_mfma_f32_32x32x16_bf16 v[64:79], a[224:227], v[176:179], v[64:79]
    ds_read_b64_tr_b16 a[248:249], v6 offset:25472
    ds_read_b64_tr_b16 a[250:251], v6 offset:25984
    s_waitcnt vmcnt(24)
    s_barrier
    s_add_u32 m0, s24, 101376
    s_mov_b32 s93, 393216
    s_mov_b32 s95, 408576
    v_accvgpr_read_b32 v14, a15
    v_cvt_pk_bf16_f32 v13, v13, v14
    v_mfma_f32_32x32x16_bf16 v[80:95], a[228:231], v[176:179], v[80:95]
    ds_read_b64_tr_b16 a[252:253], v6 offset:25536
    ds_read_b64_tr_b16 a[254:255], v6 offset:26048
    buffer_load_dwordx4 v15, s[8:11], s93 offen nt lds
    v_exp_f32 v26, v150
    v_exp_f32 v27, v151
    v_accvgpr_write_b32 a135, v13
    s_waitcnt lgkmcnt(8)
    v_mfma_f32_32x32x16_bf16 v[96:111], a[232:235], v[176:179], v[96:111]
    ds_read_b64_tr_b16 a[224:225], v3 offset:33792
    ds_read_b64_tr_b16 a[226:227], v3 offset:34304
    v_add_f32 v28, v28, v26
    v_cvt_pk_bf16_f32 v187, v26, v27
    v_add_f32 v29, v29, v27
    v_accvgpr_read_b32 v13, a16
    v_accvgpr_read_b32 v14, a17
    v_mfma_f32_32x32x16_bf16 v[112:127], a[236:239], v[176:179], v[112:127]
    ds_read_b64_tr_b16 a[228:229], v3 offset:33856
    ds_read_b64_tr_b16 a[230:231], v3 offset:34368
    buffer_load_dwordx4 v17, s[4:7], s95 offen offset:1024 nt lds
    v_cvt_pk_bf16_f32 v13, v13, v14
    s_waitcnt lgkmcnt(8)
    v_mfma_f32_32x32x16_bf16 v[64:79], a[240:243], v[180:183], v[64:79]
    ds_read_b64_tr_b16 a[232:233], v3 offset:33920
    ds_read_b64_tr_b16 a[234:235], v3 offset:34432
    v_exp_f32 v24, v152
    v_exp_f32 v25, v153
    v_accvgpr_write_b32 a136, v13
    v_mfma_f32_32x32x16_bf16 v[80:95], a[244:247], v[180:183], v[80:95]
    ds_read_b64_tr_b16 a[236:237], v3 offset:33984
    ds_read_b64_tr_b16 a[238:239], v3 offset:34496
    buffer_load_dwordx4 v16, s[8:11], s93 offen offset:2112 nt lds
    v_add_f32 v28, v28, v24
    v_cvt_pk_bf16_f32 v188, v24, v25
    v_add_f32 v29, v29, v25
    v_accvgpr_read_b32 v13, a18
    v_accvgpr_read_b32 v14, a19
    s_waitcnt lgkmcnt(8)
    v_mfma_f32_32x32x16_bf16 v[96:111], a[248:251], v[180:183], v[96:111]
    ds_read_b64_tr_b16 a[240:241], v3 offset:42240
    ds_read_b64_tr_b16 a[242:243], v3 offset:42752
    v_cvt_pk_bf16_f32 v13, v13, v14
    v_mfma_f32_32x32x16_bf16 v[112:127], a[252:255], v[180:183], v[112:127]
    ds_read_b64_tr_b16 a[244:245], v3 offset:42304
    ds_read_b64_tr_b16 a[246:247], v3 offset:42816
    buffer_load_dwordx4 v18, s[4:7], s95 offen offset:3136 nt lds
    v_exp_f32 v26, v154
    v_exp_f32 v27, v155
    v_accvgpr_write_b32 a137, v13
    s_waitcnt lgkmcnt(8)
    v_mfma_f32_32x32x16_bf16 a[64:79], a[224:227], v[32:35], 0
    ds_read_b64_tr_b16 a[248:249], v3 offset:42368
    ds_read_b64_tr_b16 a[250:251], v3 offset:42880
    v_add_f32 v28, v28, v26
    v_cvt_pk_bf16_f32 v189, v26, v27
    v_add_f32 v29, v29, v27
    v_accvgpr_read_b32 v13, a20
    v_accvgpr_read_b32 v14, a21
    v_mfma_f32_32x32x16_bf16 a[80:95], a[228:231], v[32:35], 0
    ds_read_b64_tr_b16 a[252:253], v3 offset:42432
    ds_read_b64_tr_b16 a[254:255], v3 offset:42944
    v_cvt_pk_bf16_f32 v13, v13, v14
    s_waitcnt lgkmcnt(8)
    v_mfma_f32_32x32x16_bf16 a[96:111], a[232:235], v[32:35], 0
    ds_read_b64_tr_b16 a[224:225], v3 offset:34816
    ds_read_b64_tr_b16 a[226:227], v3 offset:35328
    v_exp_f32 v24, v156
    v_exp_f32 v25, v157
    v_accvgpr_write_b32 a138, v13
    v_accvgpr_read_b32 v13, a22
    v_mfma_f32_32x32x16_bf16 a[112:127], a[236:239], v[32:35], 0
    ds_read_b64_tr_b16 a[228:229], v3 offset:34880
    ds_read_b64_tr_b16 a[230:231], v3 offset:35392
    v_add_f32 v28, v28, v24
    v_cvt_pk_bf16_f32 v190, v24, v25
    v_add_f32 v29, v29, v25
    v_accvgpr_read_b32 v14, a23
    s_waitcnt lgkmcnt(8)
    v_mfma_f32_32x32x16_bf16 a[64:79], a[240:243], v[36:39], a[64:79]
    ds_read_b64_tr_b16 a[232:233], v3 offset:34944
    ds_read_b64_tr_b16 a[234:235], v3 offset:35456
    v_cvt_pk_bf16_f32 v13, v13, v14
    v_mfma_f32_32x32x16_bf16 a[80:95], a[244:247], v[36:39], a[80:95]
    ds_read_b64_tr_b16 a[236:237], v3 offset:35008
    ds_read_b64_tr_b16 a[238:239], v3 offset:35520
    v_exp_f32 v26, v158
    v_exp_f32 v27, v159
    v_accvgpr_write_b32 a139, v13
    v_accvgpr_read_b32 v13, a24
    s_waitcnt lgkmcnt(8)
    v_mfma_f32_32x32x16_bf16 a[96:111], a[248:251], v[36:39], a[96:111]
    ds_read_b64_tr_b16 a[240:241], v3 offset:43264
    ds_read_b64_tr_b16 a[242:243], v3 offset:43776
    v_add_f32 v28, v28, v26
    v_cvt_pk_bf16_f32 v191, v26, v27
    v_add_f32 v29, v29, v27
    v_accvgpr_read_b32 v14, a25
    v_mfma_f32_32x32x16_bf16 a[112:127], a[252:255], v[36:39], a[112:127]
    ds_read_b64_tr_b16 a[244:245], v3 offset:43328
    ds_read_b64_tr_b16 a[246:247], v3 offset:43840
    v_add_f32 v28, v28, v29
    v_cmp_nge_f32 vcc, s32, v28
    s_cbranch_vccnz L_rs45
L_back45:
    v_add_f32 v22, v22, v28
    v_cvt_pk_bf16_f32 v13, v13, v14
    s_waitcnt lgkmcnt(8)
    v_mfma_f32_32x32x16_bf16 a[64:79], a[224:227], v[40:43], a[64:79]
    ds_read_b64_tr_b16 a[248:249], v3 offset:43392
    ds_read_b64_tr_b16 a[250:251], v3 offset:43904
    s_waitcnt vmcnt(24)
    s_barrier
    s_add_u32 m0, s24, 118272
    s_mov_b32 s29, 512
    s_mov_b32 s30, 40448
    v_exp_f32 v24, v128
    v_exp_f32 v25, v129
    v_accvgpr_write_b32 a140, v13
    v_accvgpr_read_b32 v13, a26
    v_mfma_f32_32x32x16_bf16 a[80:95], a[228:231], v[40:43], a[80:95]
    ds_read_b64_tr_b16 a[252:253], v3 offset:43456
    ds_read_b64_tr_b16 a[254:255], v3 offset:43968
    buffer_load_dwordx4 v19, s[16:19], s29 offen nt lds
    v_cvt_pk_bf16_f32 v176, v24, v25
    v_add_f32 v28, v24, v25
    v_accvgpr_read_b32 v14, a27
    s_waitcnt lgkmcnt(8)
    v_mfma_f32_32x32x16_bf16 a[96:111], a[232:235], v[40:43], a[96:111]
    ds_read_b128 a[224:227], v7 offset:1024
    v_cvt_pk_bf16_f32 v13, v13, v14
    v_accvgpr_write_b32 a141, v13
    v_mfma_f32_32x32x16_bf16 a[112:127], a[236:239], v[40:43], a[112:127]
    ds_read_b128 a[228:231], v10 offset:1024
    buffer_load_dwordx4 v19, s[16:19], s30 offen offset:1024 nt lds
    v_exp_f32 v26, v130
    v_exp_f32 v27, v131
    v_accvgpr_read_b32 v13, a28
    s_waitcnt lgkmcnt(6)
    v_mfma_f32_32x32x16_bf16 a[64:79], a[240:243], v[44:47], a[64:79]
    ds_read_b128 a[232:235], v7 offset:1088
    v_cvt_pk_bf16_f32 v177, v26, v27
    v_add_f32 v29, v26, v27
    v_accvgpr_read_b32 v14, a29
    v_mfma_f32_32x32x16_bf16 a[80:95], a[244:247], v[44:47], a[80:95]
    ds_read_b128 a[236:239], v10 offset:1088
    buffer_load_dwordx4 v20, s[16:19], s29 offen offset:2112 nt lds
    v_cvt_pk_bf16_f32 v13, v13, v14
    v_accvgpr_write_b32 a142, v13
    s_waitcnt lgkmcnt(4)
    v_mfma_f32_32x32x16_bf16 a[96:111], a[248:251], v[44:47], a[96:111]
    ds_read_b128 a[240:243], v7 offset:1152
    v_exp_f32 v24, v132
    v_exp_f32 v25, v133
    v_accvgpr_read_b32 v13, a30
    v_mfma_f32_32x32x16_bf16 a[112:127], a[252:255], v[44:47], a[112:127]
    ds_read_b128 a[244:247], v10 offset:1152
    buffer_load_dwordx4 v20, s[16:19], s30 offen offset:3136 nt lds
    v_add_f32 v28, v28, v24
    v_cvt_pk_bf16_f32 v178, v24, v25
    v_add_f32 v29, v29, v25
    v_accvgpr_read_b32 v14, a31
    s_waitcnt lgkmcnt(4)
    v_mfma_f32_32x32x16_bf16 v[144:159], a[224:227], a[192:195], v[160:175]
    ds_read_b128 a[248:251], v7 offset:1216
    v_cvt_pk_bf16_f32 v13, v13, v14
    v_accvgpr_write_b32 a143, v13
    v_mfma_f32_32x32x16_bf16 v[144:159], a[228:231], a[196:199], v[144:159]
    ds_read_b128 a[252:255], v10 offset:1216
    v_exp_f32 v26, v134
    v_exp_f32 v27, v135
    v_accvgpr_read_b32 v13, a32
    s_waitcnt lgkmcnt(4)
    v_mfma_f32_32x32x16_bf16 v[144:159], a[232:235], a[200:203], v[144:159]
    ds_read_b64_tr_b16 a[224:225], v4 offset:0
    ds_read_b64_tr_b16 a[226:227], v4 offset:512
    v_add_f32 v28, v28, v26
    v_cvt_pk_bf16_f32 v179, v26, v27
    v_add_f32 v29, v29, v27
    v_accvgpr_read_b32 v14, a33
    v_cvt_pk_bf16_f32 v13, v13, v14
    v_mfma_f32_32x32x16_bf16 v[144:159], a[236:239], a[204:207], v[144:159]
    ds_read_b64_tr_b16 a[228:229], v4 offset:64
    ds_read_b64_tr_b16 a[230:231], v4 offset:576
    v_accvgpr_write_b32 a144, v13
    s_waitcnt lgkmcnt(6)
    v_mfma_f32_32x32x16_bf16 v[144:159], a[240:243], a[208:211], v[144:159]
    ds_read_b64_tr_b16 a[232:233], v4 offset:128
    ds_read_b64_tr_b16 a[234:235], v4 offset:640
    v_exp_f32 v24, v136
    v_exp_f32 v25, v137
    v_accvgpr_read_b32 v13, a34
    v_mfma_f32_32x32x16_bf16 v[144:159], a[244:247], a[212:215], v[144:159]
    ds_read_b64_tr_b16 a[236:237], v4 offset:192
    ds_read_b64_tr_b16 a[238:239], v4 offset:704
    v_add_f32 v28, v28, v24
    v_cvt_pk_bf16_f32 v180, v24, v25
    v_add_f32 v29, v29, v25
    v_accvgpr_read_b32 v14, a35
    v_cvt_pk_bf16_f32 v13, v13, v14
    s_waitcnt lgkmcnt(8)
    v_mfma_f32_32x32x16_bf16 v[144:159], a[248:251], a[216:219], v[144:159]
    ds_read_b64_tr_b16 a[240:241], v4 offset:8448
    ds_read_b64_tr_b16 a[242:243], v4 offset:8960
    v_accvgpr_write_b32 a145, v13
    v_mfma_f32_32x32x16_bf16 v[144:159], a[252:255], a[220:223], v[144:159]
    ds_read_b64_tr_b16 a[244:245], v4 offset:8512
    ds_read_b64_tr_b16 a[246:247], v4 offset:9024
    v_exp_f32 v26, v138
    v_exp_f32 v27, v139
    v_accvgpr_read_b32 v13, a36
    s_waitcnt lgkmcnt(8)
    v_mfma_f32_32x32x16_bf16 v[64:79], a[224:227], v[184:187], v[64:79]
    ds_read_b64_tr_b16 a[248:249], v4 offset:8576
    ds_read_b64_tr_b16 a[250:251], v4 offset:9088
    s_waitcnt vmcnt(24)
    s_barrier
    s_add_u32 m0, s24, 135168
    s_mov_b32 s93, 401408
    s_mov_b32 s95, 416768
    v_add_f32 v28, v28, v26
    v_cvt_pk_bf16_f32 v181, v26, v27
    v_add_f32 v29, v29, v27
    v_accvgpr_read_b32 v14, a37
    v_cvt_pk_bf16_f32 v13, v13, v14
    v_mfma_f32_32x32x16_bf16 v[80:95], a[228:231], v[184:187], v[80:95]
    ds_read_b64_tr_b16 a[252:253], v4 offset:8640
    ds_read_b64_tr_b16 a[254:255], v4 offset:9152
    buffer_load_dwordx4 v15, s[8:11], s93 offen nt lds
    v_accvgpr_write_b32 a146, v13
    s_waitcnt lgkmcnt(8)
    v_mfma_f32_32x32x16_bf16 v[96:111], a[232:235], v[184:187], v[96:111]
    ds_read_b64_tr_b16 a[224:225], v1 offset:16896
    ds_read_b64_tr_b16 a[226:227], v1 offset:17408
    v_exp_f32 v24, v140
    v_exp_f32 v25, v141
    v_accvgpr_read_b32 v13, a38
    v_accvgpr_read_b32 v14, a39
    v_mfma_f32_32x32x16_bf16 v[112:127], a[236:239], v[184:187], v[112:127]
    ds_read_b64_tr_b16 a[228:229], v1 offset:16960
    ds_read_b64_tr_b16 a[230:231], v1 offset:17472
    buffer_load_dwordx4 v17, s[4:7], s95 offen offset:1024 nt lds
    v_add_f32 v28, v28, v24
    v_cvt_pk_bf16_f32 v182, v24, v25
    v_add_f32 v29, v29, v25
    v_cvt_pk_bf16_f32 v13, v13, v14
    s_waitcnt lgkmcnt(8)
    v_mfma_f32_32x32x16_bf16 v[64:79], a[240:243], v[188:191], v[64:79]
    ds_read_b64_tr_b16 a[232:233], v1 offset:17024
    ds_read_b64_tr_b16 a[234:235], v1 offset:17536
    v_accvgpr_write_b32 a147, v13
    v_mfma_f32_32x32x16_bf16 v[80:95], a[244:247], v[188:191], v[80:95]
    ds_read_b64_tr_b16 a[236:237], v1 offset:17088
    ds_read_b64_tr_b16 a[238:239], v1 offset:17600
    buffer_load_dwordx4 v16, s[8:11], s93 offen offset:2112 nt lds
    v_exp_f32 v26, v142
    v_exp_f32 v27, v143
    v_accvgpr_read_b32 v13, a40
    v_accvgpr_read_b32 v14, a41
    s_waitcnt lgkmcnt(8)
    v_mfma_f32_32x32x16_bf16 v[96:111], a[248:251], v[188:191], v[96:111]
    ds_read_b64_tr_b16 a[240:241], v1 offset:25344
    ds_read_b64_tr_b16 a[242:243], v1 offset:25856
    v_add_f32 v28, v28, v26
    v_cvt_pk_bf16_f32 v183, v26, v27
    v_add_f32 v29, v29, v27
    v_cvt_pk_bf16_f32 v13, v13, v14
    v_mfma_f32_32x32x16_bf16 v[112:127], a[252:255], v[188:191], v[112:127]
    ds_read_b64_tr_b16 a[244:245], v1 offset:25408
    ds_read_b64_tr_b16 a[246:247], v1 offset:25920
    buffer_load_dwordx4 v18, s[4:7], s95 offen offset:3136 nt lds
    v_add_f32 v28, v28, v29
    v_cmp_nge_f32 vcc, s32, v28
    s_cbranch_vccnz L_rs46
L_back46:
    v_add_f32 v22, v22, v28
    v_accvgpr_write_b32 a148, v13
    s_waitcnt lgkmcnt(8)
    v_mfma_f32_32x32x16_bf16 a[64:79], a[224:227], v[48:51], a[64:79]
    ds_read_b64_tr_b16 a[248:249], v1 offset:25472
    ds_read_b64_tr_b16 a[250:251], v1 offset:25984
    v_exp_f32 v24, v144
    v_exp_f32 v25, v145
    v_accvgpr_read_b32 v13, a42
    v_accvgpr_read_b32 v14, a43
    v_mfma_f32_32x32x16_bf16 a[80:95], a[228:231], v[48:51], a[80:95]
    ds_read_b64_tr_b16 a[252:253], v1 offset:25536
    ds_read_b64_tr_b16 a[254:255], v1 offset:26048
    v_cvt_pk_bf16_f32 v184, v24, v25
    v_add_f32 v28, v24, v25
    v_cvt_pk_bf16_f32 v13, v13, v14
    s_waitcnt lgkmcnt(8)
    v_mfma_f32_32x32x16_bf16 a[96:111], a[232:235], v[48:51], a[96:111]
    ds_read_b64_tr_b16 a[224:225], v1 offset:17920
    ds_read_b64_tr_b16 a[226:227], v1 offset:18432
    v_accvgpr_write_b32 a149, v13
    v_accvgpr_read_b32 v13, a44
    v_mfma_f32_32x32x16_bf16 a[112:127], a[236:239], v[48:51], a[112:127]
    ds_read_b64_tr_b16 a[228:229], v1 offset:17984
    ds_read_b64_tr_b16 a[230:231], v1 offset:18496
    v_exp_f32 v26, v146
    v_exp_f32 v27, v147
    v_accvgpr_read_b32 v14, a45
    s_waitcnt lgkmcnt(8)
    v_mfma_f32_32x32x16_bf16 a[64:79], a[240:243], v[52:55], a[64:79]
    ds_read_b64_tr_b16 a[232:233], v1 offset:18048
    ds_read_b64_tr_b16 a[234:235], v1 offset:18560
    v_cvt_pk_bf16_f32 v185, v26, v27
    v_add_f32 v29, v26, v27
    v_cvt_pk_bf16_f32 v13, v13, v14
    v_mfma_f32_32x32x16_bf16 a[80:95], a[244:247], v[52:55], a[80:95]
    ds_read_b64_tr_b16 a[236:237], v1 offset:18112
    ds_read_b64_tr_b16 a[238:239], v1 offset:18624
    v_accvgpr_write_b32 a150, v13
    v_accvgpr_read_b32 v13, a46
    s_waitcnt lgkmcnt(8)
    v_mfma_f32_32x32x16_bf16 a[96:111], a[248:251], v[52:55], a[96:111]
    ds_read_b64_tr_b16 a[240:241], v1 offset:26368
    ds_read_b64_tr_b16 a[242:243], v1 offset:26880
    v_exp_f32 v24, v148
    v_exp_f32 v25, v149
    v_accvgpr_read_b32 v14, a47
    v_mfma_f32_32x32x16_bf16 a[112:127], a[252:255], v[52:55], a[112:127]
    ds_read_b64_tr_b16 a[244:245], v1 offset:26432
    ds_read_b64_tr_b16 a[246:247], v1 offset:26944
    v_add_f32 v28, v28, v24
    v_cvt_pk_bf16_f32 v186, v24, v25
    v_add_f32 v29, v29, v25
    v_cvt_pk_bf16_f32 v13, v13, v14
    s_waitcnt lgkmcnt(8)
    v_mfma_f32_32x32x16_bf16 a[64:79], a[224:227], v[56:59], a[64:79]
    ds_read_b64_tr_b16 a[248:249], v1 offset:26496
    ds_read_b64_tr_b16 a[250:251], v1 offset:27008
    s_waitcnt vmcnt(24)
    s_barrier
    s_add_u32 m0, s24, 0
    s_mov_b32 s29, 82432
    s_mov_b32 s30, 122368
    v_accvgpr_write_b32 a151, v13
    v_accvgpr_read_b32 v13, a48
    v_mfma_f32_32x32x16_bf16 a[80:95], a[228:231], v[56:59], a[80:95]
    ds_read_b64_tr_b16 a[252:253], v1 offset:26560
    ds_read_b64_tr_b16 a[254:255], v1 offset:27072
    buffer_load_dwordx4 v19, s[16:19], s29 offen nt lds
    v_exp_f32 v26, v150
    v_exp_f32 v27, v151
    v_accvgpr_read_b32 v14, a49
    s_waitcnt lgkmcnt(8)
    v_mfma_f32_32x32x16_bf16 a[96:111], a[232:235], v[56:59], a[96:111]
    ds_read_b64_tr_b16 a[224:225], v4 offset:33792
    ds_read_b64_tr_b16 a[226:227], v4 offset:34304
    v_add_f32 v28, v28, v26
    v_cvt_pk_bf16_f32 v187, v26, v27
    v_add_f32 v29, v29, v27
    v_cvt_pk_bf16_f32 v13, v13, v14
    v_accvgpr_write_b32 a152, v13
    v_mfma_f32_32x32x16_bf16 a[112:127], a[236:239], v[56:59], a[112:127]
    ds_read_b64_tr_b16 a[228:229], v4 offset:33856
    ds_read_b64_tr_b16 a[230:231], v4 offset:34368
    buffer_load_dwordx4 v19, s[16:19], s30 offen offset:1024 nt lds
    v_accvgpr_read_b32 v13, a50
    s_waitcnt lgkmcnt(8)
    v_mfma_f32_32x32x16_bf16 a[64:79], a[240:243], v[60:63], a[64:79]
    ds_read_b64_tr_b16 a[232:233], v4 offset:33920
    ds_read_b64_tr_b16 a[234:235], v4 offset:34432
    v_exp_f32 v24, v152
    v_exp_f32 v25, v153
    v_accvgpr_read_b32 v14, a51
    v_mfma_f32_32x32x16_bf16 a[80:95], a[244:247], v[60:63], a[80:95]
    ds_read_b64_tr_b16 a[236:237], v4 offset:33984
    ds_read_b64_tr_b16 a[238:239], v4 offset:34496
    buffer_load_dwordx4 v20, s[16:19], s29 offen offset:2112 nt lds
    v_add_f32 v28, v28, v24
    v_cvt_pk_bf16_f32 v188, v24, v25
    v_add_f32 v29, v29, v25
    v_cvt_pk_bf16_f32 v13, v13, v14
    v_accvgpr_write_b32 a153, v13
    s_waitcnt lgkmcnt(8)
    v_mfma_f32_32x32x16_bf16 a[96:111], a[248:251], v[60:63], a[96:111]
    ds_read_b64_tr_b16 a[240:241], v4 offset:42240
    ds_read_b64_tr_b16 a[242:243], v4 offset:42752
    v_accvgpr_read_b32 v13, a52
    v_mfma_f32_32x32x16_bf16 a[112:127], a[252:255], v[60:63], a[112:127]
    ds_read_b64_tr_b16 a[244:245], v4 offset:42304
    ds_read_b64_tr_b16 a[246:247], v4 offset:42816
    buffer_load_dwordx4 v20, s[16:19], s30 offen offset:3136 nt lds
    v_exp_f32 v26, v154
    v_exp_f32 v27, v155
    v_accvgpr_read_b32 v14, a53
    s_waitcnt lgkmcnt(8)
    v_mfma_f32_32x32x16_bf16 v[64:79], a[224:227], v[176:179], v[64:79]
    ds_read_b64_tr_b16 a[248:249], v4 offset:42368
    ds_read_b64_tr_b16 a[250:251], v4 offset:42880
    v_add_f32 v28, v28, v26
    v_cvt_pk_bf16_f32 v189, v26, v27
    v_add_f32 v29, v29, v27
    v_cvt_pk_bf16_f32 v13, v13, v14
    v_accvgpr_write_b32 a154, v13
    v_mfma_f32_32x32x16_bf16 v[80:95], a[228:231], v[176:179], v[80:95]
    ds_read_b64_tr_b16 a[252:253], v4 offset:42432
    ds_read_b64_tr_b16 a[254:255], v4 offset:42944
    v_accvgpr_read_b32 v13, a54
    s_waitcnt lgkmcnt(8)
    v_mfma_f32_32x32x16_bf16 v[96:111], a[232:235], v[176:179], v[96:111]
    ds_read_b64_tr_b16 a[224:225], v4 offset:34816
    ds_read_b64_tr_b16 a[226:227], v4 offset:35328
    v_exp_f32 v24, v156
    v_exp_f32 v25, v157
    v_accvgpr_read_b32 v14, a55
    v_cvt_pk_bf16_f32 v13, v13, v14
    v_mfma_f32_32x32x16_bf16 v[112:127], a[236:239], v[176:179], v[112:127]
    ds_read_b64_tr_b16 a[228:229], v4 offset:34880
    ds_read_b64_tr_b16 a[230:231], v4 offset:35392
    v_add_f32 v28, v28, v24
    v_cvt_pk_bf16_f32 v190, v24, v25
    v_add_f32 v29, v29, v25
    v_accvgpr_write_b32 a155, v13
    s_waitcnt lgkmcnt(8)
    v_mfma_f32_32x32x16_bf16 v[64:79], a[240:243], v[180:183], v[64:79]
    ds_read_b64_tr_b16 a[232:233], v4 offset:34944
    ds_read_b64_tr_b16 a[234:235], v4 offset:35456
    v_accvgpr_read_b32 v13, a56
    v_mfma_f32_32x32x16_bf16 v[80:95], a[244:247], v[180:183], v[80:95]
    ds_read_b64_tr_b16 a[236:237], v4 offset:35008
    ds_read_b64_tr_b16 a[238:239], v4 offset:35520
    v_exp_f32 v26, v158
    v_exp_f32 v27, v159
    v_accvgpr_read_b32 v14, a57
    v_cvt_pk_bf16_f32 v13, v13, v14
    s_waitcnt lgkmcnt(8)
    v_mfma_f32_32x32x16_bf16 v[96:111], a[248:251], v[180:183], v[96:111]
    ds_read_b64_tr_b16 a[240:241], v4 offset:43264
    ds_read_b64_tr_b16 a[242:243], v4 offset:43776
    v_add_f32 v28, v28, v26
    v_cvt_pk_bf16_f32 v191, v26, v27
    v_add_f32 v29, v29, v27
    v_accvgpr_write_b32 a156, v13
    v_mfma_f32_32x32x16_bf16 v[112:127], a[252:255], v[180:183], v[112:127]
    ds_read_b64_tr_b16 a[244:245], v4 offset:43328
    ds_read_b64_tr_b16 a[246:247], v4 offset:43840
    v_add_f32 v28, v28, v29
    v_cmp_nge_f32 vcc, s32, v28
    s_cbranch_vccnz L_rs47
L_back47:
    v_add_f32 v22, v22, v28
    v_accvgpr_read_b32 v13, a58
    s_waitcnt lgkmcnt(8)
    v_mfma_f32_32x32x16_bf16 v[64:79], a[224:227], v[184:187], v[64:79]
    ds_read_b64_tr_b16 a[248:249], v4 offset:43392
    ds_read_b64_tr_b16 a[250:251], v4 offset:43904
    s_waitcnt vmcnt(24)
    s_barrier
    s_add_u32 m0, s24, 16896
    s_mov_b32 s93, 409600
    s_mov_b32 s95, 424960
    v_accvgpr_read_b32 v14, a59
    v_cvt_pk_bf16_f32 v13, v13, v14
    v_mfma_f32_32x32x16_bf16 v[80:95], a[228:231], v[184:187], v[80:95]
    ds_read_b64_tr_b16 a[252:253], v4 offset:43456
    ds_read_b64_tr_b16 a[254:255], v4 offset:43968
    buffer_load_dwordx4 v15, s[8:11], s93 offen nt lds
    v_mov_b32 v31, v22
    v_accvgpr_write_b32 a157, v13
    s_waitcnt lgkmcnt(8)
    v_mfma_f32_32x32x16_bf16 v[96:111], a[232:235], v[184:187], v[96:111]
    ds_read_b64_tr_b16 a[224:225], v2 offset:0
    ds_read_b64_tr_b16 a[226:227], v2 offset:512
    v_permlane32_swap_b32 v22, v31
    v_accvgpr_read_b32 v13, a60
    v_accvgpr_read_b32 v14, a61
    v_mfma_f32_32x32x16_bf16 v[112:127], a[236:239], v[184:187], v[112:127]
    ds_read_b64_tr_b16 a[228:229], v2 offset:64
    ds_read_b64_tr_b16 a[230:231], v2 offset:576
    buffer_load_dwordx4 v17, s[4:7], s95 offen offset:1024 nt lds
    v_add_f32 v22, v22, v31
    v_cvt_pk_bf16_f32 v13, v13, v14
    s_waitcnt lgkmcnt(8)
    v_mfma_f32_32x32x16_bf16 v[64:79], a[240:243], v[188:191], v[64:79]
    ds_read_b64_tr_b16 a[232:233], v2 offset:128
    ds_read_b64_tr_b16 a[234:235], v2 offset:640
    v_rcp_f32 v23, v22
    v_accvgpr_write_b32 a158, v13
    v_mfma_f32_32x32x16_bf16 v[80:95], a[244:247], v[188:191], v[80:95]
    ds_read_b64_tr_b16 a[236:237], v2 offset:192
    ds_read_b64_tr_b16 a[238:239], v2 offset:704
    buffer_load_dwordx4 v16, s[8:11], s93 offen offset:2112 nt lds
    v_accvgpr_read_b32 v13, a62
    v_accvgpr_read_b32 v14, a63
    s_waitcnt lgkmcnt(8)
    v_mfma_f32_32x32x16_bf16 v[96:111], a[248:251], v[188:191], v[96:111]
    ds_read_b64_tr_b16 a[240:241], v2 offset:8448
    ds_read_b64_tr_b16 a[242:243], v2 offset:8960
    v_cvt_pk_bf16_f32 v13, v13, v14
    v_mfma_f32_32x32x16_bf16 v[112:127], a[252:255], v[188:191], v[112:127]
    ds_read_b64_tr_b16 a[244:245], v2 offset:8512
    ds_read_b64_tr_b16 a[246:247], v2 offset:9024
    buffer_load_dwordx4 v18, s[4:7], s95 offen offset:3136 nt lds
    v_accvgpr_write_b32 a159, v13
    s_waitcnt lgkmcnt(8)
    v_mfma_f32_32x32x16_bf16 a[64:79], a[224:227], a[160:163], a[64:79]
    ds_read_b64_tr_b16 a[248:249], v2 offset:8576
    ds_read_b64_tr_b16 a[250:251], v2 offset:9088
    v_mfma_f32_32x32x16_bf16 a[80:95], a[228:231], a[160:163], a[80:95]
    ds_read_b64_tr_b16 a[252:253], v2 offset:8640
    ds_read_b64_tr_b16 a[254:255], v2 offset:9152
    v_mul_f32 v64, v64, v23
    v_mul_f32 v65, v65, v23
    v_cvt_pk_bf16_f32 v64, v64, v65
    v_accvgpr_write_b32 a192, v64
    s_waitcnt lgkmcnt(8)
    v_mfma_f32_32x32x16_bf16 a[96:111], a[232:235], a[160:163], a[96:111]
    ds_read_b64_tr_b16 a[224:225], v2 offset:1024
    ds_read_b64_tr_b16 a[226:227], v2 offset:1536
    v_mul_f32 v66, v66, v23
    v_mul_f32 v67, v67, v23
    v_cvt_pk_bf16_f32 v66, v66, v67
    v_accvgpr_write_b32 a193, v66
    v_mfma_f32_32x32x16_bf16 a[112:127], a[236:239], a[160:163], a[112:127]
    ds_read_b64_tr_b16 a[228:229], v2 offset:1088
    ds_read_b64_tr_b16 a[230:231], v2 offset:1600
    v_mul_f32 v68, v68, v23
    v_mul_f32 v69, v69, v23
    v_cvt_pk_bf16_f32 v68, v68, v69
    v_accvgpr_write_b32 a194, v68
    s_waitcnt lgkmcnt(8)
    v_mfma_f32_32x32x16_bf16 a[64:79], a[240:243], a[164:167], a[64:79]
    ds_read_b64_tr_b16 a[232:233], v2 offset:1152
    ds_read_b64_tr_b16 a[234:235], v2 offset:1664
    v_mul_f32 v70, v70, v23
    v_mul_f32 v71, v71, v23
    v_cvt_pk_bf16_f32 v70, v70, v71
    v_accvgpr_write_b32 a195, v70
    v_mfma_f32_32x32x16_bf16 a[80:95], a[244:247], a[164:167], a[80:95]
    ds_read_b64_tr_b16 a[236:237], v2 offset:1216
    ds_read_b64_tr_b16 a[238:239], v2 offset:1728
    v_mul_f32 v72, v72, v23
    v_mul_f32 v73, v73, v23
    v_cvt_pk_bf16_f32 v72, v72, v73
    v_accvgpr_write_b32 a196, v72
    s_waitcnt lgkmcnt(8)
    v_mfma_f32_32x32x16_bf16 a[96:111], a[248:251], a[164:167], a[96:111]
    ds_read_b64_tr_b16 a[240:241], v2 offset:9472
    ds_read_b64_tr_b16 a[242:243], v2 offset:9984
    v_mul_f32 v74, v74, v23
    v_mul_f32 v75, v75, v23
    v_cvt_pk_bf16_f32 v74, v74, v75
    v_accvgpr_write_b32 a197, v74
    v_mfma_f32_32x32x16_bf16 a[112:127], a[252:255], a[164:167], a[112:127]
    ds_read_b64_tr_b16 a[244:245], v2 offset:9536
    ds_read_b64_tr_b16 a[246:247], v2 offset:10048
    v_mul_f32 v76, v76, v23
    v_mul_f32 v77, v77, v23
    v_cvt_pk_bf16_f32 v76, v76, v77
    s_waitcnt lgkmcnt(8)
    v_mfma_f32_32x32x16_bf16 a[64:79], a[224:227], a[168:171], a[64:79]
    ds_read_b64_tr_b16 a[248:249], v2 offset:9600
    ds_read_b64_tr_b16 a[250:251], v2 offset:10112
    s_waitcnt vmcnt(24)
    s_barrier
    s_add_u32 m0, s24, 33792
    s_mov_b32 s93, 417792
    s_mov_b32 s95, 433152
    v_accvgpr_write_b32 a198, v76
    v_mul_f32 v78, v78, v23
    v_mul_f32 v79, v79, v23
    v_cvt_pk_bf16_f32 v78, v78, v79
    v_mfma_f32_32x32x16_bf16 a[80:95], a[228:231], a[168:171], a[80:95]
    ds_read_b64_tr_b16 a[252:253], v2 offset:9664
    ds_read_b64_tr_b16 a[254:255], v2 offset:10176
    buffer_load_dwordx4 v15, s[8:11], s93 offen nt lds
    v_accvgpr_write_b32 a199, v78
    v_mul_f32 v80, v80, v23
    v_mul_f32 v81, v81, v23
    v_cvt_pk_bf16_f32 v80, v80, v81
    s_waitcnt lgkmcnt(8)
    v_mfma_f32_32x32x16_bf16 a[96:111], a[232:235], a[168:171], a[96:111]
    ds_read_b128 a[224:227], v8 offset:16896
    v_accvgpr_write_b32 a200, v80
    v_mul_f32 v82, v82, v23
    v_mul_f32 v83, v83, v23
    v_cvt_pk_bf16_f32 v82, v82, v83
    v_mfma_f32_32x32x16_bf16 a[112:127], a[236:239], a[168:171], a[112:127]
    ds_read_b128 a[228:231], v11 offset:16896
    buffer_load_dwordx4 v17, s[4:7], s95 offen offset:1024 nt lds
    v_accvgpr_write_b32 a201, v82
    v_mul_f32 v84, v84, v23
    v_mul_f32 v85, v85, v23
    v_cvt_pk_bf16_f32 v84, v84, v85
    s_waitcnt lgkmcnt(6)
    v_mfma_f32_32x32x16_bf16 a[64:79], a[240:243], a[172:175], a[64:79]
    ds_read_b128 a[232:235], v8 offset:16960
    v_accvgpr_write_b32 a202, v84
    v_mul_f32 v86, v86, v23
    v_mul_f32 v87, v87, v23
    v_cvt_pk_bf16_f32 v86, v86, v87
    v_mfma_f32_32x32x16_bf16 a[80:95], a[244:247], a[172:175], a[80:95]
    ds_read_b128 a[236:239], v11 offset:16960
    buffer_load_dwordx4 v16, s[8:11], s93 offen offset:2112 nt lds
    v_accvgpr_write_b32 a203, v86
    v_mul_f32 v88, v88, v23
    v_mul_f32 v89, v89, v23
    s_waitcnt lgkmcnt(4)
    v_mfma_f32_32x32x16_bf16 a[96:111], a[248:251], a[172:175], a[96:111]
    ds_read_b128 a[240:243], v8 offset:17024
    v_cvt_pk_bf16_f32 v88, v88, v89
    v_accvgpr_write_b32 a204, v88
    v_mul_f32 v90, v90, v23
    v_mul_f32 v91, v91, v23
    v_mfma_f32_32x32x16_bf16 a[112:127], a[252:255], a[172:175], a[112:127]
    ds_read_b128 a[244:247], v11 offset:17024
    buffer_load_dwordx4 v18, s[4:7], s95 offen offset:3136 nt lds
    v_cvt_pk_bf16_f32 v90, v90, v91
    v_accvgpr_write_b32 a205, v90
    v_mul_f32 v92, v92, v23
    v_mul_f32 v93, v93, v23
    s_waitcnt lgkmcnt(4)
    v_mfma_f32_32x32x16_bf16 v[128:143], a[224:227], v[192:195], 0
    ds_read_b128 a[248:251], v8 offset:17088
    v_cvt_pk_bf16_f32 v92, v92, v93
    v_accvgpr_write_b32 a206, v92
    v_mul_f32 v94, v94, v23
    v_mul_f32 v95, v95, v23
    v_mfma_f32_32x32x16_bf16 v[128:143], a[228:231], v[196:199], v[128:143]
    ds_read_b128 a[252:255], v11 offset:17088
    v_cvt_pk_bf16_f32 v94, v94, v95
    v_accvgpr_write_b32 a207, v94
    v_mul_f32 v96, v96, v23
    v_mul_f32 v97, v97, v23
    s_waitcnt lgkmcnt(4)
    v_mfma_f32_32x32x16_bf16 v[128:143], a[232:235], v[200:203], v[128:143]
    ds_read_b128 a[224:227], v8 offset:17920
    v_cvt_pk_bf16_f32 v96, v96, v97
    v_accvgpr_write_b32 a208, v96
    v_mul_f32 v98, v98, v23
    v_mul_f32 v99, v99, v23
    v_mfma_f32_32x32x16_bf16 v[128:143], a[236:239], v[204:207], v[128:143]
    ds_read_b128 a[228:231], v11 offset:17920
    v_cvt_pk_bf16_f32 v98, v98, v99
    v_accvgpr_write_b32 a209, v98
    v_mul_f32 v100, v100, v23
    s_waitcnt lgkmcnt(4)
    v_mfma_f32_32x32x16_bf16 v[128:143], a[240:243], v[208:211], v[128:143]
    ds_read_b128 a[232:235], v8 offset:17984
    v_mul_f32 v101, v101, v23
    v_cvt_pk_bf16_f32 v100, v100, v101
    v_accvgpr_write_b32 a210, v100
    v_mul_f32 v102, v102, v23
    v_mfma_f32_32x32x16_bf16 v[128:143], a[244:247], v[212:215], v[128:143]
    ds_read_b128 a[236:239], v11 offset:17984
    v_mul_f32 v103, v103, v23
    v_cvt_pk_bf16_f32 v102, v102, v103
    v_accvgpr_write_b32 a211, v102
    v_mul_f32 v104, v104, v23
    s_waitcnt lgkmcnt(4)
    v_mfma_f32_32x32x16_bf16 v[128:143], a[248:251], v[216:219], v[128:143]
    ds_read_b128 a[240:243], v8 offset:18048
    v_mul_f32 v105, v105, v23
    v_cvt_pk_bf16_f32 v104, v104, v105
    v_accvgpr_write_b32 a212, v104
    v_mul_f32 v106, v106, v23
    v_mfma_f32_32x32x16_bf16 v[128:143], a[252:255], v[220:223], v[128:143]
    ds_read_b128 a[244:247], v11 offset:18048
    v_mul_f32 v107, v107, v23
    v_cvt_pk_bf16_f32 v106, v106, v107
    v_accvgpr_write_b32 a213, v106
    v_mul_f32 v108, v108, v23
    s_waitcnt lgkmcnt(4)
    v_mfma_f32_32x32x16_bf16 v[144:159], a[224:227], v[192:195], 0
    ds_read_b128 a[248:251], v8 offset:18112
    s_waitcnt vmcnt(24)
    s_barrier
    s_add_u32 m0, s24, 50688
    s_mov_b32 s29, 164352
    s_mov_b32 s30, 204288
    v_mul_f32 v109, v109, v23
    v_cvt_pk_bf16_f32 v108, v108, v109
    v_accvgpr_write_b32 a214, v108
    v_mul_f32 v110, v110, v23
    v_mfma_f32_32x32x16_bf16 v[144:159], a[228:231], v[196:199], v[144:159]
    ds_read_b128 a[252:255], v11 offset:18112
    buffer_load_dwordx4 v19, s[16:19], s29 offen nt lds
    v_mul_f32 v111, v111, v23
    v_cvt_pk_bf16_f32 v110, v110, v111
    v_accvgpr_write_b32 a215, v110
    s_waitcnt lgkmcnt(4)
    v_mfma_f32_32x32x16_bf16 v[144:159], a[232:235], v[200:203], v[144:159]
    ds_read_b64_tr_b16 a[224:225], v2 offset:33792
    ds_read_b64_tr_b16 a[226:227], v2 offset:34304
    v_max3_f32 v30, v128, v129, v130
    v_max3_f32 v31, v131, v132, v133
    v_max3_f32 v30, v30, v134, v135
    v_max3_f32 v31, v31, v136, v137
    v_max3_f32 v30, v30, v138, v139
    v_max3_f32 v31, v31, v140, v141
    v_max3_f32 v30, v30, v142, v143
    v_mfma_f32_32x32x16_bf16 v[144:159], a[236:239], v[204:207], v[144:159]
    ds_read_b64_tr_b16 a[228:229], v2 offset:33856
    ds_read_b64_tr_b16 a[230:231], v2 offset:34368
    buffer_load_dwordx4 v19, s[16:19], s30 offen offset:1024 nt lds
    v_max_f32 v30, v30, v31
    v_mov_b32 v31, v30
    s_nop 1
    v_permlane32_swap_b32 v30, v31
    v_max_f32 v30, v30, v31
    v_sub_f32 v30, 0, v30
    v_add_f32 v128, v128, v30
    s_waitcnt lgkmcnt(6)
    v_mfma_f32_32x32x16_bf16 v[144:159], a[240:243], v[208:211], v[144:159]
    ds_read_b64_tr_b16 a[232:233], v2 offset:33920
    ds_read_b64_tr_b16 a[234:235], v2 offset:34432
    v_add_f32 v129, v129, v30
    v_add_f32 v130, v130, v30
    v_add_f32 v131, v131, v30
    v_add_f32 v132, v132, v30
    v_add_f32 v133, v133, v30
    v_add_f32 v134, v134, v30
    v_mfma_f32_32x32x16_bf16 v[144:159], a[244:247], v[212:215], v[144:159]
    ds_read_b64_tr_b16 a[236:237], v2 offset:33984
    ds_read_b64_tr_b16 a[238:239], v2 offset:34496
    buffer_load_dwordx4 v20, s[16:19], s29 offen offset:2112 nt lds
    v_add_f32 v135, v135, v30
    v_add_f32 v136, v136, v30
    v_add_f32 v137, v137, v30
    v_add_f32 v138, v138, v30
    v_add_f32 v139, v139, v30
    v_add_f32 v140, v140, v30
    s_waitcnt lgkmcnt(8)
    v_mfma_f32_32x32x16_bf16 v[144:159], a[248:251], v[216:219], v[144:159]
    ds_read_b64_tr_b16 a[240:241], v2 offset:42240
    ds_read_b64_tr_b16 a[242:243], v2 offset:42752
    v_add_f32 v141, v141, v30
    v_add_f32 v142, v142, v30
    v_add_f32 v143, v143, v30
    v_exp_f32 v24, v128
    v_exp_f32 v25, v129
    s_nop 0
    v_cvt_pk_bf16_f32 v176, v24, v25
    v_mfma_f32_32x32x16_bf16 v[144:159], a[252:255], v[220:223], v[144:159]
    ds_read_b64_tr_b16 a[244:245], v2 offset:42304
    ds_read_b64_tr_b16 a[246:247], v2 offset:42816
    buffer_load_dwordx4 v20, s[16:19], s30 offen offset:3136 nt lds
    v_add_f32 v28, v24, v25
    v_exp_f32 v26, v130
    v_exp_f32 v27, v131
    s_nop 0
    v_cvt_pk_bf16_f32 v177, v26, v27
    v_add_f32 v29, v26, v27
    v_exp_f32 v24, v132
    v_exp_f32 v25, v133
    s_waitcnt lgkmcnt(8)
    v_mfma_f32_32x32x16_bf16 a[64:79], a[224:227], a[176:179], a[64:79]
    ds_read_b64_tr_b16 a[248:249], v2 offset:42368
    ds_read_b64_tr_b16 a[250:251], v2 offset:42880
    v_add_f32 v28, v28, v24
    v_cvt_pk_bf16_f32 v178, v24, v25
    v_add_f32 v29, v29, v25
    v_exp_f32 v26, v134
    v_exp_f32 v27, v135
    v_add_f32 v28, v28, v26
    v_mfma_f32_32x32x16_bf16 a[80:95], a[228:231], a[176:179], a[80:95]
    ds_read_b64_tr_b16 a[252:253], v2 offset:42432
    ds_read_b64_tr_b16 a[254:255], v2 offset:42944
    v_cvt_pk_bf16_f32 v179, v26, v27
    v_add_f32 v29, v29, v27
    v_exp_f32 v24, v136
    v_exp_f32 v25, v137
    v_add_f32 v28, v28, v24
    v_cvt_pk_bf16_f32 v180, v24, v25
    s_waitcnt lgkmcnt(8)
    v_mfma_f32_32x32x16_bf16 a[96:111], a[232:235], a[176:179], a[96:111]
    ds_read_b64_tr_b16 a[224:225], v2 offset:34816
    ds_read_b64_tr_b16 a[226:227], v2 offset:35328
    v_add_f32 v29, v29, v25
    v_exp_f32 v26, v138
    v_exp_f32 v27, v139
    v_add_f32 v28, v28, v26
    v_cvt_pk_bf16_f32 v181, v26, v27
    v_add_f32 v29, v29, v27
    v_mfma_f32_32x32x16_bf16 a[112:127], a[236:239], a[176:179], a[112:127]
    ds_read_b64_tr_b16 a[228:229], v2 offset:34880
    ds_read_b64_tr_b16 a[230:231], v2 offset:35392
    v_exp_f32 v24, v140
    v_exp_f32 v25, v141
    v_add_f32 v28, v28, v24
    v_cvt_pk_bf16_f32 v182, v24, v25
    v_add_f32 v29, v29, v25
    v_exp_f32 v26, v142
    s_waitcnt lgkmcnt(8)
    v_mfma_f32_32x32x16_bf16 a[64:79], a[240:243], a[180:183], a[64:79]
    ds_read_b64_tr_b16 a[232:233], v2 offset:34944
    ds_read_b64_tr_b16 a[234:235], v2 offset:35456
    v_exp_f32 v27, v143
    v_add_f32 v28, v28, v26
    v_cvt_pk_bf16_f32 v183, v26, v27
    v_add_f32 v29, v29, v27
    v_add_f32 v22, v28, v29
    v_mov_b32 v160, v30
    v_mov_b32 v161, v30
    v_mfma_f32_32x32x16_bf16 a[80:95], a[244:247], a[180:183], a[80:95]
    ds_read_b64_tr_b16 a[236:237], v2 offset:35008
    ds_read_b64_tr_b16 a[238:239], v2 offset:35520
    v_mov_b32 v162, v30
    v_mov_b32 v163, v30
    v_mov_b32 v164, v30
    v_mov_b32 v165, v30
    v_mov_b32 v166, v30
    v_mov_b32 v167, v30
    s_waitcnt lgkmcnt(8)
    v_mfma_f32_32x32x16_bf16 a[96:111], a[248:251], a[180:183], a[96:111]
    ds_read_b64_tr_b16 a[240:241], v2 offset:43264
    ds_read_b64_tr_b16 a[242:243], v2 offset:43776
    v_mov_b32 v168, v30
    v_mov_b32 v169, v30
    v_mov_b32 v170, v30
    v_mov_b32 v171, v30
    v_mov_b32 v172, v30
    v_mov_b32 v173, v30
    v_mfma_f32_32x32x16_bf16 a[112:127], a[252:255], a[180:183], a[112:127]
    ds_read_b64_tr_b16 a[244:245], v2 offset:43328
    ds_read_b64_tr_b16 a[246:247], v2 offset:43840
    v_mov_b32 v174, v30
    v_mov_b32 v175, v30
    v_add_f32 v144, v144, v30
    v_add_f32 v145, v145, v30
    v_add_f32 v146, v146, v30
    v_add_f32 v147, v147, v30
    s_waitcnt lgkmcnt(8)
    v_mfma_f32_32x32x16_bf16 a[64:79], a[224:227], a[184:187], a[64:79]
    ds_read_b64_tr_b16 a[248:249], v2 offset:43392
    ds_read_b64_tr_b16 a[250:251], v2 offset:43904
    s_waitcnt vmcnt(24)
    s_barrier
    s_add_u32 m0, s24, 67584
    s_mov_b32 s93, 425984
    s_mov_b32 s95, 441344
    v_add_f32 v148, v148, v30
    v_add_f32 v149, v149, v30
    v_add_f32 v150, v150, v30
    v_add_f32 v151, v151, v30
    v_add_f32 v152, v152, v30
    v_add_f32 v153, v153, v30
    v_mfma_f32_32x32x16_bf16 a[80:95], a[228:231], a[184:187], a[80:95]
    ds_read_b64_tr_b16 a[252:253], v2 offset:43456
    ds_read_b64_tr_b16 a[254:255], v2 offset:43968
    buffer_load_dwordx4 v15, s[8:11], s93 offen nt lds
    v_add_f32 v154, v154, v30
    v_add_f32 v155, v155, v30
    v_add_f32 v156, v156, v30
    v_add_f32 v157, v157, v30
    v_add_f32 v158, v158, v30
    v_add_f32 v159, v159, v30
    s_waitcnt lgkmcnt(8)
    v_mfma_f32_32x32x16_bf16 a[96:111], a[232:235], a[184:187], a[96:111]
    ds_read_b128 a[224:227], v9 offset:1024
    v_mul_f32 v112, v112, v23
    v_mul_f32 v113, v113, v23
    v_cvt_pk_bf16_f32 v112, v112, v113
    v_accvgpr_write_b32 a216, v112
    v_mul_f32 v114, v114, v23
    v_mul_f32 v115, v115, v23
    v_mfma_f32_32x32x16_bf16 a[112:127], a[236:239], a[184:187], a[112:127]
    ds_read_b128 a[228:231], v12 offset:1024
    buffer_load_dwordx4 v17, s[4:7], s95 offen offset:1024 nt lds
    v_cvt_pk_bf16_f32 v114, v114, v115
    v_accvgpr_write_b32 a217, v114
    v_mul_f32 v116, v116, v23
    v_mul_f32 v117, v117, v23
    v_cvt_pk_bf16_f32 v116, v116, v117
    s_waitcnt lgkmcnt(6)
    v_mfma_f32_32x32x16_bf16 a[64:79], a[240:243], a[188:191], a[64:79]
    ds_read_b128 a[232:235], v9 offset:1088
    v_accvgpr_write_b32 a218, v116
    v_mul_f32 v118, v118, v23
    v_mul_f32 v119, v119, v23
    v_cvt_pk_bf16_f32 v118, v118, v119
    v_accvgpr_write_b32 a219, v118
    v_mfma_f32_32x32x16_bf16 a[80:95], a[244:247], a[188:191], a[80:95]
    ds_read_b128 a[236:239], v12 offset:1088
    buffer_load_dwordx4 v16, s[8:11], s93 offen offset:2112 nt lds
    v_mul_f32 v120, v120, v23
    v_mul_f32 v121, v121, v23
    v_cvt_pk_bf16_f32 v120, v120, v121
    v_accvgpr_write_b32 a220, v120
    v_mul_f32 v122, v122, v23
    v_mul_f32 v123, v123, v23
    s_waitcnt lgkmcnt(4)
    v_mfma_f32_32x32x16_bf16 a[96:111], a[248:251], a[188:191], a[96:111]
    ds_read_b128 a[240:243], v9 offset:1152
    v_cvt_pk_bf16_f32 v122, v122, v123
    v_accvgpr_write_b32 a221, v122
    v_mul_f32 v124, v124, v23
    v_mul_f32 v125, v125, v23
    v_cvt_pk_bf16_f32 v124, v124, v125
    v_mfma_f32_32x32x16_bf16 a[112:127], a[252:255], a[188:191], a[112:127]
    ds_read_b128 a[244:247], v12 offset:1152
    buffer_load_dwordx4 v18, s[4:7], s95 offen offset:3136 nt lds
    v_accvgpr_write_b32 a222, v124
    v_mul_f32 v126, v126, v23
    v_mul_f32 v127, v127, v23
    v_cvt_pk_bf16_f32 v126, v126, v127
    v_accvgpr_write_b32 a223, v126
    s_waitcnt lgkmcnt(4)
    v_mfma_f32_32x32x16_bf16 v[128:143], a[224:227], v[192:195], v[160:175]
    ds_read_b128 a[248:251], v9 offset:1216
    v_exp_f32 v24, v144
    v_exp_f32 v25, v145
    v_mfma_f32_32x32x16_bf16 v[128:143], a[228:231], v[196:199], v[128:143]
    ds_read_b128 a[252:255], v12 offset:1216
    v_cvt_pk_bf16_f32 v184, v24, v25
    v_add_f32 v28, v24, v25
    s_waitcnt lgkmcnt(4)
    v_mfma_f32_32x32x16_bf16 v[128:143], a[232:235], v[200:203], v[128:143]
    ds_read_b64_tr_b16 a[224:225], v6 offset:0
    ds_read_b64_tr_b16 a[226:227], v6 offset:512
    v_mfma_f32_32x32x16_bf16 v[128:143], a[236:239], v[204:207], v[128:143]
    ds_read_b64_tr_b16 a[228:229], v6 offset:64
    ds_read_b64_tr_b16 a[230:231], v6 offset:576
    v_exp_f32 v26, v146
    v_exp_f32 v27, v147
    s_waitcnt lgkmcnt(6)
    v_mfma_f32_32x32x16_bf16 v[128:143], a[240:243], v[208:211], v[128:143]
    ds_read_b64_tr_b16 a[232:233], v6 offset:128
    ds_read_b64_tr_b16 a[234:235], v6 offset:640
    v_cvt_pk_bf16_f32 v185, v26, v27
    v_add_f32 v29, v26, v27
    v_mfma_f32_32x32x16_bf16 v[128:143], a[244:247], v[212:215], v[128:143]
    ds_read_b64_tr_b16 a[236:237], v6 offset:192
    ds_read_b64_tr_b16 a[238:239], v6 offset:704
    s_waitcnt lgkmcnt(8)
    v_mfma_f32_32x32x16_bf16 v[128:143], a[248:251], v[216:219], v[128:143]
    ds_read_b64_tr_b16 a[240:241], v6 offset:8448
    ds_read_b64_tr_b16 a[242:243], v6 offset:8960
    v_exp_f32 v24, v148
    v_exp_f32 v25, v149
    v_mfma_f32_32x32x16_bf16 v[128:143], a[252:255], v[220:223], v[128:143]
    ds_read_b64_tr_b16 a[244:245], v6 offset:8512
    ds_read_b64_tr_b16 a[246:247], v6 offset:9024
    v_add_f32 v28, v28, v24
    v_cvt_pk_bf16_f32 v186, v24, v25
    v_add_f32 v29, v29, v25
    s_waitcnt lgkmcnt(8)
    v_mfma_f32_32x32x16_bf16 v[64:79], a[224:227], v[176:179], 0
    ds_read_b64_tr_b16 a[248:249], v6 offset:8576
    ds_read_b64_tr_b16 a[250:251], v6 offset:9088
    s_waitcnt vmcnt(24)
    s_barrier
    s_add_u32 m0, s24, 84480
    s_mov_b32 s29, 246272
    s_mov_b32 s30, 286208
    v_mfma_f32_32x32x16_bf16 v[80:95], a[228:231], v[176:179], 0
    ds_read_b64_tr_b16 a[252:253], v6 offset:8640
    ds_read_b64_tr_b16 a[254:255], v6 offset:9152
    buffer_load_dwordx4 v19, s[16:19], s29 offen nt lds
    v_exp_f32 v26, v150
    v_exp_f32 v27, v151
    s_waitcnt lgkmcnt(8)
    v_mfma_f32_32x32x16_bf16 v[96:111], a[232:235], v[176:179], 0
    ds_read_b64_tr_b16 a[224:225], v3 offset:16896
    ds_read_b64_tr_b16 a[226:227], v3 offset:17408
    v_add_f32 v28, v28, v26
    v_cvt_pk_bf16_f32 v187, v26, v27
    v_add_f32 v29, v29, v27
    v_mfma_f32_32x32x16_bf16 v[112:127], a[236:239], v[176:179], 0
    ds_read_b64_tr_b16 a[228:229], v3 offset:16960
    ds_read_b64_tr_b16 a[230:231], v3 offset:17472
    buffer_load_dwordx4 v19, s[16:19], s30 offen offset:1024 nt lds
    s_waitcnt lgkmcnt(8)
    v_mfma_f32_32x32x16_bf16 v[64:79], a[240:243], v[180:183], v[64:79]
    ds_read_b64_tr_b16 a[232:233], v3 offset:17024
    ds_read_b64_tr_b16 a[234:235], v3 offset:17536
    v_exp_f32 v24, v152
    v_exp_f32 v25, v153
    v_mfma_f32_32x32x16_bf16 v[80:95], a[244:247], v[180:183], v[80:95]
    ds_read_b64_tr_b16 a[236:237], v3 offset:17088
    ds_read_b64_tr_b16 a[238:239], v3 offset:17600
    buffer_load_dwordx4 v20, s[16:19], s29 offen offset:2112 nt lds
    v_add_f32 v28, v28, v24
    v_cvt_pk_bf16_f32 v188, v24, v25
    v_add_f32 v29, v29, v25
    s_waitcnt lgkmcnt(8)
    v_mfma_f32_32x32x16_bf16 v[96:111], a[248:251], v[180:183], v[96:111]
    ds_read_b64_tr_b16 a[240:241], v3 offset:25344
    ds_read_b64_tr_b16 a[242:243], v3 offset:25856
    v_mfma_f32_32x32x16_bf16 v[112:127], a[252:255], v[180:183], v[112:127]
    ds_read_b64_tr_b16 a[244:245], v3 offset:25408
    ds_read_b64_tr_b16 a[246:247], v3 offset:25920
    buffer_load_dwordx4 v20, s[16:19], s30 offen offset:3136 nt lds
    v_exp_f32 v26, v154
    v_exp_f32 v27, v155
    s_waitcnt lgkmcnt(8)
    v_mfma_f32_32x32x16_bf16 a[0:15], a[224:227], v[32:35], 0
    ds_read_b64_tr_b16 a[248:249], v3 offset:25472
    ds_read_b64_tr_b16 a[250:251], v3 offset:25984
    v_add_f32 v28, v28, v26
    v_cvt_pk_bf16_f32 v189, v26, v27
    v_add_f32 v29, v29, v27
    v_accvgpr_read_b32 v13, a64
    v_mfma_f32_32x32x16_bf16 a[16:31], a[228:231], v[32:35], 0
    ds_read_b64_tr_b16 a[252:253], v3 offset:25536
    ds_read_b64_tr_b16 a[254:255], v3 offset:26048
    v_accvgpr_read_b32 v14, a65
    s_waitcnt lgkmcnt(8)
    v_mfma_f32_32x32x16_bf16 a[32:47], a[232:235], v[32:35], 0
    ds_read_b64_tr_b16 a[224:225], v3 offset:17920
    ds_read_b64_tr_b16 a[226:227], v3 offset:18432
    v_exp_f32 v24, v156
    v_exp_f32 v25, v157
    v_cvt_pk_bf16_f32 v224, v13, v14
    v_mfma_f32_32x32x16_bf16 a[48:63], a[236:239], v[32:35], 0
    ds_read_b64_tr_b16 a[228:229], v3 offset:17984
    ds_read_b64_tr_b16 a[230:231], v3 offset:18496
    v_add_f32 v28, v28, v24
    v_cvt_pk_bf16_f32 v190, v24, v25
    v_add_f32 v29, v29, v25
    s_waitcnt lgkmcnt(8)
    v_mfma_f32_32x32x16_bf16 a[0:15], a[240:243], v[36:39], a[0:15]
    ds_read_b64_tr_b16 a[232:233], v3 offset:18048
    ds_read_b64_tr_b16 a[234:235], v3 offset:18560
    v_accvgpr_read_b32 v13, a66
    v_mfma_f32_32x32x16_bf16 a[16:31], a[244:247], v[36:39], a[16:31]
    ds_read_b64_tr_b16 a[236:237], v3 offset:18112
    ds_read_b64_tr_b16 a[238:239], v3 offset:18624
    v_exp_f32 v26, v158
    v_exp_f32 v27, v159
    v_accvgpr_read_b32 v14, a67
    s_waitcnt lgkmcnt(8)
    v_mfma_f32_32x32x16_bf16 a[32:47], a[248:251], v[36:39], a[32:47]
    ds_read_b64_tr_b16 a[240:241], v3 offset:26368
    ds_read_b64_tr_b16 a[242:243], v3 offset:26880
    v_add_f32 v28, v28, v26
    v_cvt_pk_bf16_f32 v191, v26, v27
    v_add_f32 v29, v29, v27
    v_mfma_f32_32x32x16_bf16 a[48:63], a[252:255], v[36:39], a[48:63]
    ds_read_b64_tr_b16 a[244:245], v3 offset:26432
    ds_read_b64_tr_b16 a[246:247], v3 offset:26944
    v_add_f32 v28, v28, v29
    v_cmp_nge_f32 vcc, s32, v28
    s_cbranch_vccnz L_rs49
L_back49:
    v_add_f32 v22, v22, v28
    v_cvt_pk_bf16_f32 v225, v13, v14
    s_waitcnt lgkmcnt(8)
    v_mfma_f32_32x32x16_bf16 a[0:15], a[224:227], v[40:43], a[0:15]
    ds_read_b64_tr_b16 a[248:249], v3 offset:26496
    ds_read_b64_tr_b16 a[250:251], v3 offset:27008
    s_waitcnt vmcnt(24)
    s_barrier
    s_add_u32 m0, s24, 101376
    s_mov_b32 s93, 434176
    s_mov_b32 s95, 449536
    v_exp_f32 v24, v128
    v_exp_f32 v25, v129
    v_accvgpr_read_b32 v13, a68
    v_mfma_f32_32x32x16_bf16 a[16:31], a[228:231], v[40:43], a[16:31]
    ds_read_b64_tr_b16 a[252:253], v3 offset:26560
    ds_read_b64_tr_b16 a[254:255], v3 offset:27072
    buffer_load_dwordx4 v15, s[8:11], s93 offen nt lds
    s_waitcnt lgkmcnt(8)
    v_mfma_f32_32x32x16_bf16 a[32:47], a[232:235], v[40:43], a[32:47]
    ds_read_b128 a[224:227], v9 offset:34816
    v_cvt_pk_bf16_f32 v176, v24, v25
    v_add_f32 v28, v24, v25
    v_accvgpr_read_b32 v14, a69
    v_mfma_f32_32x32x16_bf16 a[48:63], a[236:239], v[40:43], a[48:63]
    ds_read_b128 a[228:231], v12 offset:34816
    buffer_load_dwordx4 v17, s[4:7], s95 offen offset:1024 nt lds
    v_cvt_pk_bf16_f32 v226, v13, v14
    s_waitcnt lgkmcnt(6)
    v_mfma_f32_32x32x16_bf16 a[0:15], a[240:243], v[44:47], a[0:15]
    ds_read_b128 a[232:235], v9 offset:34880
    v_exp_f32 v26, v130
    v_exp_f32 v27, v131
    v_mfma_f32_32x32x16_bf16 a[16:31], a[244:247], v[44:47], a[16:31]
    ds_read_b128 a[236:239], v12 offset:34880
    buffer_load_dwordx4 v16, s[8:11], s93 offen offset:2112 nt lds
    v_accvgpr_read_b32 v13, a70
    s_waitcnt lgkmcnt(4)
    v_mfma_f32_32x32x16_bf16 a[32:47], a[248:251], v[44:47], a[32:47]
    ds_read_b128 a[240:243], v9 offset:34944
    v_cvt_pk_bf16_f32 v177, v26, v27
    v_add_f32 v29, v26, v27
    v_accvgpr_read_b32 v14, a71
    v_mfma_f32_32x32x16_bf16 a[48:63], a[252:255], v[44:47], a[48:63]
    ds_read_b128 a[244:247], v12 offset:34944
    buffer_load_dwordx4 v18, s[4:7], s95 offen offset:3136 nt lds
    s_waitcnt lgkmcnt(4)
    v_mfma_f32_32x32x16_bf16 v[144:159], a[224:227], v[192:195], v[160:175]
    ds_read_b128 a[248:251], v9 offset:35008
    v_exp_f32 v24, v132
    v_exp_f32 v25, v133
    v_cvt_pk_bf16_f32 v227, v13, v14
    v_mfma_f32_32x32x16_bf16 v[144:159], a[228:231], v[196:199], v[144:159]
    ds_read_b128 a[252:255], v12 offset:35008
    v_accvgpr_read_b32 v13, a72
    s_waitcnt lgkmcnt(4)
    v_mfma_f32_32x32x16_bf16 v[144:159], a[232:235], v[200:203], v[144:159]
    ds_read_b64_tr_b16 a[224:225], v6 offset:33792
    ds_read_b64_tr_b16 a[226:227], v6 offset:34304
    v_add_f32 v28, v28, v24
    v_cvt_pk_bf16_f32 v178, v24, v25
    v_add_f32 v29, v29, v25
    v_mfma_f32_32x32x16_bf16 v[144:159], a[236:239], v[204:207], v[144:159]
    ds_read_b64_tr_b16 a[228:229], v6 offset:33856
    ds_read_b64_tr_b16 a[230:231], v6 offset:34368
    v_accvgpr_read_b32 v14, a73
    s_waitcnt lgkmcnt(6)
    v_mfma_f32_32x32x16_bf16 v[144:159], a[240:243], v[208:211], v[144:159]
    ds_read_b64_tr_b16 a[232:233], v6 offset:33920
    ds_read_b64_tr_b16 a[234:235], v6 offset:34432
    v_exp_f32 v26, v134
    v_exp_f32 v27, v135
    v_cvt_pk_bf16_f32 v228, v13, v14
    v_mfma_f32_32x32x16_bf16 v[144:159], a[244:247], v[212:215], v[144:159]
    ds_read_b64_tr_b16 a[236:237], v6 offset:33984
    ds_read_b64_tr_b16 a[238:239], v6 offset:34496
    s_waitcnt lgkmcnt(8)
    v_mfma_f32_32x32x16_bf16 v[144:159], a[248:251], v[216:219], v[144:159]
    ds_read_b64_tr_b16 a[240:241], v6 offset:42240
    ds_read_b64_tr_b16 a[242:243], v6 offset:42752
    v_add_f32 v28, v28, v26
    v_cvt_pk_bf16_f32 v179, v26, v27
    v_add_f32 v29, v29, v27
    v_accvgpr_read_b32 v13, a74
    v_mfma_f32_32x32x16_bf16 v[144:159], a[252:255], v[220:223], v[144:159]
    ds_read_b64_tr_b16 a[244:245], v6 offset:42304
    ds_read_b64_tr_b16 a[246:247], v6 offset:42816
    v_accvgpr_read_b32 v14, a75
    s_waitcnt lgkmcnt(8)
    v_mfma_f32_32x32x16_bf16 v[64:79], a[224:227], v[184:187], v[64:79]
    ds_read_b64_tr_b16 a[248:249], v6 offset:42368
    ds_read_b64_tr_b16 a[250:251], v6 offset:42880
    s_waitcnt vmcnt(24)
    s_barrier
    s_add_u32 m0, s24, 118272
    s_mov_b32 s29, 768
    s_mov_b32 s30, 40704
    v_exp_f32 v24, v136
    v_exp_f32 v25, v137
    v_mfma_f32_32x32x16_bf16 v[80:95], a[228:231], v[184:187], v[80:95]
    ds_read_b64_tr_b16 a[252:253], v6 offset:42432
    ds_read_b64_tr_b16 a[254:255], v6 offset:42944
    buffer_load_dwordx4 v19, s[16:19], s29 offen nt lds
    v_cvt_pk_bf16_f32 v229, v13, v14
    s_waitcnt lgkmcnt(8)
    v_mfma_f32_32x32x16_bf16 v[96:111], a[232:235], v[184:187], v[96:111]
    ds_read_b64_tr_b16 a[224:225], v1 offset:0
    ds_read_b64_tr_b16 a[226:227], v1 offset:512
    v_add_f32 v28, v28, v24
    v_cvt_pk_bf16_f32 v180, v24, v25
    v_add_f32 v29, v29, v25
    v_accvgpr_read_b32 v13, a76
    v_mfma_f32_32x32x16_bf16 v[112:127], a[236:239], v[184:187], v[112:127]
    ds_read_b64_tr_b16 a[228:229], v1 offset:64
    ds_read_b64_tr_b16 a[230:231], v1 offset:576
    buffer_load_dwordx4 v19, s[16:19], s30 offen offset:1024 nt lds
    s_waitcnt lgkmcnt(8)
    v_mfma_f32_32x32x16_bf16 v[64:79], a[240:243], v[188:191], v[64:79]
    ds_read_b64_tr_b16 a[232:233], v1 offset:128
    ds_read_b64_tr_b16 a[234:235], v1 offset:640
    v_exp_f32 v26, v138
    v_exp_f32 v27, v139
    v_accvgpr_read_b32 v14, a77
    v_mfma_f32_32x32x16_bf16 v[80:95], a[244:247], v[188:191], v[80:95]
    ds_read_b64_tr_b16 a[236:237], v1 offset:192
    ds_read_b64_tr_b16 a[238:239], v1 offset:704
    buffer_load_dwordx4 v20, s[16:19], s29 offen offset:2112 nt lds
    v_cvt_pk_bf16_f32 v230, v13, v14
    s_waitcnt lgkmcnt(8)
    v_mfma_f32_32x32x16_bf16 v[96:111], a[248:251], v[188:191], v[96:111]
    ds_read_b64_tr_b16 a[240:241], v1 offset:8448
    ds_read_b64_tr_b16 a[242:243], v1 offset:8960
    v_add_f32 v28, v28, v26
    v_cvt_pk_bf16_f32 v181, v26, v27
    v_add_f32 v29, v29, v27
    v_mfma_f32_32x32x16_bf16 v[112:127], a[252:255], v[188:191], v[112:127]
    ds_read_b64_tr_b16 a[244:245], v1 offset:8512
    ds_read_b64_tr_b16 a[246:247], v1 offset:9024
    buffer_load_dwordx4 v20, s[16:19], s30 offen offset:3136 nt lds
    v_accvgpr_read_b32 v13, a78
    s_waitcnt lgkmcnt(8)
    v_mfma_f32_32x32x16_bf16 a[0:15], a[224:227], v[48:51], a[0:15]
    ds_read_b64_tr_b16 a[248:249], v1 offset:8576
    ds_read_b64_tr_b16 a[250:251], v1 offset:9088
    v_exp_f32 v24, v140
    v_exp_f32 v25, v141
    v_accvgpr_read_b32 v14, a79
    v_mfma_f32_32x32x16_bf16 a[16:31], a[228:231], v[48:51], a[16:31]
    ds_read_b64_tr_b16 a[252:253], v1 offset:8640
    ds_read_b64_tr_b16 a[254:255], v1 offset:9152
    s_waitcnt lgkmcnt(8)
    v_mfma_f32_32x32x16_bf16 a[32:47], a[232:235], v[48:51], a[32:47]
    ds_read_b64_tr_b16 a[224:225], v1 offset:1024
    ds_read_b64_tr_b16 a[226:227], v1 offset:1536
    v_add_f32 v28, v28, v24
    v_cvt_pk_bf16_f32 v182, v24, v25
    v_add_f32 v29, v29, v25
    v_cvt_pk_bf16_f32 v231, v13, v14
    v_mfma_f32_32x32x16_bf16 a[48:63], a[236:239], v[48:51], a[48:63]
    ds_read_b64_tr_b16 a[228:229], v1 offset:1088
    ds_read_b64_tr_b16 a[230:231], v1 offset:1600
    v_accvgpr_read_b32 v13, a80
    s_waitcnt lgkmcnt(8)
    v_mfma_f32_32x32x16_bf16 a[0:15], a[240:243], v[52:55], a[0:15]
    ds_read_b64_tr_b16 a[232:233], v1 offset:1152
    ds_read_b64_tr_b16 a[234:235], v1 offset:1664
    v_exp_f32 v26, v142
    v_exp_f32 v27, v143
    v_mfma_f32_32x32x16_bf16 a[16:31], a[244:247], v[52:55], a[16:31]
    ds_read_b64_tr_b16 a[236:237], v1 offset:1216
    ds_read_b64_tr_b16 a[238:239], v1 offset:1728
    v_accvgpr_read_b32 v14, a81
    s_waitcnt lgkmcnt(8)
    v_mfma_f32_32x32x16_bf16 a[32:47], a[248:251], v[52:55], a[32:47]
    ds_read_b64_tr_b16 a[240:241], v1 offset:9472
    ds_read_b64_tr_b16 a[242:243], v1 offset:9984
    v_add_f32 v28, v28, v26
    v_cvt_pk_bf16_f32 v183, v26, v27
    v_add_f32 v29, v29, v27
    v_cvt_pk_bf16_f32 v232, v13, v14
    v_mfma_f32_32x32x16_bf16 a[48:63], a[252:255], v[52:55], a[48:63]
    ds_read_b64_tr_b16 a[244:245], v1 offset:9536
    ds_read_b64_tr_b16 a[246:247], v1 offset:10048
    v_add_f32 v28, v28, v29
    v_cmp_nge_f32 vcc, s32, v28
    s_cbranch_vccnz L_rs50
L_back50:
    v_add_f32 v22, v22, v28
    s_waitcnt lgkmcnt(8)
    v_mfma_f32_32x32x16_bf16 a[0:15], a[224:227], v[56:59], a[0:15]
    ds_read_b64_tr_b16 a[248:249], v1 offset:9600
    ds_read_b64_tr_b16 a[250:251], v1 offset:10112
    s_waitcnt vmcnt(24)
    s_barrier
    s_add_u32 m0, s24, 135168
    s_mov_b32 s93, 442368
    s_mov_b32 s95, 457728
    v_exp_f32 v24, v144
    v_exp_f32 v25, v145
    v_accvgpr_read_b32 v13, a82
    v_mfma_f32_32x32x16_bf16 a[16:31], a[228:231], v[56:59], a[16:31]
    ds_read_b64_tr_b16 a[252:253], v1 offset:9664
    ds_read_b64_tr_b16 a[254:255], v1 offset:10176
    buffer_load_dwordx4 v15, s[8:11], s93 offen nt lds
    v_cvt_pk_bf16_f32 v184, v24, v25
    v_add_f32 v28, v24, v25
    v_accvgpr_read_b32 v14, a83
    s_waitcnt lgkmcnt(8)
    v_mfma_f32_32x32x16_bf16 a[32:47], a[232:235], v[56:59], a[32:47]
    ds_read_b128 a[224:227], v7 offset:17920
    v_mfma_f32_32x32x16_bf16 a[48:63], a[236:239], v[56:59], a[48:63]
    ds_read_b128 a[228:231], v10 offset:17920
    buffer_load_dwordx4 v17, s[4:7], s95 offen offset:1024 nt lds
    v_exp_f32 v26, v146
    v_exp_f32 v27, v147
    v_cvt_pk_bf16_f32 v233, v13, v14
    s_waitcnt lgkmcnt(6)
    v_mfma_f32_32x32x16_bf16 a[0:15], a[240:243], v[60:63], a[0:15]
    ds_read_b128 a[232:235], v7 offset:17984
    v_cvt_pk_bf16_f32 v185, v26, v27
    v_add_f32 v29, v26, v27
    v_accvgpr_read_b32 v13, a84
    v_mfma_f32_32x32x16_bf16 a[16:31], a[244:247], v[60:63], a[16:31]
    ds_read_b128 a[236:239], v10 offset:17984
    buffer_load_dwordx4 v16, s[8:11], s93 offen offset:2112 nt lds
    s_waitcnt lgkmcnt(4)
    v_mfma_f32_32x32x16_bf16 a[32:47], a[248:251], v[60:63], a[32:47]
    ds_read_b128 a[240:243], v7 offset:18048
    v_exp_f32 v24, v148
    v_exp_f32 v25, v149
    v_accvgpr_read_b32 v14, a85
    v_mfma_f32_32x32x16_bf16 a[48:63], a[252:255], v[60:63], a[48:63]
    ds_read_b128 a[244:247], v10 offset:18048
    buffer_load_dwordx4 v18, s[4:7], s95 offen offset:3136 nt lds
    v_add_f32 v28, v28, v24
    v_cvt_pk_bf16_f32 v186, v24, v25
    v_add_f32 v29, v29, v25
    v_cvt_pk_bf16_f32 v234, v13, v14
    s_waitcnt lgkmcnt(4)
    v_mfma_f32_32x32x16_bf16 v[128:143], a[224:227], v[192:195], v[160:175]
    ds_read_b128 a[248:251], v7 offset:18112
    v_mfma_f32_32x32x16_bf16 v[128:143], a[228:231], v[196:199], v[128:143]
    ds_read_b128 a[252:255], v10 offset:18112
    v_exp_f32 v26, v150
    v_exp_f32 v27, v151
    v_accvgpr_read_b32 v13, a86
    s_waitcnt lgkmcnt(4)
    v_mfma_f32_32x32x16_bf16 v[128:143], a[232:235], v[200:203], v[128:143]
    ds_read_b64_tr_b16 a[224:225], v4 offset:16896
    ds_read_b64_tr_b16 a[226:227], v4 offset:17408
    v_add_f32 v28, v28, v26
    v_cvt_pk_bf16_f32 v187, v26, v27
    v_add_f32 v29, v29, v27
    v_accvgpr_read_b32 v14, a87
    v_mfma_f32_32x32x16_bf16 v[128:143], a[236:239], v[204:207], v[128:143]
    ds_read_b64_tr_b16 a[228:229], v4 offset:16960
    ds_read_b64_tr_b16 a[230:231], v4 offset:17472
    s_waitcnt lgkmcnt(6)
    v_mfma_f32_32x32x16_bf16 v[128:143], a[240:243], v[208:211], v[128:143]
    ds_read_b64_tr_b16 a[232:233], v4 offset:17024
    ds_read_b64_tr_b16 a[234:235], v4 offset:17536
    v_exp_f32 v24, v152
    v_exp_f32 v25, v153
    v_cvt_pk_bf16_f32 v235, v13, v14
    v_mfma_f32_32x32x16_bf16 v[128:143], a[244:247], v[212:215], v[128:143]
    ds_read_b64_tr_b16 a[236:237], v4 offset:17088
    ds_read_b64_tr_b16 a[238:239], v4 offset:17600
    v_add_f32 v28, v28, v24
    v_cvt_pk_bf16_f32 v188, v24, v25
    v_add_f32 v29, v29, v25
    v_accvgpr_read_b32 v13, a88
    s_waitcnt lgkmcnt(8)
    v_mfma_f32_32x32x16_bf16 v[128:143], a[248:251], v[216:219], v[128:143]
    ds_read_b64_tr_b16 a[240:241], v4 offset:25344
    ds_read_b64_tr_b16 a[242:243], v4 offset:25856
    v_mfma_f32_32x32x16_bf16 v[128:143], a[252:255], v[220:223], v[128:143]
    ds_read_b64_tr_b16 a[244:245], v4 offset:25408
    ds_read_b64_tr_b16 a[246:247], v4 offset:25920
    v_exp_f32 v26, v154
    v_exp_f32 v27, v155
    v_accvgpr_read_b32 v14, a89
    s_waitcnt lgkmcnt(8)
    v_mfma_f32_32x32x16_bf16 v[64:79], a[224:227], v[176:179], v[64:79]
    ds_read_b64_tr_b16 a[248:249], v4 offset:25472
    ds_read_b64_tr_b16 a[250:251], v4 offset:25984
    s_waitcnt vmcnt(24)
    s_barrier
    s_add_u32 m0, s24, 0
    s_mov_b32 s29, 82688
    s_mov_b32 s30, 122624
    v_add_f32 v28, v28, v26
    v_cvt_pk_bf16_f32 v189, v26, v27
    v_add_f32 v29, v29, v27
    v_cvt_pk_bf16_f32 v236, v13, v14
    v_mfma_f32_32x32x16_bf16 v[80:95], a[228:231], v[176:179], v[80:95]
    ds_read_b64_tr_b16 a[252:253], v4 offset:25536
    ds_read_b64_tr_b16 a[254:255], v4 offset:26048
    buffer_load_dwordx4 v19, s[16:19], s29 offen nt lds
    s_waitcnt lgkmcnt(8)
    v_mfma_f32_32x32x16_bf16 v[96:111], a[232:235], v[176:179], v[96:111]
    ds_read_b128 a[224:227], v7 offset:34816
    v_exp_f32 v24, v156
    v_exp_f32 v25, v157
    v_accvgpr_read_b32 v13, a90
    v_mfma_f32_32x32x16_bf16 v[112:127], a[236:239], v[176:179], v[112:127]
    ds_read_b128 a[228:231], v10 offset:34816
    buffer_load_dwordx4 v19, s[16:19], s30 offen offset:1024 nt lds
    v_add_f32 v28, v28, v24
    v_cvt_pk_bf16_f32 v190, v24, v25
    v_add_f32 v29, v29, v25
    v_accvgpr_read_b32 v14, a91
    s_waitcnt lgkmcnt(6)
    v_mfma_f32_32x32x16_bf16 v[64:79], a[240:243], v[180:183], v[64:79]
    ds_read_b128 a[232:235], v7 offset:34880
    v_mfma_f32_32x32x16_bf16 v[80:95], a[244:247], v[180:183], v[80:95]
    ds_read_b128 a[236:239], v10 offset:34880
    buffer_load_dwordx4 v20, s[16:19], s29 offen offset:2112 nt lds
    v_exp_f32 v26, v158
    v_exp_f32 v27, v159
    v_cvt_pk_bf16_f32 v237, v13, v14
    s_waitcnt lgkmcnt(4)
    v_mfma_f32_32x32x16_bf16 v[96:111], a[248:251], v[180:183], v[96:111]
    ds_read_b128 a[240:243], v7 offset:34944
    v_add_f32 v28, v28, v26
    v_cvt_pk_bf16_f32 v191, v26, v27
    v_add_f32 v29, v29, v27
    v_accvgpr_read_b32 v13, a92
    v_mfma_f32_32x32x16_bf16 v[112:127], a[252:255], v[180:183], v[112:127]
    ds_read_b128 a[244:247], v10 offset:34944
    buffer_load_dwordx4 v20, s[16:19], s30 offen offset:3136 nt lds
    v_add_f32 v28, v28, v29
    v_cmp_nge_f32 vcc, s32, v28
    s_cbranch_vccnz L_rs51
L_back51:
    v_add_f32 v22, v22, v28
    s_waitcnt lgkmcnt(4)
    v_mfma_f32_32x32x16_bf16 v[144:159], a[224:227], v[192:195], v[160:175]
    ds_read_b128 a[248:251], v7 offset:35008
    v_exp_f32 v24, v128
    v_exp_f32 v25, v129
    v_accvgpr_read_b32 v14, a93
    v_mfma_f32_32x32x16_bf16 v[144:159], a[228:231], v[196:199], v[144:159]
    ds_read_b128 a[252:255], v10 offset:35008
    v_cvt_pk_bf16_f32 v176, v24, v25
    v_add_f32 v28, v24, v25
    v_cvt_pk_bf16_f32 v238, v13, v14
    s_waitcnt lgkmcnt(4)
    v_mfma_f32_32x32x16_bf16 v[144:159], a[232:235], v[200:203], v[144:159]
    ds_read_b64_tr_b16 a[224:225], v4 offset:33792
    ds_read_b64_tr_b16 a[226:227], v4 offset:34304
    v_mfma_f32_32x32x16_bf16 v[144:159], a[236:239], v[204:207], v[144:159]
    ds_read_b64_tr_b16 a[228:229], v4 offset:33856
    ds_read_b64_tr_b16 a[230:231], v4 offset:34368
    v_exp_f32 v26, v130
    v_exp_f32 v27, v131
    v_accvgpr_read_b32 v13, a94
    s_waitcnt lgkmcnt(6)
    v_mfma_f32_32x32x16_bf16 v[144:159], a[240:243], v[208:211], v[144:159]
    ds_read_b64_tr_b16 a[232:233], v4 offset:33920
    ds_read_b64_tr_b16 a[234:235], v4 offset:34432
    v_cvt_pk_bf16_f32 v177, v26, v27
    v_add_f32 v29, v26, v27
    v_accvgpr_read_b32 v14, a95
    v_mfma_f32_32x32x16_bf16 v[144:159], a[244:247], v[212:215], v[144:159]
    ds_read_b64_tr_b16 a[236:237], v4 offset:33984
    ds_read_b64_tr_b16 a[238:239], v4 offset:34496
    s_waitcnt lgkmcnt(8)
    v_mfma_f32_32x32x16_bf16 v[144:159], a[248:251], v[216:219], v[144:159]
    ds_read_b64_tr_b16 a[240:241], v4 offset:42240
    ds_read_b64_tr_b16 a[242:243], v4 offset:42752
    v_exp_f32 v24, v132
    v_exp_f32 v25, v133
    v_cvt_pk_bf16_f32 v239, v13, v14
    v_mfma_f32_32x32x16_bf16 v[144:159], a[252:255], v[220:223], v[144:159]
    ds_read_b64_tr_b16 a[244:245], v4 offset:42304
    ds_read_b64_tr_b16 a[246:247], v4 offset:42816
    v_add_f32 v28, v28, v24
    v_cvt_pk_bf16_f32 v178, v24, v25
    v_add_f32 v29, v29, v25
    v_accvgpr_read_b32 v13, a96
    s_waitcnt lgkmcnt(8)
    v_mfma_f32_32x32x16_bf16 v[64:79], a[224:227], v[184:187], v[64:79]
    ds_read_b64_tr_b16 a[248:249], v4 offset:42368
    ds_read_b64_tr_b16 a[250:251], v4 offset:42880
    s_waitcnt vmcnt(24)
    s_barrier
    s_add_u32 m0, s24, 16896
    s_mov_b32 s93, 450560
    s_mov_b32 s95, 465920
    v_accvgpr_read_b32 v14, a97
    v_mfma_f32_32x32x16_bf16 v[80:95], a[228:231], v[184:187], v[80:95]
    ds_read_b64_tr_b16 a[252:253], v4 offset:42432
    ds_read_b64_tr_b16 a[254:255], v4 offset:42944
    buffer_load_dwordx4 v15, s[8:11], s93 offen nt lds
    v_exp_f32 v26, v134
    v_exp_f32 v27, v135
    s_waitcnt lgkmcnt(8)
    v_mfma_f32_32x32x16_bf16 v[96:111], a[232:235], v[184:187], v[96:111]
    ds_read_b64_tr_b16 a[224:225], v2 offset:0
    ds_read_b64_tr_b16 a[226:227], v2 offset:512
    v_add_f32 v28, v28, v26
    v_cvt_pk_bf16_f32 v179, v26, v27
    v_add_f32 v29, v29, v27
    v_cvt_pk_bf16_f32 v240, v13, v14
    v_mfma_f32_32x32x16_bf16 v[112:127], a[236:239], v[184:187], v[112:127]
    ds_read_b64_tr_b16 a[228:229], v2 offset:64
    ds_read_b64_tr_b16 a[230:231], v2 offset:576
    buffer_load_dwordx4 v17, s[4:7], s95 offen offset:1024 nt lds
    v_accvgpr_read_b32 v13, a98
    s_waitcnt lgkmcnt(8)
    v_mfma_f32_32x32x16_bf16 v[64:79], a[240:243], v[188:191], v[64:79]
    ds_read_b64_tr_b16 a[232:233], v2 offset:128
    ds_read_b64_tr_b16 a[234:235], v2 offset:640
    v_exp_f32 v24, v136
    v_exp_f32 v25, v137
    v_mfma_f32_32x32x16_bf16 v[80:95], a[244:247], v[188:191], v[80:95]
    ds_read_b64_tr_b16 a[236:237], v2 offset:192
    ds_read_b64_tr_b16 a[238:239], v2 offset:704
    buffer_load_dwordx4 v16, s[8:11], s93 offen offset:2112 nt lds
    v_add_f32 v28, v28, v24
    v_cvt_pk_bf16_f32 v180, v24, v25
    v_add_f32 v29, v29, v25
    v_accvgpr_read_b32 v14, a99
    s_waitcnt lgkmcnt(8)
    v_mfma_f32_32x32x16_bf16 v[96:111], a[248:251], v[188:191], v[96:111]
    ds_read_b64_tr_b16 a[240:241], v2 offset:8448
    ds_read_b64_tr_b16 a[242:243], v2 offset:8960
    v_cvt_pk_bf16_f32 v241, v13, v14
    v_mfma_f32_32x32x16_bf16 v[112:127], a[252:255], v[188:191], v[112:127]
    ds_read_b64_tr_b16 a[244:245], v2 offset:8512
    ds_read_b64_tr_b16 a[246:247], v2 offset:9024
    buffer_load_dwordx4 v18, s[4:7], s95 offen offset:3136 nt lds
    v_exp_f32 v26, v138
    v_exp_f32 v27, v139
    s_waitcnt lgkmcnt(8)
    v_mfma_f32_32x32x16_bf16 a[0:15], a[224:227], a[160:163], a[0:15]
    ds_read_b64_tr_b16 a[248:249], v2 offset:8576
    ds_read_b64_tr_b16 a[250:251], v2 offset:9088
    v_add_f32 v28, v28, v26
    v_cvt_pk_bf16_f32 v181, v26, v27
    v_add_f32 v29, v29, v27
    v_accvgpr_read_b32 v13, a100
    v_mfma_f32_32x32x16_bf16 a[16:31], a[228:231], a[160:163], a[16:31]
    ds_read_b64_tr_b16 a[252:253], v2 offset:8640
    ds_read_b64_tr_b16 a[254:255], v2 offset:9152
    v_accvgpr_read_b32 v14, a101
    s_waitcnt lgkmcnt(8)
    v_mfma_f32_32x32x16_bf16 a[32:47], a[232:235], a[160:163], a[32:47]
    ds_read_b64_tr_b16 a[224:225], v2 offset:1024
    ds_read_b64_tr_b16 a[226:227], v2 offset:1536
    v_exp_f32 v24, v140
    v_exp_f32 v25, v141
    v_mfma_f32_32x32x16_bf16 a[48:63], a[236:239], a[160:163], a[48:63]
    ds_read_b64_tr_b16 a[228:229], v2 offset:1088
    ds_read_b64_tr_b16 a[230:231], v2 offset:1600
    v_add_f32 v28, v28, v24
    v_cvt_pk_bf16_f32 v182, v24, v25
    v_add_f32 v29, v29, v25
    v_cvt_pk_bf16_f32 v242, v13, v14
    s_waitcnt lgkmcnt(8)
    v_mfma_f32_32x32x16_bf16 a[0:15], a[240:243], a[164:167], a[0:15]
    ds_read_b64_tr_b16 a[232:233], v2 offset:1152
    ds_read_b64_tr_b16 a[234:235], v2 offset:1664
    v_accvgpr_read_b32 v13, a102
    v_mfma_f32_32x32x16_bf16 a[16:31], a[244:247], a[164:167], a[16:31]
    ds_read_b64_tr_b16 a[236:237], v2 offset:1216
    ds_read_b64_tr_b16 a[238:239], v2 offset:1728
    v_exp_f32 v26, v142
    v_exp_f32 v27, v143
    s_waitcnt lgkmcnt(8)
    v_mfma_f32_32x32x16_bf16 a[32:47], a[248:251], a[164:167], a[32:47]
    ds_read_b64_tr_b16 a[240:241], v2 offset:9472
    ds_read_b64_tr_b16 a[242:243], v2 offset:9984
    v_add_f32 v28, v28, v26
    v_cvt_pk_bf16_f32 v183, v26, v27
    v_add_f32 v29, v29, v27
    v_accvgpr_read_b32 v14, a103
    v_mfma_f32_32x32x16_bf16 a[48:63], a[252:255], a[164:167], a[48:63]
    ds_read_b64_tr_b16 a[244:245], v2 offset:9536
    ds_read_b64_tr_b16 a[246:247], v2 offset:10048
    v_add_f32 v28, v28, v29
    v_cmp_nge_f32 vcc, s32, v28
    s_cbranch_vccnz L_rs52
L_back52:
    v_add_f32 v22, v22, v28
    v_cvt_pk_bf16_f32 v243, v13, v14
    s_waitcnt lgkmcnt(8)
    v_mfma_f32_32x32x16_bf16 a[0:15], a[224:227], a[168:171], a[0:15]
    ds_read_b64_tr_b16 a[248:249], v2 offset:9600
    ds_read_b64_tr_b16 a[250:251], v2 offset:10112
    s_waitcnt vmcnt(24)
    s_barrier
    s_add_u32 m0, s24, 33792
    s_mov_b32 s93, 458752
    s_mov_b32 s95, 474112
    v_exp_f32 v24, v144
    v_exp_f32 v25, v145
    v_mfma_f32_32x32x16_bf16 a[16:31], a[228:231], a[168:171], a[16:31]
    ds_read_b64_tr_b16 a[252:253], v2 offset:9664
    ds_read_b64_tr_b16 a[254:255], v2 offset:10176
    buffer_load_dwordx4 v15, s[8:11], s93 offen nt lds
    v_accvgpr_read_b32 v13, a104
    s_waitcnt lgkmcnt(8)
    v_mfma_f32_32x32x16_bf16 a[32:47], a[232:235], a[168:171], a[32:47]
    ds_read_b128 a[224:227], v8 offset:17920
    v_cvt_pk_bf16_f32 v184, v24, v25
    v_add_f32 v28, v24, v25
    v_accvgpr_read_b32 v14, a105
    v_mfma_f32_32x32x16_bf16 a[48:63], a[236:239], a[168:171], a[48:63]
    ds_read_b128 a[228:231], v11 offset:17920
    buffer_load_dwordx4 v17, s[4:7], s95 offen offset:1024 nt lds
    s_waitcnt lgkmcnt(6)
    v_mfma_f32_32x32x16_bf16 a[0:15], a[240:243], a[172:175], a[0:15]
    ds_read_b128 a[232:235], v8 offset:17984
    v_exp_f32 v26, v146
    v_exp_f32 v27, v147
    v_cvt_pk_bf16_f32 v244, v13, v14
    v_mfma_f32_32x32x16_bf16 a[16:31], a[244:247], a[172:175], a[16:31]
    ds_read_b128 a[236:239], v11 offset:17984
    buffer_load_dwordx4 v16, s[8:11], s93 offen offset:2112 nt lds
    v_accvgpr_read_b32 v13, a106
    s_waitcnt lgkmcnt(4)
    v_mfma_f32_32x32x16_bf16 a[32:47], a[248:251], a[172:175], a[32:47]
    ds_read_b128 a[240:243], v8 offset:18048
    v_cvt_pk_bf16_f32 v185, v26, v27
    v_add_f32 v29, v26, v27
    v_mfma_f32_32x32x16_bf16 a[48:63], a[252:255], a[172:175], a[48:63]
    ds_read_b128 a[244:247], v11 offset:18048
    buffer_load_dwordx4 v18, s[4:7], s95 offen offset:3136 nt lds
    v_accvgpr_read_b32 v14, a107
    s_waitcnt lgkmcnt(4)
    v_mfma_f32_32x32x16_bf16 v[128:143], a[224:227], v[192:195], v[160:175]
    ds_read_b128 a[248:251], v8 offset:18112
    v_exp_f32 v24, v148
    v_exp_f32 v25, v149
    v_cvt_pk_bf16_f32 v245, v13, v14
    v_mfma_f32_32x32x16_bf16 v[128:143], a[228:231], v[196:199], v[128:143]
    ds_read_b128 a[252:255], v11 offset:18112
    s_waitcnt lgkmcnt(4)
    v_mfma_f32_32x32x16_bf16 v[128:143], a[232:235], v[200:203], v[128:143]
    ds_read_b64_tr_b16 a[224:225], v5 offset:16896
    ds_read_b64_tr_b16 a[226:227], v5 offset:17408
    v_add_f32 v28, v28, v24
    v_cvt_pk_bf16_f32 v186, v24, v25
    v_add_f32 v29, v29, v25
    v_accvgpr_read_b32 v13, a108
    v_mfma_f32_32x32x16_bf16 v[128:143], a[236:239], v[204:207], v[128:143]
    ds_read_b64_tr_b16 a[228:229], v5 offset:16960
    ds_read_b64_tr_b16 a[230:231], v5 offset:17472
    v_accvgpr_read_b32 v14, a109
    s_waitcnt lgkmcnt(6)
    v_mfma_f32_32x32x16_bf16 v[128:143], a[240:243], v[208:211], v[128:143]
    ds_read_b64_tr_b16 a[232:233], v5 offset:17024
    ds_read_b64_tr_b16 a[234:235], v5 offset:17536
    v_exp_f32 v26, v150
    v_exp_f32 v27, v151
    v_mfma_f32_32x32x16_bf16 v[128:143], a[244:247], v[212:215], v[128:143]
    ds_read_b64_tr_b16 a[236:237], v5 offset:17088
    ds_read_b64_tr_b16 a[238:239], v5 offset:17600
    v_cvt_pk_bf16_f32 v246, v13, v14
    s_waitcnt lgkmcnt(8)
    v_mfma_f32_32x32x16_bf16 v[128:143], a[248:251], v[216:219], v[128:143]
    ds_read_b64_tr_b16 a[240:241], v5 offset:25344
    ds_read_b64_tr_b16 a[242:243], v5 offset:25856
    v_add_f32 v28, v28, v26
    v_cvt_pk_bf16_f32 v187, v26, v27
    v_add_f32 v29, v29, v27
    v_accvgpr_read_b32 v13, a110
    v_mfma_f32_32x32x16_bf16 v[128:143], a[252:255], v[220:223], v[128:143]
    ds_read_b64_tr_b16 a[244:245], v5 offset:25408
    ds_read_b64_tr_b16 a[246:247], v5 offset:25920
    s_waitcnt lgkmcnt(8)
    v_mfma_f32_32x32x16_bf16 v[64:79], a[224:227], v[176:179], v[64:79]
    ds_read_b64_tr_b16 a[248:249], v5 offset:25472
    ds_read_b64_tr_b16 a[250:251], v5 offset:25984
    s_waitcnt vmcnt(24)
    s_barrier
    s_add_u32 m0, s24, 50688
    s_mov_b32 s29, 164608
    s_mov_b32 s30, 204544
    v_exp_f32 v24, v152
    v_exp_f32 v25, v153
    v_accvgpr_read_b32 v14, a111
    v_mfma_f32_32x32x16_bf16 v[80:95], a[228:231], v[176:179], v[80:95]
    ds_read_b64_tr_b16 a[252:253], v5 offset:25536
    ds_read_b64_tr_b16 a[254:255], v5 offset:26048
    buffer_load_dwordx4 v19, s[16:19], s29 offen nt lds
    v_cvt_pk_bf16_f32 v247, v13, v14
    s_waitcnt lgkmcnt(8)
    v_mfma_f32_32x32x16_bf16 v[96:111], a[232:235], v[176:179], v[96:111]
    ds_read_b64_tr_b16 a[224:225], v2 offset:33792
    ds_read_b64_tr_b16 a[226:227], v2 offset:34304
    v_add_f32 v28, v28, v24
    v_cvt_pk_bf16_f32 v188, v24, v25
    v_add_f32 v29, v29, v25
    v_mfma_f32_32x32x16_bf16 v[112:127], a[236:239], v[176:179], v[112:127]
    ds_read_b64_tr_b16 a[228:229], v2 offset:33856
    ds_read_b64_tr_b16 a[230:231], v2 offset:34368
    buffer_load_dwordx4 v19, s[16:19], s30 offen offset:1024 nt lds
    v_accvgpr_read_b32 v13, a112
    s_waitcnt lgkmcnt(8)
    v_mfma_f32_32x32x16_bf16 v[64:79], a[240:243], v[180:183], v[64:79]
    ds_read_b64_tr_b16 a[232:233], v2 offset:33920
    ds_read_b64_tr_b16 a[234:235], v2 offset:34432
    v_exp_f32 v26, v154
    v_exp_f32 v27, v155
    v_accvgpr_read_b32 v14, a113
    v_mfma_f32_32x32x16_bf16 v[80:95], a[244:247], v[180:183], v[80:95]
    ds_read_b64_tr_b16 a[236:237], v2 offset:33984
    ds_read_b64_tr_b16 a[238:239], v2 offset:34496
    buffer_load_dwordx4 v20, s[16:19], s29 offen offset:2112 nt lds
    s_waitcnt lgkmcnt(8)
    v_mfma_f32_32x32x16_bf16 v[96:111], a[248:251], v[180:183], v[96:111]
    ds_read_b64_tr_b16 a[240:241], v2 offset:42240
    ds_read_b64_tr_b16 a[242:243], v2 offset:42752
    v_add_f32 v28, v28, v26
    v_cvt_pk_bf16_f32 v189, v26, v27
    v_add_f32 v29, v29, v27
    v_cvt_pk_bf16_f32 v248, v13, v14
    v_mfma_f32_32x32x16_bf16 v[112:127], a[252:255], v[180:183], v[112:127]
    ds_read_b64_tr_b16 a[244:245], v2 offset:42304
    ds_read_b64_tr_b16 a[246:247], v2 offset:42816
    buffer_load_dwordx4 v20, s[16:19], s30 offen offset:3136 nt lds
    v_accvgpr_read_b32 v13, a114
    s_waitcnt lgkmcnt(8)
    v_mfma_f32_32x32x16_bf16 a[0:15], a[224:227], a[176:179], a[0:15]
    ds_read_b64_tr_b16 a[248:249], v2 offset:42368
    ds_read_b64_tr_b16 a[250:251], v2 offset:42880
    v_exp_f32 v24, v156
    v_exp_f32 v25, v157
    v_mfma_f32_32x32x16_bf16 a[16:31], a[228:231], a[176:179], a[16:31]
    ds_read_b64_tr_b16 a[252:253], v2 offset:42432
    ds_read_b64_tr_b16 a[254:255], v2 offset:42944
    v_accvgpr_read_b32 v14, a115
    s_waitcnt lgkmcnt(8)
    v_mfma_f32_32x32x16_bf16 a[32:47], a[232:235], a[176:179], a[32:47]
    ds_read_b64_tr_b16 a[224:225], v2 offset:34816
    ds_read_b64_tr_b16 a[226:227], v2 offset:35328
    v_add_f32 v28, v28, v24
    v_cvt_pk_bf16_f32 v190, v24, v25
    v_add_f32 v29, v29, v25
    v_cvt_pk_bf16_f32 v249, v13, v14
    v_mfma_f32_32x32x16_bf16 a[48:63], a[236:239], a[176:179], a[48:63]
    ds_read_b64_tr_b16 a[228:229], v2 offset:34880
    ds_read_b64_tr_b16 a[230:231], v2 offset:35392
    s_waitcnt lgkmcnt(8)
    v_mfma_f32_32x32x16_bf16 a[0:15], a[240:243], a[180:183], a[0:15]
    ds_read_b64_tr_b16 a[232:233], v2 offset:34944
    ds_read_b64_tr_b16 a[234:235], v2 offset:35456
    v_exp_f32 v26, v158
    v_exp_f32 v27, v159
    v_accvgpr_read_b32 v13, a116
    v_mfma_f32_32x32x16_bf16 a[16:31], a[244:247], a[180:183], a[16:31]
    ds_read_b64_tr_b16 a[236:237], v2 offset:35008
    ds_read_b64_tr_b16 a[238:239], v2 offset:35520
    v_accvgpr_read_b32 v14, a117
    s_waitcnt lgkmcnt(8)
    v_mfma_f32_32x32x16_bf16 a[32:47], a[248:251], a[180:183], a[32:47]
    ds_read_b64_tr_b16 a[240:241], v2 offset:43264
    ds_read_b64_tr_b16 a[242:243], v2 offset:43776
    v_add_f32 v28, v28, v26
    v_cvt_pk_bf16_f32 v191, v26, v27
    v_add_f32 v29, v29, v27
    v_mfma_f32_32x32x16_bf16 a[48:63], a[252:255], a[180:183], a[48:63]
    ds_read_b64_tr_b16 a[244:245], v2 offset:43328
    ds_read_b64_tr_b16 a[246:247], v2 offset:43840
    v_add_f32 v28, v28, v29
    v_cmp_nge_f32 vcc, s32, v28
    s_cbranch_vccnz L_rs53
L_back53:
    v_add_f32 v22, v22, v28
    v_cvt_pk_bf16_f32 v250, v13, v14
    s_waitcnt lgkmcnt(8)
    v_mfma_f32_32x32x16_bf16 a[0:15], a[224:227], a[184:187], a[0:15]
    ds_read_b64_tr_b16 a[248:249], v2 offset:43392
    ds_read_b64_tr_b16 a[250:251], v2 offset:43904
    s_waitcnt vmcnt(24)
    s_barrier
    s_add_u32 m0, s24, 67584
    s_mov_b32 s93, 466944
    s_mov_b32 s95, 482304
    v_exp_f32 v24, v128
    v_exp_f32 v25, v129
    v_accvgpr_read_b32 v13, a118
    v_mfma_f32_32x32x16_bf16 a[16:31], a[228:231], a[184:187], a[16:31]
    ds_read_b64_tr_b16 a[252:253], v2 offset:43456
    ds_read_b64_tr_b16 a[254:255], v2 offset:43968
    buffer_load_dwordx4 v15, s[8:11], s93 offen nt lds
    s_waitcnt lgkmcnt(8)
    v_mfma_f32_32x32x16_bf16 a[32:47], a[232:235], a[184:187], a[32:47]
    ds_read_b128 a[224:227], v9 offset:1024
    v_cvt_pk_bf16_f32 v176, v24, v25
    v_add_f32 v28, v24, v25
    v_accvgpr_read_b32 v14, a119
    v_mfma_f32_32x32x16_bf16 a[48:63], a[236:239], a[184:187], a[48:63]
    ds_read_b128 a[228:231], v12 offset:1024
    buffer_load_dwordx4 v17, s[4:7], s95 offen offset:1024 nt lds
    v_cvt_pk_bf16_f32 v251, v13, v14
    s_waitcnt lgkmcnt(6)
    v_mfma_f32_32x32x16_bf16 a[0:15], a[240:243], a[188:191], a[0:15]
    ds_read_b128 a[232:235], v9 offset:1088
    v_exp_f32 v26, v130
    v_exp_f32 v27, v131
    v_mfma_f32_32x32x16_bf16 a[16:31], a[244:247], a[188:191], a[16:31]
    ds_read_b128 a[236:239], v12 offset:1088
    buffer_load_dwordx4 v16, s[8:11], s93 offen offset:2112 nt lds
    v_accvgpr_read_b32 v13, a120
    s_waitcnt lgkmcnt(4)
    v_mfma_f32_32x32x16_bf16 a[32:47], a[248:251], a[188:191], a[32:47]
    ds_read_b128 a[240:243], v9 offset:1152
    v_cvt_pk_bf16_f32 v177, v26, v27
    v_add_f32 v29, v26, v27
    v_accvgpr_read_b32 v14, a121
    v_mfma_f32_32x32x16_bf16 a[48:63], a[252:255], a[188:191], a[48:63]
    ds_read_b128 a[244:247], v12 offset:1152
    buffer_load_dwordx4 v18, s[4:7], s95 offen offset:3136 nt lds
    s_waitcnt lgkmcnt(4)
    v_mfma_f32_32x32x16_bf16 v[144:159], a[224:227], v[192:195], v[160:175]
    ds_read_b128 a[248:251], v9 offset:1216
    v_exp_f32 v24, v132
    v_exp_f32 v25, v133
    v_cvt_pk_bf16_f32 v252, v13, v14
    v_mfma_f32_32x32x16_bf16 v[144:159], a[228:231], v[196:199], v[144:159]
    ds_read_b128 a[252:255], v12 offset:1216
    v_accvgpr_read_b32 v13, a122
    s_waitcnt lgkmcnt(4)
    v_mfma_f32_32x32x16_bf16 v[144:159], a[232:235], v[200:203], v[144:159]
    ds_read_b64_tr_b16 a[224:225], v6 offset:0
    ds_read_b64_tr_b16 a[226:227], v6 offset:512
    v_add_f32 v28, v28, v24
    v_cvt_pk_bf16_f32 v178, v24, v25
    v_add_f32 v29, v29, v25
    v_mfma_f32_32x32x16_bf16 v[144:159], a[236:239], v[204:207], v[144:159]
    ds_read_b64_tr_b16 a[228:229], v6 offset:64
    ds_read_b64_tr_b16 a[230:231], v6 offset:576
    v_accvgpr_read_b32 v14, a123
    s_waitcnt lgkmcnt(6)
    v_mfma_f32_32x32x16_bf16 v[144:159], a[240:243], v[208:211], v[144:159]
    ds_read_b64_tr_b16 a[232:233], v6 offset:128
    ds_read_b64_tr_b16 a[234:235], v6 offset:640
    v_exp_f32 v26, v134
    v_exp_f32 v27, v135
    v_cvt_pk_bf16_f32 v253, v13, v14
    v_mfma_f32_32x32x16_bf16 v[144:159], a[244:247], v[212:215], v[144:159]
    ds_read_b64_tr_b16 a[236:237], v6 offset:192
    ds_read_b64_tr_b16 a[238:239], v6 offset:704
    s_waitcnt lgkmcnt(8)
    v_mfma_f32_32x32x16_bf16 v[144:159], a[248:251], v[216:219], v[144:159]
    ds_read_b64_tr_b16 a[240:241], v6 offset:8448
    ds_read_b64_tr_b16 a[242:243], v6 offset:8960
    v_add_f32 v28, v28, v26
    v_cvt_pk_bf16_f32 v179, v26, v27
    v_add_f32 v29, v29, v27
    v_accvgpr_read_b32 v13, a124
    v_mfma_f32_32x32x16_bf16 v[144:159], a[252:255], v[220:223], v[144:159]
    ds_read_b64_tr_b16 a[244:245], v6 offset:8512
    ds_read_b64_tr_b16 a[246:247], v6 offset:9024
    v_accvgpr_read_b32 v14, a125
    s_waitcnt lgkmcnt(8)
    v_mfma_f32_32x32x16_bf16 v[64:79], a[224:227], v[184:187], v[64:79]
    ds_read_b64_tr_b16 a[248:249], v6 offset:8576
    ds_read_b64_tr_b16 a[250:251], v6 offset:9088
    s_waitcnt vmcnt(24)
    s_barrier
    s_add_u32 m0, s24, 84480
    s_mov_b32 s29, 246528
    s_mov_b32 s30, 286464
    v_exp_f32 v24, v136
    v_exp_f32 v25, v137
    v_mfma_f32_32x32x16_bf16 v[80:95], a[228:231], v[184:187], v[80:95]
    ds_read_b64_tr_b16 a[252:253], v6 offset:8640
    ds_read_b64_tr_b16 a[254:255], v6 offset:9152
    buffer_load_dwordx4 v19, s[16:19], s29 offen nt lds
    v_cvt_pk_bf16_f32 v254, v13, v14
    s_waitcnt lgkmcnt(8)
    v_mfma_f32_32x32x16_bf16 v[96:111], a[232:235], v[184:187], v[96:111]
    ds_read_b64_tr_b16 a[224:225], v3 offset:16896
    ds_read_b64_tr_b16 a[226:227], v3 offset:17408
    v_add_f32 v28, v28, v24
    v_cvt_pk_bf16_f32 v180, v24, v25
    v_add_f32 v29, v29, v25
    v_accvgpr_read_b32 v13, a126
    v_mfma_f32_32x32x16_bf16 v[112:127], a[236:239], v[184:187], v[112:127]
    ds_read_b64_tr_b16 a[228:229], v3 offset:16960
    ds_read_b64_tr_b16 a[230:231], v3 offset:17472
    buffer_load_dwordx4 v19, s[16:19], s30 offen offset:1024 nt lds
    s_waitcnt lgkmcnt(8)
    v_mfma_f32_32x32x16_bf16 v[64:79], a[240:243], v[188:191], v[64:79]
    ds_read_b64_tr_b16 a[232:233], v3 offset:17024
    ds_read_b64_tr_b16 a[234:235], v3 offset:17536
    v_exp_f32 v26, v138
    v_exp_f32 v27, v139
    v_accvgpr_read_b32 v14, a127
    v_mfma_f32_32x32x16_bf16 v[80:95], a[244:247], v[188:191], v[80:95]
    ds_read_b64_tr_b16 a[236:237], v3 offset:17088
    ds_read_b64_tr_b16 a[238:239], v3 offset:17600
    buffer_load_dwordx4 v20, s[16:19], s29 offen offset:2112 nt lds
    v_cvt_pk_bf16_f32 v255, v13, v14
    s_waitcnt lgkmcnt(8)
    v_mfma_f32_32x32x16_bf16 v[96:111], a[248:251], v[188:191], v[96:111]
    ds_read_b64_tr_b16 a[240:241], v3 offset:25344
    ds_read_b64_tr_b16 a[242:243], v3 offset:25856
    v_add_f32 v28, v28, v26
    v_cvt_pk_bf16_f32 v181, v26, v27
    v_add_f32 v29, v29, v27
    v_mfma_f32_32x32x16_bf16 v[112:127], a[252:255], v[188:191], v[112:127]
    ds_read_b64_tr_b16 a[244:245], v3 offset:25408
    ds_read_b64_tr_b16 a[246:247], v3 offset:25920
    buffer_load_dwordx4 v20, s[16:19], s30 offen offset:3136 nt lds
    s_waitcnt lgkmcnt(8)
    v_mfma_f32_32x32x16_bf16 a[64:79], a[224:227], v[32:35], 0
    ds_read_b64_tr_b16 a[248:249], v3 offset:25472
    ds_read_b64_tr_b16 a[250:251], v3 offset:25984
    v_exp_f32 v24, v140
    v_exp_f32 v25, v141
    v_mfma_f32_32x32x16_bf16 a[80:95], a[228:231], v[32:35], 0
    ds_read_b64_tr_b16 a[252:253], v3 offset:25536
    ds_read_b64_tr_b16 a[254:255], v3 offset:26048
    s_waitcnt lgkmcnt(8)
    v_mfma_f32_32x32x16_bf16 a[96:111], a[232:235], v[32:35], 0
    ds_read_b64_tr_b16 a[224:225], v3 offset:17920
    ds_read_b64_tr_b16 a[226:227], v3 offset:18432
    v_add_f32 v28, v28, v24
    v_cvt_pk_bf16_f32 v182, v24, v25
    v_add_f32 v29, v29, v25
    v_mfma_f32_32x32x16_bf16 a[112:127], a[236:239], v[32:35], 0
    ds_read_b64_tr_b16 a[228:229], v3 offset:17984
    ds_read_b64_tr_b16 a[230:231], v3 offset:18496
    s_waitcnt lgkmcnt(8)
    v_mfma_f32_32x32x16_bf16 a[64:79], a[240:243], v[36:39], a[64:79]
    ds_read_b64_tr_b16 a[232:233], v3 offset:18048
    ds_read_b64_tr_b16 a[234:235], v3 offset:18560
    v_exp_f32 v26, v142
    v_exp_f32 v27, v143
    v_mfma_f32_32x32x16_bf16 a[80:95], a[244:247], v[36:39], a[80:95]
    ds_read_b64_tr_b16 a[236:237], v3 offset:18112
    ds_read_b64_tr_b16 a[238:239], v3 offset:18624
    s_waitcnt lgkmcnt(8)
    v_mfma_f32_32x32x16_bf16 a[96:111], a[248:251], v[36:39], a[96:111]
    ds_read_b64_tr_b16 a[240:241], v3 offset:26368
    ds_read_b64_tr_b16 a[242:243], v3 offset:26880
    v_add_f32 v28, v28, v26
    v_cvt_pk_bf16_f32 v183, v26, v27
    v_add_f32 v29, v29, v27
    v_mfma_f32_32x32x16_bf16 a[112:127], a[252:255], v[36:39], a[112:127]
    ds_read_b64_tr_b16 a[244:245], v3 offset:26432
    ds_read_b64_tr_b16 a[246:247], v3 offset:26944
    v_add_f32 v28, v28, v29
    v_cmp_nge_f32 vcc, s32, v28
    s_cbranch_vccnz L_rs54
L_back54:
    v_add_f32 v22, v22, v28
    s_waitcnt lgkmcnt(8)
    v_mfma_f32_32x32x16_bf16 a[64:79], a[224:227], v[40:43], a[64:79]
    ds_read_b64_tr_b16 a[248:249], v3 offset:26496
    ds_read_b64_tr_b16 a[250:251], v3 offset:27008
    s_waitcnt vmcnt(24)
    s_barrier
    s_add_u32 m0, s24, 101376
    s_mov_b32 s93, 475136
    s_mov_b32 s95, 490496
    v_exp_f32 v24, v144
    v_exp_f32 v25, v145
    v_mfma_f32_32x32x16_bf16 a[80:95], a[228:231], v[40:43], a[80:95]
    ds_read_b64_tr_b16 a[252:253], v3 offset:26560
    ds_read_b64_tr_b16 a[254:255], v3 offset:27072
    buffer_load_dwordx4 v15, s[8:11], s93 offen nt lds
    s_waitcnt lgkmcnt(8)
    v_mfma_f32_32x32x16_bf16 a[96:111], a[232:235], v[40:43], a[96:111]
    ds_read_b128 a[224:227], v9 offset:34816
    v_cvt_pk_bf16_f32 v184, v24, v25
    v_add_f32 v28, v24, v25
    v_mfma_f32_32x32x16_bf16 a[112:127], a[236:239], v[40:43], a[112:127]
    ds_read_b128 a[228:231], v12 offset:34816
    buffer_load_dwordx4 v17, s[4:7], s95 offen offset:1024 nt lds
    s_waitcnt lgkmcnt(6)
    v_mfma_f32_32x32x16_bf16 a[64:79], a[240:243], v[44:47], a[64:79]
    ds_read_b128 a[232:235], v9 offset:34880
    v_exp_f32 v26, v146
    v_exp_f32 v27, v147
    v_mfma_f32_32x32x16_bf16 a[80:95], a[244:247], v[44:47], a[80:95]
    ds_read_b128 a[236:239], v12 offset:34880
    buffer_load_dwordx4 v16, s[8:11], s93 offen offset:2112 nt lds
    s_waitcnt lgkmcnt(4)
    v_mfma_f32_32x32x16_bf16 a[96:111], a[248:251], v[44:47], a[96:111]
    ds_read_b128 a[240:243], v9 offset:34944
    v_cvt_pk_bf16_f32 v185, v26, v27
    v_add_f32 v29, v26, v27
    v_mfma_f32_32x32x16_bf16 a[112:127], a[252:255], v[44:47], a[112:127]
    ds_read_b128 a[244:247], v12 offset:34944
    buffer_load_dwordx4 v18, s[4:7], s95 offen offset:3136 nt lds
    s_waitcnt lgkmcnt(4)
    v_mfma_f32_32x32x16_bf16 v[128:143], a[224:227], v[192:195], v[160:175]
    ds_read_b128 a[248:251], v9 offset:35008
    v_exp_f32 v24, v148
    v_exp_f32 v25, v149
    v_mfma_f32_32x32x16_bf16 v[128:143], a[228:231], v[196:199], v[128:143]
    ds_read_b128 a[252:255], v12 offset:35008
    s_waitcnt lgkmcnt(4)
    v_mfma_f32_32x32x16_bf16 v[128:143], a[232:235], v[200:203], v[128:143]
    ds_read_b64_tr_b16 a[224:225], v6 offset:33792
    ds_read_b64_tr_b16 a[226:227], v6 offset:34304
    v_add_f32 v28, v28, v24
    v_cvt_pk_bf16_f32 v186, v24, v25
    v_add_f32 v29, v29, v25
    v_mfma_f32_32x32x16_bf16 v[128:143], a[236:239], v[204:207], v[128:143]
    ds_read_b64_tr_b16 a[228:229], v6 offset:33856
    ds_read_b64_tr_b16 a[230:231], v6 offset:34368
    s_waitcnt lgkmcnt(6)
    v_mfma_f32_32x32x16_bf16 v[128:143], a[240:243], v[208:211], v[128:143]
    ds_read_b64_tr_b16 a[232:233], v6 offset:33920
    ds_read_b64_tr_b16 a[234:235], v6 offset:34432
    v_exp_f32 v26, v150
    v_exp_f32 v27, v151
    v_mfma_f32_32x32x16_bf16 v[128:143], a[244:247], v[212:215], v[128:143]
    ds_read_b64_tr_b16 a[236:237], v6 offset:33984
    ds_read_b64_tr_b16 a[238:239], v6 offset:34496
    s_waitcnt lgkmcnt(8)
    v_mfma_f32_32x32x16_bf16 v[128:143], a[248:251], v[216:219], v[128:143]
    ds_read_b64_tr_b16 a[240:241], v6 offset:42240
    ds_read_b64_tr_b16 a[242:243], v6 offset:42752
    v_add_f32 v28, v28, v26
    v_cvt_pk_bf16_f32 v187, v26, v27
    v_add_f32 v29, v29, v27
    v_mfma_f32_32x32x16_bf16 v[128:143], a[252:255], v[220:223], v[128:143]
    ds_read_b64_tr_b16 a[244:245], v6 offset:42304
    ds_read_b64_tr_b16 a[246:247], v6 offset:42816
    s_waitcnt lgkmcnt(8)
    v_mfma_f32_32x32x16_bf16 v[64:79], a[224:227], v[176:179], v[64:79]
    ds_read_b64_tr_b16 a[248:249], v6 offset:42368
    ds_read_b64_tr_b16 a[250:251], v6 offset:42880
    s_waitcnt vmcnt(24)
    s_barrier
    s_add_u32 m0, s24, 118272
    s_mov_b32 s29, 328192
    s_mov_b32 s30, 368128
    v_exp_f32 v24, v152
    v_exp_f32 v25, v153
    v_mfma_f32_32x32x16_bf16 v[80:95], a[228:231], v[176:179], v[80:95]
    ds_read_b64_tr_b16 a[252:253], v6 offset:42432
    ds_read_b64_tr_b16 a[254:255], v6 offset:42944
    buffer_load_dwordx4 v19, s[16:19], s29 offen nt lds
    s_waitcnt lgkmcnt(8)
    v_mfma_f32_32x32x16_bf16 v[96:111], a[232:235], v[176:179], v[96:111]
    ds_read_b64_tr_b16 a[224:225], v1 offset:0
    ds_read_b64_tr_b16 a[226:227], v1 offset:512
    v_add_f32 v28, v28, v24
    v_cvt_pk_bf16_f32 v188, v24, v25
    v_add_f32 v29, v29, v25
    v_mfma_f32_32x32x16_bf16 v[112:127], a[236:239], v[176:179], v[112:127]
    ds_read_b64_tr_b16 a[228:229], v1 offset:64
    ds_read_b64_tr_b16 a[230:231], v1 offset:576
    buffer_load_dwordx4 v19, s[16:19], s30 offen offset:1024 nt lds
    s_waitcnt lgkmcnt(8)
    v_mfma_f32_32x32x16_bf16 v[64:79], a[240:243], v[180:183], v[64:79]
    ds_read_b64_tr_b16 a[232:233], v1 offset:128
    ds_read_b64_tr_b16 a[234:235], v1 offset:640
    v_exp_f32 v26, v154
    v_exp_f32 v27, v155
    v_mfma_f32_32x32x16_bf16 v[80:95], a[244:247], v[180:183], v[80:95]
    ds_read_b64_tr_b16 a[236:237], v1 offset:192
    ds_read_b64_tr_b16 a[238:239], v1 offset:704
    buffer_load_dwordx4 v20, s[16:19], s29 offen offset:2112 nt lds
    s_waitcnt lgkmcnt(8)
    v_mfma_f32_32x32x16_bf16 v[96:111], a[248:251], v[180:183], v[96:111]
    ds_read_b64_tr_b16 a[240:241], v1 offset:8448
    ds_read_b64_tr_b16 a[242:243], v1 offset:8960
    v_add_f32 v28, v28, v26
    v_cvt_pk_bf16_f32 v189, v26, v27
    v_add_f32 v29, v29, v27
    v_mfma_f32_32x32x16_bf16 v[112:127], a[252:255], v[180:183], v[112:127]
    ds_read_b64_tr_b16 a[244:245], v1 offset:8512
    ds_read_b64_tr_b16 a[246:247], v1 offset:9024
    buffer_load_dwordx4 v20, s[16:19], s30 offen offset:3136 nt lds
    s_waitcnt lgkmcnt(8)
    v_mfma_f32_32x32x16_bf16 a[64:79], a[224:227], v[48:51], a[64:79]
    ds_read_b64_tr_b16 a[248:249], v1 offset:8576
    ds_read_b64_tr_b16 a[250:251], v1 offset:9088
    v_exp_f32 v24, v156
    v_exp_f32 v25, v157
    v_mfma_f32_32x32x16_bf16 a[80:95], a[228:231], v[48:51], a[80:95]
    ds_read_b64_tr_b16 a[252:253], v1 offset:8640
    ds_read_b64_tr_b16 a[254:255], v1 offset:9152
    s_waitcnt lgkmcnt(8)
    v_mfma_f32_32x32x16_bf16 a[96:111], a[232:235], v[48:51], a[96:111]
    ds_read_b64_tr_b16 a[224:225], v1 offset:1024
    ds_read_b64_tr_b16 a[226:227], v1 offset:1536
    v_add_f32 v28, v28, v24
    v_cvt_pk_bf16_f32 v190, v24, v25
    v_add_f32 v29, v29, v25
    v_mfma_f32_32x32x16_bf16 a[112:127], a[236:239], v[48:51], a[112:127]
    ds_read_b64_tr_b16 a[228:229], v1 offset:1088
    ds_read_b64_tr_b16 a[230:231], v1 offset:1600
    s_waitcnt lgkmcnt(8)
    v_mfma_f32_32x32x16_bf16 a[64:79], a[240:243], v[52:55], a[64:79]
    ds_read_b64_tr_b16 a[232:233], v1 offset:1152
    ds_read_b64_tr_b16 a[234:235], v1 offset:1664
    v_exp_f32 v26, v158
    v_exp_f32 v27, v159
    v_mfma_f32_32x32x16_bf16 a[80:95], a[244:247], v[52:55], a[80:95]
    ds_read_b64_tr_b16 a[236:237], v1 offset:1216
    ds_read_b64_tr_b16 a[238:239], v1 offset:1728
    s_waitcnt lgkmcnt(8)
    v_mfma_f32_32x32x16_bf16 a[96:111], a[248:251], v[52:55], a[96:111]
    ds_read_b64_tr_b16 a[240:241], v1 offset:9472
    ds_read_b64_tr_b16 a[242:243], v1 offset:9984
    v_add_f32 v28, v28, v26
    v_cvt_pk_bf16_f32 v191, v26, v27
    v_add_f32 v29, v29, v27
    v_mfma_f32_32x32x16_bf16 a[112:127], a[252:255], v[52:55], a[112:127]
    ds_read_b64_tr_b16 a[244:245], v1 offset:9536
    ds_read_b64_tr_b16 a[246:247], v1 offset:10048
    v_add_f32 v28, v28, v29
    v_cmp_nge_f32 vcc, s32, v28
    s_cbranch_vccnz L_rs55
L_back55:
    v_add_f32 v22, v22, v28
    s_waitcnt lgkmcnt(8)
    v_mfma_f32_32x32x16_bf16 a[64:79], a[224:227], v[56:59], a[64:79]
    ds_read_b64_tr_b16 a[248:249], v1 offset:9600
    ds_read_b64_tr_b16 a[250:251], v1 offset:10112
    s_waitcnt vmcnt(24)
    s_barrier
    s_add_u32 m0, s24, 135168
    s_mov_b32 s93, 483328
    s_mov_b32 s95, 498688
    v_exp_f32 v24, v128
    v_exp_f32 v25, v129
    v_mfma_f32_32x32x16_bf16 a[80:95], a[228:231], v[56:59], a[80:95]
    ds_read_b64_tr_b16 a[252:253], v1 offset:9664
    ds_read_b64_tr_b16 a[254:255], v1 offset:10176
    buffer_load_dwordx4 v15, s[8:11], s93 offen nt lds
    v_cvt_pk_bf16_f32 v176, v24, v25
    v_add_f32 v28, v24, v25
    s_waitcnt lgkmcnt(8)
    v_mfma_f32_32x32x16_bf16 a[96:111], a[232:235], v[56:59], a[96:111]
    ds_read_b128 a[224:227], v7 offset:17920
    v_mfma_f32_32x32x16_bf16 a[112:127], a[236:239], v[56:59], a[112:127]
    ds_read_b128 a[228:231], v10 offset:17920
    buffer_load_dwordx4 v17, s[4:7], s95 offen offset:1024 nt lds
    v_exp_f32 v26, v130
    v_exp_f32 v27, v131
    s_waitcnt lgkmcnt(6)
    v_mfma_f32_32x32x16_bf16 a[64:79], a[240:243], v[60:63], a[64:79]
    ds_read_b128 a[232:235], v7 offset:17984
    v_cvt_pk_bf16_f32 v177, v26, v27
    v_add_f32 v29, v26, v27
    v_mfma_f32_32x32x16_bf16 a[80:95], a[244:247], v[60:63], a[80:95]
    ds_read_b128 a[236:239], v10 offset:17984
    buffer_load_dwordx4 v16, s[8:11], s93 offen offset:2112 nt lds
    s_waitcnt lgkmcnt(4)
    v_mfma_f32_32x32x16_bf16 a[96:111], a[248:251], v[60:63], a[96:111]
    ds_read_b128 a[240:243], v7 offset:18048
    v_exp_f32 v24, v132
    v_exp_f32 v25, v133
    v_mfma_f32_32x32x16_bf16 a[112:127], a[252:255], v[60:63], a[112:127]
    ds_read_b128 a[244:247], v10 offset:18048
    buffer_load_dwordx4 v18, s[4:7], s95 offen offset:3136 nt lds
    v_add_f32 v28, v28, v24
    v_cvt_pk_bf16_f32 v178, v24, v25
    v_add_f32 v29, v29, v25
    s_waitcnt lgkmcnt(4)
    v_mfma_f32_32x32x16_bf16 v[144:159], a[224:227], v[192:195], v[160:175]
    ds_read_b128 a[248:251], v7 offset:18112
    v_mfma_f32_32x32x16_bf16 v[144:159], a[228:231], v[196:199], v[144:159]
    ds_read_b128 a[252:255], v10 offset:18112
    v_exp_f32 v26, v134
    v_exp_f32 v27, v135
    s_waitcnt lgkmcnt(4)
    v_mfma_f32_32x32x16_bf16 v[144:159], a[232:235], v[200:203], v[144:159]
    ds_read_b64_tr_b16 a[224:225], v4 offset:16896
    ds_read_b64_tr_b16 a[226:227], v4 offset:17408
    v_add_f32 v28, v28, v26
    v_cvt_pk_bf16_f32 v179, v26, v27
    v_add_f32 v29, v29, v27
    v_mfma_f32_32x32x16_bf16 v[144:159], a[236:239], v[204:207], v[144:159]
    ds_read_b64_tr_b16 a[228:229], v4 offset:16960
    ds_read_b64_tr_b16 a[230:231], v4 offset:17472
    s_waitcnt lgkmcnt(6)
    v_mfma_f32_32x32x16_bf16 v[144:159], a[240:243], v[208:211], v[144:159]
    ds_read_b64_tr_b16 a[232:233], v4 offset:17024
    ds_read_b64_tr_b16 a[234:235], v4 offset:17536
    v_exp_f32 v24, v136
    v_exp_f32 v25, v137
    v_mfma_f32_32x32x16_bf16 v[144:159], a[244:247], v[212:215], v[144:159]
    ds_read_b64_tr_b16 a[236:237], v4 offset:17088
    ds_read_b64_tr_b16 a[238:239], v4 offset:17600
    v_add_f32 v28, v28, v24
    v_cvt_pk_bf16_f32 v180, v24, v25
    v_add_f32 v29, v29, v25
    s_waitcnt lgkmcnt(8)
    v_mfma_f32_32x32x16_bf16 v[144:159], a[248:251], v[216:219], v[144:159]
    ds_read_b64_tr_b16 a[240:241], v4 offset:25344
    ds_read_b64_tr_b16 a[242:243], v4 offset:25856
    v_mfma_f32_32x32x16_bf16 v[144:159], a[252:255], v[220:223], v[144:159]
    ds_read_b64_tr_b16 a[244:245], v4 offset:25408
    ds_read_b64_tr_b16 a[246:247], v4 offset:25920
    v_exp_f32 v26, v138
    v_exp_f32 v27, v139
    s_waitcnt lgkmcnt(8)
    v_mfma_f32_32x32x16_bf16 v[64:79], a[224:227], v[184:187], v[64:79]
    ds_read_b64_tr_b16 a[248:249], v4 offset:25472
    ds_read_b64_tr_b16 a[250:251], v4 offset:25984
    s_waitcnt vmcnt(24)
    s_barrier
    s_add_u32 m0, s24, 0
    s_mov_b32 s93, 491520
    s_mov_b32 s95, 506880
    v_add_f32 v28, v28, v26
    v_cvt_pk_bf16_f32 v181, v26, v27
    v_add_f32 v29, v29, v27
    v_mfma_f32_32x32x16_bf16 v[80:95], a[228:231], v[184:187], v[80:95]
    ds_read_b64_tr_b16 a[252:253], v4 offset:25536
    ds_read_b64_tr_b16 a[254:255], v4 offset:26048
    buffer_load_dwordx4 v15, s[8:11], s93 offen nt lds
    s_waitcnt lgkmcnt(8)
    v_mfma_f32_32x32x16_bf16 v[96:111], a[232:235], v[184:187], v[96:111]
    ds_read_b128 a[224:227], v7 offset:34816
    v_exp_f32 v24, v140
    v_exp_f32 v25, v141
    v_mfma_f32_32x32x16_bf16 v[112:127], a[236:239], v[184:187], v[112:127]
    ds_read_b128 a[228:231], v10 offset:34816
    buffer_load_dwordx4 v17, s[4:7], s95 offen offset:1024 nt lds
    v_add_f32 v28, v28, v24
    v_cvt_pk_bf16_f32 v182, v24, v25
    v_add_f32 v29, v29, v25
    s_waitcnt lgkmcnt(6)
    v_mfma_f32_32x32x16_bf16 v[64:79], a[240:243], v[188:191], v[64:79]
    ds_read_b128 a[232:235], v7 offset:34880
    v_mfma_f32_32x32x16_bf16 v[80:95], a[244:247], v[188:191], v[80:95]
    ds_read_b128 a[236:239], v10 offset:34880
    buffer_load_dwordx4 v16, s[8:11], s93 offen offset:2112 nt lds
    v_exp_f32 v26, v142
    v_exp_f32 v27, v143
    s_waitcnt lgkmcnt(4)
    v_mfma_f32_32x32x16_bf16 v[96:111], a[248:251], v[188:191], v[96:111]
    ds_read_b128 a[240:243], v7 offset:34944
    v_add_f32 v28, v28, v26
    v_cvt_pk_bf16_f32 v183, v26, v27
    v_add_f32 v29, v29, v27
    v_mfma_f32_32x32x16_bf16 v[112:127], a[252:255], v[188:191], v[112:127]
    ds_read_b128 a[244:247], v10 offset:34944
    buffer_load_dwordx4 v18, s[4:7], s95 offen offset:3136 nt lds
    v_add_f32 v28, v28, v29
    v_cmp_nge_f32 vcc, s32, v28
    s_cbranch_vccnz L_rs56
L_back56:
    v_add_f32 v22, v22, v28
    s_waitcnt lgkmcnt(4)
    v_mfma_f32_32x32x16_bf16 v[128:143], a[224:227], v[192:195], v[160:175]
    ds_read_b128 a[248:251], v7 offset:35008
    v_exp_f32 v24, v144
    v_exp_f32 v25, v145
    v_mfma_f32_32x32x16_bf16 v[128:143], a[228:231], v[196:199], v[128:143]
    ds_read_b128 a[252:255], v10 offset:35008
    v_cvt_pk_bf16_f32 v184, v24, v25
    v_add_f32 v28, v24, v25
    s_waitcnt lgkmcnt(4)
    v_mfma_f32_32x32x16_bf16 v[128:143], a[232:235], v[200:203], v[128:143]
    ds_read_b64_tr_b16 a[224:225], v4 offset:33792
    ds_read_b64_tr_b16 a[226:227], v4 offset:34304
    v_mfma_f32_32x32x16_bf16 v[128:143], a[236:239], v[204:207], v[128:143]
    ds_read_b64_tr_b16 a[228:229], v4 offset:33856
    ds_read_b64_tr_b16 a[230:231], v4 offset:34368
    v_exp_f32 v26, v146
    v_exp_f32 v27, v147
    s_waitcnt lgkmcnt(6)
    v_mfma_f32_32x32x16_bf16 v[128:143], a[240:243], v[208:211], v[128:143]
    ds_read_b64_tr_b16 a[232:233], v4 offset:33920
    ds_read_b64_tr_b16 a[234:235], v4 offset:34432
    v_cvt_pk_bf16_f32 v185, v26, v27
    v_add_f32 v29, v26, v27
    v_mfma_f32_32x32x16_bf16 v[128:143], a[244:247], v[212:215], v[128:143]
    ds_read_b64_tr_b16 a[236:237], v4 offset:33984
    ds_read_b64_tr_b16 a[238:239], v4 offset:34496
    s_waitcnt lgkmcnt(8)
    v_mfma_f32_32x32x16_bf16 v[128:143], a[248:251], v[216:219], v[128:143]
    ds_read_b64_tr_b16 a[240:241], v4 offset:42240
    ds_read_b64_tr_b16 a[242:243], v4 offset:42752
    v_exp_f32 v24, v148
    v_exp_f32 v25, v149
    v_mfma_f32_32x32x16_bf16 v[128:143], a[252:255], v[220:223], v[128:143]
    ds_read_b64_tr_b16 a[244:245], v4 offset:42304
    ds_read_b64_tr_b16 a[246:247], v4 offset:42816
    v_add_f32 v28, v28, v24
    v_cvt_pk_bf16_f32 v186, v24, v25
    v_add_f32 v29, v29, v25
    s_waitcnt lgkmcnt(8)
    v_mfma_f32_32x32x16_bf16 v[64:79], a[224:227], v[176:179], v[64:79]
    ds_read_b64_tr_b16 a[248:249], v4 offset:42368
    ds_read_b64_tr_b16 a[250:251], v4 offset:42880
    s_waitcnt vmcnt(24)
    s_barrier
    s_add_u32 m0, s24, 16896
    s_mov_b32 s29, 410112
    s_mov_b32 s30, 450048
    v_mfma_f32_32x32x16_bf16 v[80:95], a[228:231], v[176:179], v[80:95]
    ds_read_b64_tr_b16 a[252:253], v4 offset:42432
    ds_read_b64_tr_b16 a[254:255], v4 offset:42944
    buffer_load_dwordx4 v19, s[16:19], s29 offen nt lds
    v_exp_f32 v26, v150
    v_exp_f32 v27, v151
    s_waitcnt lgkmcnt(8)
    v_mfma_f32_32x32x16_bf16 v[96:111], a[232:235], v[176:179], v[96:111]
    ds_read_b64_tr_b16 a[224:225], v2 offset:0
    ds_read_b64_tr_b16 a[226:227], v2 offset:512
    v_add_f32 v28, v28, v26
    v_cvt_pk_bf16_f32 v187, v26, v27
    v_add_f32 v29, v29, v27
    v_mfma_f32_32x32x16_bf16 v[112:127], a[236:239], v[176:179], v[112:127]
    ds_read_b64_tr_b16 a[228:229], v2 offset:64
    ds_read_b64_tr_b16 a[230:231], v2 offset:576
    buffer_load_dwordx4 v19, s[16:19], s30 offen offset:1024 nt lds
    s_waitcnt lgkmcnt(8)
    v_mfma_f32_32x32x16_bf16 v[64:79], a[240:243], v[180:183], v[64:79]
    ds_read_b64_tr_b16 a[232:233], v2 offset:128
    ds_read_b64_tr_b16 a[234:235], v2 offset:640
    v_exp_f32 v24, v152
    v_exp_f32 v25, v153
    v_mfma_f32_32x32x16_bf16 v[80:95], a[244:247], v[180:183], v[80:95]
    ds_read_b64_tr_b16 a[236:237], v2 offset:192
    ds_read_b64_tr_b16 a[238:239], v2 offset:704
    buffer_load_dwordx4 v20, s[16:19], s29 offen offset:2112 nt lds
    v_add_f32 v28, v28, v24
    v_cvt_pk_bf16_f32 v188, v24, v25
    v_add_f32 v29, v29, v25
    s_waitcnt lgkmcnt(8)
    v_mfma_f32_32x32x16_bf16 v[96:111], a[248:251], v[180:183], v[96:111]
    ds_read_b64_tr_b16 a[240:241], v2 offset:8448
    ds_read_b64_tr_b16 a[242:243], v2 offset:8960
    v_mfma_f32_32x32x16_bf16 v[112:127], a[252:255], v[180:183], v[112:127]
    ds_read_b64_tr_b16 a[244:245], v2 offset:8512
    ds_read_b64_tr_b16 a[246:247], v2 offset:9024
    buffer_load_dwordx4 v20, s[16:19], s30 offen offset:3136 nt lds
    v_exp_f32 v26, v154
    v_exp_f32 v27, v155
    s_waitcnt lgkmcnt(8)
    v_mfma_f32_32x32x16_bf16 a[64:79], a[224:227], a[160:163], a[64:79]
    ds_read_b64_tr_b16 a[248:249], v2 offset:8576
    ds_read_b64_tr_b16 a[250:251], v2 offset:9088
    v_add_f32 v28, v28, v26
    v_cvt_pk_bf16_f32 v189, v26, v27
    v_add_f32 v29, v29, v27
    v_mfma_f32_32x32x16_bf16 a[80:95], a[228:231], a[160:163], a[80:95]
    ds_read_b64_tr_b16 a[252:253], v2 offset:8640
    ds_read_b64_tr_b16 a[254:255], v2 offset:9152
    s_waitcnt lgkmcnt(8)
    v_mfma_f32_32x32x16_bf16 a[96:111], a[232:235], a[160:163], a[96:111]
    ds_read_b64_tr_b16 a[224:225], v2 offset:1024
    ds_read_b64_tr_b16 a[226:227], v2 offset:1536
    v_exp_f32 v24, v156
    v_exp_f32 v25, v157
    v_mfma_f32_32x32x16_bf16 a[112:127], a[236:239], a[160:163], a[112:127]
    ds_read_b64_tr_b16 a[228:229], v2 offset:1088
    ds_read_b64_tr_b16 a[230:231], v2 offset:1600
    v_add_f32 v28, v28, v24
    v_cvt_pk_bf16_f32 v190, v24, v25
    v_add_f32 v29, v29, v25
    s_waitcnt lgkmcnt(8)
    v_mfma_f32_32x32x16_bf16 a[64:79], a[240:243], a[164:167], a[64:79]
    ds_read_b64_tr_b16 a[232:233], v2 offset:1152
    ds_read_b64_tr_b16 a[234:235], v2 offset:1664
    v_mfma_f32_32x32x16_bf16 a[80:95], a[244:247], a[164:167], a[80:95]
    ds_read_b64_tr_b16 a[236:237], v2 offset:1216
    ds_read_b64_tr_b16 a[238:239], v2 offset:1728
    v_exp_f32 v26, v158
    v_exp_f32 v27, v159
    s_waitcnt lgkmcnt(8)
    v_mfma_f32_32x32x16_bf16 a[96:111], a[248:251], a[164:167], a[96:111]
    ds_read_b64_tr_b16 a[240:241], v2 offset:9472
    ds_read_b64_tr_b16 a[242:243], v2 offset:9984
    v_add_f32 v28, v28, v26
    v_cvt_pk_bf16_f32 v191, v26, v27
    v_add_f32 v29, v29, v27
    v_mfma_f32_32x32x16_bf16 a[112:127], a[252:255], a[164:167], a[112:127]
    ds_read_b64_tr_b16 a[244:245], v2 offset:9536
    ds_read_b64_tr_b16 a[246:247], v2 offset:10048
    v_add_f32 v28, v28, v29
    v_cmp_nge_f32 vcc, s32, v28
    s_cbranch_vccnz L_rs57
L_back57:
    v_add_f32 v22, v22, v28
    s_waitcnt lgkmcnt(8)
    v_mfma_f32_32x32x16_bf16 a[64:79], a[224:227], a[168:171], a[64:79]
    ds_read_b64_tr_b16 a[248:249], v2 offset:9600
    ds_read_b64_tr_b16 a[250:251], v2 offset:10112
    s_waitcnt vmcnt(24)
    s_barrier
    s_add_u32 m0, s24, 33792
    s_mov_b32 s93, 499712
    s_mov_b32 s95, 515072
    v_exp_f32 v24, v128
    v_exp_f32 v25, v129
    v_mfma_f32_32x32x16_bf16 a[80:95], a[228:231], a[168:171], a[80:95]
    ds_read_b64_tr_b16 a[252:253], v2 offset:9664
    ds_read_b64_tr_b16 a[254:255], v2 offset:10176
    buffer_load_dwordx4 v15, s[8:11], s93 offen nt lds
    s_waitcnt lgkmcnt(8)
    v_mfma_f32_32x32x16_bf16 a[96:111], a[232:235], a[168:171], a[96:111]
    ds_read_b128 a[224:227], v8 offset:17920
    v_cvt_pk_bf16_f32 v176, v24, v25
    v_add_f32 v28, v24, v25
    v_mfma_f32_32x32x16_bf16 a[112:127], a[236:239], a[168:171], a[112:127]
    ds_read_b128 a[228:231], v11 offset:17920
    buffer_load_dwordx4 v17, s[4:7], s95 offen offset:1024 nt lds
    s_waitcnt lgkmcnt(6)
    v_mfma_f32_32x32x16_bf16 a[64:79], a[240:243], a[172:175], a[64:79]
    ds_read_b128 a[232:235], v8 offset:17984
    v_exp_f32 v26, v130
    v_exp_f32 v27, v131
    v_mfma_f32_32x32x16_bf16 a[80:95], a[244:247], a[172:175], a[80:95]
    ds_read_b128 a[236:239], v11 offset:17984
    buffer_load_dwordx4 v16, s[8:11], s93 offen offset:2112 nt lds
    s_waitcnt lgkmcnt(4)
    v_mfma_f32_32x32x16_bf16 a[96:111], a[248:251], a[172:175], a[96:111]
    ds_read_b128 a[240:243], v8 offset:18048
    v_cvt_pk_bf16_f32 v177, v26, v27
    v_add_f32 v29, v26, v27
    v_mfma_f32_32x32x16_bf16 a[112:127], a[252:255], a[172:175], a[112:127]
    ds_read_b128 a[244:247], v11 offset:18048
    buffer_load_dwordx4 v18, s[4:7], s95 offen offset:3136 nt lds
    s_waitcnt lgkmcnt(4)
    v_mfma_f32_32x32x16_bf16 v[144:159], a[224:227], v[192:195], v[160:175]
    ds_read_b128 a[248:251], v8 offset:18112
    v_exp_f32 v24, v132
    v_exp_f32 v25, v133
    v_mfma_f32_32x32x16_bf16 v[144:159], a[228:231], v[196:199], v[144:159]
    ds_read_b128 a[252:255], v11 offset:18112
    s_waitcnt lgkmcnt(4)
    v_mfma_f32_32x32x16_bf16 v[144:159], a[232:235], v[200:203], v[144:159]
    ds_read_b64_tr_b16 a[224:225], v5 offset:16896
    ds_read_b64_tr_b16 a[226:227], v5 offset:17408
    v_add_f32 v28, v28, v24
    v_cvt_pk_bf16_f32 v178, v24, v25
    v_add_f32 v29, v29, v25
    v_mfma_f32_32x32x16_bf16 v[144:159], a[236:239], v[204:207], v[144:159]
    ds_read_b64_tr_b16 a[228:229], v5 offset:16960
    ds_read_b64_tr_b16 a[230:231], v5 offset:17472
    s_waitcnt lgkmcnt(6)
    v_mfma_f32_32x32x16_bf16 v[144:159], a[240:243], v[208:211], v[144:159]
    ds_read_b64_tr_b16 a[232:233], v5 offset:17024
    ds_read_b64_tr_b16 a[234:235], v5 offset:17536
    v_exp_f32 v26, v134
    v_exp_f32 v27, v135
    v_mfma_f32_32x32x16_bf16 v[144:159], a[244:247], v[212:215], v[144:159]
    ds_read_b64_tr_b16 a[236:237], v5 offset:17088
    ds_read_b64_tr_b16 a[238:239], v5 offset:17600
    s_waitcnt lgkmcnt(8)
    v_mfma_f32_32x32x16_bf16 v[144:159], a[248:251], v[216:219], v[144:159]
    ds_read_b64_tr_b16 a[240:241], v5 offset:25344
    ds_read_b64_tr_b16 a[242:243], v5 offset:25856
    v_add_f32 v28, v28, v26
    v_cvt_pk_bf16_f32 v179, v26, v27
    v_add_f32 v29, v29, v27
    v_mfma_f32_32x32x16_bf16 v[144:159], a[252:255], v[220:223], v[144:159]
    ds_read_b64_tr_b16 a[244:245], v5 offset:25408
    ds_read_b64_tr_b16 a[246:247], v5 offset:25920
    s_waitcnt lgkmcnt(8)
    v_mfma_f32_32x32x16_bf16 v[64:79], a[224:227], v[184:187], v[64:79]
    ds_read_b64_tr_b16 a[248:249], v5 offset:25472
    ds_read_b64_tr_b16 a[250:251], v5 offset:25984
    s_waitcnt vmcnt(24)
    s_barrier
    s_add_u32 m0, s24, 50688
    s_mov_b32 s29, 328448
    s_mov_b32 s30, 368384
    v_exp_f32 v24, v136
    v_exp_f32 v25, v137
    v_mfma_f32_32x32x16_bf16 v[80:95], a[228:231], v[184:187], v[80:95]
    ds_read_b64_tr_b16 a[252:253], v5 offset:25536
    ds_read_b64_tr_b16 a[254:255], v5 offset:26048
    buffer_load_dwordx4 v19, s[16:19], s29 offen nt lds
    s_waitcnt lgkmcnt(8)
    v_mfma_f32_32x32x16_bf16 v[96:111], a[232:235], v[184:187], v[96:111]
    ds_read_b64_tr_b16 a[224:225], v2 offset:33792
    ds_read_b64_tr_b16 a[226:227], v2 offset:34304
    v_add_f32 v28, v28, v24
    v_cvt_pk_bf16_f32 v180, v24, v25
    v_add_f32 v29, v29, v25
    v_mfma_f32_32x32x16_bf16 v[112:127], a[236:239], v[184:187], v[112:127]
    ds_read_b64_tr_b16 a[228:229], v2 offset:33856
    ds_read_b64_tr_b16 a[230:231], v2 offset:34368
    buffer_load_dwordx4 v19, s[16:19], s30 offen offset:1024 nt lds
    s_waitcnt lgkmcnt(8)
    v_mfma_f32_32x32x16_bf16 v[64:79], a[240:243], v[188:191], v[64:79]
    ds_read_b64_tr_b16 a[232:233], v2 offset:33920
    ds_read_b64_tr_b16 a[234:235], v2 offset:34432
    v_exp_f32 v26, v138
    v_exp_f32 v27, v139
    v_mfma_f32_32x32x16_bf16 v[80:95], a[244:247], v[188:191], v[80:95]
    ds_read_b64_tr_b16 a[236:237], v2 offset:33984
    ds_read_b64_tr_b16 a[238:239], v2 offset:34496
    buffer_load_dwordx4 v20, s[16:19], s29 offen offset:2112 nt lds
    s_waitcnt lgkmcnt(8)
    v_mfma_f32_32x32x16_bf16 v[96:111], a[248:251], v[188:191], v[96:111]
    ds_read_b64_tr_b16 a[240:241], v2 offset:42240
    ds_read_b64_tr_b16 a[242:243], v2 offset:42752
    v_add_f32 v28, v28, v26
    v_cvt_pk_bf16_f32 v181, v26, v27
    v_add_f32 v29, v29, v27
    v_mfma_f32_32x32x16_bf16 v[112:127], a[252:255], v[188:191], v[112:127]
    ds_read_b64_tr_b16 a[244:245], v2 offset:42304
    ds_read_b64_tr_b16 a[246:247], v2 offset:42816
    buffer_load_dwordx4 v20, s[16:19], s30 offen offset:3136 nt lds
    s_waitcnt lgkmcnt(8)
    v_mfma_f32_32x32x16_bf16 a[64:79], a[224:227], a[176:179], a[64:79]
    ds_read_b64_tr_b16 a[248:249], v2 offset:42368
    ds_read_b64_tr_b16 a[250:251], v2 offset:42880
    v_exp_f32 v24, v140
    v_exp_f32 v25, v141
    v_mfma_f32_32x32x16_bf16 a[80:95], a[228:231], a[176:179], a[80:95]
    ds_read_b64_tr_b16 a[252:253], v2 offset:42432
    ds_read_b64_tr_b16 a[254:255], v2 offset:42944
    s_waitcnt lgkmcnt(8)
    v_mfma_f32_32x32x16_bf16 a[96:111], a[232:235], a[176:179], a[96:111]
    ds_read_b64_tr_b16 a[224:225], v2 offset:34816
    ds_read_b64_tr_b16 a[226:227], v2 offset:35328
    v_add_f32 v28, v28, v24
    v_cvt_pk_bf16_f32 v182, v24, v25
    v_add_f32 v29, v29, v25
    v_mfma_f32_32x32x16_bf16 a[112:127], a[236:239], a[176:179], a[112:127]
    ds_read_b64_tr_b16 a[228:229], v2 offset:34880
    ds_read_b64_tr_b16 a[230:231], v2 offset:35392
    s_waitcnt lgkmcnt(8)
    v_mfma_f32_32x32x16_bf16 a[64:79], a[240:243], a[180:183], a[64:79]
    ds_read_b64_tr_b16 a[232:233], v2 offset:34944
    ds_read_b64_tr_b16 a[234:235], v2 offset:35456
    v_exp_f32 v26, v142
    v_exp_f32 v27, v143
    v_mfma_f32_32x32x16_bf16 a[80:95], a[244:247], a[180:183], a[80:95]
    ds_read_b64_tr_b16 a[236:237], v2 offset:35008
    ds_read_b64_tr_b16 a[238:239], v2 offset:35520
    s_waitcnt lgkmcnt(8)
    v_mfma_f32_32x32x16_bf16 a[96:111], a[248:251], a[180:183], a[96:111]
    ds_read_b64_tr_b16 a[240:241], v2 offset:43264
    ds_read_b64_tr_b16 a[242:243], v2 offset:43776
    v_add_f32 v28, v28, v26
    v_cvt_pk_bf16_f32 v183, v26, v27
    v_add_f32 v29, v29, v27
    v_mfma_f32_32x32x16_bf16 a[112:127], a[252:255], a[180:183], a[112:127]
    ds_read_b64_tr_b16 a[244:245], v2 offset:43328
    ds_read_b64_tr_b16 a[246:247], v2 offset:43840
    v_add_f32 v28, v28, v29
    v_cmp_nge_f32 vcc, s32, v28
    s_cbranch_vccnz L_rs58
L_back58:
    v_add_f32 v22, v22, v28
    s_waitcnt lgkmcnt(8)
    v_mfma_f32_32x32x16_bf16 a[64:79], a[224:227], a[184:187], a[64:79]
    ds_read_b64_tr_b16 a[248:249], v2 offset:43392
    ds_read_b64_tr_b16 a[250:251], v2 offset:43904
    s_waitcnt vmcnt(24)
    s_barrier
    s_add_u32 m0, s24, 67584
    s_mov_b32 s93, 507904
    s_mov_b32 s95, 515072
    v_exp_f32 v24, v144
    v_exp_f32 v25, v145
    v_mfma_f32_32x32x16_bf16 a[80:95], a[228:231], a[184:187], a[80:95]
    ds_read_b64_tr_b16 a[252:253], v2 offset:43456
    ds_read_b64_tr_b16 a[254:255], v2 offset:43968
    buffer_load_dwordx4 v15, s[8:11], s93 offen nt lds
    s_waitcnt lgkmcnt(8)
    v_mfma_f32_32x32x16_bf16 a[96:111], a[232:235], a[184:187], a[96:111]
    ds_read_b128 a[224:227], v9 offset:1024
    v_cvt_pk_bf16_f32 v184, v24, v25
    v_add_f32 v28, v24, v25
    v_mfma_f32_32x32x16_bf16 a[112:127], a[236:239], a[184:187], a[112:127]
    ds_read_b128 a[228:231], v12 offset:1024
    buffer_load_dwordx4 v15, s[8:11], s95 offen offset:1024 nt lds
    s_waitcnt lgkmcnt(6)
    v_mfma_f32_32x32x16_bf16 a[64:79], a[240:243], a[188:191], a[64:79]
    ds_read_b128 a[232:235], v9 offset:1088
    v_exp_f32 v26, v146
    v_exp_f32 v27, v147
    v_mfma_f32_32x32x16_bf16 a[80:95], a[244:247], a[188:191], a[80:95]
    ds_read_b128 a[236:239], v12 offset:1088
    buffer_load_dwordx4 v16, s[8:11], s93 offen offset:2112 nt lds
    s_waitcnt lgkmcnt(4)
    v_mfma_f32_32x32x16_bf16 a[96:111], a[248:251], a[188:191], a[96:111]
    ds_read_b128 a[240:243], v9 offset:1152
    v_cvt_pk_bf16_f32 v185, v26, v27
    v_add_f32 v29, v26, v27
    v_mfma_f32_32x32x16_bf16 a[112:127], a[252:255], a[188:191], a[112:127]
    ds_read_b128 a[244:247], v12 offset:1152
    buffer_load_dwordx4 v16, s[8:11], s95 offen offset:3136 nt lds
    s_waitcnt lgkmcnt(4)
    v_mfma_f32_32x32x16_bf16 v[128:143], a[224:227], v[192:195], v[160:175]
    ds_read_b128 a[248:251], v9 offset:1216
    v_exp_f32 v24, v148
    v_exp_f32 v25, v149
    v_mfma_f32_32x32x16_bf16 v[128:143], a[228:231], v[196:199], v[128:143]
    ds_read_b128 a[252:255], v12 offset:1216
    s_waitcnt lgkmcnt(4)
    v_mfma_f32_32x32x16_bf16 v[128:143], a[232:235], v[200:203], v[128:143]
    ds_read_b64_tr_b16 a[224:225], v6 offset:0
    ds_read_b64_tr_b16 a[226:227], v6 offset:512
    v_add_f32 v28, v28, v24
    v_cvt_pk_bf16_f32 v186, v24, v25
    v_add_f32 v29, v29, v25
    v_mfma_f32_32x32x16_bf16 v[128:143], a[236:239], v[204:207], v[128:143]
    ds_read_b64_tr_b16 a[228:229], v6 offset:64
    ds_read_b64_tr_b16 a[230:231], v6 offset:576
    s_waitcnt lgkmcnt(6)
    v_mfma_f32_32x32x16_bf16 v[128:143], a[240:243], v[208:211], v[128:143]
    ds_read_b64_tr_b16 a[232:233], v6 offset:128
    ds_read_b64_tr_b16 a[234:235], v6 offset:640
    v_exp_f32 v26, v150
    v_exp_f32 v27, v151
    v_mfma_f32_32x32x16_bf16 v[128:143], a[244:247], v[212:215], v[128:143]
    ds_read_b64_tr_b16 a[236:237], v6 offset:192
    ds_read_b64_tr_b16 a[238:239], v6 offset:704
    s_waitcnt lgkmcnt(8)
    v_mfma_f32_32x32x16_bf16 v[128:143], a[248:251], v[216:219], v[128:143]
    ds_read_b64_tr_b16 a[240:241], v6 offset:8448
    ds_read_b64_tr_b16 a[242:243], v6 offset:8960
    v_add_f32 v28, v28, v26
    v_cvt_pk_bf16_f32 v187, v26, v27
    v_add_f32 v29, v29, v27
    v_mfma_f32_32x32x16_bf16 v[128:143], a[252:255], v[220:223], v[128:143]
    ds_read_b64_tr_b16 a[244:245], v6 offset:8512
    ds_read_b64_tr_b16 a[246:247], v6 offset:9024
    s_waitcnt lgkmcnt(8)
    v_mfma_f32_32x32x16_bf16 v[64:79], a[224:227], v[176:179], v[64:79]
    ds_read_b64_tr_b16 a[248:249], v6 offset:8576
    ds_read_b64_tr_b16 a[250:251], v6 offset:9088
    s_waitcnt vmcnt(24)
    s_barrier
    s_add_u32 m0, s24, 84480
    s_mov_b32 s29, 410368
    s_mov_b32 s30, 450304
    v_exp_f32 v24, v152
    v_exp_f32 v25, v153
    v_mfma_f32_32x32x16_bf16 v[80:95], a[228:231], v[176:179], v[80:95]
    ds_read_b64_tr_b16 a[252:253], v6 offset:8640
    ds_read_b64_tr_b16 a[254:255], v6 offset:9152
    buffer_load_dwordx4 v19, s[16:19], s29 offen nt lds
    s_waitcnt lgkmcnt(8)
    v_mfma_f32_32x32x16_bf16 v[96:111], a[232:235], v[176:179], v[96:111]
    ds_read_b64_tr_b16 a[224:225], v3 offset:16896
    ds_read_b64_tr_b16 a[226:227], v3 offset:17408
    v_add_f32 v28, v28, v24
    v_cvt_pk_bf16_f32 v188, v24, v25
    v_add_f32 v29, v29, v25
    v_mfma_f32_32x32x16_bf16 v[112:127], a[236:239], v[176:179], v[112:127]
    ds_read_b64_tr_b16 a[228:229], v3 offset:16960
    ds_read_b64_tr_b16 a[230:231], v3 offset:17472
    buffer_load_dwordx4 v19, s[16:19], s30 offen offset:1024 nt lds
    s_waitcnt lgkmcnt(8)
    v_mfma_f32_32x32x16_bf16 v[64:79], a[240:243], v[180:183], v[64:79]
    ds_read_b64_tr_b16 a[232:233], v3 offset:17024
    ds_read_b64_tr_b16 a[234:235], v3 offset:17536
    v_exp_f32 v26, v154
    v_exp_f32 v27, v155
    v_mfma_f32_32x32x16_bf16 v[80:95], a[244:247], v[180:183], v[80:95]
    ds_read_b64_tr_b16 a[236:237], v3 offset:17088
    ds_read_b64_tr_b16 a[238:239], v3 offset:17600
    buffer_load_dwordx4 v20, s[16:19], s29 offen offset:2112 nt lds
    s_waitcnt lgkmcnt(8)
    v_mfma_f32_32x32x16_bf16 v[96:111], a[248:251], v[180:183], v[96:111]
    ds_read_b64_tr_b16 a[240:241], v3 offset:25344
    ds_read_b64_tr_b16 a[242:243], v3 offset:25856
    v_add_f32 v28, v28, v26
    v_cvt_pk_bf16_f32 v189, v26, v27
    v_add_f32 v29, v29, v27
    v_mfma_f32_32x32x16_bf16 v[112:127], a[252:255], v[180:183], v[112:127]
    ds_read_b64_tr_b16 a[244:245], v3 offset:25408
    ds_read_b64_tr_b16 a[246:247], v3 offset:25920
    buffer_load_dwordx4 v20, s[16:19], s30 offen offset:3136 nt lds
    s_waitcnt lgkmcnt(8)
    v_mfma_f32_32x32x16_bf16 a[0:15], a[224:227], a[192:195], a[0:15]
    ds_read_b64_tr_b16 a[248:249], v3 offset:25472
    ds_read_b64_tr_b16 a[250:251], v3 offset:25984
    v_exp_f32 v24, v156
    v_exp_f32 v25, v157
    v_mfma_f32_32x32x16_bf16 a[16:31], a[228:231], a[192:195], a[16:31]
    ds_read_b64_tr_b16 a[252:253], v3 offset:25536
    ds_read_b64_tr_b16 a[254:255], v3 offset:26048
    s_waitcnt lgkmcnt(8)
    v_mfma_f32_32x32x16_bf16 a[32:47], a[232:235], a[192:195], a[32:47]
    ds_read_b64_tr_b16 a[224:225], v3 offset:17920
    ds_read_b64_tr_b16 a[226:227], v3 offset:18432
    v_add_f32 v28, v28, v24
    v_cvt_pk_bf16_f32 v190, v24, v25
    v_add_f32 v29, v29, v25
    v_mfma_f32_32x32x16_bf16 a[48:63], a[236:239], a[192:195], a[48:63]
    ds_read_b64_tr_b16 a[228:229], v3 offset:17984
    ds_read_b64_tr_b16 a[230:231], v3 offset:18496
    s_waitcnt lgkmcnt(8)
    v_mfma_f32_32x32x16_bf16 a[0:15], a[240:243], a[196:199], a[0:15]
    ds_read_b64_tr_b16 a[232:233], v3 offset:18048
    ds_read_b64_tr_b16 a[234:235], v3 offset:18560
    v_exp_f32 v26, v158
    v_exp_f32 v27, v159
    v_mfma_f32_32x32x16_bf16 a[16:31], a[244:247], a[196:199], a[16:31]
    ds_read_b64_tr_b16 a[236:237], v3 offset:18112
    ds_read_b64_tr_b16 a[238:239], v3 offset:18624
    s_waitcnt lgkmcnt(8)
    v_mfma_f32_32x32x16_bf16 a[32:47], a[248:251], a[196:199], a[32:47]
    ds_read_b64_tr_b16 a[240:241], v3 offset:26368
    ds_read_b64_tr_b16 a[242:243], v3 offset:26880
    v_add_f32 v28, v28, v26
    v_cvt_pk_bf16_f32 v191, v26, v27
    v_add_f32 v29, v29, v27
    v_mfma_f32_32x32x16_bf16 a[48:63], a[252:255], a[196:199], a[48:63]
    ds_read_b64_tr_b16 a[244:245], v3 offset:26432
    ds_read_b64_tr_b16 a[246:247], v3 offset:26944
    v_add_f32 v28, v28, v29
    v_cmp_nge_f32 vcc, s32, v28
    s_cbranch_vccnz L_rs59
L_back59:
    v_add_f32 v22, v22, v28
    s_waitcnt lgkmcnt(8)
    v_mfma_f32_32x32x16_bf16 a[0:15], a[224:227], a[200:203], a[0:15]
    ds_read_b64_tr_b16 a[248:249], v3 offset:26496
    ds_read_b64_tr_b16 a[250:251], v3 offset:27008
    s_waitcnt vmcnt(24)
    s_barrier
    s_add_u32 m0, s24, 101376
    s_mov_b32 s29, 492032
    s_mov_b32 s30, 531968
    v_exp_f32 v24, v128
    v_exp_f32 v25, v129
    v_mfma_f32_32x32x16_bf16 a[16:31], a[228:231], a[200:203], a[16:31]
    ds_read_b64_tr_b16 a[252:253], v3 offset:26560
    ds_read_b64_tr_b16 a[254:255], v3 offset:27072
    buffer_load_dwordx4 v19, s[16:19], s29 offen nt lds
    v_cvt_pk_bf16_f32 v176, v24, v25
    v_add_f32 v28, v24, v25
    s_waitcnt lgkmcnt(8)
    v_mfma_f32_32x32x16_bf16 a[32:47], a[232:235], a[200:203], a[32:47]
    ds_read_b128 a[224:227], v9 offset:34816
    v_mfma_f32_32x32x16_bf16 a[48:63], a[236:239], a[200:203], a[48:63]
    ds_read_b128 a[228:231], v12 offset:34816
    buffer_load_dwordx4 v19, s[16:19], s30 offen offset:1024 nt lds
    v_exp_f32 v26, v130
    v_exp_f32 v27, v131
    s_waitcnt lgkmcnt(6)
    v_mfma_f32_32x32x16_bf16 a[0:15], a[240:243], a[204:207], a[0:15]
    ds_read_b128 a[232:235], v9 offset:34880
    v_cvt_pk_bf16_f32 v177, v26, v27
    v_add_f32 v29, v26, v27
    v_mfma_f32_32x32x16_bf16 a[16:31], a[244:247], a[204:207], a[16:31]
    ds_read_b128 a[236:239], v12 offset:34880
    buffer_load_dwordx4 v20, s[16:19], s29 offen offset:2112 nt lds
    s_waitcnt lgkmcnt(4)
    v_mfma_f32_32x32x16_bf16 a[32:47], a[248:251], a[204:207], a[32:47]
    ds_read_b128 a[240:243], v9 offset:34944
    v_exp_f32 v24, v132
    v_exp_f32 v25, v133
    v_mfma_f32_32x32x16_bf16 a[48:63], a[252:255], a[204:207], a[48:63]
    ds_read_b128 a[244:247], v12 offset:34944
    buffer_load_dwordx4 v20, s[16:19], s30 offen offset:3136 nt lds
    v_add_f32 v28, v28, v24
    v_cvt_pk_bf16_f32 v178, v24, v25
    v_add_f32 v29, v29, v25
    s_waitcnt lgkmcnt(4)
    v_mfma_f32_32x32x16_bf16 v[144:159], a[224:227], v[192:195], v[160:175]
    ds_read_b128 a[248:251], v9 offset:35008
    v_mfma_f32_32x32x16_bf16 v[144:159], a[228:231], v[196:199], v[144:159]
    ds_read_b128 a[252:255], v12 offset:35008
    v_exp_f32 v26, v134
    v_exp_f32 v27, v135
    s_waitcnt lgkmcnt(4)
    v_mfma_f32_32x32x16_bf16 v[144:159], a[232:235], v[200:203], v[144:159]
    ds_read_b64_tr_b16 a[224:225], v6 offset:33792
    ds_read_b64_tr_b16 a[226:227], v6 offset:34304
    v_add_f32 v28, v28, v26
    v_cvt_pk_bf16_f32 v179, v26, v27
    v_add_f32 v29, v29, v27
    v_mfma_f32_32x32x16_bf16 v[144:159], a[236:239], v[204:207], v[144:159]
    ds_read_b64_tr_b16 a[228:229], v6 offset:33856
    ds_read_b64_tr_b16 a[230:231], v6 offset:34368
    s_waitcnt lgkmcnt(6)
    v_mfma_f32_32x32x16_bf16 v[144:159], a[240:243], v[208:211], v[144:159]
    ds_read_b64_tr_b16 a[232:233], v6 offset:33920
    ds_read_b64_tr_b16 a[234:235], v6 offset:34432
    v_exp_f32 v24, v136
    v_exp_f32 v25, v137
    v_mfma_f32_32x32x16_bf16 v[144:159], a[244:247], v[212:215], v[144:159]
    ds_read_b64_tr_b16 a[236:237], v6 offset:33984
    ds_read_b64_tr_b16 a[238:239], v6 offset:34496
    v_add_f32 v28, v28, v24
    v_cvt_pk_bf16_f32 v180, v24, v25
    v_add_f32 v29, v29, v25
    s_waitcnt lgkmcnt(8)
    v_mfma_f32_32x32x16_bf16 v[144:159], a[248:251], v[216:219], v[144:159]
    ds_read_b64_tr_b16 a[240:241], v6 offset:42240
    ds_read_b64_tr_b16 a[242:243], v6 offset:42752
    v_mfma_f32_32x32x16_bf16 v[144:159], a[252:255], v[220:223], v[144:159]
    ds_read_b64_tr_b16 a[244:245], v6 offset:42304
    ds_read_b64_tr_b16 a[246:247], v6 offset:42816
    v_exp_f32 v26, v138
    v_exp_f32 v27, v139
    s_waitcnt lgkmcnt(8)
    v_mfma_f32_32x32x16_bf16 v[64:79], a[224:227], v[184:187], v[64:79]
    ds_read_b64_tr_b16 a[248:249], v6 offset:42368
    ds_read_b64_tr_b16 a[250:251], v6 offset:42880
    s_waitcnt vmcnt(24)
    s_barrier
    s_add_u32 m0, s24, 118272
    s_mov_b32 s29, 573952
    s_mov_b32 s30, 613888
    v_add_f32 v28, v28, v26
    v_cvt_pk_bf16_f32 v181, v26, v27
    v_add_f32 v29, v29, v27
    v_mfma_f32_32x32x16_bf16 v[80:95], a[228:231], v[184:187], v[80:95]
    ds_read_b64_tr_b16 a[252:253], v6 offset:42432
    ds_read_b64_tr_b16 a[254:255], v6 offset:42944
    buffer_load_dwordx4 v19, s[16:19], s29 offen nt lds
    s_waitcnt lgkmcnt(8)
    v_mfma_f32_32x32x16_bf16 v[96:111], a[232:235], v[184:187], v[96:111]
    ds_read_b128 a[224:227], v7 offset:1024
    v_exp_f32 v24, v140
    v_exp_f32 v25, v141
    v_mfma_f32_32x32x16_bf16 v[112:127], a[236:239], v[184:187], v[112:127]
    ds_read_b128 a[228:231], v10 offset:1024
    buffer_load_dwordx4 v19, s[16:19], s30 offen offset:1024 nt lds
    v_add_f32 v28, v28, v24
    v_cvt_pk_bf16_f32 v182, v24, v25
    v_add_f32 v29, v29, v25
    s_waitcnt lgkmcnt(6)
    v_mfma_f32_32x32x16_bf16 v[64:79], a[240:243], v[188:191], v[64:79]
    ds_read_b128 a[232:235], v7 offset:1088
    v_mfma_f32_32x32x16_bf16 v[80:95], a[244:247], v[188:191], v[80:95]
    ds_read_b128 a[236:239], v10 offset:1088
    buffer_load_dwordx4 v20, s[16:19], s29 offen offset:2112 nt lds
    v_exp_f32 v26, v142
    v_exp_f32 v27, v143
    s_waitcnt lgkmcnt(4)
    v_mfma_f32_32x32x16_bf16 v[96:111], a[248:251], v[188:191], v[96:111]
    ds_read_b128 a[240:243], v7 offset:1152
    v_add_f32 v28, v28, v26
    v_cvt_pk_bf16_f32 v183, v26, v27
    v_add_f32 v29, v29, v27
    v_mfma_f32_32x32x16_bf16 v[112:127], a[252:255], v[188:191], v[112:127]
    ds_read_b128 a[244:247], v10 offset:1152
    buffer_load_dwordx4 v20, s[16:19], s30 offen offset:3136 nt lds
    v_add_f32 v28, v28, v29
    v_cmp_nge_f32 vcc, s32, v28
    s_cbranch_vccnz L_rs60
L_back60:
    v_add_f32 v22, v22, v28
    s_waitcnt lgkmcnt(4)
    v_mfma_f32_32x32x16_bf16 v[128:143], a[224:227], v[192:195], v[160:175]
    ds_read_b128 a[248:251], v7 offset:1216
    v_exp_f32 v24, v144
    v_exp_f32 v25, v145
    v_mfma_f32_32x32x16_bf16 v[128:143], a[228:231], v[196:199], v[128:143]
    ds_read_b128 a[252:255], v10 offset:1216
    v_cvt_pk_bf16_f32 v184, v24, v25
    v_add_f32 v28, v24, v25
    s_waitcnt lgkmcnt(4)
    v_mfma_f32_32x32x16_bf16 v[128:143], a[232:235], v[200:203], v[128:143]
    ds_read_b64_tr_b16 a[224:225], v4 offset:0
    ds_read_b64_tr_b16 a[226:227], v4 offset:512
    v_mfma_f32_32x32x16_bf16 v[128:143], a[236:239], v[204:207], v[128:143]
    ds_read_b64_tr_b16 a[228:229], v4 offset:64
    ds_read_b64_tr_b16 a[230:231], v4 offset:576
    v_exp_f32 v26, v146
    v_exp_f32 v27, v147
    s_waitcnt lgkmcnt(6)
    v_mfma_f32_32x32x16_bf16 v[128:143], a[240:243], v[208:211], v[128:143]
    ds_read_b64_tr_b16 a[232:233], v4 offset:128
    ds_read_b64_tr_b16 a[234:235], v4 offset:640
    v_cvt_pk_bf16_f32 v185, v26, v27
    v_add_f32 v29, v26, v27
    v_mfma_f32_32x32x16_bf16 v[128:143], a[244:247], v[212:215], v[128:143]
    ds_read_b64_tr_b16 a[236:237], v4 offset:192
    ds_read_b64_tr_b16 a[238:239], v4 offset:704
    s_waitcnt lgkmcnt(8)
    v_mfma_f32_32x32x16_bf16 v[128:143], a[248:251], v[216:219], v[128:143]
    ds_read_b64_tr_b16 a[240:241], v4 offset:8448
    ds_read_b64_tr_b16 a[242:243], v4 offset:8960
    v_exp_f32 v24, v148
    v_exp_f32 v25, v149
    v_mfma_f32_32x32x16_bf16 v[128:143], a[252:255], v[220:223], v[128:143]
    ds_read_b64_tr_b16 a[244:245], v4 offset:8512
    ds_read_b64_tr_b16 a[246:247], v4 offset:9024
    v_add_f32 v28, v28, v24
    v_cvt_pk_bf16_f32 v186, v24, v25
    v_add_f32 v29, v29, v25
    s_waitcnt lgkmcnt(8)
    v_mfma_f32_32x32x16_bf16 v[64:79], a[224:227], v[176:179], v[64:79]
    ds_read_b64_tr_b16 a[248:249], v4 offset:8576
    ds_read_b64_tr_b16 a[250:251], v4 offset:9088
    s_waitcnt vmcnt(24)
    s_barrier
    s_add_u32 m0, s24, 135168
    s_mov_b32 s29, 492288
    s_mov_b32 s30, 532224
    v_mfma_f32_32x32x16_bf16 v[80:95], a[228:231], v[176:179], v[80:95]
    ds_read_b64_tr_b16 a[252:253], v4 offset:8640
    ds_read_b64_tr_b16 a[254:255], v4 offset:9152
    buffer_load_dwordx4 v19, s[16:19], s29 offen nt lds
    v_exp_f32 v26, v150
    v_exp_f32 v27, v151
    s_waitcnt lgkmcnt(8)
    v_mfma_f32_32x32x16_bf16 v[96:111], a[232:235], v[176:179], v[96:111]
    ds_read_b64_tr_b16 a[224:225], v1 offset:16896
    ds_read_b64_tr_b16 a[226:227], v1 offset:17408
    v_add_f32 v28, v28, v26
    v_cvt_pk_bf16_f32 v187, v26, v27
    v_add_f32 v29, v29, v27
    v_mfma_f32_32x32x16_bf16 v[112:127], a[236:239], v[176:179], v[112:127]
    ds_read_b64_tr_b16 a[228:229], v1 offset:16960
    ds_read_b64_tr_b16 a[230:231], v1 offset:17472
    buffer_load_dwordx4 v19, s[16:19], s30 offen offset:1024 nt lds
    s_waitcnt lgkmcnt(8)
    v_mfma_f32_32x32x16_bf16 v[64:79], a[240:243], v[180:183], v[64:79]
    ds_read_b64_tr_b16 a[232:233], v1 offset:17024
    ds_read_b64_tr_b16 a[234:235], v1 offset:17536
    v_exp_f32 v24, v152
    v_exp_f32 v25, v153
    v_mfma_f32_32x32x16_bf16 v[80:95], a[244:247], v[180:183], v[80:95]
    ds_read_b64_tr_b16 a[236:237], v1 offset:17088
    ds_read_b64_tr_b16 a[238:239], v1 offset:17600
    buffer_load_dwordx4 v20, s[16:19], s29 offen offset:2112 nt lds
    v_add_f32 v28, v28, v24
    v_cvt_pk_bf16_f32 v188, v24, v25
    v_add_f32 v29, v29, v25
    s_waitcnt lgkmcnt(8)
    v_mfma_f32_32x32x16_bf16 v[96:111], a[248:251], v[180:183], v[96:111]
    ds_read_b64_tr_b16 a[240:241], v1 offset:25344
    ds_read_b64_tr_b16 a[242:243], v1 offset:25856
    v_mfma_f32_32x32x16_bf16 v[112:127], a[252:255], v[180:183], v[112:127]
    ds_read_b64_tr_b16 a[244:245], v1 offset:25408
    ds_read_b64_tr_b16 a[246:247], v1 offset:25920
    buffer_load_dwordx4 v20, s[16:19], s30 offen offset:3136 nt lds
    v_exp_f32 v26, v154
    v_exp_f32 v27, v155
    s_waitcnt lgkmcnt(8)
    v_mfma_f32_32x32x16_bf16 a[0:15], a[224:227], a[208:211], a[0:15]
    ds_read_b64_tr_b16 a[248:249], v1 offset:25472
    ds_read_b64_tr_b16 a[250:251], v1 offset:25984
    v_add_f32 v28, v28, v26
    v_cvt_pk_bf16_f32 v189, v26, v27
    v_add_f32 v29, v29, v27
    v_mfma_f32_32x32x16_bf16 a[16:31], a[228:231], a[208:211], a[16:31]
    ds_read_b64_tr_b16 a[252:253], v1 offset:25536
    ds_read_b64_tr_b16 a[254:255], v1 offset:26048
    s_waitcnt lgkmcnt(8)
    v_mfma_f32_32x32x16_bf16 a[32:47], a[232:235], a[208:211], a[32:47]
    ds_read_b64_tr_b16 a[224:225], v1 offset:17920
    ds_read_b64_tr_b16 a[226:227], v1 offset:18432
    v_exp_f32 v24, v156
    v_exp_f32 v25, v157
    v_mfma_f32_32x32x16_bf16 a[48:63], a[236:239], a[208:211], a[48:63]
    ds_read_b64_tr_b16 a[228:229], v1 offset:17984
    ds_read_b64_tr_b16 a[230:231], v1 offset:18496
    v_add_f32 v28, v28, v24
    v_cvt_pk_bf16_f32 v190, v24, v25
    v_add_f32 v29, v29, v25
    s_waitcnt lgkmcnt(8)
    v_mfma_f32_32x32x16_bf16 a[0:15], a[240:243], a[212:215], a[0:15]
    ds_read_b64_tr_b16 a[232:233], v1 offset:18048
    ds_read_b64_tr_b16 a[234:235], v1 offset:18560
    v_mfma_f32_32x32x16_bf16 a[16:31], a[244:247], a[212:215], a[16:31]
    ds_read_b64_tr_b16 a[236:237], v1 offset:18112
    ds_read_b64_tr_b16 a[238:239], v1 offset:18624
    v_exp_f32 v26, v158
    v_exp_f32 v27, v159
    s_waitcnt lgkmcnt(8)
    v_mfma_f32_32x32x16_bf16 a[32:47], a[248:251], a[212:215], a[32:47]
    ds_read_b64_tr_b16 a[240:241], v1 offset:26368
    ds_read_b64_tr_b16 a[242:243], v1 offset:26880
    v_add_f32 v28, v28, v26
    v_cvt_pk_bf16_f32 v191, v26, v27
    v_add_f32 v29, v29, v27
    v_mfma_f32_32x32x16_bf16 a[48:63], a[252:255], a[212:215], a[48:63]
    ds_read_b64_tr_b16 a[244:245], v1 offset:26432
    ds_read_b64_tr_b16 a[246:247], v1 offset:26944
    v_add_f32 v28, v28, v29
    v_cmp_nge_f32 vcc, s32, v28
    s_cbranch_vccnz L_rs61
L_back61:
    v_add_f32 v22, v22, v28
    s_waitcnt lgkmcnt(8)
    v_mfma_f32_32x32x16_bf16 a[0:15], a[224:227], a[216:219], a[0:15]
    ds_read_b64_tr_b16 a[248:249], v1 offset:26496
    ds_read_b64_tr_b16 a[250:251], v1 offset:27008
    s_waitcnt vmcnt(24)
    s_barrier
    s_add_u32 m0, s24, 0
    s_mov_b32 s29, 574208
    s_mov_b32 s30, 614144
    v_exp_f32 v24, v128
    v_exp_f32 v25, v129
    v_mfma_f32_32x32x16_bf16 a[16:31], a[228:231], a[216:219], a[16:31]
    ds_read_b64_tr_b16 a[252:253], v1 offset:26560
    ds_read_b64_tr_b16 a[254:255], v1 offset:27072
    buffer_load_dwordx4 v19, s[16:19], s29 offen nt lds
    v_cvt_pk_bf16_f32 v176, v24, v25
    v_add_f32 v28, v24, v25
    s_waitcnt lgkmcnt(8)
    v_mfma_f32_32x32x16_bf16 a[32:47], a[232:235], a[216:219], a[32:47]
    ds_read_b128 a[224:227], v7 offset:34816
    v_mfma_f32_32x32x16_bf16 a[48:63], a[236:239], a[216:219], a[48:63]
    ds_read_b128 a[228:231], v10 offset:34816
    buffer_load_dwordx4 v19, s[16:19], s30 offen offset:1024 nt lds
    v_exp_f32 v26, v130
    v_exp_f32 v27, v131
    s_waitcnt lgkmcnt(6)
    v_mfma_f32_32x32x16_bf16 a[0:15], a[240:243], a[220:223], a[0:15]
    ds_read_b128 a[232:235], v7 offset:34880
    v_cvt_pk_bf16_f32 v177, v26, v27
    v_add_f32 v29, v26, v27
    v_mfma_f32_32x32x16_bf16 a[16:31], a[244:247], a[220:223], a[16:31]
    ds_read_b128 a[236:239], v10 offset:34880
    buffer_load_dwordx4 v20, s[16:19], s29 offen offset:2112 nt lds
    s_waitcnt lgkmcnt(4)
    v_mfma_f32_32x32x16_bf16 a[32:47], a[248:251], a[220:223], a[32:47]
    ds_read_b128 a[240:243], v7 offset:34944
    v_exp_f32 v24, v132
    v_exp_f32 v25, v133
    v_mfma_f32_32x32x16_bf16 a[48:63], a[252:255], a[220:223], a[48:63]
    ds_read_b128 a[244:247], v10 offset:34944
    buffer_load_dwordx4 v20, s[16:19], s30 offen offset:3136 nt lds
    v_add_f32 v28, v28, v24
    v_cvt_pk_bf16_f32 v178, v24, v25
    v_add_f32 v29, v29, v25
    s_waitcnt lgkmcnt(4)
    v_mfma_f32_32x32x16_bf16 v[144:159], a[224:227], v[192:195], v[160:175]
    ds_read_b128 a[248:251], v7 offset:35008
    v_mfma_f32_32x32x16_bf16 v[144:159], a[228:231], v[196:199], v[144:159]
    ds_read_b128 a[252:255], v10 offset:35008
    v_exp_f32 v26, v134
    v_exp_f32 v27, v135
    s_waitcnt lgkmcnt(4)
    v_mfma_f32_32x32x16_bf16 v[144:159], a[232:235], v[200:203], v[144:159]
    ds_read_b64_tr_b16 a[224:225], v4 offset:33792
    ds_read_b64_tr_b16 a[226:227], v4 offset:34304
    v_add_f32 v28, v28, v26
    v_cvt_pk_bf16_f32 v179, v26, v27
    v_add_f32 v29, v29, v27
    v_mfma_f32_32x32x16_bf16 v[144:159], a[236:239], v[204:207], v[144:159]
    ds_read_b64_tr_b16 a[228:229], v4 offset:33856
    ds_read_b64_tr_b16 a[230:231], v4 offset:34368
    s_waitcnt lgkmcnt(6)
    v_mfma_f32_32x32x16_bf16 v[144:159], a[240:243], v[208:211], v[144:159]
    ds_read_b64_tr_b16 a[232:233], v4 offset:33920
    ds_read_b64_tr_b16 a[234:235], v4 offset:34432
    v_exp_f32 v24, v136
    v_exp_f32 v25, v137
    v_mfma_f32_32x32x16_bf16 v[144:159], a[244:247], v[212:215], v[144:159]
    ds_read_b64_tr_b16 a[236:237], v4 offset:33984
    ds_read_b64_tr_b16 a[238:239], v4 offset:34496
    v_add_f32 v28, v28, v24
    v_cvt_pk_bf16_f32 v180, v24, v25
    v_add_f32 v29, v29, v25
    s_waitcnt lgkmcnt(8)
    v_mfma_f32_32x32x16_bf16 v[144:159], a[248:251], v[216:219], v[144:159]
    ds_read_b64_tr_b16 a[240:241], v4 offset:42240
    ds_read_b64_tr_b16 a[242:243], v4 offset:42752
    v_mfma_f32_32x32x16_bf16 v[144:159], a[252:255], v[220:223], v[144:159]
    ds_read_b64_tr_b16 a[244:245], v4 offset:42304
    ds_read_b64_tr_b16 a[246:247], v4 offset:42816
    v_exp_f32 v26, v138
    v_exp_f32 v27, v139
    s_waitcnt lgkmcnt(8)
    v_mfma_f32_32x32x16_bf16 v[64:79], a[224:227], v[184:187], v[64:79]
    ds_read_b64_tr_b16 a[248:249], v4 offset:42368
    ds_read_b64_tr_b16 a[250:251], v4 offset:42880
    s_waitcnt vmcnt(24)
    s_barrier
    s_add_u32 m0, s24, 16896
    s_mov_b32 s29, 327680
    s_mov_b32 s30, 367616
    v_add_f32 v28, v28, v26
    v_cvt_pk_bf16_f32 v181, v26, v27
    v_add_f32 v29, v29, v27
    v_mfma_f32_32x32x16_bf16 v[80:95], a[228:231], v[184:187], v[80:95]
    ds_read_b64_tr_b16 a[252:253], v4 offset:42432
    ds_read_b64_tr_b16 a[254:255], v4 offset:42944
    buffer_load_dwordx4 v19, s[16:19], s29 offen nt lds
    s_waitcnt lgkmcnt(8)
    v_mfma_f32_32x32x16_bf16 v[96:111], a[232:235], v[184:187], v[96:111]
    ds_read_b64_tr_b16 a[224:225], v2 offset:0
    ds_read_b64_tr_b16 a[226:227], v2 offset:512
    v_exp_f32 v24, v140
    v_exp_f32 v25, v141
    v_mfma_f32_32x32x16_bf16 v[112:127], a[236:239], v[184:187], v[112:127]
    ds_read_b64_tr_b16 a[228:229], v2 offset:64
    ds_read_b64_tr_b16 a[230:231], v2 offset:576
    buffer_load_dwordx4 v19, s[16:19], s30 offen offset:1024 nt lds
    v_add_f32 v28, v28, v24
    v_cvt_pk_bf16_f32 v182, v24, v25
    v_add_f32 v29, v29, v25
    s_waitcnt lgkmcnt(8)
    v_mfma_f32_32x32x16_bf16 v[64:79], a[240:243], v[188:191], v[64:79]
    ds_read_b64_tr_b16 a[232:233], v2 offset:128
    ds_read_b64_tr_b16 a[234:235], v2 offset:640
    v_mfma_f32_32x32x16_bf16 v[80:95], a[244:247], v[188:191], v[80:95]
    ds_read_b64_tr_b16 a[236:237], v2 offset:192
    ds_read_b64_tr_b16 a[238:239], v2 offset:704
    buffer_load_dwordx4 v20, s[16:19], s29 offen offset:2112 nt lds
    v_exp_f32 v26, v142
    v_exp_f32 v27, v143
    s_waitcnt lgkmcnt(8)
    v_mfma_f32_32x32x16_bf16 v[96:111], a[248:251], v[188:191], v[96:111]
    ds_read_b64_tr_b16 a[240:241], v2 offset:8448
    ds_read_b64_tr_b16 a[242:243], v2 offset:8960
    v_add_f32 v28, v28, v26
    v_cvt_pk_bf16_f32 v183, v26, v27
    v_add_f32 v29, v29, v27
    v_mfma_f32_32x32x16_bf16 v[112:127], a[252:255], v[188:191], v[112:127]
    ds_read_b64_tr_b16 a[244:245], v2 offset:8512
    ds_read_b64_tr_b16 a[246:247], v2 offset:9024
    buffer_load_dwordx4 v20, s[16:19], s30 offen offset:3136 nt lds
    v_add_f32 v28, v28, v29
    v_cmp_nge_f32 vcc, s32, v28
    s_cbranch_vccnz L_rs62
L_back62:
    v_add_f32 v22, v22, v28
    s_waitcnt lgkmcnt(8)
    v_mfma_f32_32x32x16_bf16 a[64:79], a[224:227], a[192:195], a[64:79]
    ds_read_b64_tr_b16 a[248:249], v2 offset:8576
    ds_read_b64_tr_b16 a[250:251], v2 offset:9088
    v_exp_f32 v24, v144
    v_exp_f32 v25, v145
    v_accvgpr_read_b32 v160, a144
    v_and_b32 v161, 0xffff0000, v160
    v_mfma_f32_32x32x16_bf16 a[80:95], a[228:231], a[192:195], a[80:95]
    ds_read_b64_tr_b16 a[252:253], v2 offset:8640
    ds_read_b64_tr_b16 a[254:255], v2 offset:9152
    v_cvt_pk_bf16_f32 v184, v24, v25
    v_add_f32 v28, v24, v25
    v_lshlrev_b32 v160, 16, v160
    s_waitcnt lgkmcnt(8)
    v_mfma_f32_32x32x16_bf16 a[96:111], a[232:235], a[192:195], a[96:111]
    ds_read_b64_tr_b16 a[224:225], v2 offset:1024
    ds_read_b64_tr_b16 a[226:227], v2 offset:1536
    v_accvgpr_read_b32 v162, a145
    v_and_b32 v163, 0xffff0000, v162
    v_mfma_f32_32x32x16_bf16 a[112:127], a[236:239], a[192:195], a[112:127]
    ds_read_b64_tr_b16 a[228:229], v2 offset:1088
    ds_read_b64_tr_b16 a[230:231], v2 offset:1600
    v_exp_f32 v26, v146
    v_exp_f32 v27, v147
    v_lshlrev_b32 v162, 16, v162
    s_waitcnt lgkmcnt(8)
    v_mfma_f32_32x32x16_bf16 a[64:79], a[240:243], a[196:199], a[64:79]
    ds_read_b64_tr_b16 a[232:233], v2 offset:1152
    ds_read_b64_tr_b16 a[234:235], v2 offset:1664
    v_cvt_pk_bf16_f32 v185, v26, v27
    v_add_f32 v29, v26, v27
    v_accvgpr_read_b32 v164, a146
    v_and_b32 v165, 0xffff0000, v164
    v_mfma_f32_32x32x16_bf16 a[80:95], a[244:247], a[196:199], a[80:95]
    ds_read_b64_tr_b16 a[236:237], v2 offset:1216
    ds_read_b64_tr_b16 a[238:239], v2 offset:1728
    v_lshlrev_b32 v164, 16, v164
    s_waitcnt lgkmcnt(8)
    v_mfma_f32_32x32x16_bf16 a[96:111], a[248:251], a[196:199], a[96:111]
    ds_read_b64_tr_b16 a[240:241], v2 offset:9472
    ds_read_b64_tr_b16 a[242:243], v2 offset:9984
    v_exp_f32 v24, v148
    v_exp_f32 v25, v149
    v_accvgpr_read_b32 v166, a147
    v_and_b32 v167, 0xffff0000, v166
    v_mfma_f32_32x32x16_bf16 a[112:127], a[252:255], a[196:199], a[112:127]
    ds_read_b64_tr_b16 a[244:245], v2 offset:9536
    ds_read_b64_tr_b16 a[246:247], v2 offset:10048
    v_add_f32 v28, v28, v24
    v_cvt_pk_bf16_f32 v186, v24, v25
    v_add_f32 v29, v29, v25
    v_lshlrev_b32 v166, 16, v166
    s_waitcnt lgkmcnt(8)
    v_mfma_f32_32x32x16_bf16 a[64:79], a[224:227], a[200:203], a[64:79]
    ds_read_b64_tr_b16 a[248:249], v2 offset:9600
    ds_read_b64_tr_b16 a[250:251], v2 offset:10112
    s_waitcnt vmcnt(24)
    s_barrier
    s_add_u32 m0, s24, 33792
    s_mov_b32 s29, 409600
    s_mov_b32 s30, 449536
    v_accvgpr_read_b32 v168, a148
    v_and_b32 v169, 0xffff0000, v168
    v_mfma_f32_32x32x16_bf16 a[80:95], a[228:231], a[200:203], a[80:95]
    ds_read_b64_tr_b16 a[252:253], v2 offset:9664
    ds_read_b64_tr_b16 a[254:255], v2 offset:10176
    buffer_load_dwordx4 v19, s[16:19], s29 offen nt lds
    v_exp_f32 v26, v150
    v_exp_f32 v27, v151
    v_lshlrev_b32 v168, 16, v168
    s_waitcnt lgkmcnt(8)
    v_mfma_f32_32x32x16_bf16 a[96:111], a[232:235], a[200:203], a[96:111]
    ds_read_b64_tr_b16 a[224:225], v5 offset:16896
    ds_read_b64_tr_b16 a[226:227], v5 offset:17408
    v_add_f32 v28, v28, v26
    v_cvt_pk_bf16_f32 v187, v26, v27
    v_add_f32 v29, v29, v27
    v_accvgpr_read_b32 v170, a149
    v_and_b32 v171, 0xffff0000, v170
    v_mfma_f32_32x32x16_bf16 a[112:127], a[236:239], a[200:203], a[112:127]
    ds_read_b64_tr_b16 a[228:229], v5 offset:16960
    ds_read_b64_tr_b16 a[230:231], v5 offset:17472
    buffer_load_dwordx4 v19, s[16:19], s30 offen offset:1024 nt lds
    v_lshlrev_b32 v170, 16, v170
    s_waitcnt lgkmcnt(8)
    v_mfma_f32_32x32x16_bf16 a[64:79], a[240:243], a[204:207], a[64:79]
    ds_read_b64_tr_b16 a[232:233], v5 offset:17024
    ds_read_b64_tr_b16 a[234:235], v5 offset:17536
    v_exp_f32 v24, v152
    v_exp_f32 v25, v153
    v_accvgpr_read_b32 v172, a150
    v_and_b32 v173, 0xffff0000, v172
    v_mfma_f32_32x32x16_bf16 a[80:95], a[244:247], a[204:207], a[80:95]
    ds_read_b64_tr_b16 a[236:237], v5 offset:17088
    ds_read_b64_tr_b16 a[238:239], v5 offset:17600
    buffer_load_dwordx4 v20, s[16:19], s29 offen offset:2112 nt lds
    v_add_f32 v28, v28, v24
    v_cvt_pk_bf16_f32 v188, v24, v25
    v_add_f32 v29, v29, v25
    v_lshlrev_b32 v172, 16, v172
    s_waitcnt lgkmcnt(8)
    v_mfma_f32_32x32x16_bf16 a[96:111], a[248:251], a[204:207], a[96:111]
    ds_read_b64_tr_b16 a[240:241], v5 offset:25344
    ds_read_b64_tr_b16 a[242:243], v5 offset:25856
    v_accvgpr_read_b32 v174, a151
    v_and_b32 v175, 0xffff0000, v174
    v_mfma_f32_32x32x16_bf16 a[112:127], a[252:255], a[204:207], a[112:127]
    ds_read_b64_tr_b16 a[244:245], v5 offset:25408
    ds_read_b64_tr_b16 a[246:247], v5 offset:25920
    buffer_load_dwordx4 v20, s[16:19], s30 offen offset:3136 nt lds
    v_exp_f32 v26, v154
    v_exp_f32 v27, v155
    v_lshlrev_b32 v174, 16, v174
    s_waitcnt lgkmcnt(8)
    v_mfma_f32_32x32x16_bf16 v[64:79], a[224:227], v[176:179], v[64:79]
    ds_read_b64_tr_b16 a[248:249], v5 offset:25472
    ds_read_b64_tr_b16 a[250:251], v5 offset:25984
    v_add_f32 v28, v28, v26
    v_cvt_pk_bf16_f32 v189, v26, v27
    v_add_f32 v29, v29, v27
    v_mfma_f32_32x32x16_bf16 v[80:95], a[228:231], v[176:179], v[80:95]
    ds_read_b64_tr_b16 a[252:253], v5 offset:25536
    ds_read_b64_tr_b16 a[254:255], v5 offset:26048
    s_waitcnt lgkmcnt(8)
    v_mfma_f32_32x32x16_bf16 v[96:111], a[232:235], v[176:179], v[96:111]
    ds_read_b64_tr_b16 a[224:225], v5 offset:17920
    ds_read_b64_tr_b16 a[226:227], v5 offset:18432
    v_exp_f32 v24, v156
    v_exp_f32 v25, v157
    v_mfma_f32_32x32x16_bf16 v[112:127], a[236:239], v[176:179], v[112:127]
    ds_read_b64_tr_b16 a[228:229], v5 offset:17984
    ds_read_b64_tr_b16 a[230:231], v5 offset:18496
    v_add_f32 v28, v28, v24
    v_cvt_pk_bf16_f32 v190, v24, v25
    v_add_f32 v29, v29, v25
    s_waitcnt lgkmcnt(8)
    v_mfma_f32_32x32x16_bf16 v[64:79], a[240:243], v[180:183], v[64:79]
    ds_read_b64_tr_b16 a[232:233], v5 offset:18048
    ds_read_b64_tr_b16 a[234:235], v5 offset:18560
    v_mfma_f32_32x32x16_bf16 v[80:95], a[244:247], v[180:183], v[80:95]
    ds_read_b64_tr_b16 a[236:237], v5 offset:18112
    ds_read_b64_tr_b16 a[238:239], v5 offset:18624
    v_exp_f32 v26, v158
    v_exp_f32 v27, v159
    s_waitcnt lgkmcnt(8)
    v_mfma_f32_32x32x16_bf16 v[96:111], a[248:251], v[180:183], v[96:111]
    ds_read_b64_tr_b16 a[240:241], v5 offset:26368
    ds_read_b64_tr_b16 a[242:243], v5 offset:26880
    v_add_f32 v28, v28, v26
    v_cvt_pk_bf16_f32 v191, v26, v27
    v_add_f32 v29, v29, v27
    v_mfma_f32_32x32x16_bf16 v[112:127], a[252:255], v[180:183], v[112:127]
    ds_read_b64_tr_b16 a[244:245], v5 offset:26432
    ds_read_b64_tr_b16 a[246:247], v5 offset:26944
    v_add_f32 v28, v28, v29
    v_cmp_nge_f32 vcc, s32, v28
    s_cbranch_vccnz L_rs63
L_back63:
    v_add_f32 v22, v22, v28
    s_waitcnt lgkmcnt(8)
    v_mfma_f32_32x32x16_bf16 v[64:79], a[224:227], v[184:187], v[64:79]
    ds_read_b64_tr_b16 a[248:249], v5 offset:26496
    ds_read_b64_tr_b16 a[250:251], v5 offset:27008
    s_waitcnt vmcnt(24)
    s_barrier
    s_add_u32 m0, s24, 50688
    s_mov_b32 s29, 491520
    s_mov_b32 s30, 531456
    v_mfma_f32_32x32x16_bf16 v[80:95], a[228:231], v[184:187], v[80:95]
    ds_read_b64_tr_b16 a[252:253], v5 offset:26560
    ds_read_b64_tr_b16 a[254:255], v5 offset:27072
    buffer_load_dwordx4 v19, s[16:19], s29 offen nt lds
    v_mov_b32 v31, v22
    v_accvgpr_read_b32 v128, a128
    v_and_b32 v129, 0xffff0000, v128
    v_lshlrev_b32 v128, 16, v128
    s_waitcnt lgkmcnt(8)
    v_mfma_f32_32x32x16_bf16 v[96:111], a[232:235], v[184:187], v[96:111]
    ds_read_b64_tr_b16 a[224:225], v2 offset:33792
    ds_read_b64_tr_b16 a[226:227], v2 offset:34304
    v_permlane32_swap_b32 v22, v31
    v_accvgpr_read_b32 v130, a129
    v_and_b32 v131, 0xffff0000, v130
    v_lshlrev_b32 v130, 16, v130
    v_mfma_f32_32x32x16_bf16 v[112:127], a[236:239], v[184:187], v[112:127]
    ds_read_b64_tr_b16 a[228:229], v2 offset:33856
    ds_read_b64_tr_b16 a[230:231], v2 offset:34368
    buffer_load_dwordx4 v19, s[16:19], s30 offen offset:1024 nt lds
    v_add_f32 v22, v22, v31
    v_accvgpr_read_b32 v132, a130
    v_and_b32 v133, 0xffff0000, v132
    v_lshlrev_b32 v132, 16, v132
    s_waitcnt lgkmcnt(8)
    v_mfma_f32_32x32x16_bf16 v[64:79], a[240:243], v[188:191], v[64:79]
    ds_read_b64_tr_b16 a[232:233], v2 offset:33920
    ds_read_b64_tr_b16 a[234:235], v2 offset:34432
    v_rcp_f32 v23, v22
    v_accvgpr_read_b32 v134, a131
    v_and_b32 v135, 0xffff0000, v134
    v_lshlrev_b32 v134, 16, v134
    v_mfma_f32_32x32x16_bf16 v[80:95], a[244:247], v[188:191], v[80:95]
    ds_read_b64_tr_b16 a[236:237], v2 offset:33984
    ds_read_b64_tr_b16 a[238:239], v2 offset:34496
    buffer_load_dwordx4 v20, s[16:19], s29 offen offset:2112 nt lds
    v_accvgpr_read_b32 v136, a132
    v_and_b32 v137, 0xffff0000, v136
    v_lshlrev_b32 v136, 16, v136
    s_waitcnt lgkmcnt(8)
    v_mfma_f32_32x32x16_bf16 v[96:111], a[248:251], v[188:191], v[96:111]
    ds_read_b64_tr_b16 a[240:241], v2 offset:42240
    ds_read_b64_tr_b16 a[242:243], v2 offset:42752
    v_accvgpr_read_b32 v138, a133
    v_and_b32 v139, 0xffff0000, v138
    v_lshlrev_b32 v138, 16, v138
    v_mfma_f32_32x32x16_bf16 v[112:127], a[252:255], v[188:191], v[112:127]
    ds_read_b64_tr_b16 a[244:245], v2 offset:42304
    ds_read_b64_tr_b16 a[246:247], v2 offset:42816
    buffer_load_dwordx4 v20, s[16:19], s30 offen offset:3136 nt lds
    v_accvgpr_read_b32 v140, a134
    v_and_b32 v141, 0xffff0000, v140
    v_lshlrev_b32 v140, 16, v140
    s_waitcnt lgkmcnt(8)
    v_mfma_f32_32x32x16_bf16 a[64:79], a[224:227], a[208:211], a[64:79]
    ds_read_b64_tr_b16 a[248:249], v2 offset:42368
    ds_read_b64_tr_b16 a[250:251], v2 offset:42880
    v_accvgpr_read_b32 v142, a135
    v_and_b32 v143, 0xffff0000, v142
    v_lshlrev_b32 v142, 16, v142
    v_mfma_f32_32x32x16_bf16 a[80:95], a[228:231], a[208:211], a[80:95]
    ds_read_b64_tr_b16 a[252:253], v2 offset:42432
    ds_read_b64_tr_b16 a[254:255], v2 offset:42944
    s_waitcnt lgkmcnt(8)
    v_mfma_f32_32x32x16_bf16 a[96:111], a[232:235], a[208:211], a[96:111]
    ds_read_b64_tr_b16 a[224:225], v2 offset:34816
    ds_read_b64_tr_b16 a[226:227], v2 offset:35328
    v_mul_f32 v64, v64, v23
    v_mul_f32 v65, v65, v23
    v_cvt_pk_bf16_f32 v192, v64, v65
    v_mul_f32 v66, v66, v23
    v_mfma_f32_32x32x16_bf16 a[112:127], a[236:239], a[208:211], a[112:127]
    ds_read_b64_tr_b16 a[228:229], v2 offset:34880
    ds_read_b64_tr_b16 a[230:231], v2 offset:35392
    v_mul_f32 v67, v67, v23
    v_cvt_pk_bf16_f32 v193, v66, v67
    v_mul_f32 v68, v68, v23
    v_mul_f32 v69, v69, v23
    s_waitcnt lgkmcnt(8)
    v_mfma_f32_32x32x16_bf16 a[64:79], a[240:243], a[212:215], a[64:79]
    ds_read_b64_tr_b16 a[232:233], v2 offset:34944
    ds_read_b64_tr_b16 a[234:235], v2 offset:35456
    v_cvt_pk_bf16_f32 v194, v68, v69
    v_mul_f32 v70, v70, v23
    v_mul_f32 v71, v71, v23
    v_cvt_pk_bf16_f32 v195, v70, v71
    v_mfma_f32_32x32x16_bf16 a[80:95], a[244:247], a[212:215], a[80:95]
    ds_read_b64_tr_b16 a[236:237], v2 offset:35008
    ds_read_b64_tr_b16 a[238:239], v2 offset:35520
    v_mul_f32 v72, v72, v23
    v_mul_f32 v73, v73, v23
    v_cvt_pk_bf16_f32 v196, v72, v73
    s_waitcnt lgkmcnt(8)
    v_mfma_f32_32x32x16_bf16 a[96:111], a[248:251], a[212:215], a[96:111]
    ds_read_b64_tr_b16 a[240:241], v2 offset:43264
    ds_read_b64_tr_b16 a[242:243], v2 offset:43776
    v_mul_f32 v74, v74, v23
    v_mul_f32 v75, v75, v23
    v_cvt_pk_bf16_f32 v197, v74, v75
    v_mul_f32 v76, v76, v23
    v_mfma_f32_32x32x16_bf16 a[112:127], a[252:255], a[212:215], a[112:127]
    ds_read_b64_tr_b16 a[244:245], v2 offset:43328
    ds_read_b64_tr_b16 a[246:247], v2 offset:43840
    v_mul_f32 v77, v77, v23
    v_cvt_pk_bf16_f32 v198, v76, v77
    v_mul_f32 v78, v78, v23
    v_mul_f32 v79, v79, v23
    s_waitcnt lgkmcnt(8)
    v_mfma_f32_32x32x16_bf16 a[64:79], a[224:227], a[216:219], a[64:79]
    ds_read_b64_tr_b16 a[248:249], v2 offset:43392
    ds_read_b64_tr_b16 a[250:251], v2 offset:43904
    s_waitcnt vmcnt(24)
    s_barrier
    s_add_u32 m0, s24, 67584
    s_mov_b32 s29, 573440
    s_mov_b32 s30, 613376
    v_cvt_pk_bf16_f32 v199, v78, v79
    v_mul_f32 v80, v80, v23
    v_mul_f32 v81, v81, v23
    v_mfma_f32_32x32x16_bf16 a[80:95], a[228:231], a[216:219], a[80:95]
    ds_read_b64_tr_b16 a[252:253], v2 offset:43456
    ds_read_b64_tr_b16 a[254:255], v2 offset:43968
    buffer_load_dwordx4 v19, s[16:19], s29 offen nt lds
    v_cvt_pk_bf16_f32 v200, v80, v81
    v_mul_f32 v82, v82, v23
    v_mul_f32 v83, v83, v23
    v_cvt_pk_bf16_f32 v201, v82, v83
    s_waitcnt lgkmcnt(8)
    v_mfma_f32_32x32x16_bf16 a[96:111], a[232:235], a[216:219], a[96:111]
    ds_read_b64_tr_b16 a[224:225], v3 offset:0
    ds_read_b64_tr_b16 a[226:227], v3 offset:512
    v_mul_f32 v84, v84, v23
    v_mul_f32 v85, v85, v23
    v_cvt_pk_bf16_f32 v202, v84, v85
    v_mul_f32 v86, v86, v23
    v_mfma_f32_32x32x16_bf16 a[112:127], a[236:239], a[216:219], a[112:127]
    ds_read_b64_tr_b16 a[228:229], v3 offset:64
    ds_read_b64_tr_b16 a[230:231], v3 offset:576
    buffer_load_dwordx4 v19, s[16:19], s30 offen offset:1024 nt lds
    v_mul_f32 v87, v87, v23
    v_cvt_pk_bf16_f32 v203, v86, v87
    v_mul_f32 v88, v88, v23
    s_waitcnt lgkmcnt(8)
    v_mfma_f32_32x32x16_bf16 a[64:79], a[240:243], a[220:223], a[64:79]
    ds_read_b64_tr_b16 a[232:233], v3 offset:128
    ds_read_b64_tr_b16 a[234:235], v3 offset:640
    v_mul_f32 v89, v89, v23
    v_cvt_pk_bf16_f32 v204, v88, v89
    v_mul_f32 v90, v90, v23
    v_mul_f32 v91, v91, v23
    v_mfma_f32_32x32x16_bf16 a[80:95], a[244:247], a[220:223], a[80:95]
    ds_read_b64_tr_b16 a[236:237], v3 offset:192
    ds_read_b64_tr_b16 a[238:239], v3 offset:704
    buffer_load_dwordx4 v20, s[16:19], s29 offen offset:2112 nt lds
    v_cvt_pk_bf16_f32 v205, v90, v91
    v_mul_f32 v92, v92, v23
    v_mul_f32 v93, v93, v23
    v_cvt_pk_bf16_f32 v206, v92, v93
    s_waitcnt lgkmcnt(8)
    v_mfma_f32_32x32x16_bf16 a[96:111], a[248:251], a[220:223], a[96:111]
    ds_read_b64_tr_b16 a[240:241], v3 offset:8448
    ds_read_b64_tr_b16 a[242:243], v3 offset:8960
    v_mul_f32 v94, v94, v23
    v_mul_f32 v95, v95, v23
    v_cvt_pk_bf16_f32 v207, v94, v95
    v_mfma_f32_32x32x16_bf16 a[112:127], a[252:255], a[220:223], a[112:127]
    ds_read_b64_tr_b16 a[244:245], v3 offset:8512
    ds_read_b64_tr_b16 a[246:247], v3 offset:9024
    buffer_load_dwordx4 v20, s[16:19], s30 offen offset:3136 nt lds
    s_waitcnt lgkmcnt(8)
    v_mfma_f32_32x32x16_bf16 a[0:15], a[224:227], v[192:195], a[0:15]
    ds_read_b64_tr_b16 a[248:249], v3 offset:8576
    ds_read_b64_tr_b16 a[250:251], v3 offset:9088
    v_mul_f32 v96, v96, v23
    v_mul_f32 v97, v97, v23
    v_cvt_pk_bf16_f32 v208, v96, v97
    v_mul_f32 v98, v98, v23
    v_mfma_f32_32x32x16_bf16 a[16:31], a[228:231], v[192:195], a[16:31]
    ds_read_b64_tr_b16 a[252:253], v3 offset:8640
    ds_read_b64_tr_b16 a[254:255], v3 offset:9152
    v_mul_f32 v99, v99, v23
    v_cvt_pk_bf16_f32 v209, v98, v99
    v_mul_f32 v100, v100, v23
    s_waitcnt lgkmcnt(8)
    v_mfma_f32_32x32x16_bf16 a[32:47], a[232:235], v[192:195], a[32:47]
    ds_read_b64_tr_b16 a[224:225], v3 offset:1024
    ds_read_b64_tr_b16 a[226:227], v3 offset:1536
    v_mul_f32 v101, v101, v23
    v_cvt_pk_bf16_f32 v210, v100, v101
    v_mul_f32 v102, v102, v23
    v_mfma_f32_32x32x16_bf16 a[48:63], a[236:239], v[192:195], a[48:63]
    ds_read_b64_tr_b16 a[228:229], v3 offset:1088
    ds_read_b64_tr_b16 a[230:231], v3 offset:1600
    v_mul_f32 v103, v103, v23
    v_cvt_pk_bf16_f32 v211, v102, v103
    v_mul_f32 v104, v104, v23
    s_waitcnt lgkmcnt(8)
    v_mfma_f32_32x32x16_bf16 a[0:15], a[240:243], v[196:199], a[0:15]
    ds_read_b64_tr_b16 a[232:233], v3 offset:1152
    ds_read_b64_tr_b16 a[234:235], v3 offset:1664
    v_mul_f32 v105, v105, v23
    v_cvt_pk_bf16_f32 v212, v104, v105
    v_mul_f32 v106, v106, v23
    v_mfma_f32_32x32x16_bf16 a[16:31], a[244:247], v[196:199], a[16:31]
    ds_read_b64_tr_b16 a[236:237], v3 offset:1216
    ds_read_b64_tr_b16 a[238:239], v3 offset:1728
    v_mul_f32 v107, v107, v23
    v_cvt_pk_bf16_f32 v213, v106, v107
    v_mul_f32 v108, v108, v23
    v_mul_f32 v109, v109, v23
    s_waitcnt lgkmcnt(8)
    v_mfma_f32_32x32x16_bf16 a[32:47], a[248:251], v[196:199], a[32:47]
    ds_read_b64_tr_b16 a[240:241], v3 offset:9472
    ds_read_b64_tr_b16 a[242:243], v3 offset:9984
    v_cvt_pk_bf16_f32 v214, v108, v109
    v_mul_f32 v110, v110, v23
    v_mul_f32 v111, v111, v23
    v_mfma_f32_32x32x16_bf16 a[48:63], a[252:255], v[196:199], a[48:63]
    ds_read_b64_tr_b16 a[244:245], v3 offset:9536
    ds_read_b64_tr_b16 a[246:247], v3 offset:10048
    v_cvt_pk_bf16_f32 v215, v110, v111
    v_mul_f32 v112, v112, v23
    v_mul_f32 v113, v113, v23
    s_waitcnt lgkmcnt(8)
    v_mfma_f32_32x32x16_bf16 a[0:15], a[224:227], v[200:203], a[0:15]
    ds_read_b64_tr_b16 a[248:249], v3 offset:9600
    ds_read_b64_tr_b16 a[250:251], v3 offset:10112
    s_waitcnt vmcnt(24)
    s_barrier
    s_add_u32 m0, s24, 84480
    s_mov_b32 s29, 327936
    s_mov_b32 s30, 367872
    v_cvt_pk_bf16_f32 v216, v112, v113
    v_mul_f32 v114, v114, v23
    v_mul_f32 v115, v115, v23
    v_mfma_f32_32x32x16_bf16 a[16:31], a[228:231], v[200:203], a[16:31]
    ds_read_b64_tr_b16 a[252:253], v3 offset:9664
    ds_read_b64_tr_b16 a[254:255], v3 offset:10176
    buffer_load_dwordx4 v19, s[16:19], s29 offen nt lds
    v_cvt_pk_bf16_f32 v217, v114, v115
    v_mul_f32 v116, v116, v23
    v_mul_f32 v117, v117, v23
    s_waitcnt lgkmcnt(8)
    v_mfma_f32_32x32x16_bf16 a[32:47], a[232:235], v[200:203], a[32:47]
    ds_read_b64_tr_b16 a[224:225], v3 offset:16896
    ds_read_b64_tr_b16 a[226:227], v3 offset:17408
    v_cvt_pk_bf16_f32 v218, v116, v117
    v_mul_f32 v118, v118, v23
    v_mul_f32 v119, v119, v23
    v_cvt_pk_bf16_f32 v219, v118, v119
    v_mfma_f32_32x32x16_bf16 a[48:63], a[236:239], v[200:203], a[48:63]
    ds_read_b64_tr_b16 a[228:229], v3 offset:16960
    ds_read_b64_tr_b16 a[230:231], v3 offset:17472
    buffer_load_dwordx4 v19, s[16:19], s30 offen offset:1024 nt lds
    v_mul_f32 v120, v120, v23
    v_mul_f32 v121, v121, v23
    v_cvt_pk_bf16_f32 v220, v120, v121
    s_waitcnt lgkmcnt(8)
    v_mfma_f32_32x32x16_bf16 a[0:15], a[240:243], v[204:207], a[0:15]
    ds_read_b64_tr_b16 a[232:233], v3 offset:17024
    ds_read_b64_tr_b16 a[234:235], v3 offset:17536
    v_mul_f32 v122, v122, v23
    v_mul_f32 v123, v123, v23
    v_cvt_pk_bf16_f32 v221, v122, v123
    v_mfma_f32_32x32x16_bf16 a[16:31], a[244:247], v[204:207], a[16:31]
    ds_read_b64_tr_b16 a[236:237], v3 offset:17088
    ds_read_b64_tr_b16 a[238:239], v3 offset:17600
    buffer_load_dwordx4 v20, s[16:19], s29 offen offset:2112 nt lds
    v_mul_f32 v124, v124, v23
    v_mul_f32 v125, v125, v23
    v_cvt_pk_bf16_f32 v222, v124, v125
    s_waitcnt lgkmcnt(8)
    v_mfma_f32_32x32x16_bf16 a[32:47], a[248:251], v[204:207], a[32:47]
    ds_read_b64_tr_b16 a[240:241], v3 offset:25344
    ds_read_b64_tr_b16 a[242:243], v3 offset:25856
    v_mul_f32 v126, v126, v23
    v_mul_f32 v127, v127, v23
    v_cvt_pk_bf16_f32 v223, v126, v127
    v_mfma_f32_32x32x16_bf16 a[48:63], a[252:255], v[204:207], a[48:63]
    ds_read_b64_tr_b16 a[244:245], v3 offset:25408
    ds_read_b64_tr_b16 a[246:247], v3 offset:25920
    buffer_load_dwordx4 v20, s[16:19], s30 offen offset:3136 nt lds
    s_waitcnt lgkmcnt(8)
    v_mfma_f32_32x32x16_bf16 a[0:15], a[224:227], v[208:211], a[0:15]
    ds_read_b64_tr_b16 a[248:249], v3 offset:25472
    ds_read_b64_tr_b16 a[250:251], v3 offset:25984
    v_and_b32 v65, 0xffff0000, v224
    v_lshlrev_b32 v64, 16, v224
    v_and_b32 v67, 0xffff0000, v225
    v_lshlrev_b32 v66, 16, v225
    s_mov_b64 s[8:9], s[56:57]
    s_mov_b64 s[10:11], s[58:59]
    v_mfma_f32_32x32x16_bf16 a[16:31], a[228:231], v[208:211], a[16:31]
    ds_read_b64_tr_b16 a[252:253], v3 offset:25536
    ds_read_b64_tr_b16 a[254:255], v3 offset:26048
    v_and_b32 v69, 0xffff0000, v226
    v_lshlrev_b32 v68, 16, v226
    v_and_b32 v71, 0xffff0000, v227
    s_waitcnt lgkmcnt(8)
    v_mfma_f32_32x32x16_bf16 a[32:47], a[232:235], v[208:211], a[32:47]
    ds_read_b64_tr_b16 a[224:225], v3 offset:17920
    ds_read_b64_tr_b16 a[226:227], v3 offset:18432
    v_lshlrev_b32 v70, 16, v227
    v_and_b32 v73, 0xffff0000, v228
    v_lshlrev_b32 v72, 16, v228
    v_and_b32 v75, 0xffff0000, v229
    s_lshr_b32 s23, s24, 12
    s_lshl_b32 s23, s23, 1
    s_add_u32 s23, s23, 0
    s_cmp_eq_u32 s23, s91
    s_cselect_b32 s58, 0, s58
    s_cselect_b32 s23, 0, 61440
    s_add_u32 s23, s23, 135168
    v_lshl_add_u32 v22, v0, 4, s23
    v_mfma_f32_32x32x16_bf16 a[48:63], a[236:239], v[208:211], a[48:63]
    ds_read_b64_tr_b16 a[228:229], v3 offset:17984
    ds_read_b64_tr_b16 a[230:231], v3 offset:18496
    v_lshlrev_b32 v74, 16, v229
    v_and_b32 v77, 0xffff0000, v230
    v_lshlrev_b32 v76, 16, v230
    s_waitcnt lgkmcnt(8)
    v_mfma_f32_32x32x16_bf16 a[0:15], a[240:243], v[212:215], a[0:15]
    ds_read_b64_tr_b16 a[232:233], v3 offset:18048
    ds_read_b64_tr_b16 a[234:235], v3 offset:18560
    v_and_b32 v79, 0xffff0000, v231
    v_lshlrev_b32 v78, 16, v231
    v_and_b32 v81, 0xffff0000, v232
    s_lshr_b32 s23, s24, 12
    s_lshl_b32 s23, s23, 1
    s_add_u32 s23, s23, 1
    s_cmp_eq_u32 s23, s91
    s_cselect_b32 s10, 0, s10
    s_cselect_b32 s23, 0, 61440
    s_add_u32 s23, s23, 135168
    v_lshl_add_u32 v23, v0, 4, s23
    v_mfma_f32_32x32x16_bf16 a[16:31], a[244:247], v[212:215], a[16:31]
    ds_read_b64_tr_b16 a[236:237], v3 offset:18112
    ds_read_b64_tr_b16 a[238:239], v3 offset:18624
    v_lshlrev_b32 v80, 16, v232
    v_and_b32 v83, 0xffff0000, v233
    v_lshlrev_b32 v82, 16, v233
    v_and_b32 v85, 0xffff0000, v234
    s_waitcnt lgkmcnt(8)
    v_mfma_f32_32x32x16_bf16 a[32:47], a[248:251], v[212:215], a[32:47]
    ds_read_b64_tr_b16 a[240:241], v3 offset:26368
    ds_read_b64_tr_b16 a[242:243], v3 offset:26880
    v_lshlrev_b32 v84, 16, v234
    v_and_b32 v87, 0xffff0000, v235
    v_lshlrev_b32 v86, 16, v235
    v_mfma_f32_32x32x16_bf16 a[48:63], a[252:255], v[212:215], a[48:63]
    ds_read_b64_tr_b16 a[244:245], v3 offset:26432
    ds_read_b64_tr_b16 a[246:247], v3 offset:26944
    v_and_b32 v89, 0xffff0000, v236
    v_lshlrev_b32 v88, 16, v236
    v_and_b32 v91, 0xffff0000, v237
    s_waitcnt lgkmcnt(8)
    v_mfma_f32_32x32x16_bf16 a[0:15], a[224:227], v[216:219], a[0:15]
    ds_read_b64_tr_b16 a[248:249], v3 offset:26496
    ds_read_b64_tr_b16 a[250:251], v3 offset:27008
    s_waitcnt vmcnt(24)
    s_barrier
    s_add_u32 m0, s24, 101376
    s_mov_b32 s29, 409856
    s_mov_b32 s30, 449792
    v_lshlrev_b32 v90, 16, v237
    v_and_b32 v93, 0xffff0000, v238
    v_lshlrev_b32 v92, 16, v238
    v_and_b32 v95, 0xffff0000, v239
    v_mfma_f32_32x32x16_bf16 a[16:31], a[228:231], v[216:219], a[16:31]
    ds_read_b64_tr_b16 a[252:253], v3 offset:26560
    ds_read_b64_tr_b16 a[254:255], v3 offset:27072
    buffer_load_dwordx4 v19, s[16:19], s29 offen nt lds
    v_lshlrev_b32 v94, 16, v239
    v_and_b32 v97, 0xffff0000, v240
    v_lshlrev_b32 v96, 16, v240
    s_waitcnt lgkmcnt(8)
    v_mfma_f32_32x32x16_bf16 a[32:47], a[232:235], v[216:219], a[32:47]
    ds_read_b64_tr_b16 a[224:225], v3 offset:33792
    ds_read_b64_tr_b16 a[226:227], v3 offset:34304
    v_and_b32 v99, 0xffff0000, v241
    v_lshlrev_b32 v98, 16, v241
    v_and_b32 v101, 0xffff0000, v242
    v_lshlrev_b32 v100, 16, v242
    v_mfma_f32_32x32x16_bf16 a[48:63], a[236:239], v[216:219], a[48:63]
    ds_read_b64_tr_b16 a[228:229], v3 offset:33856
    ds_read_b64_tr_b16 a[230:231], v3 offset:34368
    buffer_load_dwordx4 v19, s[16:19], s30 offen offset:1024 nt lds
    v_and_b32 v103, 0xffff0000, v243
    v_lshlrev_b32 v102, 16, v243
    v_and_b32 v105, 0xffff0000, v244
    s_waitcnt lgkmcnt(8)
    v_mfma_f32_32x32x16_bf16 a[0:15], a[240:243], v[220:223], a[0:15]
    ds_read_b64_tr_b16 a[232:233], v3 offset:33920
    ds_read_b64_tr_b16 a[234:235], v3 offset:34432
    v_lshlrev_b32 v104, 16, v244
    v_and_b32 v107, 0xffff0000, v245
    v_lshlrev_b32 v106, 16, v245
    v_mfma_f32_32x32x16_bf16 a[16:31], a[244:247], v[220:223], a[16:31]
    ds_read_b64_tr_b16 a[236:237], v3 offset:33984
    ds_read_b64_tr_b16 a[238:239], v3 offset:34496
    buffer_load_dwordx4 v20, s[16:19], s29 offen offset:2112 nt lds
    v_and_b32 v109, 0xffff0000, v246
    v_lshlrev_b32 v108, 16, v246
    v_and_b32 v111, 0xffff0000, v247
    v_lshlrev_b32 v110, 16, v247
    s_waitcnt lgkmcnt(8)
    v_mfma_f32_32x32x16_bf16 a[32:47], a[248:251], v[220:223], a[32:47]
    ds_read_b64_tr_b16 a[240:241], v3 offset:42240
    ds_read_b64_tr_b16 a[242:243], v3 offset:42752
    v_and_b32 v113, 0xffff0000, v248
    v_lshlrev_b32 v112, 16, v248
    v_and_b32 v115, 0xffff0000, v249
    v_mfma_f32_32x32x16_bf16 a[48:63], a[252:255], v[220:223], a[48:63]
    ds_read_b64_tr_b16 a[244:245], v3 offset:42304
    ds_read_b64_tr_b16 a[246:247], v3 offset:42816
    buffer_load_dwordx4 v20, s[16:19], s30 offen offset:3136 nt lds
    v_lshlrev_b32 v114, 16, v249
    v_and_b32 v117, 0xffff0000, v250
    v_lshlrev_b32 v116, 16, v250
    s_waitcnt lgkmcnt(8)
    v_mfma_f32_32x32x16_bf16 a[64:79], a[224:227], v[192:195], a[64:79]
    ds_read_b64_tr_b16 a[248:249], v3 offset:42368
    ds_read_b64_tr_b16 a[250:251], v3 offset:42880
    v_and_b32 v119, 0xffff0000, v251
    v_lshlrev_b32 v118, 16, v251
    v_and_b32 v121, 0xffff0000, v252
    v_lshlrev_b32 v120, 16, v252
    v_mfma_f32_32x32x16_bf16 a[80:95], a[228:231], v[192:195], a[80:95]
    ds_read_b64_tr_b16 a[252:253], v3 offset:42432
    ds_read_b64_tr_b16 a[254:255], v3 offset:42944
    v_and_b32 v123, 0xffff0000, v253
    v_lshlrev_b32 v122, 16, v253
    v_and_b32 v125, 0xffff0000, v254
    s_waitcnt lgkmcnt(8)
    v_mfma_f32_32x32x16_bf16 a[96:111], a[232:235], v[192:195], a[96:111]
    ds_read_b64_tr_b16 a[224:225], v3 offset:34816
    ds_read_b64_tr_b16 a[226:227], v3 offset:35328
    v_lshlrev_b32 v124, 16, v254
    v_and_b32 v127, 0xffff0000, v255
    v_lshlrev_b32 v126, 16, v255
    v_mfma_f32_32x32x16_bf16 a[112:127], a[236:239], v[192:195], a[112:127]
    ds_read_b64_tr_b16 a[228:229], v3 offset:34880
    ds_read_b64_tr_b16 a[230:231], v3 offset:35392
    v_accvgpr_read_b32 v144, a136
    v_and_b32 v145, 0xffff0000, v144
    v_accvgpr_read_b32 v224, a0
    v_accvgpr_read_b32 v24, a1
    s_waitcnt lgkmcnt(8)
    v_mfma_f32_32x32x16_bf16 a[64:79], a[240:243], v[196:199], a[64:79]
    ds_read_b64_tr_b16 a[232:233], v3 offset:34944
    ds_read_b64_tr_b16 a[234:235], v3 offset:35456
    v_lshlrev_b32 v144, 16, v144
    v_accvgpr_read_b32 v146, a137
    v_cvt_pk_bf16_f32 v224, v224, v24
    v_accvgpr_read_b32 v225, a2
    v_mfma_f32_32x32x16_bf16 a[80:95], a[244:247], v[196:199], a[80:95]
    ds_read_b64_tr_b16 a[236:237], v3 offset:35008
    ds_read_b64_tr_b16 a[238:239], v3 offset:35520
    v_and_b32 v147, 0xffff0000, v146
    v_lshlrev_b32 v146, 16, v146
    v_accvgpr_read_b32 v25, a3
    v_cvt_pk_bf16_f32 v225, v225, v25
    s_waitcnt lgkmcnt(8)
    v_mfma_f32_32x32x16_bf16 a[96:111], a[248:251], v[196:199], a[96:111]
    ds_read_b64_tr_b16 a[240:241], v3 offset:43264
    ds_read_b64_tr_b16 a[242:243], v3 offset:43776
    v_accvgpr_read_b32 v148, a138
    v_accvgpr_read_b32 v226, a4
    v_accvgpr_read_b32 v26, a5
    v_mfma_f32_32x32x16_bf16 a[112:127], a[252:255], v[196:199], a[112:127]
    ds_read_b64_tr_b16 a[244:245], v3 offset:43328
    ds_read_b64_tr_b16 a[246:247], v3 offset:43840
    v_and_b32 v149, 0xffff0000, v148
    v_lshlrev_b32 v148, 16, v148
    v_cvt_pk_bf16_f32 v226, v226, v26
    v_accvgpr_read_b32 v227, a6
    s_waitcnt lgkmcnt(8)
    v_mfma_f32_32x32x16_bf16 a[64:79], a[224:227], v[200:203], a[64:79]
    ds_read_b64_tr_b16 a[248:249], v3 offset:43392
    ds_read_b64_tr_b16 a[250:251], v3 offset:43904
    s_waitcnt vmcnt(24)
    s_barrier
    s_add_u32 m0, s24, 118272
    s_mov_b32 s29, 491776
    s_mov_b32 s30, 531712
    v_accvgpr_read_b32 v150, a139
    v_and_b32 v151, 0xffff0000, v150
    v_accvgpr_read_b32 v27, a7
    v_cvt_pk_bf16_f32 v227, v227, v27
    v_mfma_f32_32x32x16_bf16 a[80:95], a[228:231], v[200:203], a[80:95]
    ds_read_b64_tr_b16 a[252:253], v3 offset:43456
    ds_read_b64_tr_b16 a[254:255], v3 offset:43968
    buffer_load_dwordx4 v19, s[16:19], s29 offen nt lds
    v_lshlrev_b32 v150, 16, v150
    s_mov_b32 s34, 16777216
    buffer_store_dwordx4 v[224:227], v21, s[56:59], s34 offen offset:0 sc1
    ds_write_b128 v22, v[224:227] offset:16896
    s_waitcnt lgkmcnt(9)
    v_mfma_f32_32x32x16_bf16 a[96:111], a[232:235], v[200:203], a[96:111]
    ds_read_b64_tr_b16 a[224:225], v1 offset:0
    ds_read_b64_tr_b16 a[226:227], v1 offset:512
    v_accvgpr_read_b32 v152, a140
    v_and_b32 v153, 0xffff0000, v152
    v_accvgpr_read_b32 v228, a8
    v_accvgpr_read_b32 v24, a9
    v_mfma_f32_32x32x16_bf16 a[112:127], a[236:239], v[200:203], a[112:127]
    ds_read_b64_tr_b16 a[228:229], v1 offset:64
    ds_read_b64_tr_b16 a[230:231], v1 offset:576
    buffer_load_dwordx4 v19, s[16:19], s30 offen offset:1024 nt lds
    v_lshlrev_b32 v152, 16, v152
    v_accvgpr_read_b32 v154, a141
    v_cvt_pk_bf16_f32 v228, v228, v24
    v_accvgpr_read_b32 v229, a10
    s_waitcnt lgkmcnt(9)
    v_mfma_f32_32x32x16_bf16 a[64:79], a[240:243], v[204:207], a[64:79]
    ds_read_b64_tr_b16 a[232:233], v1 offset:128
    ds_read_b64_tr_b16 a[234:235], v1 offset:640
    v_and_b32 v155, 0xffff0000, v154
    v_lshlrev_b32 v154, 16, v154
    v_accvgpr_read_b32 v25, a11
    v_cvt_pk_bf16_f32 v229, v229, v25
    v_mfma_f32_32x32x16_bf16 a[80:95], a[244:247], v[204:207], a[80:95]
    ds_read_b64_tr_b16 a[236:237], v1 offset:192
    ds_read_b64_tr_b16 a[238:239], v1 offset:704
    buffer_load_dwordx4 v20, s[16:19], s29 offen offset:2112 nt lds
    v_accvgpr_read_b32 v156, a142
    v_accvgpr_read_b32 v230, a12
    v_accvgpr_read_b32 v26, a13
    s_waitcnt lgkmcnt(9)
    v_mfma_f32_32x32x16_bf16 a[96:111], a[248:251], v[204:207], a[96:111]
    ds_read_b64_tr_b16 a[240:241], v1 offset:8448
    ds_read_b64_tr_b16 a[242:243], v1 offset:8960
    v_and_b32 v157, 0xffff0000, v156
    v_lshlrev_b32 v156, 16, v156
    v_cvt_pk_bf16_f32 v230, v230, v26
    v_accvgpr_read_b32 v231, a14
    v_mfma_f32_32x32x16_bf16 a[112:127], a[252:255], v[204:207], a[112:127]
    ds_read_b64_tr_b16 a[244:245], v1 offset:8512
    ds_read_b64_tr_b16 a[246:247], v1 offset:9024
    buffer_load_dwordx4 v20, s[16:19], s30 offen offset:3136 nt lds
    v_accvgpr_read_b32 v158, a143
    v_and_b32 v159, 0xffff0000, v158
    v_accvgpr_read_b32 v27, a15
    v_cvt_pk_bf16_f32 v231, v231, v27
    s_waitcnt lgkmcnt(8)
    v_mfma_f32_32x32x16_bf16 a[64:79], a[224:227], v[208:211], a[64:79]
    ds_read_b64_tr_b16 a[248:249], v1 offset:8576
    ds_read_b64_tr_b16 a[250:251], v1 offset:9088
    v_lshlrev_b32 v158, 16, v158
    s_mov_b32 s34, 17825792
    buffer_store_dwordx4 v[228:231], v21, s[56:59], s34 offen offset:0 sc1
    ds_write_b128 v22, v[228:231] offset:17920
    v_mfma_f32_32x32x16_bf16 a[80:95], a[228:231], v[208:211], a[80:95]
    ds_read_b64_tr_b16 a[252:253], v1 offset:8640
    ds_read_b64_tr_b16 a[254:255], v1 offset:9152
    v_accvgpr_read_b32 v176, a152
    v_and_b32 v177, 0xffff0000, v176
    v_accvgpr_read_b32 v232, a16
    v_accvgpr_read_b32 v24, a17
    s_waitcnt lgkmcnt(9)
    v_mfma_f32_32x32x16_bf16 a[96:111], a[232:235], v[208:211], a[96:111]
    ds_read_b64_tr_b16 a[224:225], v1 offset:1024
    ds_read_b64_tr_b16 a[226:227], v1 offset:1536
    v_lshlrev_b32 v176, 16, v176
    v_accvgpr_read_b32 v178, a153
    v_cvt_pk_bf16_f32 v232, v232, v24
    v_accvgpr_read_b32 v233, a18
    v_mfma_f32_32x32x16_bf16 a[112:127], a[236:239], v[208:211], a[112:127]
    ds_read_b64_tr_b16 a[228:229], v1 offset:1088
    ds_read_b64_tr_b16 a[230:231], v1 offset:1600
    v_and_b32 v179, 0xffff0000, v178
    v_lshlrev_b32 v178, 16, v178
    v_accvgpr_read_b32 v25, a19
    v_cvt_pk_bf16_f32 v233, v233, v25
    s_waitcnt lgkmcnt(9)
    v_mfma_f32_32x32x16_bf16 a[64:79], a[240:243], v[212:215], a[64:79]
    ds_read_b64_tr_b16 a[232:233], v1 offset:1152
    ds_read_b64_tr_b16 a[234:235], v1 offset:1664
    v_accvgpr_read_b32 v180, a154
    v_accvgpr_read_b32 v234, a20
    v_accvgpr_read_b32 v26, a21
    v_mfma_f32_32x32x16_bf16 a[80:95], a[244:247], v[212:215], a[80:95]
    ds_read_b64_tr_b16 a[236:237], v1 offset:1216
    ds_read_b64_tr_b16 a[238:239], v1 offset:1728
    v_and_b32 v181, 0xffff0000, v180
    v_lshlrev_b32 v180, 16, v180
    v_cvt_pk_bf16_f32 v234, v234, v26
    v_accvgpr_read_b32 v235, a22
    s_waitcnt lgkmcnt(8)
    v_mfma_f32_32x32x16_bf16 a[96:111], a[248:251], v[212:215], a[96:111]
    ds_read_b64_tr_b16 a[240:241], v1 offset:9472
    ds_read_b64_tr_b16 a[242:243], v1 offset:9984
    v_accvgpr_read_b32 v182, a155
    v_and_b32 v183, 0xffff0000, v182
    v_accvgpr_read_b32 v27, a23
    v_cvt_pk_bf16_f32 v235, v235, v27
    v_mfma_f32_32x32x16_bf16 a[112:127], a[252:255], v[212:215], a[112:127]
    ds_read_b64_tr_b16 a[244:245], v1 offset:9536
    ds_read_b64_tr_b16 a[246:247], v1 offset:10048
    v_lshlrev_b32 v182, 16, v182
    s_mov_b32 s34, 18874368
    buffer_store_dwordx4 v[232:235], v21, s[56:59], s34 offen offset:0 sc1
    ds_write_b128 v22, v[232:235] offset:18944
    s_waitcnt lgkmcnt(9)
    v_mfma_f32_32x32x16_bf16 a[64:79], a[224:227], v[216:219], a[64:79]
    ds_read_b64_tr_b16 a[248:249], v1 offset:9600
    ds_read_b64_tr_b16 a[250:251], v1 offset:10112
    s_waitcnt vmcnt(27)
    s_barrier
    s_add_u32 m0, s24, 135168
    s_mov_b32 s29, 573696
    s_mov_b32 s30, 613632
    v_accvgpr_read_b32 v184, a156
    v_and_b32 v185, 0xffff0000, v184
    v_accvgpr_read_b32 v236, a24
    v_accvgpr_read_b32 v24, a25
    v_mfma_f32_32x32x16_bf16 a[80:95], a[228:231], v[216:219], a[80:95]
    ds_read_b64_tr_b16 a[252:253], v1 offset:9664
    ds_read_b64_tr_b16 a[254:255], v1 offset:10176
    buffer_load_dwordx4 v19, s[16:19], s29 offen nt lds
    v_lshlrev_b32 v184, 16, v184
    v_accvgpr_read_b32 v186, a157
    v_cvt_pk_bf16_f32 v236, v236, v24
    v_accvgpr_read_b32 v237, a26
    s_waitcnt lgkmcnt(9)
    v_mfma_f32_32x32x16_bf16 a[96:111], a[232:235], v[216:219], a[96:111]
    ds_read_b64_tr_b16 a[224:225], v1 offset:16896
    ds_read_b64_tr_b16 a[226:227], v1 offset:17408
    v_and_b32 v187, 0xffff0000, v186
    v_lshlrev_b32 v186, 16, v186
    v_accvgpr_read_b32 v25, a27
    v_cvt_pk_bf16_f32 v237, v237, v25
    v_mfma_f32_32x32x16_bf16 a[112:127], a[236:239], v[216:219], a[112:127]
    ds_read_b64_tr_b16 a[228:229], v1 offset:16960
    ds_read_b64_tr_b16 a[230:231], v1 offset:17472
    buffer_load_dwordx4 v19, s[16:19], s30 offen offset:1024 nt lds
    v_accvgpr_read_b32 v188, a158
    v_accvgpr_read_b32 v238, a28
    v_accvgpr_read_b32 v26, a29
    s_waitcnt lgkmcnt(9)
    v_mfma_f32_32x32x16_bf16 a[64:79], a[240:243], v[220:223], a[64:79]
    ds_read_b64_tr_b16 a[232:233], v1 offset:17024
    ds_read_b64_tr_b16 a[234:235], v1 offset:17536
    v_and_b32 v189, 0xffff0000, v188
    v_lshlrev_b32 v188, 16, v188
    v_cvt_pk_bf16_f32 v238, v238, v26
    v_accvgpr_read_b32 v239, a30
    v_mfma_f32_32x32x16_bf16 a[80:95], a[244:247], v[220:223], a[80:95]
    ds_read_b64_tr_b16 a[236:237], v1 offset:17088
    ds_read_b64_tr_b16 a[238:239], v1 offset:17600
    buffer_load_dwordx4 v20, s[16:19], s29 offen offset:2112 nt lds
    v_accvgpr_read_b32 v190, a159
    v_and_b32 v191, 0xffff0000, v190
    v_accvgpr_read_b32 v27, a31
    v_cvt_pk_bf16_f32 v239, v239, v27
    s_waitcnt lgkmcnt(8)
    v_mfma_f32_32x32x16_bf16 a[96:111], a[248:251], v[220:223], a[96:111]
    ds_read_b64_tr_b16 a[240:241], v1 offset:25344
    ds_read_b64_tr_b16 a[242:243], v1 offset:25856
    v_lshlrev_b32 v190, 16, v190
    s_mov_b32 s34, 19922944
    buffer_store_dwordx4 v[236:239], v21, s[56:59], s34 offen offset:0 sc1
    ds_write_b128 v22, v[236:239] offset:19968
    v_mfma_f32_32x32x16_bf16 a[112:127], a[252:255], v[220:223], a[112:127]
    ds_read_b64_tr_b16 a[244:245], v1 offset:25408
    ds_read_b64_tr_b16 a[246:247], v1 offset:25920
    buffer_load_dwordx4 v20, s[16:19], s30 offen offset:3136 nt lds
    v_accvgpr_read_b32 v240, a32
    v_accvgpr_read_b32 v24, a33
    s_waitcnt lgkmcnt(9)
    v_mfma_f32_32x32x16_bf16 v[128:143], a[224:227], a[192:195], v[128:143]
    ds_read_b64_tr_b16 a[248:249], v1 offset:25472
    ds_read_b64_tr_b16 a[250:251], v1 offset:25984
    v_cvt_pk_bf16_f32 v240, v240, v24
    v_accvgpr_read_b32 v241, a34
    v_mfma_f32_32x32x16_bf16 v[144:159], a[228:231], a[192:195], v[144:159]
    ds_read_b64_tr_b16 a[252:253], v1 offset:25536
    ds_read_b64_tr_b16 a[254:255], v1 offset:26048
    v_accvgpr_read_b32 v25, a35
    v_cvt_pk_bf16_f32 v241, v241, v25
    s_waitcnt lgkmcnt(9)
    v_mfma_f32_32x32x16_bf16 v[160:175], a[232:235], a[192:195], v[160:175]
    ds_read_b64_tr_b16 a[224:225], v1 offset:17920
    ds_read_b64_tr_b16 a[226:227], v1 offset:18432
    v_accvgpr_read_b32 v242, a36
    v_accvgpr_read_b32 v26, a37
    v_mfma_f32_32x32x16_bf16 v[176:191], a[236:239], a[192:195], v[176:191]
    ds_read_b64_tr_b16 a[228:229], v1 offset:17984
    ds_read_b64_tr_b16 a[230:231], v1 offset:18496
    v_cvt_pk_bf16_f32 v242, v242, v26
    v_accvgpr_read_b32 v243, a38
    s_waitcnt lgkmcnt(8)
    v_mfma_f32_32x32x16_bf16 v[128:143], a[240:243], a[196:199], v[128:143]
    ds_read_b64_tr_b16 a[232:233], v1 offset:18048
    ds_read_b64_tr_b16 a[234:235], v1 offset:18560
    v_accvgpr_read_b32 v27, a39
    v_cvt_pk_bf16_f32 v243, v243, v27
    v_mfma_f32_32x32x16_bf16 v[144:159], a[244:247], a[196:199], v[144:159]
    ds_read_b64_tr_b16 a[236:237], v1 offset:18112
    ds_read_b64_tr_b16 a[238:239], v1 offset:18624
    s_mov_b32 s34, 20971520
    buffer_store_dwordx4 v[240:243], v21, s[8:11], s34 offen offset:0 sc1
    ds_write_b128 v23, v[240:243] offset:16896
    s_waitcnt lgkmcnt(9)
    v_mfma_f32_32x32x16_bf16 v[160:175], a[248:251], a[196:199], v[160:175]
    ds_read_b64_tr_b16 a[240:241], v1 offset:26368
    ds_read_b64_tr_b16 a[242:243], v1 offset:26880
    v_accvgpr_read_b32 v244, a40
    v_accvgpr_read_b32 v24, a41
    v_mfma_f32_32x32x16_bf16 v[176:191], a[252:255], a[196:199], v[176:191]
    ds_read_b64_tr_b16 a[244:245], v1 offset:26432
    ds_read_b64_tr_b16 a[246:247], v1 offset:26944
    v_cvt_pk_bf16_f32 v244, v244, v24
    v_accvgpr_read_b32 v245, a42
    s_waitcnt lgkmcnt(9)
    v_mfma_f32_32x32x16_bf16 v[128:143], a[224:227], a[200:203], v[128:143]
    ds_read_b64_tr_b16 a[248:249], v1 offset:26496
    ds_read_b64_tr_b16 a[250:251], v1 offset:27008
    s_waitcnt vmcnt(29)
    s_barrier
    s_add_u32 m0, s24, 0
    s_mov_b32 s29, 1024
    s_mov_b32 s30, 40960
    v_accvgpr_read_b32 v25, a43
    v_cvt_pk_bf16_f32 v245, v245, v25
    v_mfma_f32_32x32x16_bf16 v[144:159], a[228:231], a[200:203], v[144:159]
    ds_read_b64_tr_b16 a[252:253], v1 offset:26560
    ds_read_b64_tr_b16 a[254:255], v1 offset:27072
    buffer_load_dwordx4 v19, s[16:19], s29 offen nt lds
    v_accvgpr_read_b32 v246, a44
    v_accvgpr_read_b32 v26, a45
    s_waitcnt lgkmcnt(9)
    v_mfma_f32_32x32x16_bf16 v[160:175], a[232:235], a[200:203], v[160:175]
    ds_read_b64_tr_b16 a[224:225], v1 offset:33792
    ds_read_b64_tr_b16 a[226:227], v1 offset:34304
    v_cvt_pk_bf16_f32 v246, v246, v26
    v_accvgpr_read_b32 v247, a46
    v_mfma_f32_32x32x16_bf16 v[176:191], a[236:239], a[200:203], v[176:191]
    ds_read_b64_tr_b16 a[228:229], v1 offset:33856
    ds_read_b64_tr_b16 a[230:231], v1 offset:34368
    buffer_load_dwordx4 v19, s[16:19], s30 offen offset:1024 nt lds
    v_accvgpr_read_b32 v27, a47
    v_cvt_pk_bf16_f32 v247, v247, v27
    s_waitcnt lgkmcnt(8)
    v_mfma_f32_32x32x16_bf16 v[128:143], a[240:243], a[204:207], v[128:143]
    ds_read_b64_tr_b16 a[232:233], v1 offset:33920
    ds_read_b64_tr_b16 a[234:235], v1 offset:34432
    s_mov_b32 s34, 22020096
    buffer_store_dwordx4 v[244:247], v21, s[8:11], s34 offen offset:0 sc1
    ds_write_b128 v23, v[244:247] offset:17920
    v_mfma_f32_32x32x16_bf16 v[144:159], a[244:247], a[204:207], v[144:159]
    ds_read_b64_tr_b16 a[236:237], v1 offset:33984
    ds_read_b64_tr_b16 a[238:239], v1 offset:34496
    buffer_load_dwordx4 v20, s[16:19], s29 offen offset:2112 nt lds
    v_accvgpr_read_b32 v248, a48
    v_accvgpr_read_b32 v24, a49
    s_waitcnt lgkmcnt(9)
    v_mfma_f32_32x32x16_bf16 v[160:175], a[248:251], a[204:207], v[160:175]
    ds_read_b64_tr_b16 a[240:241], v1 offset:42240
    ds_read_b64_tr_b16 a[242:243], v1 offset:42752
    v_cvt_pk_bf16_f32 v248, v248, v24
    v_accvgpr_read_b32 v249, a50
    v_mfma_f32_32x32x16_bf16 v[176:191], a[252:255], a[204:207], v[176:191]
    ds_read_b64_tr_b16 a[244:245], v1 offset:42304
    ds_read_b64_tr_b16 a[246:247], v1 offset:42816
    buffer_load_dwordx4 v20, s[16:19], s30 offen offset:3136 nt lds
    v_accvgpr_read_b32 v25, a51
    v_cvt_pk_bf16_f32 v249, v249, v25
    s_waitcnt lgkmcnt(9)
    v_mfma_f32_32x32x16_bf16 v[128:143], a[224:227], a[208:211], v[128:143]
    ds_read_b64_tr_b16 a[248:249], v1 offset:42368
    ds_read_b64_tr_b16 a[250:251], v1 offset:42880
    v_accvgpr_read_b32 v250, a52
    v_accvgpr_read_b32 v26, a53
    v_mfma_f32_32x32x16_bf16 v[144:159], a[228:231], a[208:211], v[144:159]
    ds_read_b64_tr_b16 a[252:253], v1 offset:42432
    ds_read_b64_tr_b16 a[254:255], v1 offset:42944
    v_cvt_pk_bf16_f32 v250, v250, v26
    v_accvgpr_read_b32 v251, a54
    s_waitcnt lgkmcnt(8)
    v_mfma_f32_32x32x16_bf16 v[160:175], a[232:235], a[208:211], v[160:175]
    ds_read_b64_tr_b16 a[224:225], v1 offset:34816
    ds_read_b64_tr_b16 a[226:227], v1 offset:35328
    v_accvgpr_read_b32 v27, a55
    v_cvt_pk_bf16_f32 v251, v251, v27
    v_mfma_f32_32x32x16_bf16 v[176:191], a[236:239], a[208:211], v[176:191]
    ds_read_b64_tr_b16 a[228:229], v1 offset:34880
    ds_read_b64_tr_b16 a[230:231], v1 offset:35392
    s_mov_b32 s34, 23068672
    buffer_store_dwordx4 v[248:251], v21, s[8:11], s34 offen offset:0 sc1
    ds_write_b128 v23, v[248:251] offset:18944
    s_waitcnt lgkmcnt(9)
    v_mfma_f32_32x32x16_bf16 v[128:143], a[240:243], a[212:215], v[128:143]
    ds_read_b64_tr_b16 a[232:233], v1 offset:34944
    ds_read_b64_tr_b16 a[234:235], v1 offset:35456
    v_accvgpr_read_b32 v252, a56
    v_accvgpr_read_b32 v24, a57
    v_mfma_f32_32x32x16_bf16 v[144:159], a[244:247], a[212:215], v[144:159]
    ds_read_b64_tr_b16 a[236:237], v1 offset:35008
    ds_read_b64_tr_b16 a[238:239], v1 offset:35520
    v_cvt_pk_bf16_f32 v252, v252, v24
    v_accvgpr_read_b32 v253, a58
    s_waitcnt lgkmcnt(9)
    v_mfma_f32_32x32x16_bf16 v[160:175], a[248:251], a[212:215], v[160:175]
    ds_read_b64_tr_b16 a[240:241], v1 offset:43264
    ds_read_b64_tr_b16 a[242:243], v1 offset:43776
    v_accvgpr_read_b32 v25, a59
    v_cvt_pk_bf16_f32 v253, v253, v25
    v_mfma_f32_32x32x16_bf16 v[176:191], a[252:255], a[212:215], v[176:191]
    ds_read_b64_tr_b16 a[244:245], v1 offset:43328
    ds_read_b64_tr_b16 a[246:247], v1 offset:43840
    v_accvgpr_read_b32 v254, a60
    v_accvgpr_read_b32 v26, a61
    s_waitcnt lgkmcnt(9)
    v_mfma_f32_32x32x16_bf16 v[128:143], a[224:227], a[216:219], v[128:143]
    ds_read_b64_tr_b16 a[248:249], v1 offset:43392
    ds_read_b64_tr_b16 a[250:251], v1 offset:43904
    s_waitcnt vmcnt(31)
    s_barrier
    s_add_u32 m0, s24, 16896
    s_mov_b32 s29, 82944
    s_mov_b32 s30, 122880
    v_cvt_pk_bf16_f32 v254, v254, v26
    v_accvgpr_read_b32 v255, a62
    v_mfma_f32_32x32x16_bf16 v[144:159], a[228:231], a[216:219], v[144:159]
    ds_read_b64_tr_b16 a[252:253], v1 offset:43456
    ds_read_b64_tr_b16 a[254:255], v1 offset:43968
    buffer_load_dwordx4 v19, s[16:19], s29 offen nt lds
    v_accvgpr_read_b32 v27, a63
    v_cvt_pk_bf16_f32 v255, v255, v27
    s_waitcnt lgkmcnt(8)
    v_mfma_f32_32x32x16_bf16 v[160:175], a[232:235], a[216:219], v[160:175]
    ds_read_b64_tr_b16 a[224:225], v2 offset:0
    ds_read_b64_tr_b16 a[226:227], v2 offset:512
    s_mov_b32 s34, 24117248
    buffer_store_dwordx4 v[252:255], v21, s[8:11], s34 offen offset:0 sc1
    ds_write_b128 v23, v[252:255] offset:19968
    v_mfma_f32_32x32x16_bf16 v[176:191], a[236:239], a[216:219], v[176:191]
    ds_read_b64_tr_b16 a[228:229], v2 offset:64
    ds_read_b64_tr_b16 a[230:231], v2 offset:576
    buffer_load_dwordx4 v19, s[16:19], s30 offen offset:1024 nt lds
    v_accvgpr_read_b32 v224, a64
    v_accvgpr_read_b32 v24, a65
    s_waitcnt lgkmcnt(9)
    v_mfma_f32_32x32x16_bf16 v[128:143], a[240:243], a[220:223], v[128:143]
    ds_read_b64_tr_b16 a[232:233], v2 offset:128
    ds_read_b64_tr_b16 a[234:235], v2 offset:640
    v_cvt_pk_bf16_f32 v224, v224, v24
    v_accvgpr_read_b32 v225, a66
    v_mfma_f32_32x32x16_bf16 v[144:159], a[244:247], a[220:223], v[144:159]
    ds_read_b64_tr_b16 a[236:237], v2 offset:192
    ds_read_b64_tr_b16 a[238:239], v2 offset:704
    buffer_load_dwordx4 v20, s[16:19], s29 offen offset:2112 nt lds
    v_accvgpr_read_b32 v25, a67
    v_cvt_pk_bf16_f32 v225, v225, v25
    s_waitcnt lgkmcnt(9)
    v_mfma_f32_32x32x16_bf16 v[160:175], a[248:251], a[220:223], v[160:175]
    ds_read_b64_tr_b16 a[240:241], v2 offset:8448
    ds_read_b64_tr_b16 a[242:243], v2 offset:8960
    v_accvgpr_read_b32 v226, a68
    v_accvgpr_read_b32 v26, a69
    v_mfma_f32_32x32x16_bf16 v[176:191], a[252:255], a[220:223], v[176:191]
    ds_read_b64_tr_b16 a[244:245], v2 offset:8512
    ds_read_b64_tr_b16 a[246:247], v2 offset:9024
    buffer_load_dwordx4 v20, s[16:19], s30 offen offset:3136 nt lds
    v_cvt_pk_bf16_f32 v226, v226, v26
    v_accvgpr_read_b32 v227, a70
    s_waitcnt lgkmcnt(8)
    v_mfma_f32_32x32x16_bf16 v[128:143], a[224:227], v[192:195], v[128:143]
    ds_read_b64_tr_b16 a[248:249], v2 offset:8576
    ds_read_b64_tr_b16 a[250:251], v2 offset:9088
    v_accvgpr_read_b32 v27, a71
    v_cvt_pk_bf16_f32 v227, v227, v27
    v_mfma_f32_32x32x16_bf16 v[144:159], a[228:231], v[192:195], v[144:159]
    ds_read_b64_tr_b16 a[252:253], v2 offset:8640
    ds_read_b64_tr_b16 a[254:255], v2 offset:9152
    s_mov_b32 s34, 25165824
    buffer_store_dwordx4 v[224:227], v21, s[56:59], s34 offen offset:0 sc1
    ds_write_b128 v22, v[224:227] offset:21056
    s_waitcnt lgkmcnt(9)
    v_mfma_f32_32x32x16_bf16 v[160:175], a[232:235], v[192:195], v[160:175]
    ds_read_b64_tr_b16 a[224:225], v2 offset:1024
    ds_read_b64_tr_b16 a[226:227], v2 offset:1536
    v_accvgpr_read_b32 v228, a72
    v_accvgpr_read_b32 v24, a73
    v_mfma_f32_32x32x16_bf16 v[176:191], a[236:239], v[192:195], v[176:191]
    ds_read_b64_tr_b16 a[228:229], v2 offset:1088
    ds_read_b64_tr_b16 a[230:231], v2 offset:1600
    v_cvt_pk_bf16_f32 v228, v228, v24
    v_accvgpr_read_b32 v229, a74
    s_waitcnt lgkmcnt(9)
    v_mfma_f32_32x32x16_bf16 v[128:143], a[240:243], v[196:199], v[128:143]
    ds_read_b64_tr_b16 a[232:233], v2 offset:1152
    ds_read_b64_tr_b16 a[234:235], v2 offset:1664
    v_accvgpr_read_b32 v25, a75
    v_cvt_pk_bf16_f32 v229, v229, v25
    v_mfma_f32_32x32x16_bf16 v[144:159], a[244:247], v[196:199], v[144:159]
    ds_read_b64_tr_b16 a[236:237], v2 offset:1216
    ds_read_b64_tr_b16 a[238:239], v2 offset:1728
    v_accvgpr_read_b32 v230, a76
    v_accvgpr_read_b32 v26, a77
    s_waitcnt lgkmcnt(9)
    v_mfma_f32_32x32x16_bf16 v[160:175], a[248:251], v[196:199], v[160:175]
    ds_read_b64_tr_b16 a[240:241], v2 offset:9472
    ds_read_b64_tr_b16 a[242:243], v2 offset:9984
    v_cvt_pk_bf16_f32 v230, v230, v26
    v_accvgpr_read_b32 v231, a78
    v_mfma_f32_32x32x16_bf16 v[176:191], a[252:255], v[196:199], v[176:191]
    ds_read_b64_tr_b16 a[244:245], v2 offset:9536
    ds_read_b64_tr_b16 a[246:247], v2 offset:10048
    v_accvgpr_read_b32 v27, a79
    v_cvt_pk_bf16_f32 v231, v231, v27
    s_waitcnt lgkmcnt(8)
    v_mfma_f32_32x32x16_bf16 v[128:143], a[224:227], v[200:203], v[128:143]
    ds_read_b64_tr_b16 a[248:249], v2 offset:9600
    ds_read_b64_tr_b16 a[250:251], v2 offset:10112
    s_waitcnt vmcnt(33)
    s_barrier
    s_add_u32 m0, s24, 33792
    s_mov_b32 s29, 164864
    s_mov_b32 s30, 204800
    s_mov_b32 s34, 26214400
    buffer_store_dwordx4 v[228:231], v21, s[56:59], s34 offen offset:0 sc1
    ds_write_b128 v22, v[228:231] offset:22080
    v_mfma_f32_32x32x16_bf16 v[144:159], a[228:231], v[200:203], v[144:159]
    ds_read_b64_tr_b16 a[252:253], v2 offset:9664
    ds_read_b64_tr_b16 a[254:255], v2 offset:10176
    buffer_load_dwordx4 v19, s[16:19], s29 offen nt lds
    v_accvgpr_read_b32 v232, a80
    v_accvgpr_read_b32 v24, a81
    s_waitcnt lgkmcnt(9)
    v_mfma_f32_32x32x16_bf16 v[160:175], a[232:235], v[200:203], v[160:175]
    ds_read_b64_tr_b16 a[224:225], v2 offset:16896
    ds_read_b64_tr_b16 a[226:227], v2 offset:17408
    v_cvt_pk_bf16_f32 v232, v232, v24
    v_accvgpr_read_b32 v233, a82
    v_mfma_f32_32x32x16_bf16 v[176:191], a[236:239], v[200:203], v[176:191]
    ds_read_b64_tr_b16 a[228:229], v2 offset:16960
    ds_read_b64_tr_b16 a[230:231], v2 offset:17472
    buffer_load_dwordx4 v19, s[16:19], s30 offen offset:1024 nt lds
    v_accvgpr_read_b32 v25, a83
    v_cvt_pk_bf16_f32 v233, v233, v25
    s_waitcnt lgkmcnt(9)
    v_mfma_f32_32x32x16_bf16 v[128:143], a[240:243], v[204:207], v[128:143]
    ds_read_b64_tr_b16 a[232:233], v2 offset:17024
    ds_read_b64_tr_b16 a[234:235], v2 offset:17536
    v_accvgpr_read_b32 v234, a84
    v_accvgpr_read_b32 v26, a85
    v_mfma_f32_32x32x16_bf16 v[144:159], a[244:247], v[204:207], v[144:159]
    ds_read_b64_tr_b16 a[236:237], v2 offset:17088
    ds_read_b64_tr_b16 a[238:239], v2 offset:17600
    buffer_load_dwordx4 v20, s[16:19], s29 offen offset:2112 nt lds
    v_cvt_pk_bf16_f32 v234, v234, v26
    v_accvgpr_read_b32 v235, a86
    s_waitcnt lgkmcnt(8)
    v_mfma_f32_32x32x16_bf16 v[160:175], a[248:251], v[204:207], v[160:175]
    ds_read_b64_tr_b16 a[240:241], v2 offset:25344
    ds_read_b64_tr_b16 a[242:243], v2 offset:25856
    v_accvgpr_read_b32 v27, a87
    v_cvt_pk_bf16_f32 v235, v235, v27
    v_mfma_f32_32x32x16_bf16 v[176:191], a[252:255], v[204:207], v[176:191]
    ds_read_b64_tr_b16 a[244:245], v2 offset:25408
    ds_read_b64_tr_b16 a[246:247], v2 offset:25920
    buffer_load_dwordx4 v20, s[16:19], s30 offen offset:3136 nt lds
    s_mov_b32 s34, 27262976
    buffer_store_dwordx4 v[232:235], v21, s[56:59], s34 offen offset:0 sc1
    ds_write_b128 v22, v[232:235] offset:23104
    s_waitcnt lgkmcnt(9)
    v_mfma_f32_32x32x16_bf16 v[128:143], a[224:227], v[208:211], v[128:143]
    ds_read_b64_tr_b16 a[248:249], v2 offset:25472
    ds_read_b64_tr_b16 a[250:251], v2 offset:25984
    v_accvgpr_read_b32 v236, a88
    v_accvgpr_read_b32 v24, a89
    v_mfma_f32_32x32x16_bf16 v[144:159], a[228:231], v[208:211], v[144:159]
    ds_read_b64_tr_b16 a[252:253], v2 offset:25536
    ds_read_b64_tr_b16 a[254:255], v2 offset:26048
    v_cvt_pk_bf16_f32 v236, v236, v24
    v_accvgpr_read_b32 v237, a90
    s_waitcnt lgkmcnt(9)
    v_mfma_f32_32x32x16_bf16 v[160:175], a[232:235], v[208:211], v[160:175]
    ds_read_b64_tr_b16 a[224:225], v2 offset:17920
    ds_read_b64_tr_b16 a[226:227], v2 offset:18432
    v_accvgpr_read_b32 v25, a91
    v_cvt_pk_bf16_f32 v237, v237, v25
    v_mfma_f32_32x32x16_bf16 v[176:191], a[236:239], v[208:211], v[176:191]
    ds_read_b64_tr_b16 a[228:229], v2 offset:17984
    ds_read_b64_tr_b16 a[230:231], v2 offset:18496
    v_accvgpr_read_b32 v238, a92
    v_accvgpr_read_b32 v26, a93
    s_waitcnt lgkmcnt(9)
    v_mfma_f32_32x32x16_bf16 v[128:143], a[240:243], v[212:215], v[128:143]
    ds_read_b64_tr_b16 a[232:233], v2 offset:18048
    ds_read_b64_tr_b16 a[234:235], v2 offset:18560
    v_cvt_pk_bf16_f32 v238, v238, v26
    v_accvgpr_read_b32 v239, a94
    v_mfma_f32_32x32x16_bf16 v[144:159], a[244:247], v[212:215], v[144:159]
    ds_read_b64_tr_b16 a[236:237], v2 offset:18112
    ds_read_b64_tr_b16 a[238:239], v2 offset:18624
    v_accvgpr_read_b32 v27, a95
    v_cvt_pk_bf16_f32 v239, v239, v27
    s_waitcnt lgkmcnt(8)
    v_mfma_f32_32x32x16_bf16 v[160:175], a[248:251], v[212:215], v[160:175]
    ds_read_b64_tr_b16 a[240:241], v2 offset:26368
    ds_read_b64_tr_b16 a[242:243], v2 offset:26880
    s_mov_b32 s34, 28311552
    buffer_store_dwordx4 v[236:239], v21, s[56:59], s34 offen offset:0 sc1
    ds_write_b128 v22, v[236:239] offset:24128
    v_mfma_f32_32x32x16_bf16 v[176:191], a[252:255], v[212:215], v[176:191]
    ds_read_b64_tr_b16 a[244:245], v2 offset:26432
    ds_read_b64_tr_b16 a[246:247], v2 offset:26944
    v_accvgpr_read_b32 v240, a96
    v_accvgpr_read_b32 v24, a97
    s_waitcnt lgkmcnt(9)
    v_mfma_f32_32x32x16_bf16 v[128:143], a[224:227], v[216:219], v[128:143]
    ds_read_b64_tr_b16 a[248:249], v2 offset:26496
    ds_read_b64_tr_b16 a[250:251], v2 offset:27008
    s_waitcnt vmcnt(36)
    s_barrier
    s_add_u32 m0, s24, 50688
    s_mov_b32 s29, 246784
    s_mov_b32 s30, 286720
    v_cvt_pk_bf16_f32 v240, v240, v24
    v_accvgpr_read_b32 v241, a98
    v_mfma_f32_32x32x16_bf16 v[144:159], a[228:231], v[216:219], v[144:159]
    ds_read_b64_tr_b16 a[252:253], v2 offset:26560
    ds_read_b64_tr_b16 a[254:255], v2 offset:27072
    buffer_load_dwordx4 v19, s[16:19], s29 offen nt lds
    v_accvgpr_read_b32 v25, a99
    v_cvt_pk_bf16_f32 v241, v241, v25
    s_waitcnt lgkmcnt(9)
    v_mfma_f32_32x32x16_bf16 v[160:175], a[232:235], v[216:219], v[160:175]
    ds_read_b64_tr_b16 a[224:225], v2 offset:33792
    ds_read_b64_tr_b16 a[226:227], v2 offset:34304
    v_accvgpr_read_b32 v242, a100
    v_accvgpr_read_b32 v26, a101
    v_mfma_f32_32x32x16_bf16 v[176:191], a[236:239], v[216:219], v[176:191]
    ds_read_b64_tr_b16 a[228:229], v2 offset:33856
    ds_read_b64_tr_b16 a[230:231], v2 offset:34368
    buffer_load_dwordx4 v19, s[16:19], s30 offen offset:1024 nt lds
    v_cvt_pk_bf16_f32 v242, v242, v26
    v_accvgpr_read_b32 v243, a102
    s_waitcnt lgkmcnt(8)
    v_mfma_f32_32x32x16_bf16 v[128:143], a[240:243], v[220:223], v[128:143]
    ds_read_b64_tr_b16 a[232:233], v2 offset:33920
    ds_read_b64_tr_b16 a[234:235], v2 offset:34432
    v_accvgpr_read_b32 v27, a103
    v_cvt_pk_bf16_f32 v243, v243, v27
    v_mfma_f32_32x32x16_bf16 v[144:159], a[244:247], v[220:223], v[144:159]
    ds_read_b64_tr_b16 a[236:237], v2 offset:33984
    ds_read_b64_tr_b16 a[238:239], v2 offset:34496
    buffer_load_dwordx4 v20, s[16:19], s29 offen offset:2112 nt lds
    s_mov_b32 s34, 29360128
    buffer_store_dwordx4 v[240:243], v21, s[8:11], s34 offen offset:0 sc1
    ds_write_b128 v23, v[240:243] offset:21056
    s_waitcnt lgkmcnt(9)
    v_mfma_f32_32x32x16_bf16 v[160:175], a[248:251], v[220:223], v[160:175]
    ds_read_b64_tr_b16 a[240:241], v2 offset:42240
    ds_read_b64_tr_b16 a[242:243], v2 offset:42752
    v_accvgpr_read_b32 v244, a104
    v_accvgpr_read_b32 v24, a105
    v_mfma_f32_32x32x16_bf16 v[176:191], a[252:255], v[220:223], v[176:191]
    ds_read_b64_tr_b16 a[244:245], v2 offset:42304
    ds_read_b64_tr_b16 a[246:247], v2 offset:42816
    buffer_load_dwordx4 v20, s[16:19], s30 offen offset:3136 nt lds
    v_cvt_pk_bf16_f32 v244, v244, v24
    v_accvgpr_read_b32 v245, a106
    s_waitcnt lgkmcnt(9)
    v_mfma_f32_32x32x16_bf16 v[64:79], a[224:227], a[192:195], v[64:79]
    ds_read_b64_tr_b16 a[248:249], v2 offset:42368
    ds_read_b64_tr_b16 a[250:251], v2 offset:42880
    v_accvgpr_read_b32 v25, a107
    v_cvt_pk_bf16_f32 v245, v245, v25
    v_and_b32 v12, 7, v0
    v_lshrrev_b32 v16, 3, v0
    v_mfma_f32_32x32x16_bf16 v[80:95], a[228:231], a[192:195], v[80:95]
    ds_read_b64_tr_b16 a[252:253], v2 offset:42432
    ds_read_b64_tr_b16 a[254:255], v2 offset:42944
    v_accvgpr_read_b32 v246, a108
    v_accvgpr_read_b32 v26, a109
    v_lshlrev_b32 v8, 4, v12
    s_waitcnt lgkmcnt(9)
    v_mfma_f32_32x32x16_bf16 v[96:111], a[232:235], a[192:195], v[96:111]
    ds_read_b64_tr_b16 a[224:225], v2 offset:34816
    ds_read_b64_tr_b16 a[226:227], v2 offset:35328
    v_cvt_pk_bf16_f32 v246, v246, v26
    v_accvgpr_read_b32 v247, a110
    v_and_b32 v17, 1, v16
    v_mfma_f32_32x32x16_bf16 v[112:127], a[236:239], a[192:195], v[112:127]
    ds_read_b64_tr_b16 a[228:229], v2 offset:34880
    ds_read_b64_tr_b16 a[230:231], v2 offset:35392
    v_accvgpr_read_b32 v27, a111
    v_cvt_pk_bf16_f32 v247, v247, v27
    v_lshl_add_u32 v8, v17, 9, v8
    s_waitcnt lgkmcnt(8)
    v_mfma_f32_32x32x16_bf16 v[64:79], a[240:243], a[196:199], v[64:79]
    ds_read_b64_tr_b16 a[232:233], v2 offset:34944
    ds_read_b64_tr_b16 a[234:235], v2 offset:35456
    s_mov_b32 s34, 30408704
    buffer_store_dwordx4 v[244:247], v21, s[8:11], s34 offen offset:0 sc1
    ds_write_b128 v23, v[244:247] offset:22080
    v_lshrrev_b32 v17, 4, v0
    v_mfma_f32_32x32x16_bf16 v[80:95], a[244:247], a[196:199], v[80:95]
    ds_read_b64_tr_b16 a[236:237], v2 offset:35008
    ds_read_b64_tr_b16 a[238:239], v2 offset:35520
    v_accvgpr_read_b32 v248, a112
    v_accvgpr_read_b32 v24, a113
    v_mul_u32_u24 v17, 1048576, v17
    s_waitcnt lgkmcnt(9)
    v_mfma_f32_32x32x16_bf16 v[96:111], a[248:251], a[196:199], v[96:111]
    ds_read_b64_tr_b16 a[240:241], v2 offset:43264
    ds_read_b64_tr_b16 a[242:243], v2 offset:43776
    v_cvt_pk_bf16_f32 v248, v248, v24
    v_accvgpr_read_b32 v249, a114
    v_add_u32 v8, v8, v17
    v_mfma_f32_32x32x16_bf16 v[112:127], a[252:255], a[196:199], v[112:127]
    ds_read_b64_tr_b16 a[244:245], v2 offset:43328
    ds_read_b64_tr_b16 a[246:247], v2 offset:43840
    v_accvgpr_read_b32 v25, a115
    v_cvt_pk_bf16_f32 v249, v249, v25
    v_mul_u32_u24 v9, 2560, v12
    s_waitcnt lgkmcnt(9)
    v_mfma_f32_32x32x16_bf16 v[64:79], a[224:227], a[200:203], v[64:79]
    ds_read_b64_tr_b16 a[248:249], v2 offset:43392
    ds_read_b64_tr_b16 a[250:251], v2 offset:43904
    s_waitcnt vmcnt(38)
    s_barrier
    s_add_u32 m0, s24, 67584
    s_mov_b32 s29, 328704
    s_mov_b32 s30, 368640
    v_accvgpr_read_b32 v250, a116
    v_accvgpr_read_b32 v26, a117
    v_lshl_add_u32 v9, v16, 4, v9
    v_mfma_f32_32x32x16_bf16 v[80:95], a[228:231], a[200:203], v[80:95]
    ds_read_b64_tr_b16 a[252:253], v2 offset:43456
    ds_read_b64_tr_b16 a[254:255], v2 offset:43968
    buffer_load_dwordx4 v19, s[16:19], s29 offen nt lds
    v_cvt_pk_bf16_f32 v250, v250, v26
    v_accvgpr_read_b32 v251, a118
    v_lshlrev_b32 v12, 3, v12
    s_waitcnt lgkmcnt(8)
    v_mfma_f32_32x32x16_bf16 v[96:111], a[232:235], a[200:203], v[96:111]
    ds_read_b64_tr_b16 a[224:225], v3 offset:0
    ds_read_b64_tr_b16 a[226:227], v3 offset:512
    v_accvgpr_read_b32 v27, a119
    v_cvt_pk_bf16_f32 v251, v251, v27
    v_bfe_u32 v16, v0, 2, 1
    v_lshrrev_b32 v17, 5, v0
    v_mfma_f32_32x32x16_bf16 v[112:127], a[236:239], a[200:203], v[112:127]
    ds_read_b64_tr_b16 a[228:229], v3 offset:64
    ds_read_b64_tr_b16 a[230:231], v3 offset:576
    buffer_load_dwordx4 v19, s[16:19], s30 offen offset:1024 nt lds
    s_mov_b32 s34, 31457280
    buffer_store_dwordx4 v[248:251], v21, s[8:11], s34 offen offset:0 sc1
    ds_write_b128 v23, v[248:251] offset:23104
    v_xor_b32 v16, v16, v17
    s_waitcnt lgkmcnt(9)
    v_mfma_f32_32x32x16_bf16 v[64:79], a[240:243], a[204:207], v[64:79]
    ds_read_b64_tr_b16 a[232:233], v3 offset:128
    ds_read_b64_tr_b16 a[234:235], v3 offset:640
    v_accvgpr_read_b32 v252, a120
    v_accvgpr_read_b32 v24, a121
    v_bfe_u32 v17, v0, 4, 1
    v_mfma_f32_32x32x16_bf16 v[80:95], a[244:247], a[204:207], v[80:95]
    ds_read_b64_tr_b16 a[236:237], v3 offset:192
    ds_read_b64_tr_b16 a[238:239], v3 offset:704
    buffer_load_dwordx4 v20, s[16:19], s29 offen offset:2112 nt lds
    v_cvt_pk_bf16_f32 v252, v252, v24
    v_accvgpr_read_b32 v253, a122
    v_or_b32 v16, v16, v17
    s_waitcnt lgkmcnt(9)
    v_mfma_f32_32x32x16_bf16 v[96:111], a[248:251], a[204:207], v[96:111]
    ds_read_b64_tr_b16 a[240:241], v3 offset:8448
    ds_read_b64_tr_b16 a[242:243], v3 offset:8960
    v_accvgpr_read_b32 v25, a123
    v_cvt_pk_bf16_f32 v253, v253, v25
    v_bfe_u32 v17, v0, 1, 1
    v_mfma_f32_32x32x16_bf16 v[112:127], a[252:255], a[204:207], v[112:127]
    ds_read_b64_tr_b16 a[244:245], v3 offset:8512
    ds_read_b64_tr_b16 a[246:247], v3 offset:9024
    buffer_load_dwordx4 v20, s[16:19], s30 offen offset:3136 nt lds
    v_accvgpr_read_b32 v254, a124
    v_accvgpr_read_b32 v26, a125
    v_lshl_add_u32 v16, v16, 2, v17
    s_waitcnt lgkmcnt(9)
    v_mfma_f32_32x32x16_bf16 v[64:79], a[224:227], a[208:211], v[64:79]
    ds_read_b64_tr_b16 a[248:249], v3 offset:8576
    ds_read_b64_tr_b16 a[250:251], v3 offset:9088
    v_cvt_pk_bf16_f32 v254, v254, v26
    v_accvgpr_read_b32 v255, a126
    v_bfe_u32 v17, v0, 3, 1
    v_mfma_f32_32x32x16_bf16 v[80:95], a[228:231], a[208:211], v[80:95]
    ds_read_b64_tr_b16 a[252:253], v3 offset:8640
    ds_read_b64_tr_b16 a[254:255], v3 offset:9152
    v_accvgpr_read_b32 v27, a127
    v_cvt_pk_bf16_f32 v255, v255, v27
    v_lshl_add_u32 v16, v17, 1, v16
    s_waitcnt lgkmcnt(8)
    v_mfma_f32_32x32x16_bf16 v[96:111], a[232:235], a[208:211], v[96:111]
    ds_read_b64_tr_b16 a[224:225], v3 offset:1024
    ds_read_b64_tr_b16 a[226:227], v3 offset:1536
    s_mov_b32 s34, 32505856
    buffer_store_dwordx4 v[252:255], v21, s[8:11], s34 offen offset:0 sc1
    ds_write_b128 v23, v[252:255] offset:24128
    v_and_b32 v17, 1, v0
    v_mfma_f32_32x32x16_bf16 v[112:127], a[236:239], a[208:211], v[112:127]
    ds_read_b64_tr_b16 a[228:229], v3 offset:1088
    ds_read_b64_tr_b16 a[230:231], v3 offset:1600
    v_cvt_pk_bf16_f32 v224, v128, v129
    v_lshlrev_b32 v17, 4, v17
    s_waitcnt lgkmcnt(9)
    v_mfma_f32_32x32x16_bf16 v[64:79], a[240:243], a[212:215], v[64:79]
    ds_read_b64_tr_b16 a[232:233], v3 offset:1152
    ds_read_b64_tr_b16 a[234:235], v3 offset:1664
    v_cvt_pk_bf16_f32 v225, v130, v131
    v_mov_b32 v18, 0x3f80
    v_mfma_f32_32x32x16_bf16 v[80:95], a[244:247], a[212:215], v[80:95]
    ds_read_b64_tr_b16 a[236:237], v3 offset:1216
    ds_read_b64_tr_b16 a[238:239], v3 offset:1728
    v_cvt_pk_bf16_f32 v226, v132, v133
    v_lshlrev_b32 v17, v17, v18
    v_cmp_eq_u32 vcc, 0, v16
    s_waitcnt lgkmcnt(9)
    v_mfma_f32_32x32x16_bf16 v[96:111], a[248:251], a[212:215], v[96:111]
    ds_read_b64_tr_b16 a[240:241], v3 offset:9472
    ds_read_b64_tr_b16 a[242:243], v3 offset:9984
    v_cndmask_b32 v4, 0, v17, vcc
    v_mfma_f32_32x32x16_bf16 v[112:127], a[252:255], a[212:215], v[112:127]
    ds_read_b64_tr_b16 a[244:245], v3 offset:9536
    ds_read_b64_tr_b16 a[246:247], v3 offset:10048
    v_cvt_pk_bf16_f32 v227, v134, v135
    v_cmp_eq_u32 vcc, 1, v16
    s_waitcnt lgkmcnt(8)
    v_mfma_f32_32x32x16_bf16 v[64:79], a[224:227], a[216:219], v[64:79]
    ds_read_b64_tr_b16 a[248:249], v3 offset:9600
    ds_read_b64_tr_b16 a[250:251], v3 offset:10112
    s_waitcnt vmcnt(39)
    s_barrier
    s_add_u32 m0, s24, 84480
    s_mov_b32 s29, 410624
    s_mov_b32 s30, 450560
    v_cvt_pk_bf16_f32 v228, v136, v137
    v_cndmask_b32 v5, 0, v17, vcc
    v_mfma_f32_32x32x16_bf16 v[80:95], a[228:231], a[216:219], v[80:95]
    ds_read_b64_tr_b16 a[252:253], v3 offset:9664
    ds_read_b64_tr_b16 a[254:255], v3 offset:10176
    buffer_load_dwordx4 v19, s[16:19], s29 offen nt lds
    v_cvt_pk_bf16_f32 v229, v138, v139
    v_cmp_eq_u32 vcc, 2, v16
    s_waitcnt lgkmcnt(8)
    v_mfma_f32_32x32x16_bf16 v[96:111], a[232:235], a[216:219], v[96:111]
    ds_read_b64_tr_b16 a[224:225], v3 offset:16896
    ds_read_b64_tr_b16 a[226:227], v3 offset:17408
    s_mov_b32 s34, 0
    buffer_store_dwordx4 v[224:227], v21, s[56:59], s34 offen offset:0 sc1
    v_cndmask_b32 v6, 0, v17, vcc
    v_mfma_f32_32x32x16_bf16 v[112:127], a[236:239], a[216:219], v[112:127]
    ds_read_b64_tr_b16 a[228:229], v3 offset:16960
    ds_read_b64_tr_b16 a[230:231], v3 offset:17472
    buffer_load_dwordx4 v19, s[16:19], s30 offen offset:1024 nt lds
    v_cvt_pk_bf16_f32 v230, v140, v141
    v_cmp_eq_u32 vcc, 3, v16
    s_waitcnt lgkmcnt(8)
    v_mfma_f32_32x32x16_bf16 v[64:79], a[240:243], a[220:223], v[64:79]
    ds_read_b64_tr_b16 a[232:233], v3 offset:17024
    ds_read_b64_tr_b16 a[234:235], v3 offset:17536
    v_cvt_pk_bf16_f32 v231, v142, v143
    v_cndmask_b32 v7, 0, v17, vcc
    v_mfma_f32_32x32x16_bf16 v[80:95], a[244:247], a[220:223], v[80:95]
    ds_read_b64_tr_b16 a[236:237], v3 offset:17088
    ds_read_b64_tr_b16 a[238:239], v3 offset:17600
    buffer_load_dwordx4 v20, s[16:19], s29 offen offset:2112 nt lds
    v_mov_b32 v14, s100
    s_waitcnt lgkmcnt(8)
    v_mfma_f32_32x32x16_bf16 v[96:111], a[248:251], a[220:223], v[96:111]
    ds_read_b64_tr_b16 a[240:241], v3 offset:25344
    ds_read_b64_tr_b16 a[242:243], v3 offset:25856
    v_cvt_pk_bf16_f32 v232, v144, v145
    v_mov_b32 v15, s101
    v_mfma_f32_32x32x16_bf16 v[112:127], a[252:255], a[220:223], v[112:127]
    ds_read_b64_tr_b16 a[244:245], v3 offset:25408
    ds_read_b64_tr_b16 a[246:247], v3 offset:25920
    buffer_load_dwordx4 v20, s[16:19], s30 offen offset:3136 nt lds
    v_cvt_pk_bf16_f32 v233, v146, v147
    v_mov_b32 v18, 1
    s_waitcnt lgkmcnt(8)
    v_mfma_f32_32x32x16_bf16 v[64:79], a[224:227], v[192:195], v[64:79]
    ds_read_b64_tr_b16 a[248:249], v3 offset:25472
    ds_read_b64_tr_b16 a[250:251], v3 offset:25984
    v_cvt_pk_bf16_f32 v234, v148, v149
    s_add_u32 s4, s84, s94
    s_addc_u32 s5, s85, 0
    s_cmp_eq_u32 s24, 0
    s_cselect_b32 s6, 512, 0
    s_mov_b32 s20, 16
    v_mfma_f32_32x32x16_bf16 v[80:95], a[228:231], v[192:195], v[80:95]
    ds_read_b64_tr_b16 a[252:253], v3 offset:25536
    ds_read_b64_tr_b16 a[254:255], v3 offset:26048
    s_mov_b32 s34, 1048576
    buffer_store_dwordx4 v[228:231], v21, s[56:59], s34 offen offset:0 sc1
    s_waitcnt lgkmcnt(8)
    v_mfma_f32_32x32x16_bf16 v[96:111], a[232:235], v[192:195], v[96:111]
    ds_read_b64_tr_b16 a[224:225], v3 offset:17920
    ds_read_b64_tr_b16 a[226:227], v3 offset:18432
    v_cvt_pk_bf16_f32 v235, v150, v151
    s_lshr_b32 s23, s24, 12
    s_lshl_b32 s23, s23, 7
    s_add_u32 s23, s23, 135168
    v_and_b32 v13, 7, v0
    v_lshl_add_u32 v13, v13, 4, s23
    v_lshrrev_b32 v16, 3, v0
    v_lshl_add_u32 v13, v16, 9, v13
    v_mfma_f32_32x32x16_bf16 v[112:127], a[236:239], v[192:195], v[112:127]
    ds_read_b64_tr_b16 a[228:229], v3 offset:17984
    ds_read_b64_tr_b16 a[230:231], v3 offset:18496
    v_cvt_pk_bf16_f32 v236, v152, v153
    s_waitcnt lgkmcnt(8)
    v_mfma_f32_32x32x16_bf16 v[64:79], a[240:243], v[196:199], v[64:79]
    ds_read_b64_tr_b16 a[232:233], v3 offset:18048
    ds_read_b64_tr_b16 a[234:235], v3 offset:18560
    v_cvt_pk_bf16_f32 v237, v154, v155
    s_add_u32 s12, s91, 1
    s_and_b32 s12, s12, 7
    s_lshl_b32 s12, s12, 12
    s_add_u32 s12, s12, s78
    v_mfma_f32_32x32x16_bf16 v[80:95], a[244:247], v[196:199], v[80:95]
    ds_read_b64_tr_b16 a[236:237], v3 offset:18112
    ds_read_b64_tr_b16 a[238:239], v3 offset:18624
    s_waitcnt lgkmcnt(8)
    v_mfma_f32_32x32x16_bf16 v[96:111], a[248:251], v[196:199], v[96:111]
    ds_read_b64_tr_b16 a[240:241], v3 offset:26368
    ds_read_b64_tr_b16 a[242:243], v3 offset:26880
    v_cvt_pk_bf16_f32 v238, v156, v157
    v_mfma_f32_32x32x16_bf16 v[112:127], a[252:255], v[196:199], v[112:127]
    ds_read_b64_tr_b16 a[244:245], v3 offset:26432
    ds_read_b64_tr_b16 a[246:247], v3 offset:26944
    v_cvt_pk_bf16_f32 v239, v158, v159
    s_add_u32 s13, s91, 2
    s_and_b32 s13, s13, 7
    s_lshl_b32 s13, s13, 12
    s_add_u32 s13, s13, s78
    s_waitcnt lgkmcnt(8)
    v_mfma_f32_32x32x16_bf16 v[64:79], a[224:227], v[200:203], v[64:79]
    ds_read_b64_tr_b16 a[248:249], v3 offset:26496
    ds_read_b64_tr_b16 a[250:251], v3 offset:27008
    s_waitcnt vmcnt(38)
    s_barrier
    s_add_u32 m0, s24, 101376
    s_mov_b32 s29, 492544
    s_mov_b32 s30, 532480
    s_mov_b32 s34, 2097152
    buffer_store_dwordx4 v[232:235], v21, s[56:59], s34 offen offset:0 sc1
    v_mfma_f32_32x32x16_bf16 v[80:95], a[228:231], v[200:203], v[80:95]
    ds_read_b64_tr_b16 a[252:253], v3 offset:26560
    ds_read_b64_tr_b16 a[254:255], v3 offset:27072
    buffer_load_dwordx4 v19, s[16:19], s29 offen nt lds
    v_cvt_pk_bf16_f32 v240, v160, v161
    s_waitcnt lgkmcnt(8)
    v_mfma_f32_32x32x16_bf16 v[96:111], a[232:235], v[200:203], v[96:111]
    ds_read_b64_tr_b16 a[224:225], v3 offset:33792
    ds_read_b64_tr_b16 a[226:227], v3 offset:34304
    v_cvt_pk_bf16_f32 v241, v162, v163
    s_add_u32 s14, s91, 3
    s_and_b32 s14, s14, 7
    s_lshl_b32 s14, s14, 12
    s_add_u32 s14, s14, s78
    v_mfma_f32_32x32x16_bf16 v[112:127], a[236:239], v[200:203], v[112:127]
    ds_read_b64_tr_b16 a[228:229], v3 offset:33856
    ds_read_b64_tr_b16 a[230:231], v3 offset:34368
    buffer_load_dwordx4 v19, s[16:19], s30 offen offset:1024 nt lds
    v_cvt_pk_bf16_f32 v242, v164, v165
    s_waitcnt lgkmcnt(8)
    v_mfma_f32_32x32x16_bf16 v[64:79], a[240:243], v[204:207], v[64:79]
    ds_read_b64_tr_b16 a[232:233], v3 offset:33920
    ds_read_b64_tr_b16 a[234:235], v3 offset:34432
    v_mfma_f32_32x32x16_bf16 v[80:95], a[244:247], v[204:207], v[80:95]
    ds_read_b64_tr_b16 a[236:237], v3 offset:33984
    ds_read_b64_tr_b16 a[238:239], v3 offset:34496
    buffer_load_dwordx4 v20, s[16:19], s29 offen offset:2112 nt lds
    v_cvt_pk_bf16_f32 v243, v166, v167
    s_add_u32 s15, s91, 4
    s_and_b32 s15, s15, 7
    s_lshl_b32 s15, s15, 12
    s_add_u32 s15, s15, s78
    s_waitcnt lgkmcnt(8)
    v_mfma_f32_32x32x16_bf16 v[96:111], a[248:251], v[204:207], v[96:111]
    ds_read_b64_tr_b16 a[240:241], v3 offset:42240
    ds_read_b64_tr_b16 a[242:243], v3 offset:42752
    v_cvt_pk_bf16_f32 v244, v168, v169
    v_mfma_f32_32x32x16_bf16 v[112:127], a[252:255], v[204:207], v[112:127]
    ds_read_b64_tr_b16 a[244:245], v3 offset:42304
    ds_read_b64_tr_b16 a[246:247], v3 offset:42816
    buffer_load_dwordx4 v20, s[16:19], s30 offen offset:3136 nt lds
    v_cvt_pk_bf16_f32 v245, v170, v171
    s_mov_b32 s34, 3145728
    buffer_store_dwordx4 v[236:239], v21, s[56:59], s34 offen offset:0 sc1
    s_add_u32 s25, s91, 5
    s_and_b32 s25, s25, 7
    s_lshl_b32 s25, s25, 12
    s_add_u32 s25, s25, s78
    s_waitcnt lgkmcnt(8)
    v_mfma_f32_32x32x16_bf16 v[64:79], a[224:227], v[208:211], v[64:79]
    ds_read_b64_tr_b16 a[248:249], v3 offset:42368
    ds_read_b64_tr_b16 a[250:251], v3 offset:42880
    v_mfma_f32_32x32x16_bf16 v[80:95], a[228:231], v[208:211], v[80:95]
    ds_read_b64_tr_b16 a[252:253], v3 offset:42432
    ds_read_b64_tr_b16 a[254:255], v3 offset:42944
    v_cvt_pk_bf16_f32 v246, v172, v173
    s_waitcnt lgkmcnt(8)
    v_mfma_f32_32x32x16_bf16 v[96:111], a[232:235], v[208:211], v[96:111]
    ds_read_b64_tr_b16 a[224:225], v3 offset:34816
    ds_read_b64_tr_b16 a[226:227], v3 offset:35328
    v_cvt_pk_bf16_f32 v247, v174, v175
    s_add_u32 s26, s91, 6
    s_and_b32 s26, s26, 7
    s_lshl_b32 s26, s26, 12
    s_add_u32 s26, s26, s78
    v_mfma_f32_32x32x16_bf16 v[112:127], a[236:239], v[208:211], v[112:127]
    ds_read_b64_tr_b16 a[228:229], v3 offset:34880
    ds_read_b64_tr_b16 a[230:231], v3 offset:35392
    s_waitcnt lgkmcnt(8)
    v_mfma_f32_32x32x16_bf16 v[64:79], a[240:243], v[212:215], v[64:79]
    ds_read_b64_tr_b16 a[232:233], v3 offset:34944
    ds_read_b64_tr_b16 a[234:235], v3 offset:35456
    v_cvt_pk_bf16_f32 v248, v176, v177
    v_mfma_f32_32x32x16_bf16 v[80:95], a[244:247], v[212:215], v[80:95]
    ds_read_b64_tr_b16 a[236:237], v3 offset:35008
    ds_read_b64_tr_b16 a[238:239], v3 offset:35520
    v_cvt_pk_bf16_f32 v249, v178, v179
    s_add_u32 s27, s91, 7
    s_and_b32 s27, s27, 7
    s_lshl_b32 s27, s27, 12
    s_add_u32 s27, s27, s78
    s_waitcnt lgkmcnt(8)
    v_mfma_f32_32x32x16_bf16 v[96:111], a[248:251], v[212:215], v[96:111]
    ds_read_b64_tr_b16 a[240:241], v3 offset:43264
    ds_read_b64_tr_b16 a[242:243], v3 offset:43776
    v_cvt_pk_bf16_f32 v250, v180, v181
    s_mov_b32 s34, 4194304
    buffer_store_dwordx4 v[240:243], v21, s[8:11], s34 offen offset:0 sc1
    v_mfma_f32_32x32x16_bf16 v[112:127], a[252:255], v[212:215], v[112:127]
    ds_read_b64_tr_b16 a[244:245], v3 offset:43328
    ds_read_b64_tr_b16 a[246:247], v3 offset:43840
    s_waitcnt lgkmcnt(8)
    v_mfma_f32_32x32x16_bf16 v[64:79], a[224:227], v[216:219], v[64:79]
    ds_read_b64_tr_b16 a[248:249], v3 offset:43392
    ds_read_b64_tr_b16 a[250:251], v3 offset:43904
    s_waitcnt vmcnt(39)
    s_barrier
    s_add_u32 m0, s24, 118272
    s_mov_b32 s29, 574464
    s_mov_b32 s30, 614400
    v_cvt_pk_bf16_f32 v251, v182, v183
    v_mfma_f32_32x32x16_bf16 v[80:95], a[228:231], v[216:219], v[80:95]
    ds_read_b64_tr_b16 a[252:253], v3 offset:43456
    ds_read_b64_tr_b16 a[254:255], v3 offset:43968
    buffer_load_dwordx4 v19, s[16:19], s29 offen nt lds
    v_cvt_pk_bf16_f32 v252, v184, v185
    s_waitcnt lgkmcnt(8)
    v_mfma_f32_32x32x16_bf16 v[96:111], a[232:235], v[216:219], v[96:111]
    ds_read_b64_tr_b16 a[224:225], v1 offset:0
    ds_read_b64_tr_b16 a[226:227], v1 offset:512
    v_cvt_pk_bf16_f32 v253, v186, v187
    v_mfma_f32_32x32x16_bf16 v[112:127], a[236:239], v[216:219], v[112:127]
    ds_read_b64_tr_b16 a[228:229], v1 offset:64
    ds_read_b64_tr_b16 a[230:231], v1 offset:576
    buffer_load_dwordx4 v19, s[16:19], s30 offen offset:1024 nt lds
    s_waitcnt lgkmcnt(8)
    v_mfma_f32_32x32x16_bf16 v[64:79], a[240:243], v[220:223], v[64:79]
    ds_read_b64_tr_b16 a[232:233], v1 offset:128
    ds_read_b64_tr_b16 a[234:235], v1 offset:640
    v_cvt_pk_bf16_f32 v254, v188, v189
    v_mfma_f32_32x32x16_bf16 v[80:95], a[244:247], v[220:223], v[80:95]
    ds_read_b64_tr_b16 a[236:237], v1 offset:192
    ds_read_b64_tr_b16 a[238:239], v1 offset:704
    buffer_load_dwordx4 v20, s[16:19], s29 offen offset:2112 nt lds
    v_cvt_pk_bf16_f32 v255, v190, v191
    s_mov_b32 s34, 5242880
    buffer_store_dwordx4 v[244:247], v21, s[8:11], s34 offen offset:0 sc1
    s_waitcnt lgkmcnt(8)
    v_mfma_f32_32x32x16_bf16 v[96:111], a[248:251], v[220:223], v[96:111]
    ds_read_b64_tr_b16 a[240:241], v1 offset:8448
    ds_read_b64_tr_b16 a[242:243], v1 offset:8960
    v_mfma_f32_32x32x16_bf16 v[112:127], a[252:255], v[220:223], v[112:127]
    ds_read_b64_tr_b16 a[244:245], v1 offset:8512
    ds_read_b64_tr_b16 a[246:247], v1 offset:9024
    buffer_load_dwordx4 v20, s[16:19], s30 offen offset:3136 nt lds
    s_waitcnt lgkmcnt(8)
    v_mfma_f32_32x32x16_bf16 v[128:143], a[224:227], v[32:35], 0
    ds_read_b64_tr_b16 a[248:249], v1 offset:8576
    ds_read_b64_tr_b16 a[250:251], v1 offset:9088
    v_mfma_f32_32x32x16_bf16 v[144:159], a[228:231], v[32:35], 0
    ds_read_b64_tr_b16 a[252:253], v1 offset:8640
    ds_read_b64_tr_b16 a[254:255], v1 offset:9152
    s_waitcnt lgkmcnt(8)
    v_mfma_f32_32x32x16_bf16 v[160:175], a[232:235], v[32:35], 0
    ds_read_b64_tr_b16 a[224:225], v1 offset:1024
    ds_read_b64_tr_b16 a[226:227], v1 offset:1536
    v_mfma_f32_32x32x16_bf16 v[176:191], a[236:239], v[32:35], 0
    ds_read_b64_tr_b16 a[228:229], v1 offset:1088
    ds_read_b64_tr_b16 a[230:231], v1 offset:1600
    s_waitcnt lgkmcnt(8)
    v_mfma_f32_32x32x16_bf16 v[128:143], a[240:243], v[36:39], v[128:143]
    ds_read_b64_tr_b16 a[232:233], v1 offset:1152
    ds_read_b64_tr_b16 a[234:235], v1 offset:1664
    s_mov_b32 s34, 6291456
    buffer_store_dwordx4 v[248:251], v21, s[8:11], s34 offen offset:0 sc1
    v_mfma_f32_32x32x16_bf16 v[144:159], a[244:247], v[36:39], v[144:159]
    ds_read_b64_tr_b16 a[236:237], v1 offset:1216
    ds_read_b64_tr_b16 a[238:239], v1 offset:1728
    s_waitcnt lgkmcnt(8)
    v_mfma_f32_32x32x16_bf16 v[160:175], a[248:251], v[36:39], v[160:175]
    ds_read_b64_tr_b16 a[240:241], v1 offset:9472
    ds_read_b64_tr_b16 a[242:243], v1 offset:9984
    v_mfma_f32_32x32x16_bf16 v[176:191], a[252:255], v[36:39], v[176:191]
    ds_read_b64_tr_b16 a[244:245], v1 offset:9536
    ds_read_b64_tr_b16 a[246:247], v1 offset:10048
    s_waitcnt lgkmcnt(8)
    v_mfma_f32_32x32x16_bf16 v[128:143], a[224:227], v[40:43], v[128:143]
    ds_read_b64_tr_b16 a[248:249], v1 offset:9600
    ds_read_b64_tr_b16 a[250:251], v1 offset:10112
    s_waitcnt vmcnt(39)
    s_barrier
    v_mfma_f32_32x32x16_bf16 v[144:159], a[228:231], v[40:43], v[144:159]
    ds_read_b64_tr_b16 a[252:253], v1 offset:9664
    ds_read_b64_tr_b16 a[254:255], v1 offset:10176
    ds_write_b128 v22, v[224:227] offset:0
    s_waitcnt lgkmcnt(9)
    v_mfma_f32_32x32x16_bf16 v[160:175], a[232:235], v[40:43], v[160:175]
    ds_read_b64_tr_b16 a[224:225], v1 offset:16896
    ds_read_b64_tr_b16 a[226:227], v1 offset:17408
    v_mfma_f32_32x32x16_bf16 v[176:191], a[236:239], v[40:43], v[176:191]
    ds_read_b64_tr_b16 a[228:229], v1 offset:16960
    ds_read_b64_tr_b16 a[230:231], v1 offset:17472
    s_mov_b32 s34, 7340032
    buffer_store_dwordx4 v[252:255], v21, s[8:11], s34 offen offset:0 sc1
    v_cvt_pk_bf16_f32 v64, v64, v65
    ds_write_b128 v22, v[228:231] offset:1024
    s_waitcnt lgkmcnt(10)
    v_mfma_f32_32x32x16_bf16 v[128:143], a[240:243], v[44:47], v[128:143]
    ds_read_b64_tr_b16 a[232:233], v1 offset:17024
    ds_read_b64_tr_b16 a[234:235], v1 offset:17536
    v_cvt_pk_bf16_f32 v65, v66, v67
    v_mfma_f32_32x32x16_bf16 v[144:159], a[244:247], v[44:47], v[144:159]
    ds_read_b64_tr_b16 a[236:237], v1 offset:17088
    ds_read_b64_tr_b16 a[238:239], v1 offset:17600
    v_cvt_pk_bf16_f32 v66, v68, v69
    s_waitcnt lgkmcnt(10)
    v_mfma_f32_32x32x16_bf16 v[160:175], a[248:251], v[44:47], v[160:175]
    ds_read_b64_tr_b16 a[240:241], v1 offset:25344
    ds_read_b64_tr_b16 a[242:243], v1 offset:25856
    ds_write_b128 v22, v[232:235] offset:2048
    v_mfma_f32_32x32x16_bf16 v[176:191], a[252:255], v[44:47], v[176:191]
    ds_read_b64_tr_b16 a[244:245], v1 offset:25408
    ds_read_b64_tr_b16 a[246:247], v1 offset:25920
    v_cvt_pk_bf16_f32 v67, v70, v71
    s_waitcnt lgkmcnt(10)
    v_mfma_f32_32x32x16_bf16 v[128:143], a[224:227], v[48:51], v[128:143]
    ds_read_b64_tr_b16 a[248:249], v1 offset:25472
    ds_read_b64_tr_b16 a[250:251], v1 offset:25984
    s_mov_b32 s34, 8388608
    buffer_store_dwordx4 v[64:67], v21, s[56:59], s34 offen offset:0 sc1
    ds_write_b128 v22, v[64:67] offset:4096
    v_mfma_f32_32x32x16_bf16 v[144:159], a[228:231], v[48:51], v[144:159]
    ds_read_b64_tr_b16 a[252:253], v1 offset:25536
    ds_read_b64_tr_b16 a[254:255], v1 offset:26048
    s_waitcnt lgkmcnt(11)
    ds_write_b128 v22, v[236:239] offset:3072
    s_waitcnt lgkmcnt(11)
    v_mfma_f32_32x32x16_bf16 v[160:175], a[232:235], v[48:51], v[160:175]
    ds_read_b64_tr_b16 a[224:225], v1 offset:17920
    ds_read_b64_tr_b16 a[226:227], v1 offset:18432
    v_cvt_pk_bf16_f32 v68, v72, v73
    v_mfma_f32_32x32x16_bf16 v[176:191], a[236:239], v[48:51], v[176:191]
    ds_read_b64_tr_b16 a[228:229], v1 offset:17984
    ds_read_b64_tr_b16 a[230:231], v1 offset:18496
    v_cvt_pk_bf16_f32 v69, v74, v75
    s_waitcnt lgkmcnt(10)
    v_mfma_f32_32x32x16_bf16 v[128:143], a[240:243], v[52:55], v[128:143]
    ds_read_b64_tr_b16 a[232:233], v1 offset:18048
    ds_read_b64_tr_b16 a[234:235], v1 offset:18560
    v_cvt_pk_bf16_f32 v70, v76, v77
    ds_write_b128 v23, v[240:243] offset:0
    v_mfma_f32_32x32x16_bf16 v[144:159], a[244:247], v[52:55], v[144:159]
    ds_read_b64_tr_b16 a[236:237], v1 offset:18112
    ds_read_b64_tr_b16 a[238:239], v1 offset:18624
    s_waitcnt lgkmcnt(10)
    v_mfma_f32_32x32x16_bf16 v[160:175], a[248:251], v[52:55], v[160:175]
    ds_read_b64_tr_b16 a[240:241], v1 offset:26368
    ds_read_b64_tr_b16 a[242:243], v1 offset:26880
    v_cvt_pk_bf16_f32 v71, v78, v79
    v_mfma_f32_32x32x16_bf16 v[176:191], a[252:255], v[52:55], v[176:191]
    ds_read_b64_tr_b16 a[244:245], v1 offset:26432
    ds_read_b64_tr_b16 a[246:247], v1 offset:26944
    s_mov_b32 s34, 9437184
    buffer_store_dwordx4 v[68:71], v21, s[56:59], s34 offen offset:0 sc1
    ds_write_b128 v22, v[68:71] offset:5120
    s_waitcnt lgkmcnt(11)
    ds_write_b128 v23, v[244:247] offset:1024
    s_waitcnt lgkmcnt(11)
    v_mfma_f32_32x32x16_bf16 v[128:143], a[224:227], v[56:59], v[128:143]
    ds_read_b64_tr_b16 a[248:249], v1 offset:26496
    ds_read_b64_tr_b16 a[250:251], v1 offset:27008
    s_waitcnt vmcnt(36)
    s_barrier
    v_mfma_f32_32x32x16_bf16 v[144:159], a[228:231], v[56:59], v[144:159]
    ds_read_b64_tr_b16 a[252:253], v1 offset:26560
    ds_read_b64_tr_b16 a[254:255], v1 offset:27072
    v_cvt_pk_bf16_f32 v80, v80, v81
    s_waitcnt lgkmcnt(10)
    v_mfma_f32_32x32x16_bf16 v[160:175], a[232:235], v[56:59], v[160:175]
    ds_read_b64_tr_b16 a[224:225], v1 offset:33792
    ds_read_b64_tr_b16 a[226:227], v1 offset:34304
    v_cvt_pk_bf16_f32 v81, v82, v83
    ds_write_b128 v23, v[248:251] offset:2048
    v_mfma_f32_32x32x16_bf16 v[176:191], a[236:239], v[56:59], v[176:191]
    ds_read_b64_tr_b16 a[228:229], v1 offset:33856
    ds_read_b64_tr_b16 a[230:231], v1 offset:34368
    v_cvt_pk_bf16_f32 v82, v84, v85
    s_waitcnt lgkmcnt(11)
    v_mfma_f32_32x32x16_bf16 v[128:143], a[240:243], v[60:63], v[128:143]
    ds_read_b64_tr_b16 a[232:233], v1 offset:33920
    ds_read_b64_tr_b16 a[234:235], v1 offset:34432
    v_mfma_f32_32x32x16_bf16 v[144:159], a[244:247], v[60:63], v[144:159]
    ds_read_b64_tr_b16 a[236:237], v1 offset:33984
    ds_read_b64_tr_b16 a[238:239], v1 offset:34496
    v_cvt_pk_bf16_f32 v83, v86, v87
    s_waitcnt lgkmcnt(11)
    ds_write_b128 v23, v[252:255] offset:3072
    s_waitcnt lgkmcnt(10)
    v_mfma_f32_32x32x16_bf16 v[160:175], a[248:251], v[60:63], v[160:175]
    ds_read_b64_tr_b16 a[240:241], v1 offset:42240
    ds_read_b64_tr_b16 a[242:243], v1 offset:42752
    s_mov_b32 s34, 10485760
    buffer_store_dwordx4 v[80:83], v21, s[56:59], s34 offen offset:0 sc1
    ds_write_b128 v22, v[80:83] offset:6144
    v_mfma_f32_32x32x16_bf16 v[176:191], a[252:255], v[60:63], v[176:191]
    ds_read_b64_tr_b16 a[244:245], v1 offset:42304
    ds_read_b64_tr_b16 a[246:247], v1 offset:42816
    s_waitcnt lgkmcnt(10)
    v_mfma_f32_32x32x16_bf16 v[128:143], a[224:227], a[160:163], v[128:143]
    ds_read_b64_tr_b16 a[248:249], v1 offset:42368
    ds_read_b64_tr_b16 a[250:251], v1 offset:42880
    v_cvt_pk_bf16_f32 v84, v88, v89
    v_mfma_f32_32x32x16_bf16 v[144:159], a[228:231], a[160:163], v[144:159]
    ds_read_b64_tr_b16 a[252:253], v1 offset:42432
    ds_read_b64_tr_b16 a[254:255], v1 offset:42944
    v_cvt_pk_bf16_f32 v85, v90, v91
    s_waitcnt lgkmcnt(10)
    v_mfma_f32_32x32x16_bf16 v[160:175], a[232:235], a[160:163], v[160:175]
    ds_read_b64_tr_b16 a[224:225], v1 offset:34816
    ds_read_b64_tr_b16 a[226:227], v1 offset:35328
    v_cvt_pk_bf16_f32 v86, v92, v93
    v_mfma_f32_32x32x16_bf16 v[176:191], a[236:239], a[160:163], v[176:191]
    ds_read_b64_tr_b16 a[228:229], v1 offset:34880
    ds_read_b64_tr_b16 a[230:231], v1 offset:35392
    s_waitcnt lgkmcnt(8)
    v_mfma_f32_32x32x16_bf16 v[128:143], a[240:243], a[164:167], v[128:143]
    ds_read_b64_tr_b16 a[232:233], v1 offset:34944
    ds_read_b64_tr_b16 a[234:235], v1 offset:35456
    v_cvt_pk_bf16_f32 v87, v94, v95
    v_mfma_f32_32x32x16_bf16 v[144:159], a[244:247], a[164:167], v[144:159]
    ds_read_b64_tr_b16 a[236:237], v1 offset:35008
    ds_read_b64_tr_b16 a[238:239], v1 offset:35520
    s_mov_b32 s34, 11534336
    buffer_store_dwordx4 v[84:87], v21, s[56:59], s34 offen offset:0 sc1
    ds_write_b128 v22, v[84:87] offset:7168
    s_waitcnt lgkmcnt(9)
    v_mfma_f32_32x32x16_bf16 v[160:175], a[248:251], a[164:167], v[160:175]
    ds_read_b64_tr_b16 a[240:241], v1 offset:43264
    ds_read_b64_tr_b16 a[242:243], v1 offset:43776
    v_mfma_f32_32x32x16_bf16 v[176:191], a[252:255], a[164:167], v[176:191]
    ds_read_b64_tr_b16 a[244:245], v1 offset:43328
    ds_read_b64_tr_b16 a[246:247], v1 offset:43840
    v_cvt_pk_bf16_f32 v96, v96, v97
    s_waitcnt lgkmcnt(9)
    v_mfma_f32_32x32x16_bf16 v[128:143], a[224:227], a[168:171], v[128:143]
    ds_read_b64_tr_b16 a[248:249], v1 offset:43392
    ds_read_b64_tr_b16 a[250:251], v1 offset:43904
    s_waitcnt vmcnt(31)
    s_barrier
    v_cvt_pk_bf16_f32 v97, v98, v99
    v_mfma_f32_32x32x16_bf16 v[144:159], a[228:231], a[168:171], v[144:159]
    ds_read_b64_tr_b16 a[252:253], v1 offset:43456
    ds_read_b64_tr_b16 a[254:255], v1 offset:43968
    v_cvt_pk_bf16_f32 v98, v100, v101
    s_waitcnt lgkmcnt(9)
    v_mfma_f32_32x32x16_bf16 v[160:175], a[232:235], a[168:171], v[160:175]
    ds_read_b64_tr_b16 a[224:225], v2 offset:0
    ds_read_b64_tr_b16 a[226:227], v2 offset:512
    v_mfma_f32_32x32x16_bf16 v[176:191], a[236:239], a[168:171], v[176:191]
    ds_read_b64_tr_b16 a[228:229], v2 offset:64
    ds_read_b64_tr_b16 a[230:231], v2 offset:576
    v_cvt_pk_bf16_f32 v99, v102, v103
    s_waitcnt lgkmcnt(8)
    v_mfma_f32_32x32x16_bf16 v[128:143], a[240:243], a[172:175], v[128:143]
    ds_read_b64_tr_b16 a[232:233], v2 offset:128
    ds_read_b64_tr_b16 a[234:235], v2 offset:640
    s_mov_b32 s34, 12582912
    buffer_store_dwordx4 v[96:99], v21, s[8:11], s34 offen offset:0 sc1
    ds_write_b128 v23, v[96:99] offset:4096
    v_mfma_f32_32x32x16_bf16 v[144:159], a[244:247], a[172:175], v[144:159]
    ds_read_b64_tr_b16 a[236:237], v2 offset:192
    ds_read_b64_tr_b16 a[238:239], v2 offset:704
    s_waitcnt lgkmcnt(9)
    v_mfma_f32_32x32x16_bf16 v[160:175], a[248:251], a[172:175], v[160:175]
    ds_read_b64_tr_b16 a[240:241], v2 offset:8448
    ds_read_b64_tr_b16 a[242:243], v2 offset:8960
    v_cvt_pk_bf16_f32 v100, v104, v105
    v_mfma_f32_32x32x16_bf16 v[176:191], a[252:255], a[172:175], v[176:191]
    ds_read_b64_tr_b16 a[244:245], v2 offset:8512
    ds_read_b64_tr_b16 a[246:247], v2 offset:9024
    v_cvt_pk_bf16_f32 v101, v106, v107
    s_waitcnt lgkmcnt(9)
    v_mfma_f32_32x32x16_bf16 v[128:143], a[224:227], a[176:179], v[128:143]
    ds_read_b64_tr_b16 a[248:249], v2 offset:8576
    ds_read_b64_tr_b16 a[250:251], v2 offset:9088
    v_cvt_pk_bf16_f32 v102, v108, v109
    v_mfma_f32_32x32x16_bf16 v[144:159], a[228:231], a[176:179], v[144:159]
    ds_read_b64_tr_b16 a[252:253], v2 offset:8640
    ds_read_b64_tr_b16 a[254:255], v2 offset:9152
    s_waitcnt lgkmcnt(8)
    v_mfma_f32_32x32x16_bf16 v[160:175], a[232:235], a[176:179], v[160:175]
    ds_read_b64_tr_b16 a[224:225], v2 offset:1024
    ds_read_b64_tr_b16 a[226:227], v2 offset:1536
    v_cvt_pk_bf16_f32 v103, v110, v111
    v_mfma_f32_32x32x16_bf16 v[176:191], a[236:239], a[176:179], v[176:191]
    ds_read_b64_tr_b16 a[228:229], v2 offset:1088
    ds_read_b64_tr_b16 a[230:231], v2 offset:1600
    s_mov_b32 s34, 13631488
    buffer_store_dwordx4 v[100:103], v21, s[8:11], s34 offen offset:0 sc1
    ds_write_b128 v23, v[100:103] offset:5120
    s_waitcnt lgkmcnt(9)
    v_mfma_f32_32x32x16_bf16 v[128:143], a[240:243], a[180:183], v[128:143]
    ds_read_b64_tr_b16 a[232:233], v2 offset:1152
    ds_read_b64_tr_b16 a[234:235], v2 offset:1664
    v_mfma_f32_32x32x16_bf16 v[144:159], a[244:247], a[180:183], v[144:159]
    ds_read_b64_tr_b16 a[236:237], v2 offset:1216
    ds_read_b64_tr_b16 a[238:239], v2 offset:1728
    v_cvt_pk_bf16_f32 v112, v112, v113
    s_waitcnt lgkmcnt(9)
    v_mfma_f32_32x32x16_bf16 v[160:175], a[248:251], a[180:183], v[160:175]
    ds_read_b64_tr_b16 a[240:241], v2 offset:9472
    ds_read_b64_tr_b16 a[242:243], v2 offset:9984
    v_cvt_pk_bf16_f32 v113, v114, v115
    v_mfma_f32_32x32x16_bf16 v[176:191], a[252:255], a[180:183], v[176:191]
    ds_read_b64_tr_b16 a[244:245], v2 offset:9536
    ds_read_b64_tr_b16 a[246:247], v2 offset:10048
    v_cvt_pk_bf16_f32 v114, v116, v117
    s_waitcnt lgkmcnt(9)
    v_mfma_f32_32x32x16_bf16 v[128:143], a[224:227], a[184:187], v[128:143]
    ds_read_b64_tr_b16 a[248:249], v2 offset:9600
    ds_read_b64_tr_b16 a[250:251], v2 offset:10112
    s_waitcnt vmcnt(27)
    s_barrier
    v_mfma_f32_32x32x16_bf16 v[144:159], a[228:231], a[184:187], v[144:159]
    ds_read_b64_tr_b16 a[252:253], v2 offset:9664
    ds_read_b64_tr_b16 a[254:255], v2 offset:10176
    v_cvt_pk_bf16_f32 v115, v118, v119
    s_waitcnt lgkmcnt(8)
    v_mfma_f32_32x32x16_bf16 v[160:175], a[232:235], a[184:187], v[160:175]
    ds_read_b64_tr_b16 a[224:225], v2 offset:16896
    ds_read_b64_tr_b16 a[226:227], v2 offset:17408
    s_mov_b32 s34, 14680064
    buffer_store_dwordx4 v[112:115], v21, s[8:11], s34 offen offset:0 sc1
    ds_write_b128 v23, v[112:115] offset:6144
    v_mfma_f32_32x32x16_bf16 v[176:191], a[236:239], a[184:187], v[176:191]
    ds_read_b64_tr_b16 a[228:229], v2 offset:16960
    ds_read_b64_tr_b16 a[230:231], v2 offset:17472
    s_waitcnt lgkmcnt(9)
    v_mfma_f32_32x32x16_bf16 v[128:143], a[240:243], a[188:191], v[128:143]
    ds_read_b64_tr_b16 a[232:233], v2 offset:17024
    ds_read_b64_tr_b16 a[234:235], v2 offset:17536
    v_cvt_pk_bf16_f32 v116, v120, v121
    v_mfma_f32_32x32x16_bf16 v[144:159], a[244:247], a[188:191], v[144:159]
    ds_read_b64_tr_b16 a[236:237], v2 offset:17088
    ds_read_b64_tr_b16 a[238:239], v2 offset:17600
    v_cvt_pk_bf16_f32 v117, v122, v123
    s_waitcnt lgkmcnt(9)
    v_mfma_f32_32x32x16_bf16 v[160:175], a[248:251], a[188:191], v[160:175]
    ds_read_b64_tr_b16 a[240:241], v2 offset:25344
    ds_read_b64_tr_b16 a[242:243], v2 offset:25856
    v_cvt_pk_bf16_f32 v118, v124, v125
    v_mfma_f32_32x32x16_bf16 v[176:191], a[252:255], a[188:191], v[176:191]
    ds_read_b64_tr_b16 a[244:245], v2 offset:25408
    ds_read_b64_tr_b16 a[246:247], v2 offset:25920
    s_waitcnt lgkmcnt(8)
    v_mfma_f32_32x32x16_bf16 v[128:143], a[224:227], a[192:195], v[128:143]
    ds_read_b64_tr_b16 a[248:249], v2 offset:25472
    ds_read_b64_tr_b16 a[250:251], v2 offset:25984
    v_cvt_pk_bf16_f32 v119, v126, v127
    v_mfma_f32_32x32x16_bf16 v[144:159], a[228:231], a[192:195], v[144:159]
    ds_read_b64_tr_b16 a[252:253], v2 offset:25536
    ds_read_b64_tr_b16 a[254:255], v2 offset:26048
    s_mov_b32 s34, 15728640
    buffer_store_dwordx4 v[116:119], v21, s[8:11], s34 offen offset:0 sc1
    ds_write_b128 v23, v[116:119] offset:7168
    s_waitcnt lgkmcnt(9)
    v_mfma_f32_32x32x16_bf16 v[160:175], a[232:235], a[192:195], v[160:175]
    ds_read_b64_tr_b16 a[224:225], v2 offset:17920
    ds_read_b64_tr_b16 a[226:227], v2 offset:18432
    v_mfma_f32_32x32x16_bf16 v[176:191], a[236:239], a[192:195], v[176:191]
    ds_read_b64_tr_b16 a[228:229], v2 offset:17984
    ds_read_b64_tr_b16 a[230:231], v2 offset:18496
    s_waitcnt lgkmcnt(9)
    v_mfma_f32_32x32x16_bf16 v[128:143], a[240:243], a[196:199], v[128:143]
    ds_read_b64_tr_b16 a[232:233], v2 offset:18048
    ds_read_b64_tr_b16 a[234:235], v2 offset:18560
    v_mfma_f32_32x32x16_bf16 v[144:159], a[244:247], a[196:199], v[144:159]
    ds_read_b64_tr_b16 a[236:237], v2 offset:18112
    ds_read_b64_tr_b16 a[238:239], v2 offset:18624
    s_waitcnt lgkmcnt(9)
    v_mfma_f32_32x32x16_bf16 v[160:175], a[248:251], a[196:199], v[160:175]
    ds_read_b64_tr_b16 a[240:241], v2 offset:26368
    ds_read_b64_tr_b16 a[242:243], v2 offset:26880
    v_mfma_f32_32x32x16_bf16 v[176:191], a[252:255], a[196:199], v[176:191]
    ds_read_b64_tr_b16 a[244:245], v2 offset:26432
    ds_read_b64_tr_b16 a[246:247], v2 offset:26944
    s_waitcnt lgkmcnt(8)
    v_mfma_f32_32x32x16_bf16 v[128:143], a[224:227], a[200:203], v[128:143]
    ds_read_b64_tr_b16 a[248:249], v2 offset:26496
    ds_read_b64_tr_b16 a[250:251], v2 offset:27008
    s_waitcnt vmcnt(8)
    s_barrier
    s_mov_b64 exec, 1
    buffer_store_dwordx2 v[14:15], off, s[4:7], 0 offset:128 sc1
    s_mov_b64 exec, -1
    v_mfma_f32_32x32x16_bf16 v[144:159], a[228:231], a[200:203], v[144:159]
    ds_read_b64_tr_b16 a[252:253], v2 offset:26560
    ds_read_b64_tr_b16 a[254:255], v2 offset:27072
    s_waitcnt lgkmcnt(8)
    v_mfma_f32_32x32x16_bf16 v[160:175], a[232:235], a[200:203], v[160:175]
    ds_read_b64_tr_b16 a[224:225], v2 offset:33792
    ds_read_b64_tr_b16 a[226:227], v2 offset:34304
    v_mfma_f32_32x32x16_bf16 v[176:191], a[236:239], a[200:203], v[176:191]
    ds_read_b64_tr_b16 a[228:229], v2 offset:33856
    ds_read_b64_tr_b16 a[230:231], v2 offset:34368
    s_waitcnt lgkmcnt(8)
    v_mfma_f32_32x32x16_bf16 v[128:143], a[240:243], a[204:207], v[128:143]
    ds_read_b64_tr_b16 a[232:233], v2 offset:33920
    ds_read_b64_tr_b16 a[234:235], v2 offset:34432
    v_mfma_f32_32x32x16_bf16 v[144:159], a[244:247], a[204:207], v[144:159]
    ds_read_b64_tr_b16 a[236:237], v2 offset:33984
    ds_read_b64_tr_b16 a[238:239], v2 offset:34496
    s_waitcnt lgkmcnt(8)
    v_mfma_f32_32x32x16_bf16 v[160:175], a[248:251], a[204:207], v[160:175]
    ds_read_b64_tr_b16 a[240:241], v2 offset:42240
    ds_read_b64_tr_b16 a[242:243], v2 offset:42752
    v_mfma_f32_32x32x16_bf16 v[176:191], a[252:255], a[204:207], v[176:191]
    ds_read_b64_tr_b16 a[244:245], v2 offset:42304
    ds_read_b64_tr_b16 a[246:247], v2 offset:42816
    s_waitcnt lgkmcnt(8)
    v_mfma_f32_32x32x16_bf16 v[128:143], a[224:227], a[208:211], v[128:143]
    ds_read_b64_tr_b16 a[248:249], v2 offset:42368
    ds_read_b64_tr_b16 a[250:251], v2 offset:42880
    v_mfma_f32_32x32x16_bf16 v[144:159], a[228:231], a[208:211], v[144:159]
    ds_read_b64_tr_b16 a[252:253], v2 offset:42432
    ds_read_b64_tr_b16 a[254:255], v2 offset:42944
    s_waitcnt lgkmcnt(8)
    v_mfma_f32_32x32x16_bf16 v[160:175], a[232:235], a[208:211], v[160:175]
    ds_read_b64_tr_b16 a[224:225], v2 offset:34816
    ds_read_b64_tr_b16 a[226:227], v2 offset:35328
    v_mfma_f32_32x32x16_bf16 v[176:191], a[236:239], a[208:211], v[176:191]
    ds_read_b64_tr_b16 a[228:229], v2 offset:34880
    ds_read_b64_tr_b16 a[230:231], v2 offset:35392
    s_waitcnt lgkmcnt(8)
    v_mfma_f32_32x32x16_bf16 v[128:143], a[240:243], a[212:215], v[128:143]
    ds_read_b64_tr_b16 a[232:233], v2 offset:34944
    ds_read_b64_tr_b16 a[234:235], v2 offset:35456
    v_mfma_f32_32x32x16_bf16 v[144:159], a[244:247], a[212:215], v[144:159]
    ds_read_b64_tr_b16 a[236:237], v2 offset:35008
    ds_read_b64_tr_b16 a[238:239], v2 offset:35520
    s_waitcnt lgkmcnt(8)
    v_mfma_f32_32x32x16_bf16 v[160:175], a[248:251], a[212:215], v[160:175]
    ds_read_b64_tr_b16 a[240:241], v2 offset:43264
    ds_read_b64_tr_b16 a[242:243], v2 offset:43776
    v_mfma_f32_32x32x16_bf16 v[176:191], a[252:255], a[212:215], v[176:191]
    ds_read_b64_tr_b16 a[244:245], v2 offset:43328
    ds_read_b64_tr_b16 a[246:247], v2 offset:43840
    s_waitcnt lgkmcnt(8)
    v_mfma_f32_32x32x16_bf16 v[128:143], a[224:227], a[216:219], v[128:143]
    ds_read_b64_tr_b16 a[248:249], v2 offset:43392
    ds_read_b64_tr_b16 a[250:251], v2 offset:43904
    s_barrier
    v_mfma_f32_32x32x16_bf16 v[144:159], a[228:231], a[216:219], v[144:159]
    ds_read_b64_tr_b16 a[252:253], v2 offset:43456
    ds_read_b64_tr_b16 a[254:255], v2 offset:43968
    s_waitcnt lgkmcnt(8)
    v_mfma_f32_32x32x16_bf16 v[160:175], a[232:235], a[216:219], v[160:175]
    ds_read_b64_tr_b16 a[224:225], v3 offset:0
    ds_read_b64_tr_b16 a[226:227], v3 offset:512
    v_mfma_f32_32x32x16_bf16 v[176:191], a[236:239], a[216:219], v[176:191]
    ds_read_b64_tr_b16 a[228:229], v3 offset:64
    ds_read_b64_tr_b16 a[230:231], v3 offset:576
    s_waitcnt lgkmcnt(8)
    v_mfma_f32_32x32x16_bf16 v[128:143], a[240:243], a[220:223], v[128:143]
    ds_read_b64_tr_b16 a[232:233], v3 offset:128
    ds_read_b64_tr_b16 a[234:235], v3 offset:640
    v_mfma_f32_32x32x16_bf16 v[144:159], a[244:247], a[220:223], v[144:159]
    ds_read_b64_tr_b16 a[236:237], v3 offset:192
    ds_read_b64_tr_b16 a[238:239], v3 offset:704
    s_waitcnt lgkmcnt(8)
    v_mfma_f32_32x32x16_bf16 v[160:175], a[248:251], a[220:223], v[160:175]
    ds_read_b64_tr_b16 a[240:241], v3 offset:8448
    ds_read_b64_tr_b16 a[242:243], v3 offset:8960
    v_mfma_f32_32x32x16_bf16 v[176:191], a[252:255], a[220:223], v[176:191]
    ds_read_b64_tr_b16 a[244:245], v3 offset:8512
    ds_read_b64_tr_b16 a[246:247], v3 offset:9024
    s_waitcnt lgkmcnt(8)
    v_mfma_f32_32x32x16_bf16 v[128:143], a[224:227], v[192:195], v[128:143]
    ds_read_b64_tr_b16 a[248:249], v3 offset:8576
    ds_read_b64_tr_b16 a[250:251], v3 offset:9088
    v_mfma_f32_32x32x16_bf16 v[144:159], a[228:231], v[192:195], v[144:159]
    ds_read_b64_tr_b16 a[252:253], v3 offset:8640
    ds_read_b64_tr_b16 a[254:255], v3 offset:9152
    s_waitcnt lgkmcnt(8)
    v_mfma_f32_32x32x16_bf16 v[160:175], a[232:235], v[192:195], v[160:175]
    ds_read_b64_tr_b16 a[224:225], v3 offset:1024
    ds_read_b64_tr_b16 a[226:227], v3 offset:1536
    v_mfma_f32_32x32x16_bf16 v[176:191], a[236:239], v[192:195], v[176:191]
    ds_read_b64_tr_b16 a[228:229], v3 offset:1088
    ds_read_b64_tr_b16 a[230:231], v3 offset:1600
    s_waitcnt lgkmcnt(8)
    v_mfma_f32_32x32x16_bf16 v[128:143], a[240:243], v[196:199], v[128:143]
    ds_read_b64_tr_b16 a[232:233], v3 offset:1152
    ds_read_b64_tr_b16 a[234:235], v3 offset:1664
    v_mfma_f32_32x32x16_bf16 v[144:159], a[244:247], v[196:199], v[144:159]
    ds_read_b64_tr_b16 a[236:237], v3 offset:1216
    ds_read_b64_tr_b16 a[238:239], v3 offset:1728
    s_waitcnt lgkmcnt(8)
    v_mfma_f32_32x32x16_bf16 v[160:175], a[248:251], v[196:199], v[160:175]
    ds_read_b64_tr_b16 a[240:241], v3 offset:9472
    ds_read_b64_tr_b16 a[242:243], v3 offset:9984
    v_mfma_f32_32x32x16_bf16 v[176:191], a[252:255], v[196:199], v[176:191]
    ds_read_b64_tr_b16 a[244:245], v3 offset:9536
    ds_read_b64_tr_b16 a[246:247], v3 offset:10048
    s_waitcnt lgkmcnt(8)
    v_mfma_f32_32x32x16_bf16 v[128:143], a[224:227], v[200:203], v[128:143]
    ds_read_b64_tr_b16 a[248:249], v3 offset:9600
    ds_read_b64_tr_b16 a[250:251], v3 offset:10112
    s_barrier
    v_mfma_f32_32x32x16_bf16 v[144:159], a[228:231], v[200:203], v[144:159]
    ds_read_b64_tr_b16 a[252:253], v3 offset:9664
    ds_read_b64_tr_b16 a[254:255], v3 offset:10176
    s_waitcnt lgkmcnt(8)
    v_mfma_f32_32x32x16_bf16 v[160:175], a[232:235], v[200:203], v[160:175]
    ds_read_b64_tr_b16 a[224:225], v3 offset:16896
    ds_read_b64_tr_b16 a[226:227], v3 offset:17408
    v_mfma_f32_32x32x16_bf16 v[176:191], a[236:239], v[200:203], v[176:191]
    ds_read_b64_tr_b16 a[228:229], v3 offset:25344
    ds_read_b64_tr_b16 a[230:231], v3 offset:25856
    s_waitcnt lgkmcnt(8)
    v_mfma_f32_32x32x16_bf16 v[128:143], a[240:243], v[204:207], v[128:143]
    ds_read_b64_tr_b16 a[232:233], v3 offset:17920
    ds_read_b64_tr_b16 a[234:235], v3 offset:18432
    v_mfma_f32_32x32x16_bf16 v[144:159], a[244:247], v[204:207], v[144:159]
    ds_read_b64_tr_b16 a[236:237], v3 offset:26368
    ds_read_b64_tr_b16 a[238:239], v3 offset:26880
    s_waitcnt lgkmcnt(8)
    v_mfma_f32_32x32x16_bf16 v[160:175], a[248:251], v[204:207], v[160:175]
    ds_read_b64_tr_b16 a[240:241], v3 offset:16960
    ds_read_b64_tr_b16 a[242:243], v3 offset:17472
    v_mfma_f32_32x32x16_bf16 v[176:191], a[252:255], v[204:207], v[176:191]
    ds_read_b64_tr_b16 a[244:245], v3 offset:25408
    ds_read_b64_tr_b16 a[246:247], v3 offset:25920
    s_waitcnt lgkmcnt(8)
    v_mfma_f32_32x32x16_bf16 v[128:143], a[224:227], v[208:211], v[128:143]
    ds_read_b64_tr_b16 a[248:249], v3 offset:17984
    ds_read_b64_tr_b16 a[250:251], v3 offset:18496
    v_mfma_f32_32x32x16_bf16 v[128:143], a[228:231], v[212:215], v[128:143]
    ds_read_b64_tr_b16 a[252:253], v3 offset:26432
    ds_read_b64_tr_b16 a[254:255], v3 offset:26944
    s_waitcnt lgkmcnt(8)
    v_mfma_f32_32x32x16_bf16 v[128:143], a[232:235], v[216:219], v[128:143]
    ds_read_b64_tr_b16 a[224:225], v3 offset:17024
    ds_read_b64_tr_b16 a[226:227], v3 offset:17536
    buffer_load_dwordx2 v[16:17], v12, s[84:87], s90 offen offset:128 sc1
    v_mfma_f32_32x32x16_bf16 v[128:143], a[236:239], v[220:223], v[128:143]
    ds_read_b64_tr_b16 a[228:229], v3 offset:25472
    ds_read_b64_tr_b16 a[230:231], v3 offset:25984
    s_waitcnt lgkmcnt(8)
    v_mfma_f32_32x32x16_bf16 v[144:159], a[240:243], v[208:211], v[144:159]
    ds_read_b64_tr_b16 a[232:233], v3 offset:18048
    ds_read_b64_tr_b16 a[234:235], v3 offset:18560
    v_mfma_f32_32x32x16_bf16 v[144:159], a[244:247], v[212:215], v[144:159]
    ds_read_b64_tr_b16 a[236:237], v3 offset:26496
    ds_read_b64_tr_b16 a[238:239], v3 offset:27008
    s_waitcnt lgkmcnt(8)
    v_mfma_f32_32x32x16_bf16 v[144:159], a[248:251], v[216:219], v[144:159]
    ds_read_b64_tr_b16 a[240:241], v3 offset:17088
    ds_read_b64_tr_b16 a[242:243], v3 offset:17600
    v_mfma_f32_32x32x16_bf16 v[144:159], a[252:255], v[220:223], v[144:159]
    ds_read_b64_tr_b16 a[244:245], v3 offset:25536
    ds_read_b64_tr_b16 a[246:247], v3 offset:26048
    v_cvt_pk_bf16_f32 v128, v128, v129
    v_cvt_pk_bf16_f32 v129, v130, v131
    v_cvt_pk_bf16_f32 v130, v132, v133
    s_waitcnt lgkmcnt(8)
    v_mfma_f32_32x32x16_bf16 v[160:175], a[224:227], v[208:211], v[160:175]
    ds_read_b64_tr_b16 a[248:249], v3 offset:18112
    ds_read_b64_tr_b16 a[250:251], v3 offset:18624
    v_cvt_pk_bf16_f32 v131, v134, v135
    s_mov_b32 s34, 33554432
    buffer_store_dwordx4 v[128:131], v21, s[56:59], s34 offen offset:0 sc1
    ds_write_b128 v22, v[128:131] offset:8192
    v_mfma_f32_32x32x16_bf16 v[160:175], a[228:231], v[212:215], v[160:175]
    ds_read_b64_tr_b16 a[252:253], v3 offset:26560
    ds_read_b64_tr_b16 a[254:255], v3 offset:27072
    v_cvt_pk_bf16_f32 v132, v136, v137
    v_cvt_pk_bf16_f32 v133, v138, v139
    v_cvt_pk_bf16_f32 v134, v140, v141
    s_waitcnt lgkmcnt(9)
    v_mfma_f32_32x32x16_bf16 v[160:175], a[232:235], v[216:219], v[160:175]
    v_cvt_pk_bf16_f32 v135, v142, v143
    s_mov_b32 s34, 34603008
    buffer_store_dwordx4 v[132:135], v21, s[56:59], s34 offen offset:0 sc1
    ds_write_b128 v22, v[132:135] offset:9216
    v_mfma_f32_32x32x16_bf16 v[160:175], a[236:239], v[220:223], v[160:175]
    v_cvt_pk_bf16_f32 v144, v144, v145
    v_cvt_pk_bf16_f32 v145, v146, v147
    v_cvt_pk_bf16_f32 v146, v148, v149
    s_waitcnt lgkmcnt(6)
    v_mfma_f32_32x32x16_bf16 v[176:191], a[240:243], v[208:211], v[176:191]
    v_cvt_pk_bf16_f32 v147, v150, v151
    s_mov_b32 s34, 35651584
    buffer_store_dwordx4 v[144:147], v21, s[56:59], s34 offen offset:0 sc1
    ds_write_b128 v22, v[144:147] offset:10240
    v_mfma_f32_32x32x16_bf16 v[176:191], a[244:247], v[212:215], v[176:191]
    v_cvt_pk_bf16_f32 v148, v152, v153
    v_cvt_pk_bf16_f32 v149, v154, v155
    v_cvt_pk_bf16_f32 v150, v156, v157
    s_waitcnt lgkmcnt(2)
    v_mfma_f32_32x32x16_bf16 v[176:191], a[248:251], v[216:219], v[176:191]
    v_cvt_pk_bf16_f32 v151, v158, v159
    s_mov_b32 s34, 36700160
    buffer_store_dwordx4 v[148:151], v21, s[56:59], s34 offen offset:0 sc1
    ds_write_b128 v22, v[148:151] offset:11264
    v_mfma_f32_32x32x16_bf16 v[176:191], a[252:255], v[220:223], v[176:191]
    v_cvt_pk_bf16_f32 v160, v160, v161
    v_cvt_pk_bf16_f32 v161, v162, v163
    v_cvt_pk_bf16_f32 v162, v164, v165
    v_cvt_pk_bf16_f32 v163, v166, v167
    s_mov_b32 s34, 37748736
    buffer_store_dwordx4 v[160:163], v21, s[8:11], s34 offen offset:0 sc1
    ds_write_b128 v23, v[160:163] offset:8192
    v_cvt_pk_bf16_f32 v164, v168, v169
    v_cvt_pk_bf16_f32 v165, v170, v171
    v_cvt_pk_bf16_f32 v166, v172, v173
    v_cvt_pk_bf16_f32 v167, v174, v175
    s_mov_b32 s34, 38797312
    buffer_store_dwordx4 v[164:167], v21, s[8:11], s34 offen offset:0 sc1
    ds_write_b128 v23, v[164:167] offset:9216
    v_cvt_pk_bf16_f32 v176, v176, v177
    v_cvt_pk_bf16_f32 v177, v178, v179
    v_cvt_pk_bf16_f32 v178, v180, v181
    v_cvt_pk_bf16_f32 v179, v182, v183
    s_mov_b32 s34, 39845888
    buffer_store_dwordx4 v[176:179], v21, s[8:11], s34 offen offset:0 sc1
    ds_write_b128 v23, v[176:179] offset:10240
    v_cvt_pk_bf16_f32 v180, v184, v185
    v_cvt_pk_bf16_f32 v181, v186, v187
    v_cvt_pk_bf16_f32 v182, v188, v189
    v_cvt_pk_bf16_f32 v183, v190, v191
    s_mov_b32 s34, 40894464
    buffer_store_dwordx4 v[180:183], v21, s[8:11], s34 offen offset:0 sc1
    ds_write_b128 v23, v[180:183] offset:11264
    s_waitcnt vmcnt(10)
    s_barrier
    s_mov_b64 exec, 1
    buffer_store_dwordx2 v[14:15], off, s[4:7], 0 offset:256 sc1
    s_mov_b64 exec, -1
    s_waitcnt vmcnt(9)
    v_cmp_eq_u64 vcc, s[100:101], v[16:17]
    s_cmp_eq_u64 vcc, -1
    s_cselect_b32 s21, 0, 0x80000000
    s_cselect_b32 s23, 0, 13
    s_or_b32 s20, s20, s23
    v_or_b32 v10, s21, v8
    v_or_b32 v11, s21, v9
    ds_read_b128 a[0:3], v13 offset:16896
    s_add_u32 s23, s12, 16777216
    buffer_load_dwordx4 a[4:7], v10, s[84:87], s23 offen sc1
    s_add_u32 s23, s13, 16777216
    buffer_load_dwordx4 a[8:11], v10, s[84:87], s23 offen sc1
    s_add_u32 s23, s14, 16777216
    buffer_load_dwordx4 a[12:15], v10, s[84:87], s23 offen sc1
    s_add_u32 s23, s15, 16777216
    buffer_load_dwordx4 a[16:19], v10, s[84:87], s23 offen sc1
    s_add_u32 s23, s25, 16777216
    buffer_load_dwordx4 a[20:23], v10, s[84:87], s23 offen sc1
    s_add_u32 s23, s26, 16777216
    buffer_load_dwordx4 a[24:27], v10, s[84:87], s23 offen sc1
    s_add_u32 s23, s27, 16777216
    buffer_load_dwordx4 a[28:31], v10, s[84:87], s23 offen sc1
    ds_read_b128 a[32:35], v13 offset:21056
    s_add_u32 s23, s12, 25165824
    buffer_load_dwordx4 a[36:39], v10, s[84:87], s23 offen sc1
    s_add_u32 s23, s13, 25165824
    buffer_load_dwordx4 a[40:43], v10, s[84:87], s23 offen sc1
    s_add_u32 s23, s14, 25165824
    buffer_load_dwordx4 a[44:47], v10, s[84:87], s23 offen sc1
    s_add_u32 s23, s15, 25165824
    buffer_load_dwordx4 a[48:51], v10, s[84:87], s23 offen sc1
    s_add_u32 s23, s25, 25165824
    buffer_load_dwordx4 a[52:55], v10, s[84:87], s23 offen sc1
    s_add_u32 s23, s26, 25165824
    buffer_load_dwordx4 a[56:59], v10, s[84:87], s23 offen sc1
    s_add_u32 s23, s27, 25165824
    buffer_load_dwordx4 a[60:63], v10, s[84:87], s23 offen sc1
    ds_read_b128 a[64:67], v13 offset:0
    s_add_u32 s23, s12, 0
    buffer_load_dwordx4 a[68:71], v10, s[84:87], s23 offen sc1
    s_add_u32 s23, s13, 0
    buffer_load_dwordx4 a[72:75], v10, s[84:87], s23 offen sc1
    s_add_u32 s23, s14, 0
    buffer_load_dwordx4 a[76:79], v10, s[84:87], s23 offen sc1
    s_add_u32 s23, s15, 0
    buffer_load_dwordx4 a[80:83], v10, s[84:87], s23 offen sc1
    s_add_u32 s23, s25, 0
    buffer_load_dwordx4 a[84:87], v10, s[84:87], s23 offen sc1
    s_add_u32 s23, s26, 0
    buffer_load_dwordx4 a[88:91], v10, s[84:87], s23 offen sc1
    s_add_u32 s23, s27, 0
    buffer_load_dwordx4 a[92:95], v10, s[84:87], s23 offen sc1
    s_waitcnt vmcnt(22)
    s_waitcnt lgkmcnt(0)
    s_barrier
    s_mov_b64 exec, 1
    buffer_store_dwordx2 v[14:15], off, s[4:7], 0 offset:384 sc1
    s_mov_b64 exec, -1
    s_memrealtime s[8:9]
    s_waitcnt lgkmcnt(0)
    buffer_load_dwordx2 v[16:17], v12, s[84:87], s90 offen offset:256 sc1
    v_mfma_f32_32x32x16_bf16 a[128:143], v[4:7], a[0:3], 0
    s_waitcnt vmcnt(22)
    v_mfma_f32_32x32x16_bf16 a[128:143], v[4:7], a[4:7], a[128:143]
    s_waitcnt vmcnt(21)
    v_mfma_f32_32x32x16_bf16 a[128:143], v[4:7], a[8:11], a[128:143]
    s_waitcnt vmcnt(20)
    v_mfma_f32_32x32x16_bf16 a[128:143], v[4:7], a[12:15], a[128:143]
    s_waitcnt vmcnt(19)
    v_mfma_f32_32x32x16_bf16 a[128:143], v[4:7], a[16:19], a[128:143]
    s_waitcnt vmcnt(18)
    v_mfma_f32_32x32x16_bf16 a[128:143], v[4:7], a[20:23], a[128:143]
    s_waitcnt vmcnt(17)
    v_mfma_f32_32x32x16_bf16 a[128:143], v[4:7], a[24:27], a[128:143]
    s_waitcnt vmcnt(16)
    v_mfma_f32_32x32x16_bf16 a[128:143], v[4:7], a[28:31], a[128:143]
    s_nop 11
    v_accvgpr_read_b32 v24, a128
    v_accvgpr_read_b32 v28, a129
    v_cvt_pk_bf16_f32 v24, v24, v28
    v_accvgpr_read_b32 v25, a130
    v_accvgpr_read_b32 v29, a131
    v_cvt_pk_bf16_f32 v25, v25, v29
    v_accvgpr_read_b32 v26, a132
    v_accvgpr_read_b32 v30, a133
    v_cvt_pk_bf16_f32 v26, v26, v30
    v_accvgpr_read_b32 v27, a134
    v_accvgpr_read_b32 v31, a135
    v_cvt_pk_bf16_f32 v27, v27, v31
    buffer_store_dwordx4 v[24:27], v11, s[80:83], s79 offen offset:512
    v_mfma_f32_32x32x16_bf16 a[144:159], v[4:7], a[32:35], 0
    s_waitcnt vmcnt(16)
    v_mfma_f32_32x32x16_bf16 a[144:159], v[4:7], a[36:39], a[144:159]
    s_waitcnt vmcnt(15)
    v_mfma_f32_32x32x16_bf16 a[144:159], v[4:7], a[40:43], a[144:159]
    s_waitcnt vmcnt(14)
    v_mfma_f32_32x32x16_bf16 a[144:159], v[4:7], a[44:47], a[144:159]
    s_waitcnt vmcnt(13)
    v_mfma_f32_32x32x16_bf16 a[144:159], v[4:7], a[48:51], a[144:159]
    s_waitcnt vmcnt(12)
    v_mfma_f32_32x32x16_bf16 a[144:159], v[4:7], a[52:55], a[144:159]
    s_waitcnt vmcnt(11)
    v_mfma_f32_32x32x16_bf16 a[144:159], v[4:7], a[56:59], a[144:159]
    s_waitcnt vmcnt(10)
    v_mfma_f32_32x32x16_bf16 a[144:159], v[4:7], a[60:63], a[144:159]
    s_nop 11
    v_accvgpr_read_b32 v24, a144
    v_accvgpr_read_b32 v28, a145
    v_cvt_pk_bf16_f32 v24, v24, v28
    v_accvgpr_read_b32 v25, a146
    v_accvgpr_read_b32 v29, a147
    v_cvt_pk_bf16_f32 v25, v25, v29
    v_accvgpr_read_b32 v26, a148
    v_accvgpr_read_b32 v30, a149
    v_cvt_pk_bf16_f32 v26, v26, v30
    v_accvgpr_read_b32 v27, a150
    v_accvgpr_read_b32 v31, a151
    v_cvt_pk_bf16_f32 v27, v27, v31
    buffer_store_dwordx4 v[24:27], v11, s[80:83], s79 offen offset:768
    v_mfma_f32_32x32x16_bf16 a[160:175], v[4:7], a[64:67], 0
    s_waitcnt vmcnt(10)
    v_mfma_f32_32x32x16_bf16 a[160:175], v[4:7], a[68:71], a[160:175]
    s_waitcnt vmcnt(9)
    v_mfma_f32_32x32x16_bf16 a[160:175], v[4:7], a[72:75], a[160:175]
    s_waitcnt vmcnt(8)
    v_mfma_f32_32x32x16_bf16 a[160:175], v[4:7], a[76:79], a[160:175]
    s_waitcnt vmcnt(7)
    v_mfma_f32_32x32x16_bf16 a[160:175], v[4:7], a[80:83], a[160:175]
    s_waitcnt vmcnt(6)
    v_mfma_f32_32x32x16_bf16 a[160:175], v[4:7], a[84:87], a[160:175]
    s_waitcnt vmcnt(5)
    v_mfma_f32_32x32x16_bf16 a[160:175], v[4:7], a[88:91], a[160:175]
    s_waitcnt vmcnt(4)
    v_mfma_f32_32x32x16_bf16 a[160:175], v[4:7], a[92:95], a[160:175]
    s_nop 11
    v_accvgpr_read_b32 v24, a160
    v_accvgpr_read_b32 v28, a161
    v_cvt_pk_bf16_f32 v24, v24, v28
    v_accvgpr_read_b32 v25, a162
    v_accvgpr_read_b32 v29, a163
    v_cvt_pk_bf16_f32 v25, v25, v29
    v_accvgpr_read_b32 v26, a164
    v_accvgpr_read_b32 v30, a165
    v_cvt_pk_bf16_f32 v26, v26, v30
    v_accvgpr_read_b32 v27, a166
    v_accvgpr_read_b32 v31, a167
    v_cvt_pk_bf16_f32 v27, v27, v31
    buffer_store_dwordx4 v[24:27], v11, s[80:83], s79 offen offset:0
    s_waitcnt vmcnt(3)
    v_cmp_eq_u64 vcc, s[100:101], v[16:17]
    s_cmp_eq_u64 vcc, -1
    s_cselect_b32 s21, 0, 0x80000000
    s_cselect_b32 s23, 0, 2
    s_or_b32 s20, s20, s23
    v_or_b32 v10, s21, v8
    v_or_b32 v11, s21, v9
    ds_read_b128 a[96:99], v13 offset:4096
    s_add_u32 s23, s12, 8388608
    buffer_load_dwordx4 a[100:103], v10, s[84:87], s23 offen sc1
    s_add_u32 s23, s13, 8388608
    buffer_load_dwordx4 a[104:107], v10, s[84:87], s23 offen sc1
    s_add_u32 s23, s14, 8388608
    buffer_load_dwordx4 a[108:111], v10, s[84:87], s23 offen sc1
    s_add_u32 s23, s15, 8388608
    buffer_load_dwordx4 a[112:115], v10, s[84:87], s23 offen sc1
    s_add_u32 s23, s25, 8388608
    buffer_load_dwordx4 a[116:119], v10, s[84:87], s23 offen sc1
    s_add_u32 s23, s26, 8388608
    buffer_load_dwordx4 a[120:123], v10, s[84:87], s23 offen sc1
    s_add_u32 s23, s27, 8388608
    buffer_load_dwordx4 a[124:127], v10, s[84:87], s23 offen sc1
    buffer_load_dwordx2 v[16:17], v12, s[84:87], s90 offen offset:384 sc1
    s_waitcnt lgkmcnt(0)
    v_mfma_f32_32x32x16_bf16 a[176:191], v[4:7], a[96:99], 0
    s_waitcnt vmcnt(7)
    v_mfma_f32_32x32x16_bf16 a[176:191], v[4:7], a[100:103], a[176:191]
    s_waitcnt vmcnt(6)
    v_mfma_f32_32x32x16_bf16 a[176:191], v[4:7], a[104:107], a[176:191]
    s_waitcnt vmcnt(5)
    v_mfma_f32_32x32x16_bf16 a[176:191], v[4:7], a[108:111], a[176:191]
    s_waitcnt vmcnt(4)
    v_mfma_f32_32x32x16_bf16 a[176:191], v[4:7], a[112:115], a[176:191]
    s_waitcnt vmcnt(3)
    v_mfma_f32_32x32x16_bf16 a[176:191], v[4:7], a[116:119], a[176:191]
    s_waitcnt vmcnt(2)
    v_mfma_f32_32x32x16_bf16 a[176:191], v[4:7], a[120:123], a[176:191]
    s_waitcnt vmcnt(1)
    v_mfma_f32_32x32x16_bf16 a[176:191], v[4:7], a[124:127], a[176:191]
    s_nop 11
    v_accvgpr_read_b32 v24, a176
    v_accvgpr_read_b32 v28, a177
    v_cvt_pk_bf16_f32 v24, v24, v28
    v_accvgpr_read_b32 v25, a178
    v_accvgpr_read_b32 v29, a179
    v_cvt_pk_bf16_f32 v25, v25, v29
    v_accvgpr_read_b32 v26, a180
    v_accvgpr_read_b32 v30, a181
    v_cvt_pk_bf16_f32 v26, v26, v30
    v_accvgpr_read_b32 v27, a182
    v_accvgpr_read_b32 v31, a183
    v_cvt_pk_bf16_f32 v27, v27, v31
    buffer_store_dwordx4 v[24:27], v11, s[80:83], s79 offen offset:256
    s_waitcnt vmcnt(1)
    v_cmp_eq_u64 vcc, s[100:101], v[16:17]
    s_cmp_eq_u64 vcc, -1
    s_cbranch_scc1 L_tg4
L_tp4:
    buffer_load_dwordx2 v[16:17], v12, s[84:87], s90 offen offset:384 sc1
    s_memrealtime s[10:11]
    s_waitcnt vmcnt(0)
    v_cmp_eq_u64 vcc, s[100:101], v[16:17]
    s_cmp_eq_u64 vcc, -1
    s_cbranch_scc1 L_tg4
    s_waitcnt lgkmcnt(0)
    s_sub_u32 s10, s10, s8
    s_cmp_lt_u32 s10, 20000
    s_cbranch_scc1 L_tp4
    s_branch L_slow
L_tg4:
    s_waitcnt lgkmcnt(0)
    ds_read_b128 a[0:3], v13 offset:8192
    s_add_u32 s23, s12, 33554432
    buffer_load_dwordx4 a[4:7], v8, s[84:87], s23 offen sc1
    s_add_u32 s23, s13, 33554432
    buffer_load_dwordx4 a[8:11], v8, s[84:87], s23 offen sc1
    s_add_u32 s23, s14, 33554432
    buffer_load_dwordx4 a[12:15], v8, s[84:87], s23 offen sc1
    s_add_u32 s23, s15, 33554432
    buffer_load_dwordx4 a[16:19], v8, s[84:87], s23 offen sc1
    s_add_u32 s23, s25, 33554432
    buffer_load_dwordx4 a[20:23], v8, s[84:87], s23 offen sc1
    s_add_u32 s23, s26, 33554432
    buffer_load_dwordx4 a[24:27], v8, s[84:87], s23 offen sc1
    s_add_u32 s23, s27, 33554432
    buffer_load_dwordx4 a[28:31], v8, s[84:87], s23 offen sc1
    s_mov_b64 exec, 1
    buffer_atomic_add v18, off, s[96:99], 0 offset:4 sc0
    s_mov_b64 exec, -1
    s_waitcnt lgkmcnt(0)
    v_mfma_f32_32x32x16_bf16 a[128:143], v[4:7], a[0:3], 0
    s_waitcnt vmcnt(7)
    v_mfma_f32_32x32x16_bf16 a[128:143], v[4:7], a[4:7], a[128:143]
    s_waitcnt vmcnt(6)
    v_mfma_f32_32x32x16_bf16 a[128:143], v[4:7], a[8:11], a[128:143]
    s_waitcnt vmcnt(5)
    v_mfma_f32_32x32x16_bf16 a[128:143], v[4:7], a[12:15], a[128:143]
    s_waitcnt vmcnt(4)
    v_mfma_f32_32x32x16_bf16 a[128:143], v[4:7], a[16:19], a[128:143]
    s_waitcnt vmcnt(3)
    v_mfma_f32_32x32x16_bf16 a[128:143], v[4:7], a[20:23], a[128:143]
    s_waitcnt vmcnt(2)
    v_mfma_f32_32x32x16_bf16 a[128:143], v[4:7], a[24:27], a[128:143]
    s_waitcnt vmcnt(1)
    v_mfma_f32_32x32x16_bf16 a[128:143], v[4:7], a[28:31], a[128:143]
    s_nop 11
    v_accvgpr_read_b32 v24, a128
    v_accvgpr_read_b32 v28, a129
    v_cvt_pk_bf16_f32 v24, v24, v28
    v_accvgpr_read_b32 v25, a130
    v_accvgpr_read_b32 v29, a131
    v_cvt_pk_bf16_f32 v25, v25, v29
    v_accvgpr_read_b32 v26, a132
    v_accvgpr_read_b32 v30, a133
    v_cvt_pk_bf16_f32 v26, v26, v30
    v_accvgpr_read_b32 v27, a134
    v_accvgpr_read_b32 v31, a135
    v_cvt_pk_bf16_f32 v27, v27, v31
    buffer_store_dwordx4 v[24:27], v9, s[80:83], s79 offen offset:1024
    s_waitcnt vmcnt(1)
    s_bitcmp1_b32 s20, 2
    s_cbranch_scc0 L_tn2
    ds_read_b128 a[0:3], v13 offset:16896
    s_add_u32 s23, s12, 16777216
    buffer_load_dwordx4 a[4:7], v8, s[84:87], s23 offen sc1
    s_add_u32 s23, s13, 16777216
    buffer_load_dwordx4 a[8:11], v8, s[84:87], s23 offen sc1
    s_add_u32 s23, s14, 16777216
    buffer_load_dwordx4 a[12:15], v8, s[84:87], s23 offen sc1
    s_add_u32 s23, s15, 16777216
    buffer_load_dwordx4 a[16:19], v8, s[84:87], s23 offen sc1
    s_add_u32 s23, s25, 16777216
    buffer_load_dwordx4 a[20:23], v8, s[84:87], s23 offen sc1
    s_add_u32 s23, s26, 16777216
    buffer_load_dwordx4 a[24:27], v8, s[84:87], s23 offen sc1
    s_add_u32 s23, s27, 16777216
    buffer_load_dwordx4 a[28:31], v8, s[84:87], s23 offen sc1
    s_waitcnt lgkmcnt(0)
    v_mfma_f32_32x32x16_bf16 a[128:143], v[4:7], a[0:3], 0
    s_waitcnt vmcnt(6)
    v_mfma_f32_32x32x16_bf16 a[128:143], v[4:7], a[4:7], a[128:143]
    s_waitcnt vmcnt(5)
    v_mfma_f32_32x32x16_bf16 a[128:143], v[4:7], a[8:11], a[128:143]
    s_waitcnt vmcnt(4)
    v_mfma_f32_32x32x16_bf16 a[128:143], v[4:7], a[12:15], a[128:143]
    s_waitcnt vmcnt(3)
    v_mfma_f32_32x32x16_bf16 a[128:143], v[4:7], a[16:19], a[128:143]
    s_waitcnt vmcnt(2)
    v_mfma_f32_32x32x16_bf16 a[128:143], v[4:7], a[20:23], a[128:143]
    s_waitcnt vmcnt(1)
    v_mfma_f32_32x32x16_bf16 a[128:143], v[4:7], a[24:27], a[128:143]
    s_waitcnt vmcnt(0)
    v_mfma_f32_32x32x16_bf16 a[128:143], v[4:7], a[28:31], a[128:143]
    s_nop 11
    v_accvgpr_read_b32 v24, a128
    v_accvgpr_read_b32 v28, a129
    v_cvt_pk_bf16_f32 v24, v24, v28
    v_accvgpr_read_b32 v25, a130
    v_accvgpr_read_b32 v29, a131
    v_cvt_pk_bf16_f32 v25, v25, v29
    v_accvgpr_read_b32 v26, a132
    v_accvgpr_read_b32 v30, a133
    v_cvt_pk_bf16_f32 v26, v26, v30
    v_accvgpr_read_b32 v27, a134
    v_accvgpr_read_b32 v31, a135
    v_cvt_pk_bf16_f32 v27, v27, v31
    buffer_store_dwordx4 v[24:27], v9, s[80:83], s79 offen offset:512
L_tn2:
    s_nop 1
    s_bitcmp1_b32 s20, 3
    s_cbranch_scc0 L_tn3
    ds_read_b128 a[0:3], v13 offset:21056
    s_add_u32 s23, s12, 25165824
    buffer_load_dwordx4 a[4:7], v8, s[84:87], s23 offen sc1
    s_add_u32 s23, s13, 25165824
    buffer_load_dwordx4 a[8:11], v8, s[84:87], s23 offen sc1
    s_add_u32 s23, s14, 25165824
    buffer_load_dwordx4 a[12:15], v8, s[84:87], s23 offen sc1
    s_add_u32 s23, s15, 25165824
    buffer_load_dwordx4 a[16:19], v8, s[84:87], s23 offen sc1
    s_add_u32 s23, s25, 25165824
    buffer_load_dwordx4 a[20:23], v8, s[84:87], s23 offen sc1
    s_add_u32 s23, s26, 25165824
    buffer_load_dwordx4 a[24:27], v8, s[84:87], s23 offen sc1
    s_add_u32 s23, s27, 25165824
    buffer_load_dwordx4 a[28:31], v8, s[84:87], s23 offen sc1
    s_waitcnt lgkmcnt(0)
    v_mfma_f32_32x32x16_bf16 a[128:143], v[4:7], a[0:3], 0
    s_waitcnt vmcnt(6)
    v_mfma_f32_32x32x16_bf16 a[128:143], v[4:7], a[4:7], a[128:143]
    s_waitcnt vmcnt(5)
    v_mfma_f32_32x32x16_bf16 a[128:143], v[4:7], a[8:11], a[128:143]
    s_waitcnt vmcnt(4)
    v_mfma_f32_32x32x16_bf16 a[128:143], v[4:7], a[12:15], a[128:143]
    s_waitcnt vmcnt(3)
    v_mfma_f32_32x32x16_bf16 a[128:143], v[4:7], a[16:19], a[128:143]
    s_waitcnt vmcnt(2)
    v_mfma_f32_32x32x16_bf16 a[128:143], v[4:7], a[20:23], a[128:143]
    s_waitcnt vmcnt(1)
    v_mfma_f32_32x32x16_bf16 a[128:143], v[4:7], a[24:27], a[128:143]
    s_waitcnt vmcnt(0)
    v_mfma_f32_32x32x16_bf16 a[128:143], v[4:7], a[28:31], a[128:143]
    s_nop 11
    v_accvgpr_read_b32 v24, a128
    v_accvgpr_read_b32 v28, a129
    v_cvt_pk_bf16_f32 v24, v24, v28
    v_accvgpr_read_b32 v25, a130
    v_accvgpr_read_b32 v29, a131
    v_cvt_pk_bf16_f32 v25, v25, v29
    v_accvgpr_read_b32 v26, a132
    v_accvgpr_read_b32 v30, a133
    v_cvt_pk_bf16_f32 v26, v26, v30
    v_accvgpr_read_b32 v27, a134
    v_accvgpr_read_b32 v31, a135
    v_cvt_pk_bf16_f32 v27, v27, v31
    buffer_store_dwordx4 v[24:27], v9, s[80:83], s79 offen offset:768
L_tn3:
    s_nop 1
    s_bitcmp1_b32 s20, 0
    s_cbranch_scc0 L_tn0
    ds_read_b128 a[0:3], v13 offset:0
    s_add_u32 s23, s12, 0
    buffer_load_dwordx4 a[4:7], v8, s[84:87], s23 offen sc1
    s_add_u32 s23, s13, 0
    buffer_load_dwordx4 a[8:11], v8, s[84:87], s23 offen sc1
    s_add_u32 s23, s14, 0
    buffer_load_dwordx4 a[12:15], v8, s[84:87], s23 offen sc1
    s_add_u32 s23, s15, 0
    buffer_load_dwordx4 a[16:19], v8, s[84:87], s23 offen sc1
    s_add_u32 s23, s25, 0
    buffer_load_dwordx4 a[20:23], v8, s[84:87], s23 offen sc1
    s_add_u32 s23, s26, 0
    buffer_load_dwordx4 a[24:27], v8, s[84:87], s23 offen sc1
    s_add_u32 s23, s27, 0
    buffer_load_dwordx4 a[28:31], v8, s[84:87], s23 offen sc1
    s_waitcnt lgkmcnt(0)
    v_mfma_f32_32x32x16_bf16 a[128:143], v[4:7], a[0:3], 0
    s_waitcnt vmcnt(6)
    v_mfma_f32_32x32x16_bf16 a[128:143], v[4:7], a[4:7], a[128:143]
    s_waitcnt vmcnt(5)
    v_mfma_f32_32x32x16_bf16 a[128:143], v[4:7], a[8:11], a[128:143]
    s_waitcnt vmcnt(4)
    v_mfma_f32_32x32x16_bf16 a[128:143], v[4:7], a[12:15], a[128:143]
    s_waitcnt vmcnt(3)
    v_mfma_f32_32x32x16_bf16 a[128:143], v[4:7], a[16:19], a[128:143]
    s_waitcnt vmcnt(2)
    v_mfma_f32_32x32x16_bf16 a[128:143], v[4:7], a[20:23], a[128:143]
    s_waitcnt vmcnt(1)
    v_mfma_f32_32x32x16_bf16 a[128:143], v[4:7], a[24:27], a[128:143]
    s_waitcnt vmcnt(0)
    v_mfma_f32_32x32x16_bf16 a[128:143], v[4:7], a[28:31], a[128:143]
    s_nop 11
    v_accvgpr_read_b32 v24, a128
    v_accvgpr_read_b32 v28, a129
    v_cvt_pk_bf16_f32 v24, v24, v28
    v_accvgpr_read_b32 v25, a130
    v_accvgpr_read_b32 v29, a131
    v_cvt_pk_bf16_f32 v25, v25, v29
    v_accvgpr_read_b32 v26, a132
    v_accvgpr_read_b32 v30, a133
    v_cvt_pk_bf16_f32 v26, v26, v30
    v_accvgpr_read_b32 v27, a134
    v_accvgpr_read_b32 v31, a135
    v_cvt_pk_bf16_f32 v27, v27, v31
    buffer_store_dwordx4 v[24:27], v9, s[80:83], s79 offen offset:0
L_tn0:
    s_nop 1
    s_bitcmp1_b32 s20, 1
    s_cbranch_scc0 L_tn1
    ds_read_b128 a[0:3], v13 offset:4096
    s_add_u32 s23, s12, 8388608
    buffer_load_dwordx4 a[4:7], v8, s[84:87], s23 offen sc1
    s_add_u32 s23, s13, 8388608
    buffer_load_dwordx4 a[8:11], v8, s[84:87], s23 offen sc1
    s_add_u32 s23, s14, 8388608
    buffer_load_dwordx4 a[12:15], v8, s[84:87], s23 offen sc1
    s_add_u32 s23, s15, 8388608
    buffer_load_dwordx4 a[16:19], v8, s[84:87], s23 offen sc1
    s_add_u32 s23, s25, 8388608
    buffer_load_dwordx4 a[20:23], v8, s[84:87], s23 offen sc1
    s_add_u32 s23, s26, 8388608
    buffer_load_dwordx4 a[24:27], v8, s[84:87], s23 offen sc1
    s_add_u32 s23, s27, 8388608
    buffer_load_dwordx4 a[28:31], v8, s[84:87], s23 offen sc1
    s_waitcnt lgkmcnt(0)
    v_mfma_f32_32x32x16_bf16 a[128:143], v[4:7], a[0:3], 0
    s_waitcnt vmcnt(6)
    v_mfma_f32_32x32x16_bf16 a[128:143], v[4:7], a[4:7], a[128:143]
    s_waitcnt vmcnt(5)
    v_mfma_f32_32x32x16_bf16 a[128:143], v[4:7], a[8:11], a[128:143]
    s_waitcnt vmcnt(4)
    v_mfma_f32_32x32x16_bf16 a[128:143], v[4:7], a[12:15], a[128:143]
    s_waitcnt vmcnt(3)
    v_mfma_f32_32x32x16_bf16 a[128:143], v[4:7], a[16:19], a[128:143]
    s_waitcnt vmcnt(2)
    v_mfma_f32_32x32x16_bf16 a[128:143], v[4:7], a[20:23], a[128:143]
    s_waitcnt vmcnt(1)
    v_mfma_f32_32x32x16_bf16 a[128:143], v[4:7], a[24:27], a[128:143]
    s_waitcnt vmcnt(0)
    v_mfma_f32_32x32x16_bf16 a[128:143], v[4:7], a[28:31], a[128:143]
    s_nop 11
    v_accvgpr_read_b32 v24, a128
    v_accvgpr_read_b32 v28, a129
    v_cvt_pk_bf16_f32 v24, v24, v28
    v_accvgpr_read_b32 v25, a130
    v_accvgpr_read_b32 v29, a131
    v_cvt_pk_bf16_f32 v25, v25, v29
    v_accvgpr_read_b32 v26, a132
    v_accvgpr_read_b32 v30, a133
    v_cvt_pk_bf16_f32 v26, v26, v30
    v_accvgpr_read_b32 v27, a134
    v_accvgpr_read_b32 v31, a135
    v_cvt_pk_bf16_f32 v27, v27, v31
    buffer_store_dwordx4 v[24:27], v9, s[80:83], s79 offen offset:256
L_tn1:
    s_nop 1
    s_waitcnt lgkmcnt(0)
    v_readfirstlane_b32 s10, v18
    s_and_b32 s11, s10, 15
    s_cmp_lg_u32 s11, 7
    s_cbranch_scc1 L_done
    s_lshr_b32 s10, s10, 8
    s_branch L_rescue
L_slow:
    v_lshlrev_b32 v10, 4, v0
    v_add_u32 v11, 135168, v10
    s_lshr_b32 s10, s24, 12
    s_lshl_b32 s10, s10, 7
    s_sub_u32 s10, s78, s10
    s_lshl_b32 s11, s91, 12
    s_add_u32 s10, s10, s11
    ds_read_b128 v[64:67], v11 offset:0
    ds_read_b128 v[68:71], v11 offset:1024
    ds_read_b128 v[72:75], v11 offset:2048
    ds_read_b128 v[76:79], v11 offset:3072
    s_waitcnt lgkmcnt(0)
    s_add_u32 s11, s10, 0
    buffer_store_dwordx4 v[64:67], v10, s[84:87], s11 offen sc1
    s_add_u32 s11, s10, 1048576
    buffer_store_dwordx4 v[68:71], v10, s[84:87], s11 offen sc1
    s_add_u32 s11, s10, 2097152
    buffer_store_dwordx4 v[72:75], v10, s[84:87], s11 offen sc1
    s_add_u32 s11, s10, 3145728
    buffer_store_dwordx4 v[76:79], v10, s[84:87], s11 offen sc1
    ds_read_b128 v[80:83], v11 offset:4096
    ds_read_b128 v[84:87], v11 offset:5120
    ds_read_b128 v[88:91], v11 offset:6144
    ds_read_b128 v[92:95], v11 offset:7168
    s_waitcnt lgkmcnt(0)
    s_add_u32 s11, s10, 8388608
    buffer_store_dwordx4 v[80:83], v10, s[84:87], s11 offen sc1
    s_add_u32 s11, s10, 9437184
    buffer_store_dwordx4 v[84:87], v10, s[84:87], s11 offen sc1
    s_add_u32 s11, s10, 10485760
    buffer_store_dwordx4 v[88:91], v10, s[84:87], s11 offen sc1
    s_add_u32 s11, s10, 11534336
    buffer_store_dwordx4 v[92:95], v10, s[84:87], s11 offen sc1
    ds_read_b128 v[96:99], v11 offset:16896
    ds_read_b128 v[100:103], v11 offset:17920
    ds_read_b128 v[104:107], v11 offset:18944
    ds_read_b128 v[108:111], v11 offset:19968
    s_waitcnt lgkmcnt(0)
    s_add_u32 s11, s10, 16777216
    buffer_store_dwordx4 v[96:99], v10, s[84:87], s11 offen sc1
    s_add_u32 s11, s10, 17825792
    buffer_store_dwordx4 v[100:103], v10, s[84:87], s11 offen sc1
    s_add_u32 s11, s10, 18874368
    buffer_store_dwordx4 v[104:107], v10, s[84:87], s11 offen sc1
    s_add_u32 s11, s10, 19922944
    buffer_store_dwordx4 v[108:111], v10, s[84:87], s11 offen sc1
    ds_read_b128 v[112:115], v11 offset:21056
    ds_read_b128 v[116:119], v11 offset:22080
    ds_read_b128 v[120:123], v11 offset:23104
    ds_read_b128 v[124:127], v11 offset:24128
    s_waitcnt lgkmcnt(0)
    s_add_u32 s11, s10, 25165824
    buffer_store_dwordx4 v[112:115], v10, s[84:87], s11 offen sc1
    s_add_u32 s11, s10, 26214400
    buffer_store_dwordx4 v[116:119], v10, s[84:87], s11 offen sc1
    s_add_u32 s11, s10, 27262976
    buffer_store_dwordx4 v[120:123], v10, s[84:87], s11 offen sc1
    s_add_u32 s11, s10, 28311552
    buffer_store_dwordx4 v[124:127], v10, s[84:87], s11 offen sc1
    ds_read_b128 v[128:131], v11 offset:8192
    ds_read_b128 v[132:135], v11 offset:9216
    ds_read_b128 v[136:139], v11 offset:10240
    ds_read_b128 v[140:143], v11 offset:11264
    s_waitcnt lgkmcnt(0)
    s_add_u32 s11, s10, 33554432
    buffer_store_dwordx4 v[128:131], v10, s[84:87], s11 offen sc1
    s_add_u32 s11, s10, 34603008
    buffer_store_dwordx4 v[132:135], v10, s[84:87], s11 offen sc1
    s_add_u32 s11, s10, 35651584
    buffer_store_dwordx4 v[136:139], v10, s[84:87], s11 offen sc1
    s_add_u32 s11, s10, 36700160
    buffer_store_dwordx4 v[140:143], v10, s[84:87], s11 offen sc1
    s_waitcnt vmcnt(0)
    s_mov_b64 exec, 1
    buffer_atomic_add v18, off, s[96:99], 0 offset:4 sc0
    s_mov_b64 exec, -1
    s_waitcnt vmcnt(0)
    v_readfirstlane_b32 s10, v18
    s_and_b32 s11, s10, 15
    s_lshr_b32 s10, s10, 8
    s_cmp_eq_u32 s11, 7
    s_cselect_b32 s10, s10, 0
    s_lshl_b32 s11, 1, s91
    s_or_b32 s10, s10, s11
    s_lshl_b32 s11, s11, 8
    v_mov_b32 v18, s11
    s_mov_b32 s98, 8
    s_mov_b64 exec, 1
    buffer_atomic_or v18, off, s[96:99], 0 offset:4 sc0
    s_mov_b64 exec, -1
    s_waitcnt vmcnt(0)
    v_readfirstlane_b32 s11, v18
    s_and_b32 s11, s11, 15
    s_cmp_lg_u32 s11, 8
    s_cbranch_scc1 L_done
L_rescue:
    s_and_b32 s10, s10, 255
    s_cmp_eq_u32 s10, 0
    s_cbranch_scc1 L_done
    s_ff1_i32_b32 s11, s10
    s_bitset0_b32 s10, s11
    s_mov_b32 s8, 0
L_rw:
    s_lshr_b32 s79, s2, 4
    s_lshl_b32 s78, s3, 4
    s_add_u32 s78, s78, s79
    s_mul_i32 s78, s78, 32768
    s_mul_i32 s79, s79, 327680
    s_mul_i32 s9, s3, 1280
    s_add_u32 s79, s79, s9
    s_lshr_b32 s9, s11, 1
    s_mul_i32 s9, s9, 1024
    s_add_u32 s78, s78, s9
    s_mul_i32 s9, s9, 80
    s_add_u32 s79, s79, s9
    s_and_b32 s9, s11, 1
    s_lshl_b32 s9, s9, 7
    s_add_u32 s79, s79, s9
    s_mul_i32 s9, s9, 32768
    s_add_u32 s78, s78, s9
    s_lshl_b32 s9, s8, 7
    s_add_u32 s78, s78, s9
    s_mul_i32 s9, s8, 20480
    s_add_u32 s79, s79, s9
    s_add_u32 s23, s78, 0
    buffer_load_dwordx4 a[0:3], v8, s[84:87], s23 offen sc1
    s_add_u32 s23, s78, 4096
    buffer_load_dwordx4 a[4:7], v8, s[84:87], s23 offen sc1
    s_add_u32 s23, s78, 8192
    buffer_load_dwordx4 a[8:11], v8, s[84:87], s23 offen sc1
    s_add_u32 s23, s78, 12288
    buffer_load_dwordx4 a[12:15], v8, s[84:87], s23 offen sc1
    s_add_u32 s23, s78, 16384
    buffer_load_dwordx4 a[16:19], v8, s[84:87], s23 offen sc1
    s_add_u32 s23, s78, 20480
    buffer_load_dwordx4 a[20:23], v8, s[84:87], s23 offen sc1
    s_add_u32 s23, s78, 24576
    buffer_load_dwordx4 a[24:27], v8, s[84:87], s23 offen sc1
    s_add_u32 s23, s78, 28672
    buffer_load_dwordx4 a[28:31], v8, s[84:87], s23 offen sc1
    s_waitcnt vmcnt(7)
    v_mfma_f32_32x32x16_bf16 a[128:143], v[4:7], a[0:3], 0
    s_waitcnt vmcnt(6)
    v_mfma_f32_32x32x16_bf16 a[128:143], v[4:7], a[4:7], a[128:143]
    s_waitcnt vmcnt(5)
    v_mfma_f32_32x32x16_bf16 a[128:143], v[4:7], a[8:11], a[128:143]
    s_waitcnt vmcnt(4)
    v_mfma_f32_32x32x16_bf16 a[128:143], v[4:7], a[12:15], a[128:143]
    s_waitcnt vmcnt(3)
    v_mfma_f32_32x32x16_bf16 a[128:143], v[4:7], a[16:19], a[128:143]
    s_waitcnt vmcnt(2)
    v_mfma_f32_32x32x16_bf16 a[128:143], v[4:7], a[20:23], a[128:143]
    s_waitcnt vmcnt(1)
    v_mfma_f32_32x32x16_bf16 a[128:143], v[4:7], a[24:27], a[128:143]
    s_waitcnt vmcnt(0)
    v_mfma_f32_32x32x16_bf16 a[128:143], v[4:7], a[28:31], a[128:143]
    s_nop 11
    v_accvgpr_read_b32 v24, a128
    v_accvgpr_read_b32 v28, a129
    v_cvt_pk_bf16_f32 v24, v24, v28
    v_accvgpr_read_b32 v25, a130
    v_accvgpr_read_b32 v29, a131
    v_cvt_pk_bf16_f32 v25, v25, v29
    v_accvgpr_read_b32 v26, a132
    v_accvgpr_read_b32 v30, a133
    v_cvt_pk_bf16_f32 v26, v26, v30
    v_accvgpr_read_b32 v27, a134
    v_accvgpr_read_b32 v31, a135
    v_cvt_pk_bf16_f32 v27, v27, v31
    buffer_store_dwordx4 v[24:27], v9, s[80:83], s79 offen offset:0
    s_add_u32 s23, s78, 8388608
    buffer_load_dwordx4 a[0:3], v8, s[84:87], s23 offen sc1
    s_add_u32 s23, s78, 8392704
    buffer_load_dwordx4 a[4:7], v8, s[84:87], s23 offen sc1
    s_add_u32 s23, s78, 8396800
    buffer_load_dwordx4 a[8:11], v8, s[84:87], s23 offen sc1
    s_add_u32 s23, s78, 8400896
    buffer_load_dwordx4 a[12:15], v8, s[84:87], s23 offen sc1
    s_add_u32 s23, s78, 8404992
    buffer_load_dwordx4 a[16:19], v8, s[84:87], s23 offen sc1
    s_add_u32 s23, s78, 8409088
    buffer_load_dwordx4 a[20:23], v8, s[84:87], s23 offen sc1
    s_add_u32 s23, s78, 8413184
    buffer_load_dwordx4 a[24:27], v8, s[84:87], s23 offen sc1
    s_add_u32 s23, s78, 8417280
    buffer_load_dwordx4 a[28:31], v8, s[84:87], s23 offen sc1
    s_waitcnt vmcnt(7)
    v_mfma_f32_32x32x16_bf16 a[128:143], v[4:7], a[0:3], 0
    s_waitcnt vmcnt(6)
    v_mfma_f32_32x32x16_bf16 a[128:143], v[4:7], a[4:7], a[128:143]
    s_waitcnt vmcnt(5)
    v_mfma_f32_32x32x16_bf16 a[128:143], v[4:7], a[8:11], a[128:143]
    s_waitcnt vmcnt(4)
    v_mfma_f32_32x32x16_bf16 a[128:143], v[4:7], a[12:15], a[128:143]
    s_waitcnt vmcnt(3)
    v_mfma_f32_32x32x16_bf16 a[128:143], v[4:7], a[16:19], a[128:143]
    s_waitcnt vmcnt(2)
    v_mfma_f32_32x32x16_bf16 a[128:143], v[4:7], a[20:23], a[128:143]
    s_waitcnt vmcnt(1)
    v_mfma_f32_32x32x16_bf16 a[128:143], v[4:7], a[24:27], a[128:143]
    s_waitcnt vmcnt(0)
    v_mfma_f32_32x32x16_bf16 a[128:143], v[4:7], a[28:31], a[128:143]
    s_nop 11
    v_accvgpr_read_b32 v24, a128
    v_accvgpr_read_b32 v28, a129
    v_cvt_pk_bf16_f32 v24, v24, v28
    v_accvgpr_read_b32 v25, a130
    v_accvgpr_read_b32 v29, a131
    v_cvt_pk_bf16_f32 v25, v25, v29
    v_accvgpr_read_b32 v26, a132
    v_accvgpr_read_b32 v30, a133
    v_cvt_pk_bf16_f32 v26, v26, v30
    v_accvgpr_read_b32 v27, a134
    v_accvgpr_read_b32 v31, a135
    v_cvt_pk_bf16_f32 v27, v27, v31
    buffer_store_dwordx4 v[24:27], v9, s[80:83], s79 offen offset:256
    s_add_u32 s23, s78, 16777216
    buffer_load_dwordx4 a[0:3], v8, s[84:87], s23 offen sc1
    s_add_u32 s23, s78, 16781312
    buffer_load_dwordx4 a[4:7], v8, s[84:87], s23 offen sc1
    s_add_u32 s23, s78, 16785408
    buffer_load_dwordx4 a[8:11], v8, s[84:87], s23 offen sc1
    s_add_u32 s23, s78, 16789504
    buffer_load_dwordx4 a[12:15], v8, s[84:87], s23 offen sc1
    s_add_u32 s23, s78, 16793600
    buffer_load_dwordx4 a[16:19], v8, s[84:87], s23 offen sc1
    s_add_u32 s23, s78, 16797696
    buffer_load_dwordx4 a[20:23], v8, s[84:87], s23 offen sc1
    s_add_u32 s23, s78, 16801792
    buffer_load_dwordx4 a[24:27], v8, s[84:87], s23 offen sc1
    s_add_u32 s23, s78, 16805888
    buffer_load_dwordx4 a[28:31], v8, s[84:87], s23 offen sc1
    s_waitcnt vmcnt(7)
    v_mfma_f32_32x32x16_bf16 a[128:143], v[4:7], a[0:3], 0
    s_waitcnt vmcnt(6)
    v_mfma_f32_32x32x16_bf16 a[128:143], v[4:7], a[4:7], a[128:143]
    s_waitcnt vmcnt(5)
    v_mfma_f32_32x32x16_bf16 a[128:143], v[4:7], a[8:11], a[128:143]
    s_waitcnt vmcnt(4)
    v_mfma_f32_32x32x16_bf16 a[128:143], v[4:7], a[12:15], a[128:143]
    s_waitcnt vmcnt(3)
    v_mfma_f32_32x32x16_bf16 a[128:143], v[4:7], a[16:19], a[128:143]
    s_waitcnt vmcnt(2)
    v_mfma_f32_32x32x16_bf16 a[128:143], v[4:7], a[20:23], a[128:143]
    s_waitcnt vmcnt(1)
    v_mfma_f32_32x32x16_bf16 a[128:143], v[4:7], a[24:27], a[128:143]
    s_waitcnt vmcnt(0)
    v_mfma_f32_32x32x16_bf16 a[128:143], v[4:7], a[28:31], a[128:143]
    s_nop 11
    v_accvgpr_read_b32 v24, a128
    v_accvgpr_read_b32 v28, a129
    v_cvt_pk_bf16_f32 v24, v24, v28
    v_accvgpr_read_b32 v25, a130
    v_accvgpr_read_b32 v29, a131
    v_cvt_pk_bf16_f32 v25, v25, v29
    v_accvgpr_read_b32 v26, a132
    v_accvgpr_read_b32 v30, a133
    v_cvt_pk_bf16_f32 v26, v26, v30
    v_accvgpr_read_b32 v27, a134
    v_accvgpr_read_b32 v31, a135
    v_cvt_pk_bf16_f32 v27, v27, v31
    buffer_store_dwordx4 v[24:27], v9, s[80:83], s79 offen offset:512
    s_add_u32 s23, s78, 25165824
    buffer_load_dwordx4 a[0:3], v8, s[84:87], s23 offen sc1
    s_add_u32 s23, s78, 25169920
    buffer_load_dwordx4 a[4:7], v8, s[84:87], s23 offen sc1
    s_add_u32 s23, s78, 25174016
    buffer_load_dwordx4 a[8:11], v8, s[84:87], s23 offen sc1
    s_add_u32 s23, s78, 25178112
    buffer_load_dwordx4 a[12:15], v8, s[84:87], s23 offen sc1
    s_add_u32 s23, s78, 25182208
    buffer_load_dwordx4 a[16:19], v8, s[84:87], s23 offen sc1
    s_add_u32 s23, s78, 25186304
    buffer_load_dwordx4 a[20:23], v8, s[84:87], s23 offen sc1
    s_add_u32 s23, s78, 25190400
    buffer_load_dwordx4 a[24:27], v8, s[84:87], s23 offen sc1
    s_add_u32 s23, s78, 25194496
    buffer_load_dwordx4 a[28:31], v8, s[84:87], s23 offen sc1
    s_waitcnt vmcnt(7)
    v_mfma_f32_32x32x16_bf16 a[128:143], v[4:7], a[0:3], 0
    s_waitcnt vmcnt(6)
    v_mfma_f32_32x32x16_bf16 a[128:143], v[4:7], a[4:7], a[128:143]
    s_waitcnt vmcnt(5)
    v_mfma_f32_32x32x16_bf16 a[128:143], v[4:7], a[8:11], a[128:143]
    s_waitcnt vmcnt(4)
    v_mfma_f32_32x32x16_bf16 a[128:143], v[4:7], a[12:15], a[128:143]
    s_waitcnt vmcnt(3)
    v_mfma_f32_32x32x16_bf16 a[128:143], v[4:7], a[16:19], a[128:143]
    s_waitcnt vmcnt(2)
    v_mfma_f32_32x32x16_bf16 a[128:143], v[4:7], a[20:23], a[128:143]
    s_waitcnt vmcnt(1)
    v_mfma_f32_32x32x16_bf16 a[128:143], v[4:7], a[24:27], a[128:143]
    s_waitcnt vmcnt(0)
    v_mfma_f32_32x32x16_bf16 a[128:143], v[4:7], a[28:31], a[128:143]
    s_nop 11
    v_accvgpr_read_b32 v24, a128
    v_accvgpr_read_b32 v28, a129
    v_cvt_pk_bf16_f32 v24, v24, v28
    v_accvgpr_read_b32 v25, a130
    v_accvgpr_read_b32 v29, a131
    v_cvt_pk_bf16_f32 v25, v25, v29
    v_accvgpr_read_b32 v26, a132
    v_accvgpr_read_b32 v30, a133
    v_cvt_pk_bf16_f32 v26, v26, v30
    v_accvgpr_read_b32 v27, a134
    v_accvgpr_read_b32 v31, a135
    v_cvt_pk_bf16_f32 v27, v27, v31
    buffer_store_dwordx4 v[24:27], v9, s[80:83], s79 offen offset:768
    s_add_u32 s23, s78, 33554432
    buffer_load_dwordx4 a[0:3], v8, s[84:87], s23 offen sc1
    s_add_u32 s23, s78, 33558528
    buffer_load_dwordx4 a[4:7], v8, s[84:87], s23 offen sc1
    s_add_u32 s23, s78, 33562624
    buffer_load_dwordx4 a[8:11], v8, s[84:87], s23 offen sc1
    s_add_u32 s23, s78, 33566720
    buffer_load_dwordx4 a[12:15], v8, s[84:87], s23 offen sc1
    s_add_u32 s23, s78, 33570816
    buffer_load_dwordx4 a[16:19], v8, s[84:87], s23 offen sc1
    s_add_u32 s23, s78, 33574912
    buffer_load_dwordx4 a[20:23], v8, s[84:87], s23 offen sc1
    s_add_u32 s23, s78, 33579008
    buffer_load_dwordx4 a[24:27], v8, s[84:87], s23 offen sc1
    s_add_u32 s23, s78, 33583104
    buffer_load_dwordx4 a[28:31], v8, s[84:87], s23 offen sc1
    s_waitcnt vmcnt(7)
    v_mfma_f32_32x32x16_bf16 a[128:143], v[4:7], a[0:3], 0
    s_waitcnt vmcnt(6)
    v_mfma_f32_32x32x16_bf16 a[128:143], v[4:7], a[4:7], a[128:143]
    s_waitcnt vmcnt(5)
    v_mfma_f32_32x32x16_bf16 a[128:143], v[4:7], a[8:11], a[128:143]
    s_waitcnt vmcnt(4)
    v_mfma_f32_32x32x16_bf16 a[128:143], v[4:7], a[12:15], a[128:143]
    s_waitcnt vmcnt(3)
    v_mfma_f32_32x32x16_bf16 a[128:143], v[4:7], a[16:19], a[128:143]
    s_waitcnt vmcnt(2)
    v_mfma_f32_32x32x16_bf16 a[128:143], v[4:7], a[20:23], a[128:143]
    s_waitcnt vmcnt(1)
    v_mfma_f32_32x32x16_bf16 a[128:143], v[4:7], a[24:27], a[128:143]
    s_waitcnt vmcnt(0)
    v_mfma_f32_32x32x16_bf16 a[128:143], v[4:7], a[28:31], a[128:143]
    s_nop 11
    v_accvgpr_read_b32 v24, a128
    v_accvgpr_read_b32 v28, a129
    v_cvt_pk_bf16_f32 v24, v24, v28
    v_accvgpr_read_b32 v25, a130
    v_accvgpr_read_b32 v29, a131
    v_cvt_pk_bf16_f32 v25, v25, v29
    v_accvgpr_read_b32 v26, a132
    v_accvgpr_read_b32 v30, a133
    v_cvt_pk_bf16_f32 v26, v26, v30
    v_accvgpr_read_b32 v27, a134
    v_accvgpr_read_b32 v31, a135
    v_cvt_pk_bf16_f32 v27, v27, v31
    buffer_store_dwordx4 v[24:27], v9, s[80:83], s79 offen offset:1024
    s_waitcnt vmcnt(0)
    s_add_u32 s8, s8, 1
    s_cmp_lt_u32 s8, 4
    s_cbranch_scc1 L_rw
    s_branch L_rescue
L_done:
L_end:
    s_endpgm
L_rs1:
    s_mov_b32 s35, 1
    s_branch L_rare1
L_rs3:
    s_mov_b32 s35, 3
    s_branch L_rare1
L_rs5:
    s_mov_b32 s35, 5
    s_branch L_rare1
L_rs7:
    s_mov_b32 s35, 7
    s_branch L_rare1
L_rs9:
    s_mov_b32 s35, 9
    s_branch L_rare1
L_rs11:
    s_mov_b32 s35, 11
    s_branch L_rare1
L_rs13:
    s_mov_b32 s35, 13
    s_branch L_rare1
L_rs17:
    s_mov_b32 s35, 17
    s_branch L_rare1
L_rs19:
    s_mov_b32 s35, 19
    s_branch L_rare1
L_rs21:
    s_mov_b32 s35, 21
    s_branch L_rare1
L_rs23:
    s_mov_b32 s35, 23
    s_branch L_rare1
L_rs25:
    s_mov_b32 s35, 25
    s_branch L_rare1
L_rs27:
    s_mov_b32 s35, 27
    s_branch L_rare1
L_rs29:
    s_mov_b32 s35, 29
    s_branch L_rare1
L_rs33:
    s_mov_b32 s35, 33
    s_branch L_rare1
L_rs35:
    s_mov_b32 s35, 35
    s_branch L_rare1
L_rs37:
    s_mov_b32 s35, 37
    s_branch L_rare1
L_rs39:
    s_mov_b32 s35, 39
    s_branch L_rare1
L_rs41:
    s_mov_b32 s35, 41
    s_branch L_rare1
L_rs43:
    s_mov_b32 s35, 43
    s_branch L_rare1
L_rs45:
    s_mov_b32 s35, 45
    s_branch L_rare1
L_rs49:
    s_mov_b32 s35, 49
    s_branch L_rare1
L_rs51:
    s_mov_b32 s35, 51
    s_branch L_rare1
L_rs53:
    s_mov_b32 s35, 53
    s_branch L_rare1
L_rs55:
    s_mov_b32 s35, 55
    s_branch L_rare1
L_rs57:
    s_mov_b32 s35, 57
    s_branch L_rare1
L_rs59:
    s_mov_b32 s35, 59
    s_branch L_rare1
L_rs61:
    s_mov_b32 s35, 61
    s_branch L_rare1
L_rare1:
    s_nop 15
    v_max3_f32 v30, v144, v145, v146
    v_max3_f32 v31, v147, v148, v149
    v_max3_f32 v30, v30, v150, v151
    v_max3_f32 v31, v31, v152, v153
    v_max3_f32 v30, v30, v154, v155
    v_max3_f32 v31, v31, v156, v157
    v_max3_f32 v30, v30, v158, v159
    v_max_f32 v30, v30, v31
    v_mov_b32 v31, v30
    s_nop 1
    v_permlane32_swap_b32 v30, v31
    v_max_f32 v30, v30, v31
    v_max_f32 v30, 0, v30
    v_sub_f32 v31, 0, v30
    v_exp_f32 v31, v31
    v_sub_f32 v144, v144, v30
    v_sub_f32 v145, v145, v30
    v_sub_f32 v146, v146, v30
    v_sub_f32 v147, v147, v30
    v_sub_f32 v148, v148, v30
    v_sub_f32 v149, v149, v30
    v_sub_f32 v150, v150, v30
    v_sub_f32 v151, v151, v30
    v_sub_f32 v152, v152, v30
    v_sub_f32 v153, v153, v30
    v_sub_f32 v154, v154, v30
    v_sub_f32 v155, v155, v30
    v_sub_f32 v156, v156, v30
    v_sub_f32 v157, v157, v30
    v_sub_f32 v158, v158, v30
    v_sub_f32 v159, v159, v30
    v_sub_f32 v128, v128, v30
    v_sub_f32 v129, v129, v30
    v_sub_f32 v130, v130, v30
    v_sub_f32 v131, v131, v30
    v_sub_f32 v132, v132, v30
    v_sub_f32 v133, v133, v30
    v_sub_f32 v134, v134, v30
    v_sub_f32 v135, v135, v30
    v_sub_f32 v136, v136, v30
    v_sub_f32 v137, v137, v30
    v_sub_f32 v138, v138, v30
    v_sub_f32 v139, v139, v30
    v_sub_f32 v140, v140, v30
    v_sub_f32 v141, v141, v30
    v_sub_f32 v142, v142, v30
    v_sub_f32 v143, v143, v30
    v_sub_f32 v160, v160, v30
    v_sub_f32 v161, v161, v30
    v_sub_f32 v162, v162, v30
    v_sub_f32 v163, v163, v30
    v_sub_f32 v164, v164, v30
    v_sub_f32 v165, v165, v30
    v_sub_f32 v166, v166, v30
    v_sub_f32 v167, v167, v30
    v_sub_f32 v168, v168, v30
    v_sub_f32 v169, v169, v30
    v_sub_f32 v170, v170, v30
    v_sub_f32 v171, v171, v30
    v_sub_f32 v172, v172, v30
    v_sub_f32 v173, v173, v30
    v_sub_f32 v174, v174, v30
    v_sub_f32 v175, v175, v30
    v_mul_f32 v64, v64, v31
    v_mul_f32 v65, v65, v31
    v_mul_f32 v66, v66, v31
    v_mul_f32 v67, v67, v31
    v_mul_f32 v68, v68, v31
    v_mul_f32 v69, v69, v31
    v_mul_f32 v70, v70, v31
    v_mul_f32 v71, v71, v31
    v_mul_f32 v72, v72, v31
    v_mul_f32 v73, v73, v31
    v_mul_f32 v74, v74, v31
    v_mul_f32 v75, v75, v31
    v_mul_f32 v76, v76, v31
    v_mul_f32 v77, v77, v31
    v_mul_f32 v78, v78, v31
    v_mul_f32 v79, v79, v31
    v_mul_f32 v80, v80, v31
    v_mul_f32 v81, v81, v31
    v_mul_f32 v82, v82, v31
    v_mul_f32 v83, v83, v31
    v_mul_f32 v84, v84, v31
    v_mul_f32 v85, v85, v31
    v_mul_f32 v86, v86, v31
    v_mul_f32 v87, v87, v31
    v_mul_f32 v88, v88, v31
    v_mul_f32 v89, v89, v31
    v_mul_f32 v90, v90, v31
    v_mul_f32 v91, v91, v31
    v_mul_f32 v92, v92, v31
    v_mul_f32 v93, v93, v31
    v_mul_f32 v94, v94, v31
    v_mul_f32 v95, v95, v31
    v_mul_f32 v96, v96, v31
    v_mul_f32 v97, v97, v31
    v_mul_f32 v98, v98, v31
    v_mul_f32 v99, v99, v31
    v_mul_f32 v100, v100, v31
    v_mul_f32 v101, v101, v31
    v_mul_f32 v102, v102, v31
    v_mul_f32 v103, v103, v31
    v_mul_f32 v104, v104, v31
    v_mul_f32 v105, v105, v31
    v_mul_f32 v106, v106, v31
    v_mul_f32 v107, v107, v31
    v_mul_f32 v108, v108, v31
    v_mul_f32 v109, v109, v31
    v_mul_f32 v110, v110, v31
    v_mul_f32 v111, v111, v31
    v_mul_f32 v112, v112, v31
    v_mul_f32 v113, v113, v31
    v_mul_f32 v114, v114, v31
    v_mul_f32 v115, v115, v31
    v_mul_f32 v116, v116, v31
    v_mul_f32 v117, v117, v31
    v_mul_f32 v118, v118, v31
    v_mul_f32 v119, v119, v31
    v_mul_f32 v120, v120, v31
    v_mul_f32 v121, v121, v31
    v_mul_f32 v122, v122, v31
    v_mul_f32 v123, v123, v31
    v_mul_f32 v124, v124, v31
    v_mul_f32 v125, v125, v31
    v_mul_f32 v126, v126, v31
    v_mul_f32 v127, v127, v31
    v_mul_f32 v22, v22, v31
    v_exp_f32 v24, v144
    v_exp_f32 v25, v145
    s_nop 0
    v_cvt_pk_bf16_f32 v184, v24, v25
    v_add_f32 v28, v24, v25
    v_exp_f32 v26, v146
    v_exp_f32 v27, v147
    s_nop 0
    v_cvt_pk_bf16_f32 v185, v26, v27
    v_add_f32 v29, v26, v27
    v_exp_f32 v24, v148
    v_exp_f32 v25, v149
    v_add_f32 v28, v28, v24
    v_cvt_pk_bf16_f32 v186, v24, v25
    v_add_f32 v29, v29, v25
    v_exp_f32 v26, v150
    v_exp_f32 v27, v151
    v_add_f32 v28, v28, v26
    v_cvt_pk_bf16_f32 v187, v26, v27
    v_add_f32 v29, v29, v27
    v_exp_f32 v24, v152
    v_exp_f32 v25, v153
    v_add_f32 v28, v28, v24
    v_cvt_pk_bf16_f32 v188, v24, v25
    v_add_f32 v29, v29, v25
    v_exp_f32 v26, v154
    v_exp_f32 v27, v155
    v_add_f32 v28, v28, v26
    v_cvt_pk_bf16_f32 v189, v26, v27
    v_add_f32 v29, v29, v27
    v_exp_f32 v24, v156
    v_exp_f32 v25, v157
    v_add_f32 v28, v28, v24
    v_cvt_pk_bf16_f32 v190, v24, v25
    v_add_f32 v29, v29, v25
    v_exp_f32 v26, v158
    v_exp_f32 v27, v159
    v_add_f32 v28, v28, v26
    v_cvt_pk_bf16_f32 v191, v26, v27
    v_add_f32 v29, v29, v27
    v_add_f32 v28, v28, v29
    s_nop 3
    s_cmp_eq_u32 s35, 1
    s_cbranch_scc1 L_back1
    s_cmp_eq_u32 s35, 3
    s_cbranch_scc1 L_back3
    s_cmp_eq_u32 s35, 5
    s_cbranch_scc1 L_back5
    s_cmp_eq_u32 s35, 7
    s_cbranch_scc1 L_back7
    s_cmp_eq_u32 s35, 9
    s_cbranch_scc1 L_back9
    s_cmp_eq_u32 s35, 11
    s_cbranch_scc1 L_back11
    s_cmp_eq_u32 s35, 13
    s_cbranch_scc1 L_back13
    s_cmp_eq_u32 s35, 17
    s_cbranch_scc1 L_back17
    s_cmp_eq_u32 s35, 19
    s_cbranch_scc1 L_back19
    s_cmp_eq_u32 s35, 21
    s_cbranch_scc1 L_back21
    s_cmp_eq_u32 s35, 23
    s_cbranch_scc1 L_back23
    s_cmp_eq_u32 s35, 25
    s_cbranch_scc1 L_back25
    s_cmp_eq_u32 s35, 27
    s_cbranch_scc1 L_back27
    s_cmp_eq_u32 s35, 29
    s_cbranch_scc1 L_back29
    s_cmp_eq_u32 s35, 33
    s_cbranch_scc1 L_back33
    s_cmp_eq_u32 s35, 35
    s_cbranch_scc1 L_back35
    s_cmp_eq_u32 s35, 37
    s_cbranch_scc1 L_back37
    s_cmp_eq_u32 s35, 39
    s_cbranch_scc1 L_back39
    s_cmp_eq_u32 s35, 41
    s_cbranch_scc1 L_back41
    s_cmp_eq_u32 s35, 43
    s_cbranch_scc1 L_back43
    s_cmp_eq_u32 s35, 45
    s_cbranch_scc1 L_back45
    s_cmp_eq_u32 s35, 49
    s_cbranch_scc1 L_back49
    s_cmp_eq_u32 s35, 51
    s_cbranch_scc1 L_back51
    s_cmp_eq_u32 s35, 53
    s_cbranch_scc1 L_back53
    s_cmp_eq_u32 s35, 55
    s_cbranch_scc1 L_back55
    s_cmp_eq_u32 s35, 57
    s_cbranch_scc1 L_back57
    s_cmp_eq_u32 s35, 59
    s_cbranch_scc1 L_back59
    s_branch L_back61
L_rs2:
    s_mov_b32 s35, 2
    s_branch L_rare2
L_rs4:
    s_mov_b32 s35, 4
    s_branch L_rare2
L_rs6:
    s_mov_b32 s35, 6
    s_branch L_rare2
L_rs8:
    s_mov_b32 s35, 8
    s_branch L_rare2
L_rs10:
    s_mov_b32 s35, 10
    s_branch L_rare2
L_rs12:
    s_mov_b32 s35, 12
    s_branch L_rare2
L_rs14:
    s_mov_b32 s35, 14
    s_branch L_rare2
L_rs18:
    s_mov_b32 s35, 18
    s_branch L_rare2
L_rs20:
    s_mov_b32 s35, 20
    s_branch L_rare2
L_rs22:
    s_mov_b32 s35, 22
    s_branch L_rare2
L_rs24:
    s_mov_b32 s35, 24
    s_branch L_rare2
L_rs26:
    s_mov_b32 s35, 26
    s_branch L_rare2
L_rs28:
    s_mov_b32 s35, 28
    s_branch L_rare2
L_rs30:
    s_mov_b32 s35, 30
    s_branch L_rare2
L_rs34:
    s_mov_b32 s35, 34
    s_branch L_rare2
L_rs36:
    s_mov_b32 s35, 36
    s_branch L_rare2
L_rs38:
    s_mov_b32 s35, 38
    s_branch L_rare2
L_rs40:
    s_mov_b32 s35, 40
    s_branch L_rare2
L_rs42:
    s_mov_b32 s35, 42
    s_branch L_rare2
L_rs44:
    s_mov_b32 s35, 44
    s_branch L_rare2
L_rs46:
    s_mov_b32 s35, 46
    s_branch L_rare2
L_rs50:
    s_mov_b32 s35, 50
    s_branch L_rare2
L_rs52:
    s_mov_b32 s35, 52
    s_branch L_rare2
L_rs54:
    s_mov_b32 s35, 54
    s_branch L_rare2
L_rs56:
    s_mov_b32 s35, 56
    s_branch L_rare2
L_rs58:
    s_mov_b32 s35, 58
    s_branch L_rare2
L_rs60:
    s_mov_b32 s35, 60
    s_branch L_rare2
L_rs62:
    s_mov_b32 s35, 62
    s_branch L_rare2
L_rare2:
    s_nop 15
    v_max3_f32 v30, v128, v129, v130
    v_max3_f32 v31, v131, v132, v133
    v_max3_f32 v30, v30, v134, v135
    v_max3_f32 v31, v31, v136, v137
    v_max3_f32 v30, v30, v138, v139
    v_max3_f32 v31, v31, v140, v141
    v_max3_f32 v30, v30, v142, v143
    v_max_f32 v30, v30, v31
    v_mov_b32 v31, v30
    s_nop 1
    v_permlane32_swap_b32 v30, v31
    v_max_f32 v30, v30, v31
    v_max_f32 v30, 0, v30
    v_sub_f32 v31, 0, v30
    v_exp_f32 v31, v31
    v_sub_f32 v128, v128, v30
    v_sub_f32 v129, v129, v30
    v_sub_f32 v130, v130, v30
    v_sub_f32 v131, v131, v30
    v_sub_f32 v132, v132, v30
    v_sub_f32 v133, v133, v30
    v_sub_f32 v134, v134, v30
    v_sub_f32 v135, v135, v30
    v_sub_f32 v136, v136, v30
    v_sub_f32 v137, v137, v30
    v_sub_f32 v138, v138, v30
    v_sub_f32 v139, v139, v30
    v_sub_f32 v140, v140, v30
    v_sub_f32 v141, v141, v30
    v_sub_f32 v142, v142, v30
    v_sub_f32 v143, v143, v30
    v_sub_f32 v144, v144, v30
    v_sub_f32 v145, v145, v30
    v_sub_f32 v146, v146, v30
    v_sub_f32 v147, v147, v30
    v_sub_f32 v148, v148, v30
    v_sub_f32 v149, v149, v30
    v_sub_f32 v150, v150, v30
    v_sub_f32 v151, v151, v30
    v_sub_f32 v152, v152, v30
    v_sub_f32 v153, v153, v30
    v_sub_f32 v154, v154, v30
    v_sub_f32 v155, v155, v30
    v_sub_f32 v156, v156, v30
    v_sub_f32 v157, v157, v30
    v_sub_f32 v158, v158, v30
    v_sub_f32 v159, v159, v30
    v_sub_f32 v160, v160, v30
    v_sub_f32 v161, v161, v30
    v_sub_f32 v162, v162, v30
    v_sub_f32 v163, v163, v30
    v_sub_f32 v164, v164, v30
    v_sub_f32 v165, v165, v30
    v_sub_f32 v166, v166, v30
    v_sub_f32 v167, v167, v30
    v_sub_f32 v168, v168, v30
    v_sub_f32 v169, v169, v30
    v_sub_f32 v170, v170, v30
    v_sub_f32 v171, v171, v30
    v_sub_f32 v172, v172, v30
    v_sub_f32 v173, v173, v30
    v_sub_f32 v174, v174, v30
    v_sub_f32 v175, v175, v30
    v_mul_f32 v64, v64, v31
    v_mul_f32 v65, v65, v31
    v_mul_f32 v66, v66, v31
    v_mul_f32 v67, v67, v31
    v_mul_f32 v68, v68, v31
    v_mul_f32 v69, v69, v31
    v_mul_f32 v70, v70, v31
    v_mul_f32 v71, v71, v31
    v_mul_f32 v72, v72, v31
    v_mul_f32 v73, v73, v31
    v_mul_f32 v74, v74, v31
    v_mul_f32 v75, v75, v31
    v_mul_f32 v76, v76, v31
    v_mul_f32 v77, v77, v31
    v_mul_f32 v78, v78, v31
    v_mul_f32 v79, v79, v31
    v_mul_f32 v80, v80, v31
    v_mul_f32 v81, v81, v31
    v_mul_f32 v82, v82, v31
    v_mul_f32 v83, v83, v31
    v_mul_f32 v84, v84, v31
    v_mul_f32 v85, v85, v31
    v_mul_f32 v86, v86, v31
    v_mul_f32 v87, v87, v31
    v_mul_f32 v88, v88, v31
    v_mul_f32 v89, v89, v31
    v_mul_f32 v90, v90, v31
    v_mul_f32 v91, v91, v31
    v_mul_f32 v92, v92, v31
    v_mul_f32 v93, v93, v31
    v_mul_f32 v94, v94, v31
    v_mul_f32 v95, v95, v31
    v_mul_f32 v96, v96, v31
    v_mul_f32 v97, v97, v31
    v_mul_f32 v98, v98, v31
    v_mul_f32 v99, v99, v31
    v_mul_f32 v100, v100, v31
    v_mul_f32 v101, v101, v31
    v_mul_f32 v102, v102, v31
    v_mul_f32 v103, v103, v31
    v_mul_f32 v104, v104, v31
    v_mul_f32 v105, v105, v31
    v_mul_f32 v106, v106, v31
    v_mul_f32 v107, v107, v31
    v_mul_f32 v108, v108, v31
    v_mul_f32 v109, v109, v31
    v_mul_f32 v110, v110, v31
    v_mul_f32 v111, v111, v31
    v_mul_f32 v112, v112, v31
    v_mul_f32 v113, v113, v31
    v_mul_f32 v114, v114, v31
    v_mul_f32 v115, v115, v31
    v_mul_f32 v116, v116, v31
    v_mul_f32 v117, v117, v31
    v_mul_f32 v118, v118, v31
    v_mul_f32 v119, v119, v31
    v_mul_f32 v120, v120, v31
    v_mul_f32 v121, v121, v31
    v_mul_f32 v122, v122, v31
    v_mul_f32 v123, v123, v31
    v_mul_f32 v124, v124, v31
    v_mul_f32 v125, v125, v31
    v_mul_f32 v126, v126, v31
    v_mul_f32 v127, v127, v31
    v_mul_f32 v22, v22, v31
    v_exp_f32 v24, v128
    v_exp_f32 v25, v129
    s_nop 0
    v_cvt_pk_bf16_f32 v176, v24, v25
    v_add_f32 v28, v24, v25
    v_exp_f32 v26, v130
    v_exp_f32 v27, v131
    s_nop 0
    v_cvt_pk_bf16_f32 v177, v26, v27
    v_add_f32 v29, v26, v27
    v_exp_f32 v24, v132
    v_exp_f32 v25, v133
    v_add_f32 v28, v28, v24
    v_cvt_pk_bf16_f32 v178, v24, v25
    v_add_f32 v29, v29, v25
    v_exp_f32 v26, v134
    v_exp_f32 v27, v135
    v_add_f32 v28, v28, v26
    v_cvt_pk_bf16_f32 v179, v26, v27
    v_add_f32 v29, v29, v27
    v_exp_f32 v24, v136
    v_exp_f32 v25, v137
    v_add_f32 v28, v28, v24
    v_cvt_pk_bf16_f32 v180, v24, v25
    v_add_f32 v29, v29, v25
    v_exp_f32 v26, v138
    v_exp_f32 v27, v139
    v_add_f32 v28, v28, v26
    v_cvt_pk_bf16_f32 v181, v26, v27
    v_add_f32 v29, v29, v27
    v_exp_f32 v24, v140
    v_exp_f32 v25, v141
    v_add_f32 v28, v28, v24
    v_cvt_pk_bf16_f32 v182, v24, v25
    v_add_f32 v29, v29, v25
    v_exp_f32 v26, v142
    v_exp_f32 v27, v143
    v_add_f32 v28, v28, v26
    v_cvt_pk_bf16_f32 v183, v26, v27
    v_add_f32 v29, v29, v27
    v_add_f32 v28, v28, v29
    s_nop 3
    s_cmp_eq_u32 s35, 2
    s_cbranch_scc1 L_back2
    s_cmp_eq_u32 s35, 4
    s_cbranch_scc1 L_back4
    s_cmp_eq_u32 s35, 6
    s_cbranch_scc1 L_back6
    s_cmp_eq_u32 s35, 8
    s_cbranch_scc1 L_back8
    s_cmp_eq_u32 s35, 10
    s_cbranch_scc1 L_back10
    s_cmp_eq_u32 s35, 12
    s_cbranch_scc1 L_back12
    s_cmp_eq_u32 s35, 14
    s_cbranch_scc1 L_back14
    s_cmp_eq_u32 s35, 18
    s_cbranch_scc1 L_back18
    s_cmp_eq_u32 s35, 20
    s_cbranch_scc1 L_back20
    s_cmp_eq_u32 s35, 22
    s_cbranch_scc1 L_back22
    s_cmp_eq_u32 s35, 24
    s_cbranch_scc1 L_back24
    s_cmp_eq_u32 s35, 26
    s_cbranch_scc1 L_back26
    s_cmp_eq_u32 s35, 28
    s_cbranch_scc1 L_back28
    s_cmp_eq_u32 s35, 30
    s_cbranch_scc1 L_back30
    s_cmp_eq_u32 s35, 34
    s_cbranch_scc1 L_back34
    s_cmp_eq_u32 s35, 36
    s_cbranch_scc1 L_back36
    s_cmp_eq_u32 s35, 38
    s_cbranch_scc1 L_back38
    s_cmp_eq_u32 s35, 40
    s_cbranch_scc1 L_back40
    s_cmp_eq_u32 s35, 42
    s_cbranch_scc1 L_back42
    s_cmp_eq_u32 s35, 44
    s_cbranch_scc1 L_back44
    s_cmp_eq_u32 s35, 46
    s_cbranch_scc1 L_back46
    s_cmp_eq_u32 s35, 50
    s_cbranch_scc1 L_back50
    s_cmp_eq_u32 s35, 52
    s_cbranch_scc1 L_back52
    s_cmp_eq_u32 s35, 54
    s_cbranch_scc1 L_back54
    s_cmp_eq_u32 s35, 56
    s_cbranch_scc1 L_back56
    s_cmp_eq_u32 s35, 58
    s_cbranch_scc1 L_back58
    s_cmp_eq_u32 s35, 60
    s_cbranch_scc1 L_back60
    s_branch L_back62
L_rs15:
    s_mov_b32 s35, 15
    s_branch L_rare15
L_rs31:
    s_mov_b32 s35, 31
    s_branch L_rare15
L_rs47:
    s_mov_b32 s35, 47
    s_branch L_rare15
L_rs63:
    s_mov_b32 s35, 63
    s_branch L_rare15
L_rare15:
    s_nop 15
    v_max3_f32 v30, v144, v145, v146
    v_max3_f32 v31, v147, v148, v149
    v_max3_f32 v30, v30, v150, v151
    v_max3_f32 v31, v31, v152, v153
    v_max3_f32 v30, v30, v154, v155
    v_max3_f32 v31, v31, v156, v157
    v_max3_f32 v30, v30, v158, v159
    v_max_f32 v30, v30, v31
    v_mov_b32 v31, v30
    s_nop 1
    v_permlane32_swap_b32 v30, v31
    v_max_f32 v30, v30, v31
    v_max_f32 v30, 0, v30
    v_sub_f32 v31, 0, v30
    v_exp_f32 v31, v31
    v_sub_f32 v144, v144, v30
    v_sub_f32 v145, v145, v30
    v_sub_f32 v146, v146, v30
    v_sub_f32 v147, v147, v30
    v_sub_f32 v148, v148, v30
    v_sub_f32 v149, v149, v30
    v_sub_f32 v150, v150, v30
    v_sub_f32 v151, v151, v30
    v_sub_f32 v152, v152, v30
    v_sub_f32 v153, v153, v30
    v_sub_f32 v154, v154, v30
    v_sub_f32 v155, v155, v30
    v_sub_f32 v156, v156, v30
    v_sub_f32 v157, v157, v30
    v_sub_f32 v158, v158, v30
    v_sub_f32 v159, v159, v30
    v_mul_f32 v64, v64, v31
    v_mul_f32 v65, v65, v31
    v_mul_f32 v66, v66, v31
    v_mul_f32 v67, v67, v31
    v_mul_f32 v68, v68, v31
    v_mul_f32 v69, v69, v31
    v_mul_f32 v70, v70, v31
    v_mul_f32 v71, v71, v31
    v_mul_f32 v72, v72, v31
    v_mul_f32 v73, v73, v31
    v_mul_f32 v74, v74, v31
    v_mul_f32 v75, v75, v31
    v_mul_f32 v76, v76, v31
    v_mul_f32 v77, v77, v31
    v_mul_f32 v78, v78, v31
    v_mul_f32 v79, v79, v31
    v_mul_f32 v80, v80, v31
    v_mul_f32 v81, v81, v31
    v_mul_f32 v82, v82, v31
    v_mul_f32 v83, v83, v31
    v_mul_f32 v84, v84, v31
    v_mul_f32 v85, v85, v31
    v_mul_f32 v86, v86, v31
    v_mul_f32 v87, v87, v31
    v_mul_f32 v88, v88, v31
    v_mul_f32 v89, v89, v31
    v_mul_f32 v90, v90, v31
    v_mul_f32 v91, v91, v31
    v_mul_f32 v92, v92, v31
    v_mul_f32 v93, v93, v31
    v_mul_f32 v94, v94, v31
    v_mul_f32 v95, v95, v31
    v_mul_f32 v96, v96, v31
    v_mul_f32 v97, v97, v31
    v_mul_f32 v98, v98, v31
    v_mul_f32 v99, v99, v31
    v_mul_f32 v100, v100, v31
    v_mul_f32 v101, v101, v31
    v_mul_f32 v102, v102, v31
    v_mul_f32 v103, v103, v31
    v_mul_f32 v104, v104, v31
    v_mul_f32 v105, v105, v31
    v_mul_f32 v106, v106, v31
    v_mul_f32 v107, v107, v31
    v_mul_f32 v108, v108, v31
    v_mul_f32 v109, v109, v31
    v_mul_f32 v110, v110, v31
    v_mul_f32 v111, v111, v31
    v_mul_f32 v112, v112, v31
    v_mul_f32 v113, v113, v31
    v_mul_f32 v114, v114, v31
    v_mul_f32 v115, v115, v31
    v_mul_f32 v116, v116, v31
    v_mul_f32 v117, v117, v31
    v_mul_f32 v118, v118, v31
    v_mul_f32 v119, v119, v31
    v_mul_f32 v120, v120, v31
    v_mul_f32 v121, v121, v31
    v_mul_f32 v122, v122, v31
    v_mul_f32 v123, v123, v31
    v_mul_f32 v124, v124, v31
    v_mul_f32 v125, v125, v31
    v_mul_f32 v126, v126, v31
    v_mul_f32 v127, v127, v31
    v_mul_f32 v22, v22, v31
    v_exp_f32 v24, v144
    v_exp_f32 v25, v145
    s_nop 0
    v_cvt_pk_bf16_f32 v184, v24, v25
    v_add_f32 v28, v24, v25
    v_exp_f32 v26, v146
    v_exp_f32 v27, v147
    s_nop 0
    v_cvt_pk_bf16_f32 v185, v26, v27
    v_add_f32 v29, v26, v27
    v_exp_f32 v24, v148
    v_exp_f32 v25, v149
    v_add_f32 v28, v28, v24
    v_cvt_pk_bf16_f32 v186, v24, v25
    v_add_f32 v29, v29, v25
    v_exp_f32 v26, v150
    v_exp_f32 v27, v151
    v_add_f32 v28, v28, v26
    v_cvt_pk_bf16_f32 v187, v26, v27
    v_add_f32 v29, v29, v27
    v_exp_f32 v24, v152
    v_exp_f32 v25, v153
    v_add_f32 v28, v28, v24
    v_cvt_pk_bf16_f32 v188, v24, v25
    v_add_f32 v29, v29, v25
    v_exp_f32 v26, v154
    v_exp_f32 v27, v155
    v_add_f32 v28, v28, v26
    v_cvt_pk_bf16_f32 v189, v26, v27
    v_add_f32 v29, v29, v27
    v_exp_f32 v24, v156
    v_exp_f32 v25, v157
    v_add_f32 v28, v28, v24
    v_cvt_pk_bf16_f32 v190, v24, v25
    v_add_f32 v29, v29, v25
    v_exp_f32 v26, v158
    v_exp_f32 v27, v159
    v_add_f32 v28, v28, v26
    v_cvt_pk_bf16_f32 v191, v26, v27
    v_add_f32 v29, v29, v27
    v_add_f32 v28, v28, v29
    s_nop 3
    s_cmp_eq_u32 s35, 15
    s_cbranch_scc1 L_back15
    s_cmp_eq_u32 s35, 31
    s_cbranch_scc1 L_back31
    s_cmp_eq_u32 s35, 47
    s_cbranch_scc1 L_back47
    s_branch L_back63
L_cend:
.section .rodata,"a"
.p2align 6
.amdhsa_kernel concat_heads__mha_block_cached__mha_block_cached__near_ridge_kernel
  .amdhsa_next_free_vgpr 512
  .amdhsa_next_free_sgpr 102
  .amdhsa_accum_offset 256
  .amdhsa_group_segment_fixed_size 0
  .amdhsa_kernarg_size 104
  .amdhsa_user_sgpr_count 2
  .amdhsa_user_sgpr_kernarg_segment_ptr 1
  .amdhsa_system_sgpr_workgroup_id_x 1
.end_amdhsa_kernel
```
